```python
import torch

def _softmax(x, axis=-1):
    return torch.softmax(x, dim=axis)
def _gelu(x):
    return torch.nn.functional.gelu(x, approximate="tanh")
def _silu(x):
    return torch.nn.functional.silu(x)
def _sigmoid(x):
    return torch.sigmoid(x)
def _layernorm(x, axis=-1, eps=1e-5):
    m = x.mean(dim=axis, keepdim=True)
    v = x.var(dim=axis, keepdim=True, unbiased=False)
    return (x - m) / torch.sqrt(v + eps)
def _scatter_add(tgt, idx, src, axis=0):
    return tgt.clone().index_add_(axis, idx, src)
def _segment_sum(src, seg, n):
    out = torch.zeros((n,) + src.shape[1:], dtype=src.dtype)
    return out.index_add_(0, seg, src)
def _pad(x, pw):
    flat = tuple(v for pair in reversed(pw) for v in pair)
    return torch.nn.functional.pad(x, flat)

kernel_name = 'sequential_preLN__compressed_kv_cla__mixer_channel_mlp__prompt'

def setup_inputs():

    _w = (lambda a: (lambda t: t.to(torch.bfloat16) if t.is_floating_point() else t)(torch.as_tensor(a)))
    def _A_setup():
        B, H, Sq, Sk, D, M = 1, 32, 2048, 2048, 128, 512
        Dc = 4 * D
        return {
            "x": _w((lambda *s: torch.randn(*s, dtype=torch.bfloat16) * 0.05)(B, Sq, M)),
            "c_kv": _w((lambda *s: torch.randn(*s, dtype=torch.bfloat16) * 0.4)(B, Sk, Dc)),
            "w_q": _w((lambda *s: torch.randn(*s, dtype=torch.bfloat16) * 3.2)(M, H, D) * (M ** -0.5)),
            "w_uk": _w((lambda *s: torch.randn(*s, dtype=torch.bfloat16) * 3.2)(Dc, H, D) * (Dc ** -0.5)),
            "w_uv": _w((lambda *s: torch.randn(*s, dtype=torch.bfloat16) * 0.4)(Dc, H, D) * (Dc ** -0.5)),
            "w_o": _w((lambda *s: torch.randn(*s, dtype=torch.bfloat16) * 0.4)(H, D, M) * ((H * D) ** -0.5)),
        }
    _A_in = _A_setup()

    def _B_setup():
        B, S, D, F = 1, 2048, 512, 1376
        return {
            "x": _w((lambda *s: torch.randn(*s, dtype=torch.bfloat16) * 0.05)(B, S, D)),
            "w1": _w((lambda *s: torch.randn(*s, dtype=torch.bfloat16) * 0.8)(D, F) * (D ** -0.5)),
            "b1": _w((lambda *s: torch.randn(*s, dtype=torch.bfloat16) * 0.4)(F)),
            "w2": _w((lambda *s: torch.randn(*s, dtype=torch.bfloat16) * 0.05)(F, D) * (F ** -0.5)),
            "b2": _w((lambda *s: torch.randn(*s, dtype=torch.bfloat16) * 0.05)(D)),
        }
    _B_in = _B_setup()

    return {
        "A_x": _A_in["x"],
        "A_c_kv": _A_in["c_kv"],
        "A_w_q": _A_in["w_q"],
        "A_w_uk": _A_in["w_uk"],
        "A_w_uv": _A_in["w_uv"],
        "A_w_o": _A_in["w_o"],
        "B_x": _B_in["x"],
        "B_w1": _B_in["w1"],
        "B_b1": _B_in["b1"],
        "B_w2": _B_in["w2"],
        "B_b2": _B_in["b2"],
    }

def reference(A_x, A_c_kv, A_w_q, A_w_uk, A_w_uv, A_w_o, B_x, B_w1, B_b1, B_w2, B_b2):
    def _A_ref(x, c_kv, w_q, w_uk, w_uv, w_o):
        B, Sq, M = x.shape[0], x.shape[1], x.shape[2]
        Sk = c_kv.shape[1]
        H, D = w_q.shape[1], w_q.shape[2]
        q = torch.einsum("bqm,mhd->bhqd", x, w_q)
        k = torch.einsum("bkc,chd->bhkd", c_kv, w_uk)
        v = torch.einsum("bkc,chd->bhkd", c_kv, w_uv)
        scores = torch.einsum("bhqd,bhkd->bhqk", q, k) * (D ** -0.5)
        off = Sk - Sq
        qi = torch.arange(Sq)[:, None]
        kj = torch.arange(Sk)[None, :]
        cmask = kj <= (qi + off)
        scores = torch.where(cmask[None, None], scores, -1e9)
        p = _softmax(scores, axis=-1)
        ctx = torch.einsum("bhqk,bhkd->bhqd", p, v)
        return torch.einsum("bhqd,hdm->bqm", ctx, w_o)

    def _B_ref(x, w1, b1, w2, b2):
        y = _layernorm(x, axis=-1)
        h = _gelu(torch.einsum("bsd,df->bsf", y, w1) + b1)
        return torch.einsum("bsf,fd->bsd", h, w2) + b2

    x = A_x
    h = x + _A_ref(_layernorm(x, axis=-1), A_c_kv, A_w_q, A_w_uk, A_w_uv, A_w_o)
    h2 = h + _B_ref(_layernorm(h, axis=-1), B_w1, B_b1, B_w2, B_b2)
    return h2
```

```asm
; @launch grid=(256,1,1) block=(256,1,1) lds=163840
.amdgcn_target "amdgcn-amd-amdhsa--gfx950"
.text
.globl sequential_preLN__compressed_kv_cla__mixer_channel_mlp__prompt_kernel
.p2align 8
.type sequential_preLN__compressed_kv_cla__mixer_channel_mlp__prompt_kernel,@function
sequential_preLN__compressed_kv_cla__mixer_channel_mlp__prompt_kernel:
  s_cmp_ge_u32 s2, 256
  s_cbranch_scc0 L_go
  s_endpgm
L_go:
  s_load_dwordx16 s[40:55], s[0:1], 0
  s_load_dwordx8 s[56:63], s[0:1], 64
  s_load_dwordx4 s[64:67], s[0:1], 96
  s_getpc_b64 s[38:39]
  s_lshr_b32 s23, s2, 3
  v_lshl_add_u32 v27, v0, 5, s23
  v_lshlrev_b32 v27, 7, v27
  v_cmp_gt_u32 vcc, 22, v0
  s_and_saveexec_b64 s[4:5], vcc
  s_cbranch_execz L_nopf
  global_load_dword v19, v27, s[38:39]
L_nopf:
  s_mov_b64 exec, -1
  v_and_b32 v1, 63, v0
  v_lshrrev_b32 v20, 6, v0
  v_lshlrev_b32 v2, 4, v1
  v_readfirstlane_b32 s20, v20
  s_lshr_b32 s22, s2, 5
  s_and_b32 s21, s2, 7
  s_bfe_u32 s23, s2, 0x20003
  s_lshl2_add_u32 s21, s21, s23
  v_lshrrev_b32 v20, 3, v1
  v_lshlrev_b32 v20, 10, v20
  v_and_b32 v21, 7, v1
  v_lshrrev_b32 v22, 4, v1
  v_xor_b32 v21, v21, v22
  v_lshl_add_u32 v3, v21, 4, v20
  v_xor_b32 v4, 64, v3
  s_and_b32 s23, s20, 1
  s_lshl_b32 s30, s23, 18
  s_lshl_b32 s23, s23, 2
  s_lshr_b32 s24, s20, 1
  s_add_u32 s23, s23, s24
  s_lshl_b32 s23, s23, 18
  s_lshl_b32 s29, s22, 15
  s_add_u32 s29, s29, s23
  s_lshl_b32 s28, s20, 13
  s_mul_i32 s31, s2, 2
  s_mul_i32 s23, s22, 2
  s_add_u32 s31, s31, s23
  s_and_b32 s31, s31, 7
  s_lshl_b32 s32, s31, 19
  s_lshl_b32 s31, s31, 7
  s_waitcnt lgkmcnt(0)
  s_mov_b32 s4, s42
  s_mov_b32 s5, s43
  s_mov_b32 s6, 0x200000
  s_mov_b32 s7, 0x20000
  s_add_u32 m0, s28, 0
  s_add_u32 s26, s29, s31
  buffer_load_dwordx4 v3, s[4:7], s26 offen lds
  v_lshlrev_b32 v20, 13, v22
  v_lshlrev_b32 v23, 2, v22
  s_add_u32 s31, s31, 128
  s_add_u32 s26, s26, 7168
  buffer_load_dwordx4 v4, s[4:7], s26 offen offset:1024 lds
  v_and_b32 v21, 15, v1
  v_xor_b32 v23, v21, v23
  s_and_b32 s31, s31, 0x3ff
  s_add_u32 s26, s26, 7168
  buffer_load_dwordx4 v3, s[4:7], s26 offen offset:2048 lds
  v_lshl_add_u32 v15, v23, 4, v20
  v_xor_b32 v16, 32, v15
  s_add_u32 s26, s26, 7168
  buffer_load_dwordx4 v4, s[4:7], s26 offen offset:3072 lds
  s_lshl_b32 s24, s21, 8
  s_add_u32 s30, s30, s24
  s_add_u32 m0, s28, 4096
  s_add_u32 s26, s26, 502784
  buffer_load_dwordx4 v3, s[4:7], s26 offen lds
  s_mov_b32 s14, 0x400000
  s_mov_b32 s15, 0x20000
  s_add_u32 s26, s26, 7168
  buffer_load_dwordx4 v4, s[4:7], s26 offen offset:1024 lds
  s_mov_b32 s8, s66
  s_mov_b32 s9, s67
  s_add_u32 s26, s26, 7168
  buffer_load_dwordx4 v3, s[4:7], s26 offen offset:2048 lds
  s_mov_b32 s10, 0x10000000
  s_mov_b32 s11, 0x20000
  s_add_u32 s26, s26, 7168
  buffer_load_dwordx4 v4, s[4:7], s26 offen offset:3072 lds
  s_cmp_lt_u32 s20, 2
  s_cselect_b32 s12, s46, s48
  s_cselect_b32 s13, s47, s49
  s_add_u32 m0, s28, 32768
  s_add_u32 s27, s30, s32
  buffer_load_dwordx4 v15, s[12:15], s27 offen lds
  s_add_u32 s32, s32, 524288
  s_add_u32 s27, s27, 31744
  buffer_load_dwordx4 v15, s[12:15], s27 offen offset:1024 lds
  s_and_b32 s32, s32, 0x3fffff
  s_add_u32 s27, s27, 31744
  buffer_load_dwordx4 v16, s[12:15], s27 offen offset:2048 lds
  s_add_u32 s27, s27, 31744
  buffer_load_dwordx4 v16, s[12:15], s27 offen offset:3072 lds
  s_add_u32 m0, s28, 36864
  s_add_u32 s27, s27, 35840
  buffer_load_dwordx4 v15, s[12:15], s27 offen lds
  s_add_u32 s27, s27, 31744
  buffer_load_dwordx4 v15, s[12:15], s27 offen offset:1024 lds
  s_add_u32 s27, s27, 31744
  buffer_load_dwordx4 v16, s[12:15], s27 offen offset:2048 lds
  s_add_u32 s27, s27, 31744
  buffer_load_dwordx4 v16, s[12:15], s27 offen offset:3072 lds
  s_add_u32 m0, s28, 65536
  s_add_u32 s26, s29, s31
  buffer_load_dwordx4 v3, s[4:7], s26 offen lds
  s_and_b32 s25, s20, 1
  s_lshl_b32 s25, s25, 14
  v_lshrrev_b32 v24, 1, v21
  v_xor_b32 v24, v24, v22
  v_lshlrev_b32 v24, 4, v24
  v_lshl_add_u32 v24, v21, 7, v24
  v_add_u32 v5, s25, v24
  s_add_u32 s31, s31, 128
  s_add_u32 s26, s26, 7168
  buffer_load_dwordx4 v4, s[4:7], s26 offen offset:1024 lds
  v_xor_b32 v6, 64, v5
  v_lshrrev_b32 v24, 2, v21
  v_lshl_add_u32 v25, v22, 3, v24
  v_lshlrev_b32 v24, 2, v24
  v_and_b32 v26, 1, v22
  v_lshl_add_u32 v24, v26, 1, v24
  v_bfe_u32 v26, v21, 1, 1
  s_and_b32 s31, s31, 0x3ff
  s_add_u32 s26, s26, 7168
  buffer_load_dwordx4 v3, s[4:7], s26 offen offset:2048 lds
  v_xor_b32 v24, v24, v26
  v_lshlrev_b32 v24, 4, v24
  v_lshl_add_u32 v24, v25, 8, v24
  v_and_b32 v26, 1, v21
  v_lshl_add_u32 v24, v26, 3, v24
  s_lshr_b32 s25, s20, 1
  s_lshl_b32 s25, s25, 14
  s_add_u32 s26, s26, 7168
  buffer_load_dwordx4 v4, s[4:7], s26 offen offset:3072 lds
  v_add_u32 v7, s25, v24
  v_xor_b32 v8, 32, v7
  v_xor_b32 v9, 64, v7
  v_xor_b32 v10, 96, v7
  v_xor_b32 v11, 128, v7
  v_xor_b32 v12, 160, v7
  v_xor_b32 v13, 192, v7
  s_add_u32 m0, s28, 69632
  s_add_u32 s26, s26, 502784
  buffer_load_dwordx4 v3, s[4:7], s26 offen lds
  v_xor_b32 v14, 224, v7
  s_lshl_b32 s23, s2, 13
  s_lshl_b32 s24, s20, 12
  s_add_u32 s23, s23, s24
  v_and_b32 v25, 3, v1
  v_lshrrev_b32 v23, 2, v1
  v_lshlrev_b32 v24, 10, v25
  s_add_u32 s26, s26, 7168
  buffer_load_dwordx4 v4, s[4:7], s26 offen offset:1024 lds
  v_lshl_add_u32 v24, v23, 4, v24
  v_add_u32 v24, s23, v24
  s_mov_b32 s16, s64
  s_mov_b32 s17, s65
  s_mov_b32 s18, 0x100
  s_mov_b32 s19, 0x20000
  s_mov_b32 s68, s40
  s_add_u32 s26, s26, 7168
  buffer_load_dwordx4 v3, s[4:7], s26 offen offset:2048 lds
  s_mov_b32 s69, s41
  s_mov_b32 s70, 0x200000
  s_mov_b32 s71, 0x20000
  s_mov_b32 s76, s44
  s_mov_b32 s77, s45
  s_mov_b32 s78, 0x400000
  s_mov_b32 s79, 0x20000
  s_add_u32 s26, s26, 7168
  buffer_load_dwordx4 v4, s[4:7], s26 offen offset:3072 lds
  s_mov_b32 s72, s54
  s_mov_b32 s73, s55
  s_mov_b32 s74, 0x158000
  s_mov_b32 s75, 0x20000
  s_waitcnt vmcnt(8)
  s_barrier
  s_cmp_ge_u32 s20, 2
  s_cbranch_scc1 L_kv_v
  ds_read_b64_tr_b16 v[192:193], v7 offset:32768
  ds_read_b64_tr_b16 v[194:195], v7 offset:33792
  ds_read_b64_tr_b16 v[196:197], v7 offset:40960
  ds_read_b64_tr_b16 v[198:199], v7 offset:41984
  ds_read_b64_tr_b16 v[200:201], v8 offset:32768
  ds_read_b64_tr_b16 v[202:203], v8 offset:33792
  ds_read_b64_tr_b16 v[204:205], v8 offset:40960
  ds_read_b64_tr_b16 v[206:207], v8 offset:41984
  ds_read_b128 v[128:131], v5 offset:0
  ds_read_b128 v[132:135], v6 offset:0
  s_waitcnt lgkmcnt(0)
  v_mfma_f32_16x16x32_bf16 a[0:3], v[192:195], v[128:131], 0
  s_add_u32 m0, s28, 98304
  v_mov_b32 v20, 0
  v_and_b32 v21, 31, v1
  v_mfma_f32_16x16x32_bf16 a[0:3], v[196:199], v[132:135], a[0:3]
  s_add_u32 s27, s30, s32
  v_lshlrev_b32 v18, 2, v21
  v_lshlrev_b32 v26, 3, v21
  v_mfma_f32_16x16x32_bf16 a[4:7], v[204:207], v[132:135], 0
  buffer_load_dwordx4 v15, s[12:15], s27 offen lds
  s_add_u32 s32, s32, 524288
  v_mfma_f32_16x16x32_bf16 a[4:7], v[200:203], v[128:131], a[4:7]
  s_add_u32 s27, s27, 31744
  ds_read_b128 v[136:139], v5 offset:2048
  ds_read_b128 v[140:143], v6 offset:2048
  s_waitcnt lgkmcnt(0)
  v_mfma_f32_16x16x32_bf16 a[36:39], v[200:203], v[136:139], 0
  buffer_load_dwordx4 v15, s[12:15], s27 offen offset:1024 lds
  s_and_b32 s32, s32, 0x3fffff
  v_mfma_f32_16x16x32_bf16 a[36:39], v[204:207], v[140:143], a[36:39]
  s_add_u32 s27, s27, 31744
  v_mfma_f32_16x16x32_bf16 a[32:35], v[196:199], v[140:143], 0
  buffer_load_dwordx4 v16, s[12:15], s27 offen offset:2048 lds
  v_mfma_f32_16x16x32_bf16 a[32:35], v[192:195], v[136:139], a[32:35]
  s_add_u32 s27, s27, 31744
  ds_read_b128 v[144:147], v5 offset:4096
  ds_read_b128 v[148:151], v6 offset:4096
  s_waitcnt lgkmcnt(0)
  v_mfma_f32_16x16x32_bf16 a[64:67], v[192:195], v[144:147], 0
  buffer_load_dwordx4 v16, s[12:15], s27 offen offset:3072 lds
  s_add_u32 m0, s28, 102400
  v_mfma_f32_16x16x32_bf16 a[64:67], v[196:199], v[148:151], a[64:67]
  s_add_u32 s27, s27, 35840
  v_mfma_f32_16x16x32_bf16 a[68:71], v[204:207], v[148:151], 0
  buffer_load_dwordx4 v15, s[12:15], s27 offen lds
  v_mfma_f32_16x16x32_bf16 a[68:71], v[200:203], v[144:147], a[68:71]
  s_add_u32 s27, s27, 31744
  ds_read_b128 v[152:155], v5 offset:6144
  ds_read_b128 v[156:159], v6 offset:6144
  s_waitcnt lgkmcnt(0)
  v_mfma_f32_16x16x32_bf16 a[100:103], v[200:203], v[152:155], 0
  buffer_load_dwordx4 v15, s[12:15], s27 offen offset:1024 lds
  v_mfma_f32_16x16x32_bf16 a[100:103], v[204:207], v[156:159], a[100:103]
  s_add_u32 s27, s27, 31744
  v_mfma_f32_16x16x32_bf16 a[96:99], v[196:199], v[156:159], 0
  buffer_load_dwordx4 v16, s[12:15], s27 offen offset:2048 lds
  v_mfma_f32_16x16x32_bf16 a[96:99], v[192:195], v[152:155], a[96:99]
  s_add_u32 s27, s27, 31744
  ds_read_b128 v[160:163], v5 offset:8192
  ds_read_b128 v[164:167], v6 offset:8192
  s_waitcnt lgkmcnt(0)
  v_mfma_f32_16x16x32_bf16 a[128:131], v[192:195], v[160:163], 0
  buffer_load_dwordx4 v16, s[12:15], s27 offen offset:3072 lds
  s_add_u32 m0, s28, 131072
  v_mfma_f32_16x16x32_bf16 a[128:131], v[196:199], v[164:167], a[128:131]
  s_add_u32 s26, s29, s31
  v_mfma_f32_16x16x32_bf16 a[132:135], v[204:207], v[164:167], 0
  buffer_load_dwordx4 v3, s[4:7], s26 offen lds
  v_mfma_f32_16x16x32_bf16 a[132:135], v[200:203], v[160:163], a[132:135]
  s_lshl_b32 s25, s2, 7
  ds_read_b128 v[168:171], v5 offset:10240
  ds_read_b128 v[172:175], v6 offset:10240
  s_waitcnt lgkmcnt(0)
  v_mfma_f32_16x16x32_bf16 a[164:167], v[200:203], v[168:171], 0
  s_add_u32 s31, s31, 128
  v_mfma_f32_16x16x32_bf16 a[164:167], v[204:207], v[172:175], a[164:167]
  s_add_u32 s26, s26, 7168
  v_mfma_f32_16x16x32_bf16 a[160:163], v[196:199], v[172:175], 0
  buffer_load_dwordx4 v4, s[4:7], s26 offen offset:1024 lds
  v_mfma_f32_16x16x32_bf16 a[160:163], v[192:195], v[168:171], a[160:163]
  s_add_u32 s25, s25, 73400320
  ds_read_b128 v[176:179], v5 offset:12288
  ds_read_b128 v[180:183], v6 offset:12288
  s_waitcnt lgkmcnt(0)
  v_mfma_f32_16x16x32_bf16 a[192:195], v[192:195], v[176:179], 0
  s_and_b32 s31, s31, 0x3ff
  v_mfma_f32_16x16x32_bf16 a[192:195], v[196:199], v[180:183], a[192:195]
  s_add_u32 s26, s26, 7168
  v_mfma_f32_16x16x32_bf16 a[196:199], v[204:207], v[180:183], 0
  buffer_load_dwordx4 v3, s[4:7], s26 offen offset:2048 lds
  v_mfma_f32_16x16x32_bf16 a[196:199], v[200:203], v[176:179], a[196:199]
  s_and_b32 s35, s2, 31
  ds_read_b128 v[184:187], v5 offset:14336
  ds_read_b128 v[188:191], v6 offset:14336
  s_waitcnt lgkmcnt(0)
  v_mfma_f32_16x16x32_bf16 a[228:231], v[200:203], v[184:187], 0
  s_lshl_b32 s35, s35, 3
  v_mfma_f32_16x16x32_bf16 a[228:231], v[204:207], v[188:191], a[228:231]
  s_add_u32 s26, s26, 7168
  v_mfma_f32_16x16x32_bf16 a[224:227], v[196:199], v[188:191], 0
  buffer_load_dwordx4 v4, s[4:7], s26 offen offset:3072 lds
  v_mfma_f32_16x16x32_bf16 a[224:227], v[192:195], v[184:187], a[224:227]
  s_getreg_b32 s3, hwreg(HW_REG_XCC_ID, 0, 3)
  ds_read_b64_tr_b16 v[208:209], v9 offset:32768
  ds_read_b64_tr_b16 v[210:211], v9 offset:33792
  ds_read_b64_tr_b16 v[212:213], v9 offset:40960
  ds_read_b64_tr_b16 v[214:215], v9 offset:41984
  ds_read_b64_tr_b16 v[216:217], v10 offset:32768
  ds_read_b64_tr_b16 v[218:219], v10 offset:33792
  ds_read_b64_tr_b16 v[220:221], v10 offset:40960
  ds_read_b64_tr_b16 v[222:223], v10 offset:41984
  s_waitcnt lgkmcnt(0)
  v_mfma_f32_16x16x32_bf16 a[8:11], v[208:211], v[128:131], 0
  s_add_u32 m0, s28, 135168
  v_lshrrev_b32 v31, 4, v1
  v_mul_u32_u24 v31, 768, v31
  v_mfma_f32_16x16x32_bf16 a[8:11], v[212:215], v[132:135], a[8:11]
  s_add_u32 s26, s26, 502784
  v_add_u32 v31, v31, v2
  v_mfma_f32_16x16x32_bf16 a[12:15], v[220:223], v[132:135], 0
  buffer_load_dwordx4 v3, s[4:7], s26 offen lds
  v_mfma_f32_16x16x32_bf16 a[12:15], v[216:219], v[128:131], a[12:15]
  s_lshl_b32 s3, s3, 2
  v_mfma_f32_16x16x32_bf16 a[44:47], v[216:219], v[136:139], 0
  s_lshl_b32 s3, 1, s3
  v_mfma_f32_16x16x32_bf16 a[44:47], v[220:223], v[140:143], a[44:47]
  s_add_u32 s26, s26, 7168
  v_mfma_f32_16x16x32_bf16 a[40:43], v[212:215], v[140:143], 0
  buffer_load_dwordx4 v4, s[4:7], s26 offen offset:1024 lds
  v_mfma_f32_16x16x32_bf16 a[40:43], v[208:211], v[136:139], a[40:43]
  s_lshr_b32 s36, s2, 1
  v_mfma_f32_16x16x32_bf16 a[72:75], v[208:211], v[144:147], 0
  s_mul_i32 s36, s36, 17408
  v_mfma_f32_16x16x32_bf16 a[72:75], v[212:215], v[148:151], a[72:75]
  s_add_u32 s26, s26, 7168
  v_mfma_f32_16x16x32_bf16 a[76:79], v[220:223], v[148:151], 0
  buffer_load_dwordx4 v3, s[4:7], s26 offen offset:2048 lds
  v_mfma_f32_16x16x32_bf16 a[76:79], v[216:219], v[144:147], a[76:79]
  s_and_b32 s24, s2, 1
  ds_read_b64_tr_b16 v[224:225], v11 offset:32768
  ds_read_b64_tr_b16 v[226:227], v11 offset:33792
  ds_read_b64_tr_b16 v[228:229], v11 offset:40960
  ds_read_b64_tr_b16 v[230:231], v11 offset:41984
  ds_read_b64_tr_b16 v[232:233], v12 offset:32768
  ds_read_b64_tr_b16 v[234:235], v12 offset:33792
  ds_read_b64_tr_b16 v[236:237], v12 offset:40960
  ds_read_b64_tr_b16 v[238:239], v12 offset:41984
  s_waitcnt lgkmcnt(0)
  v_mfma_f32_16x16x32_bf16 a[108:111], v[216:219], v[152:155], 0
  s_lshl_b32 s24, s24, 1
  v_mfma_f32_16x16x32_bf16 a[108:111], v[220:223], v[156:159], a[108:111]
  s_add_u32 s26, s26, 7168
  v_mfma_f32_16x16x32_bf16 a[104:107], v[212:215], v[156:159], 0
  buffer_load_dwordx4 v4, s[4:7], s26 offen offset:3072 lds
  v_mfma_f32_16x16x32_bf16 a[104:107], v[208:211], v[152:155], a[104:107]
  s_add_u32 s24, s24, s20
  v_mfma_f32_16x16x32_bf16 a[136:139], v[208:211], v[160:163], 0
  s_lshl_b32 s24, s24, 8
  v_mfma_f32_16x16x32_bf16 a[136:139], v[212:215], v[164:167], a[136:139]
  s_add_u32 s36, s36, s24
  v_mfma_f32_16x16x32_bf16 a[140:143], v[220:223], v[164:167], 0
  s_add_u32 s36, s36, 33554432
  v_mfma_f32_16x16x32_bf16 a[140:143], v[216:219], v[160:163], a[140:143]
  s_add_u32 s37, s36, 4096
  v_mfma_f32_16x16x32_bf16 a[172:175], v[216:219], v[168:171], 0
  s_add_u32 s38, s36, 8192
  ds_read_b64_tr_b16 v[240:241], v13 offset:32768
  ds_read_b64_tr_b16 v[242:243], v13 offset:33792
  ds_read_b64_tr_b16 v[244:245], v13 offset:40960
  ds_read_b64_tr_b16 v[246:247], v13 offset:41984
  ds_read_b64_tr_b16 v[248:249], v14 offset:32768
  ds_read_b64_tr_b16 v[250:251], v14 offset:33792
  ds_read_b64_tr_b16 v[252:253], v14 offset:40960
  ds_read_b64_tr_b16 v[254:255], v14 offset:41984
  s_waitcnt lgkmcnt(0)
  v_mfma_f32_16x16x32_bf16 a[172:175], v[220:223], v[172:175], a[172:175]
  s_add_u32 s39, s36, 12288
  v_mfma_f32_16x16x32_bf16 a[168:171], v[212:215], v[172:175], 0
  buffer_load_dwordx4 v[64:67], v24, s[68:71], 0 offen offset:0
  v_mfma_f32_16x16x32_bf16 a[168:171], v[208:211], v[168:171], a[168:171]
  buffer_load_dwordx4 v[68:71], v24, s[68:71], 0 offen offset:256
  v_mfma_f32_16x16x32_bf16 a[200:203], v[208:211], v[176:179], 0
  v_add_u32 v5, 0x10000, v5
  v_add_u32 v6, 0x10000, v6
  v_mfma_f32_16x16x32_bf16 a[200:203], v[212:215], v[180:183], a[200:203]
  v_add_u32 v7, 0x10000, v7
  v_add_u32 v8, 0x10000, v8
  v_mfma_f32_16x16x32_bf16 a[204:207], v[220:223], v[180:183], 0
  v_add_u32 v9, 0x10000, v9
  v_add_u32 v10, 0x10000, v10
  v_mfma_f32_16x16x32_bf16 a[204:207], v[216:219], v[176:179], a[204:207]
  v_add_u32 v11, 0x10000, v11
  v_add_u32 v12, 0x10000, v12
  v_mfma_f32_16x16x32_bf16 a[236:239], v[216:219], v[184:187], 0
  v_add_u32 v13, 0x10000, v13
  v_add_u32 v14, 0x10000, v14
  v_mfma_f32_16x16x32_bf16 a[236:239], v[220:223], v[188:191], a[236:239]
  buffer_load_dwordx4 v[72:75], v24, s[68:71], 0 offen offset:512
  v_mfma_f32_16x16x32_bf16 a[232:235], v[212:215], v[188:191], 0
  buffer_load_dwordx4 v[76:79], v24, s[68:71], 0 offen offset:768
  v_mfma_f32_16x16x32_bf16 a[232:235], v[208:211], v[184:187], a[232:235]
  s_waitcnt vmcnt(12) lgkmcnt(0)
  s_barrier
  v_mfma_f32_16x16x32_bf16 a[16:19], v[224:227], v[128:131], 0
  s_add_u32 m0, s28, 0
  ds_read_b64_tr_b16 v[192:193], v7 offset:32768
  v_and_b32 v27, 15, v1
  v_mfma_f32_16x16x32_bf16 a[16:19], v[228:231], v[132:135], a[16:19]
  s_add_u32 s27, s30, s32
  ds_read_b64_tr_b16 v[194:195], v7 offset:33792
  v_lshrrev_b32 v28, 4, v1
  v_mfma_f32_16x16x32_bf16 a[20:23], v[236:239], v[132:135], 0
  buffer_load_dwordx4 v15, s[12:15], s27 offen lds
  v_mfma_f32_16x16x32_bf16 a[20:23], v[232:235], v[128:131], a[20:23]
  ds_read_b64_tr_b16 v[196:197], v7 offset:40960
  v_mul_u32_u24 v30, 2752, v27
  v_mfma_f32_16x16x32_bf16 a[52:55], v[232:235], v[136:139], 0
  s_add_u32 s32, s32, 524288
  ds_read_b64_tr_b16 v[198:199], v7 offset:41984
  v_lshl_add_u32 v30, v28, 4, v30
  v_mfma_f32_16x16x32_bf16 a[52:55], v[236:239], v[140:143], a[52:55]
  s_add_u32 s27, s27, 31744
  ds_read_b64_tr_b16 v[200:201], v8 offset:32768
  v_add_u32 v25, 44032, v30
  v_mfma_f32_16x16x32_bf16 a[48:51], v[228:231], v[140:143], 0
  buffer_load_dwordx4 v15, s[12:15], s27 offen offset:1024 lds
  v_mfma_f32_16x16x32_bf16 a[48:51], v[224:227], v[136:139], a[48:51]
  ds_read_b64_tr_b16 v[202:203], v8 offset:33792
  v_mfma_f32_16x16x32_bf16 a[80:83], v[224:227], v[144:147], 0
  s_and_b32 s32, s32, 0x3fffff
  ds_read_b64_tr_b16 v[204:205], v8 offset:40960
  v_mfma_f32_16x16x32_bf16 a[80:83], v[228:231], v[148:151], a[80:83]
  s_add_u32 s27, s27, 31744
  ds_read_b64_tr_b16 v[206:207], v8 offset:41984
  v_mfma_f32_16x16x32_bf16 a[84:87], v[236:239], v[148:151], 0
  buffer_load_dwordx4 v16, s[12:15], s27 offen offset:2048 lds
  v_mfma_f32_16x16x32_bf16 a[84:87], v[232:235], v[144:147], a[84:87]
  ds_read_b64_tr_b16 v[208:209], v9 offset:32768
  v_mfma_f32_16x16x32_bf16 a[116:119], v[232:235], v[152:155], 0
  ds_read_b64_tr_b16 v[210:211], v9 offset:33792
  v_mfma_f32_16x16x32_bf16 a[116:119], v[236:239], v[156:159], a[116:119]
  s_add_u32 s27, s27, 31744
  ds_read_b64_tr_b16 v[212:213], v9 offset:40960
  v_mfma_f32_16x16x32_bf16 a[112:115], v[228:231], v[156:159], 0
  buffer_load_dwordx4 v16, s[12:15], s27 offen offset:3072 lds
  v_mfma_f32_16x16x32_bf16 a[112:115], v[224:227], v[152:155], a[112:115]
  ds_read_b64_tr_b16 v[214:215], v9 offset:41984
  v_mfma_f32_16x16x32_bf16 a[144:147], v[224:227], v[160:163], 0
  s_add_u32 m0, s28, 4096
  ds_read_b64_tr_b16 v[216:217], v10 offset:32768
  v_mfma_f32_16x16x32_bf16 a[144:147], v[228:231], v[164:167], a[144:147]
  s_add_u32 s27, s27, 35840
  ds_read_b64_tr_b16 v[218:219], v10 offset:33792
  v_lshlrev_b32 v28, 3, v28
  v_mfma_f32_16x16x32_bf16 a[148:151], v[236:239], v[164:167], 0
  buffer_load_dwordx4 v15, s[12:15], s27 offen lds
  v_mfma_f32_16x16x32_bf16 a[148:151], v[232:235], v[160:163], a[148:151]
  ds_read_b64_tr_b16 v[220:221], v10 offset:40960
  v_sub_u32 v28, v27, v28
  v_mfma_f32_16x16x32_bf16 a[180:183], v[232:235], v[168:171], 0
  ds_read_b64_tr_b16 v[222:223], v10 offset:41984
  v_and_b32 v27, 1, v27
  v_mfma_f32_16x16x32_bf16 a[180:183], v[236:239], v[172:175], a[180:183]
  s_add_u32 s27, s27, 31744
  v_lshlrev_b32 v27, 4, v27
  v_mov_b32 v29, 0x3f80
  v_mfma_f32_16x16x32_bf16 a[176:179], v[228:231], v[172:175], 0
  buffer_load_dwordx4 v15, s[12:15], s27 offen offset:1024 lds
  v_mfma_f32_16x16x32_bf16 a[176:179], v[224:227], v[168:171], a[176:179]
  v_lshlrev_b32 v27, v27, v29
  v_ashrrev_i32 v28, 1, v28
  v_mfma_f32_16x16x32_bf16 a[208:211], v[224:227], v[176:179], 0
  v_cmp_eq_i32 vcc, 0, v28
  s_nop 1
  v_mfma_f32_16x16x32_bf16 a[208:211], v[228:231], v[180:183], a[208:211]
  s_add_u32 s27, s27, 31744
  v_cndmask_b32 v48, 0, v27, vcc
  v_cmp_eq_i32 vcc, 1, v28
  v_mfma_f32_16x16x32_bf16 a[212:215], v[236:239], v[180:183], 0
  buffer_load_dwordx4 v16, s[12:15], s27 offen offset:2048 lds
  v_mfma_f32_16x16x32_bf16 a[212:215], v[232:235], v[176:179], a[212:215]
  buffer_store_dword v20, v18, s[8:11], s25 offen sc1
  v_mfma_f32_16x16x32_bf16 a[244:247], v[232:235], v[184:187], 0
  s_nop 1
  v_cndmask_b32 v49, 0, v27, vcc
  v_cmp_eq_i32 vcc, 2, v28
  v_mfma_f32_16x16x32_bf16 a[244:247], v[236:239], v[188:191], a[244:247]
  s_add_u32 s27, s27, 31744
  s_nop 1
  v_cndmask_b32 v50, 0, v27, vcc
  v_mfma_f32_16x16x32_bf16 a[240:243], v[228:231], v[188:191], 0
  buffer_load_dwordx4 v16, s[12:15], s27 offen offset:3072 lds
  v_mfma_f32_16x16x32_bf16 a[240:243], v[224:227], v[184:187], a[240:243]
  v_cmp_eq_i32 vcc, 3, v28
  s_nop 1
  v_mfma_f32_16x16x32_bf16 a[24:27], v[240:243], v[128:131], 0
  v_cndmask_b32 v51, 0, v27, vcc
  v_cmp_eq_i32 vcc, -8, v28
  v_mfma_f32_16x16x32_bf16 a[24:27], v[244:247], v[132:135], a[24:27]
  s_nop 1
  v_cndmask_b32 v52, 0, v27, vcc
  v_cmp_eq_i32 vcc, -7, v28
  v_mfma_f32_16x16x32_bf16 a[28:31], v[252:255], v[132:135], 0
  s_nop 1
  v_cndmask_b32 v53, 0, v27, vcc
  v_cmp_eq_i32 vcc, -6, v28
  v_mfma_f32_16x16x32_bf16 a[28:31], v[248:251], v[128:131], a[28:31]
  ds_read_b128 v[128:131], v5 offset:0
  ds_read_b128 v[132:135], v6 offset:0
  s_waitcnt lgkmcnt(0)
  v_mfma_f32_16x16x32_bf16 a[60:63], v[248:251], v[136:139], 0
  s_nop 1
  v_cndmask_b32 v54, 0, v27, vcc
  v_cmp_eq_i32 vcc, -5, v28
  v_mfma_f32_16x16x32_bf16 a[60:63], v[252:255], v[140:143], a[60:63]
  s_nop 1
  v_cndmask_b32 v55, 0, v27, vcc
  s_waitcnt vmcnt(9)
  v_mfma_f32_16x16x32_bf16 a[56:59], v[244:247], v[140:143], 0
  v_lshlrev_b32 v80, 16, v64
  v_and_b32 v81, 0xffff0000, v64
  v_mfma_f32_16x16x32_bf16 a[56:59], v[240:243], v[136:139], a[56:59]
  ds_read_b128 v[136:139], v5 offset:2048
  ds_read_b128 v[140:143], v6 offset:2048
  s_waitcnt lgkmcnt(0)
  v_mfma_f32_16x16x32_bf16 a[88:91], v[240:243], v[144:147], 0
  v_lshlrev_b32 v82, 16, v65
  v_and_b32 v83, 0xffff0000, v65
  v_mfma_f32_16x16x32_bf16 a[88:91], v[244:247], v[148:151], a[88:91]
  v_lshlrev_b32 v84, 16, v66
  v_and_b32 v85, 0xffff0000, v66
  v_mfma_f32_16x16x32_bf16 a[92:95], v[252:255], v[148:151], 0
  v_lshlrev_b32 v86, 16, v67
  v_and_b32 v87, 0xffff0000, v67
  v_mfma_f32_16x16x32_bf16 a[92:95], v[248:251], v[144:147], a[92:95]
  ds_read_b128 v[144:147], v5 offset:4096
  ds_read_b128 v[148:151], v6 offset:4096
  s_waitcnt lgkmcnt(0)
  v_mfma_f32_16x16x32_bf16 a[124:127], v[248:251], v[152:155], 0
  v_lshlrev_b32 v88, 16, v68
  v_and_b32 v89, 0xffff0000, v68
  v_mfma_f32_16x16x32_bf16 a[124:127], v[252:255], v[156:159], a[124:127]
  v_lshlrev_b32 v90, 16, v69
  v_and_b32 v91, 0xffff0000, v69
  v_mfma_f32_16x16x32_bf16 a[120:123], v[244:247], v[156:159], 0
  v_lshlrev_b32 v92, 16, v70
  v_and_b32 v93, 0xffff0000, v70
  v_mfma_f32_16x16x32_bf16 a[120:123], v[240:243], v[152:155], a[120:123]
  ds_read_b128 v[152:155], v5 offset:6144
  ds_read_b128 v[156:159], v6 offset:6144
  s_waitcnt lgkmcnt(0)
  v_mfma_f32_16x16x32_bf16 a[152:155], v[240:243], v[160:163], 0
  v_lshlrev_b32 v94, 16, v71
  v_and_b32 v95, 0xffff0000, v71
  v_mfma_f32_16x16x32_bf16 a[152:155], v[244:247], v[164:167], a[152:155]
  v_lshlrev_b32 v96, 16, v72
  v_and_b32 v97, 0xffff0000, v72
  v_mfma_f32_16x16x32_bf16 a[156:159], v[252:255], v[164:167], 0
  v_lshlrev_b32 v98, 16, v73
  v_and_b32 v99, 0xffff0000, v73
  v_mfma_f32_16x16x32_bf16 a[156:159], v[248:251], v[160:163], a[156:159]
  ds_read_b128 v[160:163], v5 offset:8192
  ds_read_b128 v[164:167], v6 offset:8192
  s_waitcnt lgkmcnt(0)
  v_mfma_f32_16x16x32_bf16 a[188:191], v[248:251], v[168:171], 0
  v_lshlrev_b32 v100, 16, v74
  v_and_b32 v101, 0xffff0000, v74
  v_mfma_f32_16x16x32_bf16 a[188:191], v[252:255], v[172:175], a[188:191]
  v_lshlrev_b32 v102, 16, v75
  v_and_b32 v103, 0xffff0000, v75
  v_mfma_f32_16x16x32_bf16 a[184:187], v[244:247], v[172:175], 0
  v_lshlrev_b32 v104, 16, v76
  v_and_b32 v105, 0xffff0000, v76
  v_mfma_f32_16x16x32_bf16 a[184:187], v[240:243], v[168:171], a[184:187]
  ds_read_b128 v[168:171], v5 offset:10240
  ds_read_b128 v[172:175], v6 offset:10240
  s_waitcnt lgkmcnt(0)
  v_mfma_f32_16x16x32_bf16 a[216:219], v[240:243], v[176:179], 0
  v_lshlrev_b32 v106, 16, v77
  v_and_b32 v107, 0xffff0000, v77
  v_mfma_f32_16x16x32_bf16 a[216:219], v[244:247], v[180:183], a[216:219]
  v_lshlrev_b32 v108, 16, v78
  v_and_b32 v109, 0xffff0000, v78
  v_mfma_f32_16x16x32_bf16 a[220:223], v[252:255], v[180:183], 0
  v_lshlrev_b32 v110, 16, v79
  v_and_b32 v111, 0xffff0000, v79
  v_mfma_f32_16x16x32_bf16 a[220:223], v[248:251], v[176:179], a[220:223]
  ds_read_b128 v[176:179], v5 offset:12288
  ds_read_b128 v[180:183], v6 offset:12288
  s_waitcnt lgkmcnt(0)
  v_mfma_f32_16x16x32_bf16 a[252:255], v[248:251], v[184:187], 0
  v_add_f32 v20, v80, v82
  v_add_f32 v21, v81, v83
  v_mfma_f32_16x16x32_bf16 a[252:255], v[252:255], v[188:191], a[252:255]
  v_add_f32 v20, v20, v84
  v_add_f32 v21, v21, v85
  v_mfma_f32_16x16x32_bf16 a[248:251], v[244:247], v[188:191], 0
  v_add_f32 v20, v20, v86
  v_add_f32 v21, v21, v87
  v_mfma_f32_16x16x32_bf16 a[248:251], v[240:243], v[184:187], a[248:251]
  s_waitcnt lgkmcnt(10)
  v_add_f32 v20, v20, v88
  v_add_f32 v21, v21, v89
  v_mfma_f32_16x16x32_bf16 a[0:3], v[192:195], v[128:131], a[0:3]
  ds_read_b128 v[184:187], v5 offset:14336
  v_add_f32 v20, v20, v90
  v_mfma_f32_16x16x32_bf16 a[0:3], v[196:199], v[132:135], a[0:3]
  ds_read_b128 v[188:191], v6 offset:14336
  v_add_f32 v21, v21, v91
  v_mfma_f32_16x16x32_bf16 a[4:7], v[204:207], v[132:135], a[4:7]
  ds_read_b64_tr_b16 v[224:225], v11 offset:32768
  v_add_f32 v20, v20, v92
  v_mfma_f32_16x16x32_bf16 a[4:7], v[200:203], v[128:131], a[4:7]
  v_add_f32 v21, v21, v93
  v_add_f32 v20, v20, v94
  v_mfma_f32_16x16x32_bf16 a[36:39], v[200:203], v[136:139], a[36:39]
  s_add_u32 m0, s28, 32768
  ds_read_b64_tr_b16 v[226:227], v11 offset:33792
  v_add_f32 v21, v21, v95
  v_mfma_f32_16x16x32_bf16 a[36:39], v[204:207], v[140:143], a[36:39]
  s_add_u32 s26, s29, s31
  v_add_f32 v20, v20, v96
  v_add_f32 v21, v21, v97
  v_mfma_f32_16x16x32_bf16 a[32:35], v[196:199], v[140:143], a[32:35]
  buffer_load_dwordx4 v3, s[4:7], s26 offen lds
  v_mfma_f32_16x16x32_bf16 a[32:35], v[192:195], v[136:139], a[32:35]
  s_waitcnt lgkmcnt(10)
  ds_read_b64_tr_b16 v[228:229], v11 offset:40960
  v_add_f32 v20, v20, v98
  v_mfma_f32_16x16x32_bf16 a[64:67], v[192:195], v[144:147], a[64:67]
  v_add_f32 v21, v21, v99
  v_add_f32 v20, v20, v100
  v_mfma_f32_16x16x32_bf16 a[64:67], v[196:199], v[148:151], a[64:67]
  ds_read_b64_tr_b16 v[230:231], v11 offset:41984
  v_add_f32 v21, v21, v101
  v_mfma_f32_16x16x32_bf16 a[68:71], v[204:207], v[148:151], a[68:71]
  v_add_f32 v20, v20, v102
  v_add_f32 v21, v21, v103
  v_mfma_f32_16x16x32_bf16 a[68:71], v[200:203], v[144:147], a[68:71]
  s_add_u32 s31, s31, 128
  ds_read_b64_tr_b16 v[232:233], v12 offset:32768
  v_add_f32 v20, v20, v104
  v_mfma_f32_16x16x32_bf16 a[100:103], v[200:203], v[152:155], a[100:103]
  s_add_u32 s26, s26, 7168
  v_add_f32 v21, v21, v105
  v_add_f32 v20, v20, v106
  v_mfma_f32_16x16x32_bf16 a[100:103], v[204:207], v[156:159], a[100:103]
  buffer_load_dwordx4 v4, s[4:7], s26 offen offset:1024 lds
  v_mfma_f32_16x16x32_bf16 a[96:99], v[196:199], v[156:159], a[96:99]
  ds_read_b64_tr_b16 v[234:235], v12 offset:33792
  v_add_f32 v21, v21, v107
  v_mfma_f32_16x16x32_bf16 a[96:99], v[192:195], v[152:155], a[96:99]
  s_waitcnt lgkmcnt(10)
  v_add_f32 v20, v20, v108
  v_add_f32 v21, v21, v109
  v_mfma_f32_16x16x32_bf16 a[128:131], v[192:195], v[160:163], a[128:131]
  ds_read_b64_tr_b16 v[236:237], v12 offset:40960
  v_add_f32 v20, v20, v110
  v_mfma_f32_16x16x32_bf16 a[128:131], v[196:199], v[164:167], a[128:131]
  v_add_f32 v21, v21, v111
  v_add_f32 v20, v20, v21
  v_mfma_f32_16x16x32_bf16 a[132:135], v[204:207], v[164:167], a[132:135]
  s_and_b32 s31, s31, 0x3ff
  ds_read_b64_tr_b16 v[238:239], v12 offset:41984
  s_nop 1
  v_mfma_f32_16x16x32_bf16 a[132:135], v[200:203], v[160:163], a[132:135]
  s_add_u32 s26, s26, 7168
  v_add_f32_dpp v20, v20, v20 row_ror:4 row_mask:0xf bank_mask:0xf
  s_nop 1
  v_mfma_f32_16x16x32_bf16 a[164:167], v[200:203], v[168:171], a[164:167]
  buffer_load_dwordx4 v3, s[4:7], s26 offen offset:2048 lds
  v_mfma_f32_16x16x32_bf16 a[164:167], v[204:207], v[172:175], a[164:167]
  ds_read_b64_tr_b16 v[240:241], v13 offset:32768
  v_add_f32_dpp v20, v20, v20 row_ror:8 row_mask:0xf bank_mask:0xf
  v_mfma_f32_16x16x32_bf16 a[160:163], v[196:199], v[172:175], a[160:163]
  v_mov_b32 v21, v20
  s_nop 1
  v_mfma_f32_16x16x32_bf16 a[160:163], v[192:195], v[168:171], a[160:163]
  s_waitcnt lgkmcnt(9)
  ds_read_b64_tr_b16 v[242:243], v13 offset:33792
  v_permlane16_swap_b32 v20, v21
  v_mfma_f32_16x16x32_bf16 a[192:195], v[192:195], v[176:179], a[192:195]
  v_add_f32 v20, v20, v21
  v_mov_b32 v21, v20
  v_mfma_f32_16x16x32_bf16 a[192:195], v[196:199], v[180:183], a[192:195]
  ds_read_b64_tr_b16 v[244:245], v13 offset:40960
  s_nop 1
  v_mfma_f32_16x16x32_bf16 a[196:199], v[204:207], v[180:183], a[196:199]
  v_permlane32_swap_b32 v20, v21
  v_add_f32 v20, v20, v21
  v_mfma_f32_16x16x32_bf16 a[196:199], v[200:203], v[176:179], a[196:199]
  s_add_u32 s26, s26, 7168
  ds_read_b64_tr_b16 v[246:247], v13 offset:41984
  v_mul_f32 v20, 0x3b000000, v20
  v_mfma_f32_16x16x32_bf16 a[228:231], v[200:203], v[184:187], a[228:231]
  buffer_load_dwordx4 v4, s[4:7], s26 offen offset:3072 lds
  v_mfma_f32_16x16x32_bf16 a[228:231], v[204:207], v[188:191], a[228:231]
  ds_read_b64_tr_b16 v[248:249], v14 offset:32768
  v_sub_f32 v80, v80, v20
  v_mfma_f32_16x16x32_bf16 a[224:227], v[196:199], v[188:191], a[224:227]
  v_sub_f32 v81, v81, v20
  v_sub_f32 v82, v82, v20
  v_mfma_f32_16x16x32_bf16 a[224:227], v[192:195], v[184:187], a[224:227]
  ds_read_b64_tr_b16 v[250:251], v14 offset:33792
  v_sub_f32 v83, v83, v20
  v_mfma_f32_16x16x32_bf16 a[8:11], v[208:211], v[128:131], a[8:11]
  s_add_u32 m0, s28, 36864
  v_sub_f32 v84, v84, v20
  v_sub_f32 v85, v85, v20
  v_mfma_f32_16x16x32_bf16 a[8:11], v[212:215], v[132:135], a[8:11]
  s_add_u32 s26, s26, 502784
  ds_read_b64_tr_b16 v[252:253], v14 offset:40960
  v_sub_f32 v86, v86, v20
  v_mfma_f32_16x16x32_bf16 a[12:15], v[220:223], v[132:135], a[12:15]
  buffer_load_dwordx4 v3, s[4:7], s26 offen lds
  v_mfma_f32_16x16x32_bf16 a[12:15], v[216:219], v[128:131], a[12:15]
  ds_read_b64_tr_b16 v[254:255], v14 offset:41984
  v_sub_f32 v87, v87, v20
  v_mfma_f32_16x16x32_bf16 a[44:47], v[216:219], v[136:139], a[44:47]
  v_sub_f32 v88, v88, v20
  v_sub_f32 v89, v89, v20
  v_mfma_f32_16x16x32_bf16 a[44:47], v[220:223], v[140:143], a[44:47]
  v_sub_f32 v90, v90, v20
  v_sub_f32 v91, v91, v20
  v_mfma_f32_16x16x32_bf16 a[40:43], v[212:215], v[140:143], a[40:43]
  v_sub_f32 v92, v92, v20
  v_sub_f32 v93, v93, v20
  v_mfma_f32_16x16x32_bf16 a[40:43], v[208:211], v[136:139], a[40:43]
  v_sub_f32 v94, v94, v20
  v_sub_f32 v95, v95, v20
  v_mfma_f32_16x16x32_bf16 a[72:75], v[208:211], v[144:147], a[72:75]
  s_add_u32 s26, s26, 7168
  v_sub_f32 v96, v96, v20
  v_sub_f32 v97, v97, v20
  v_mfma_f32_16x16x32_bf16 a[72:75], v[212:215], v[148:151], a[72:75]
  buffer_load_dwordx4 v4, s[4:7], s26 offen offset:1024 lds
  v_mfma_f32_16x16x32_bf16 a[76:79], v[220:223], v[148:151], a[76:79]
  v_sub_f32 v98, v98, v20
  v_sub_f32 v99, v99, v20
  v_mfma_f32_16x16x32_bf16 a[76:79], v[216:219], v[144:147], a[76:79]
  v_sub_f32 v100, v100, v20
  v_sub_f32 v101, v101, v20
  v_mfma_f32_16x16x32_bf16 a[108:111], v[216:219], v[152:155], a[108:111]
  v_sub_f32 v102, v102, v20
  v_sub_f32 v103, v103, v20
  v_mfma_f32_16x16x32_bf16 a[108:111], v[220:223], v[156:159], a[108:111]
  v_sub_f32 v104, v104, v20
  v_sub_f32 v105, v105, v20
  v_mfma_f32_16x16x32_bf16 a[104:107], v[212:215], v[156:159], a[104:107]
  v_sub_f32 v106, v106, v20
  v_sub_f32 v107, v107, v20
  v_mfma_f32_16x16x32_bf16 a[104:107], v[208:211], v[152:155], a[104:107]
  s_add_u32 s26, s26, 7168
  v_sub_f32 v108, v108, v20
  v_sub_f32 v109, v109, v20
  v_mfma_f32_16x16x32_bf16 a[136:139], v[208:211], v[160:163], a[136:139]
  buffer_load_dwordx4 v3, s[4:7], s26 offen offset:2048 lds
  v_mfma_f32_16x16x32_bf16 a[136:139], v[212:215], v[164:167], a[136:139]
  v_sub_f32 v110, v110, v20
  v_sub_f32 v111, v111, v20
  v_mfma_f32_16x16x32_bf16 a[140:143], v[220:223], v[164:167], a[140:143]
  v_mul_f32 v20, v80, v80
  v_mul_f32 v21, v81, v81
  v_mfma_f32_16x16x32_bf16 a[140:143], v[216:219], v[160:163], a[140:143]
  v_fmac_f32 v20, v82, v82
  v_fmac_f32 v21, v83, v83
  v_mfma_f32_16x16x32_bf16 a[172:175], v[216:219], v[168:171], a[172:175]
  v_fmac_f32 v20, v84, v84
  v_fmac_f32 v21, v85, v85
  v_mfma_f32_16x16x32_bf16 a[172:175], v[220:223], v[172:175], a[172:175]
  v_fmac_f32 v20, v86, v86
  v_fmac_f32 v21, v87, v87
  v_mfma_f32_16x16x32_bf16 a[168:171], v[212:215], v[172:175], a[168:171]
  s_add_u32 s26, s26, 7168
  v_fmac_f32 v20, v88, v88
  v_fmac_f32 v21, v89, v89
  v_mfma_f32_16x16x32_bf16 a[168:171], v[208:211], v[168:171], a[168:171]
  buffer_load_dwordx4 v4, s[4:7], s26 offen offset:3072 lds
  v_mfma_f32_16x16x32_bf16 a[200:203], v[208:211], v[176:179], a[200:203]
  v_add_u32 v5, 0x10000, v5
  v_add_u32 v6, 0x10000, v6
  v_mfma_f32_16x16x32_bf16 a[200:203], v[212:215], v[180:183], a[200:203]
  v_add_u32 v7, 0xffff0000, v7
  v_add_u32 v8, 0xffff0000, v8
  v_mfma_f32_16x16x32_bf16 a[204:207], v[220:223], v[180:183], a[204:207]
  v_add_u32 v9, 0xffff0000, v9
  v_add_u32 v10, 0xffff0000, v10
  v_mfma_f32_16x16x32_bf16 a[204:207], v[216:219], v[176:179], a[204:207]
  v_add_u32 v11, 0xffff0000, v11
  v_add_u32 v12, 0xffff0000, v12
  v_mfma_f32_16x16x32_bf16 a[236:239], v[216:219], v[184:187], a[236:239]
  v_add_u32 v13, 0xffff0000, v13
  v_add_u32 v14, 0xffff0000, v14
  v_mfma_f32_16x16x32_bf16 a[236:239], v[220:223], v[188:191], a[236:239]
  v_fmac_f32 v20, v90, v90
  v_fmac_f32 v21, v91, v91
  v_mfma_f32_16x16x32_bf16 a[232:235], v[212:215], v[188:191], a[232:235]
  v_fmac_f32 v20, v92, v92
  v_fmac_f32 v21, v93, v93
  v_mfma_f32_16x16x32_bf16 a[232:235], v[208:211], v[184:187], a[232:235]
  s_waitcnt vmcnt(8) lgkmcnt(0)
  s_barrier
  v_mfma_f32_16x16x32_bf16 a[16:19], v[224:227], v[128:131], a[16:19]
  s_add_u32 m0, s28, 65536
  ds_read_b64_tr_b16 v[192:193], v7 offset:0
  v_fmac_f32 v20, v94, v94
  v_mfma_f32_16x16x32_bf16 a[16:19], v[228:231], v[132:135], a[16:19]
  s_add_u32 s27, s30, s32
  ds_read_b64_tr_b16 v[194:195], v7 offset:1024
  v_fmac_f32 v21, v95, v95
  v_mfma_f32_16x16x32_bf16 a[20:23], v[236:239], v[132:135], a[20:23]
  buffer_load_dwordx4 v15, s[12:15], s27 offen lds
  v_mfma_f32_16x16x32_bf16 a[20:23], v[232:235], v[128:131], a[20:23]
  ds_read_b64_tr_b16 v[196:197], v7 offset:8192
  v_fmac_f32 v20, v96, v96
  v_mfma_f32_16x16x32_bf16 a[52:55], v[232:235], v[136:139], a[52:55]
  s_add_u32 s32, s32, 524288
  ds_read_b64_tr_b16 v[198:199], v7 offset:9216
  v_fmac_f32 v21, v97, v97
  v_mfma_f32_16x16x32_bf16 a[52:55], v[236:239], v[140:143], a[52:55]
  s_add_u32 s27, s27, 31744
  ds_read_b64_tr_b16 v[200:201], v8 offset:0
  v_fmac_f32 v20, v98, v98
  v_mfma_f32_16x16x32_bf16 a[48:51], v[228:231], v[140:143], a[48:51]
  buffer_load_dwordx4 v15, s[12:15], s27 offen offset:1024 lds
  v_mfma_f32_16x16x32_bf16 a[48:51], v[224:227], v[136:139], a[48:51]
  ds_read_b64_tr_b16 v[202:203], v8 offset:1024
  v_fmac_f32 v21, v99, v99
  v_mfma_f32_16x16x32_bf16 a[80:83], v[224:227], v[144:147], a[80:83]
  s_and_b32 s32, s32, 0x3fffff
  ds_read_b64_tr_b16 v[204:205], v8 offset:8192
  v_fmac_f32 v20, v100, v100
  v_mfma_f32_16x16x32_bf16 a[80:83], v[228:231], v[148:151], a[80:83]
  s_add_u32 s27, s27, 31744
  ds_read_b64_tr_b16 v[206:207], v8 offset:9216
  v_fmac_f32 v21, v101, v101
  v_mfma_f32_16x16x32_bf16 a[84:87], v[236:239], v[148:151], a[84:87]
  buffer_load_dwordx4 v16, s[12:15], s27 offen offset:2048 lds
  v_mfma_f32_16x16x32_bf16 a[84:87], v[232:235], v[144:147], a[84:87]
  ds_read_b64_tr_b16 v[208:209], v9 offset:0
  v_fmac_f32 v20, v102, v102
  v_mfma_f32_16x16x32_bf16 a[116:119], v[232:235], v[152:155], a[116:119]
  ds_read_b64_tr_b16 v[210:211], v9 offset:1024
  v_fmac_f32 v21, v103, v103
  v_mfma_f32_16x16x32_bf16 a[116:119], v[236:239], v[156:159], a[116:119]
  s_add_u32 s27, s27, 31744
  ds_read_b64_tr_b16 v[212:213], v9 offset:8192
  v_fmac_f32 v20, v104, v104
  v_mfma_f32_16x16x32_bf16 a[112:115], v[228:231], v[156:159], a[112:115]
  buffer_load_dwordx4 v16, s[12:15], s27 offen offset:3072 lds
  v_mfma_f32_16x16x32_bf16 a[112:115], v[224:227], v[152:155], a[112:115]
  ds_read_b64_tr_b16 v[214:215], v9 offset:9216
  v_fmac_f32 v21, v105, v105
  v_mfma_f32_16x16x32_bf16 a[144:147], v[224:227], v[160:163], a[144:147]
  s_add_u32 m0, s28, 69632
  ds_read_b64_tr_b16 v[216:217], v10 offset:0
  v_fmac_f32 v20, v106, v106
  v_mfma_f32_16x16x32_bf16 a[144:147], v[228:231], v[164:167], a[144:147]
  s_add_u32 s27, s27, 35840
  ds_read_b64_tr_b16 v[218:219], v10 offset:1024
  v_fmac_f32 v21, v107, v107
  v_mfma_f32_16x16x32_bf16 a[148:151], v[236:239], v[164:167], a[148:151]
  buffer_load_dwordx4 v15, s[12:15], s27 offen lds
  v_mfma_f32_16x16x32_bf16 a[148:151], v[232:235], v[160:163], a[148:151]
  ds_read_b64_tr_b16 v[220:221], v10 offset:8192
  v_fmac_f32 v20, v108, v108
  v_mfma_f32_16x16x32_bf16 a[180:183], v[232:235], v[168:171], a[180:183]
  ds_read_b64_tr_b16 v[222:223], v10 offset:9216
  v_fmac_f32 v21, v109, v109
  v_mfma_f32_16x16x32_bf16 a[180:183], v[236:239], v[172:175], a[180:183]
  s_add_u32 s27, s27, 31744
  v_fmac_f32 v20, v110, v110
  v_fmac_f32 v21, v111, v111
  v_mfma_f32_16x16x32_bf16 a[176:179], v[228:231], v[172:175], a[176:179]
  buffer_load_dwordx4 v15, s[12:15], s27 offen offset:1024 lds
  v_mfma_f32_16x16x32_bf16 a[176:179], v[224:227], v[168:171], a[176:179]
  v_add_f32 v20, v20, v21
  s_nop 1
  v_mfma_f32_16x16x32_bf16 a[208:211], v[224:227], v[176:179], a[208:211]
  v_add_f32_dpp v20, v20, v20 row_ror:4 row_mask:0xf bank_mask:0xf
  s_nop 1
  v_mfma_f32_16x16x32_bf16 a[208:211], v[228:231], v[180:183], a[208:211]
  s_add_u32 s27, s27, 31744
  v_add_f32_dpp v20, v20, v20 row_ror:8 row_mask:0xf bank_mask:0xf
  v_mov_b32 v21, v20
  v_mfma_f32_16x16x32_bf16 a[212:215], v[236:239], v[180:183], a[212:215]
  buffer_load_dwordx4 v16, s[12:15], s27 offen offset:2048 lds
  v_mfma_f32_16x16x32_bf16 a[212:215], v[232:235], v[176:179], a[212:215]
  s_nop 1
  v_permlane16_swap_b32 v20, v21
  v_add_f32 v20, v20, v21
  v_mfma_f32_16x16x32_bf16 a[244:247], v[232:235], v[184:187], a[244:247]
  v_mov_b32 v21, v20
  s_nop 1
  v_mfma_f32_16x16x32_bf16 a[244:247], v[236:239], v[188:191], a[244:247]
  s_add_u32 s27, s27, 31744
  v_permlane32_swap_b32 v20, v21
  v_add_f32 v20, v20, v21
  v_mfma_f32_16x16x32_bf16 a[240:243], v[228:231], v[188:191], a[240:243]
  buffer_load_dwordx4 v16, s[12:15], s27 offen offset:3072 lds
  v_mfma_f32_16x16x32_bf16 a[240:243], v[224:227], v[184:187], a[240:243]
  v_mov_b32 v21, 0x3727c5ac
  v_fmac_f32 v21, 0x3b000000, v20
  v_mfma_f32_16x16x32_bf16 a[24:27], v[240:243], v[128:131], a[24:27]
  v_rsq_f32 v20, v21
  v_mfma_f32_16x16x32_bf16 a[24:27], v[244:247], v[132:135], a[24:27]
  s_nop 0
  v_mul_f32 v20, 0x3e0293ee, v20
  v_mul_f32 v80, v80, v20
  v_mfma_f32_16x16x32_bf16 a[28:31], v[252:255], v[132:135], a[28:31]
  v_mul_f32 v81, v81, v20
  v_cvt_pk_bf16_f32 v64, v80, v81
  v_mfma_f32_16x16x32_bf16 a[28:31], v[248:251], v[128:131], a[28:31]
  ds_read_b128 v[128:131], v5 offset:0
  v_mul_f32 v82, v82, v20
  v_mfma_f32_16x16x32_bf16 a[60:63], v[248:251], v[136:139], a[60:63]
  ds_read_b128 v[132:135], v6 offset:0
  v_mul_f32 v83, v83, v20
  v_mfma_f32_16x16x32_bf16 a[60:63], v[252:255], v[140:143], a[60:63]
  v_cvt_pk_bf16_f32 v65, v82, v83
  v_mul_f32 v84, v84, v20
  v_mfma_f32_16x16x32_bf16 a[56:59], v[244:247], v[140:143], a[56:59]
  v_mul_f32 v85, v85, v20
  v_cvt_pk_bf16_f32 v66, v84, v85
  v_mfma_f32_16x16x32_bf16 a[56:59], v[240:243], v[136:139], a[56:59]
  ds_read_b128 v[136:139], v5 offset:2048
  v_mul_f32 v86, v86, v20
  v_mfma_f32_16x16x32_bf16 a[88:91], v[240:243], v[144:147], a[88:91]
  ds_read_b128 v[140:143], v6 offset:2048
  v_mul_f32 v87, v87, v20
  v_mfma_f32_16x16x32_bf16 a[88:91], v[244:247], v[148:151], a[88:91]
  v_cvt_pk_bf16_f32 v67, v86, v87
  v_mfma_f32_16x16x32_bf16 a[92:95], v[252:255], v[148:151], a[92:95]
  buffer_store_dwordx4 v[64:67], v31, s[8:11], s36 offen sc1
  v_mfma_f32_16x16x32_bf16 a[92:95], v[248:251], v[144:147], a[92:95]
  ds_read_b128 v[144:147], v5 offset:4096
  v_mul_f32 v88, v88, v20
  v_mfma_f32_16x16x32_bf16 a[124:127], v[248:251], v[152:155], a[124:127]
  ds_read_b128 v[148:151], v6 offset:4096
  v_mul_f32 v89, v89, v20
  v_mfma_f32_16x16x32_bf16 a[124:127], v[252:255], v[156:159], a[124:127]
  v_cvt_pk_bf16_f32 v68, v88, v89
  v_mul_f32 v90, v90, v20
  v_mfma_f32_16x16x32_bf16 a[120:123], v[244:247], v[156:159], a[120:123]
  v_mul_f32 v91, v91, v20
  v_cvt_pk_bf16_f32 v69, v90, v91
  v_mfma_f32_16x16x32_bf16 a[120:123], v[240:243], v[152:155], a[120:123]
  ds_read_b128 v[152:155], v5 offset:6144
  v_mul_f32 v92, v92, v20
  v_mfma_f32_16x16x32_bf16 a[152:155], v[240:243], v[160:163], a[152:155]
  ds_read_b128 v[156:159], v6 offset:6144
  v_mul_f32 v93, v93, v20
  v_mfma_f32_16x16x32_bf16 a[152:155], v[244:247], v[164:167], a[152:155]
  v_cvt_pk_bf16_f32 v70, v92, v93
  v_mul_f32 v94, v94, v20
  v_mfma_f32_16x16x32_bf16 a[156:159], v[252:255], v[164:167], a[156:159]
  v_mul_f32 v95, v95, v20
  v_cvt_pk_bf16_f32 v71, v94, v95
  v_mfma_f32_16x16x32_bf16 a[156:159], v[248:251], v[160:163], a[156:159]
  ds_read_b128 v[160:163], v5 offset:8192
  v_mfma_f32_16x16x32_bf16 a[188:191], v[248:251], v[168:171], a[188:191]
  ds_read_b128 v[164:167], v6 offset:8192
  v_mfma_f32_16x16x32_bf16 a[188:191], v[252:255], v[172:175], a[188:191]
  buffer_store_dwordx4 v[68:71], v31, s[8:11], s37 offen sc1
  v_mfma_f32_16x16x32_bf16 a[184:187], v[244:247], v[172:175], a[184:187]
  v_mul_f32 v96, v96, v20
  v_mul_f32 v97, v97, v20
  v_mfma_f32_16x16x32_bf16 a[184:187], v[240:243], v[168:171], a[184:187]
  ds_read_b128 v[168:171], v5 offset:10240
  v_cvt_pk_bf16_f32 v72, v96, v97
  v_mfma_f32_16x16x32_bf16 a[216:219], v[240:243], v[176:179], a[216:219]
  ds_read_b128 v[172:175], v6 offset:10240
  v_mul_f32 v98, v98, v20
  v_mfma_f32_16x16x32_bf16 a[216:219], v[244:247], v[180:183], a[216:219]
  v_mul_f32 v99, v99, v20
  v_cvt_pk_bf16_f32 v73, v98, v99
  v_mfma_f32_16x16x32_bf16 a[220:223], v[252:255], v[180:183], a[220:223]
  v_mul_f32 v100, v100, v20
  v_mul_f32 v101, v101, v20
  v_mfma_f32_16x16x32_bf16 a[220:223], v[248:251], v[176:179], a[220:223]
  ds_read_b128 v[176:179], v5 offset:12288
  v_cvt_pk_bf16_f32 v74, v100, v101
  v_mfma_f32_16x16x32_bf16 a[252:255], v[248:251], v[184:187], a[252:255]
  ds_read_b128 v[180:183], v6 offset:12288
  v_mul_f32 v102, v102, v20
  v_mfma_f32_16x16x32_bf16 a[252:255], v[252:255], v[188:191], a[252:255]
  v_mul_f32 v103, v103, v20
  v_cvt_pk_bf16_f32 v75, v102, v103
  v_mfma_f32_16x16x32_bf16 a[248:251], v[244:247], v[188:191], a[248:251]
  buffer_store_dwordx4 v[72:75], v31, s[8:11], s38 offen sc1
  v_mfma_f32_16x16x32_bf16 a[248:251], v[240:243], v[184:187], a[248:251]
  s_waitcnt lgkmcnt(10)
  v_mul_f32 v104, v104, v20
  v_mul_f32 v105, v105, v20
  v_mfma_f32_16x16x32_bf16 a[0:3], v[192:195], v[128:131], a[0:3]
  ds_read_b128 v[184:187], v5 offset:14336
  v_cvt_pk_bf16_f32 v76, v104, v105
  v_mfma_f32_16x16x32_bf16 a[0:3], v[196:199], v[132:135], a[0:3]
  ds_read_b128 v[188:191], v6 offset:14336
  v_mul_f32 v106, v106, v20
  v_mfma_f32_16x16x32_bf16 a[4:7], v[204:207], v[132:135], a[4:7]
  ds_read_b64_tr_b16 v[224:225], v11 offset:0
  v_mul_f32 v107, v107, v20
  v_mfma_f32_16x16x32_bf16 a[4:7], v[200:203], v[128:131], a[4:7]
  v_cvt_pk_bf16_f32 v77, v106, v107
  v_mul_f32 v108, v108, v20
  v_mfma_f32_16x16x32_bf16 a[36:39], v[200:203], v[136:139], a[36:39]
  s_add_u32 m0, s28, 98304
  ds_read_b64_tr_b16 v[226:227], v11 offset:1024
  v_mul_f32 v109, v109, v20
  v_mfma_f32_16x16x32_bf16 a[36:39], v[204:207], v[140:143], a[36:39]
  s_add_u32 s26, s29, s31
  v_cvt_pk_bf16_f32 v78, v108, v109
  v_mul_f32 v110, v110, v20
  v_mfma_f32_16x16x32_bf16 a[32:35], v[196:199], v[140:143], a[32:35]
  buffer_load_dwordx4 v3, s[4:7], s26 offen lds
  v_mfma_f32_16x16x32_bf16 a[32:35], v[192:195], v[136:139], a[32:35]
  s_waitcnt lgkmcnt(10)
  ds_read_b64_tr_b16 v[228:229], v11 offset:8192
  v_mul_f32 v111, v111, v20
  v_mfma_f32_16x16x32_bf16 a[64:67], v[192:195], v[144:147], a[64:67]
  v_cvt_pk_bf16_f32 v79, v110, v111
  v_mfma_f32_16x16x32_bf16 a[64:67], v[196:199], v[148:151], a[64:67]
  ds_read_b64_tr_b16 v[230:231], v11 offset:9216
  v_mfma_f32_16x16x32_bf16 a[68:71], v[204:207], v[148:151], a[68:71]
  buffer_store_dwordx4 v[76:79], v31, s[8:11], s39 offen sc1
  v_mfma_f32_16x16x32_bf16 a[68:71], v[200:203], v[144:147], a[68:71]
  s_add_u32 s31, s31, 128
  ds_read_b64_tr_b16 v[232:233], v12 offset:0
  v_mfma_f32_16x16x32_bf16 a[100:103], v[200:203], v[152:155], a[100:103]
  s_add_u32 s26, s26, 7168
  v_mfma_f32_16x16x32_bf16 a[100:103], v[204:207], v[156:159], a[100:103]
  buffer_load_dwordx4 v4, s[4:7], s26 offen offset:1024 lds
  v_mfma_f32_16x16x32_bf16 a[96:99], v[196:199], v[156:159], a[96:99]
  ds_read_b64_tr_b16 v[234:235], v12 offset:1024
  v_mfma_f32_16x16x32_bf16 a[96:99], v[192:195], v[152:155], a[96:99]
  s_waitcnt lgkmcnt(10)
  v_mfma_f32_16x16x32_bf16 a[128:131], v[192:195], v[160:163], a[128:131]
  ds_read_b64_tr_b16 v[236:237], v12 offset:8192
  v_mfma_f32_16x16x32_bf16 a[128:131], v[196:199], v[164:167], a[128:131]
  v_mfma_f32_16x16x32_bf16 a[132:135], v[204:207], v[164:167], a[132:135]
  s_and_b32 s31, s31, 0x3ff
  ds_read_b64_tr_b16 v[238:239], v12 offset:9216
  v_mfma_f32_16x16x32_bf16 a[132:135], v[200:203], v[160:163], a[132:135]
  s_add_u32 s26, s26, 7168
  v_mfma_f32_16x16x32_bf16 a[164:167], v[200:203], v[168:171], a[164:167]
  buffer_load_dwordx4 v3, s[4:7], s26 offen offset:2048 lds
  v_mfma_f32_16x16x32_bf16 a[164:167], v[204:207], v[172:175], a[164:167]
  ds_read_b64_tr_b16 v[240:241], v13 offset:0
  v_mfma_f32_16x16x32_bf16 a[160:163], v[196:199], v[172:175], a[160:163]
  v_mfma_f32_16x16x32_bf16 a[160:163], v[192:195], v[168:171], a[160:163]
  s_waitcnt lgkmcnt(9)
  ds_read_b64_tr_b16 v[242:243], v13 offset:1024
  v_mfma_f32_16x16x32_bf16 a[192:195], v[192:195], v[176:179], a[192:195]
  v_mfma_f32_16x16x32_bf16 a[192:195], v[196:199], v[180:183], a[192:195]
  ds_read_b64_tr_b16 v[244:245], v13 offset:8192
  v_mfma_f32_16x16x32_bf16 a[196:199], v[204:207], v[180:183], a[196:199]
  v_mfma_f32_16x16x32_bf16 a[196:199], v[200:203], v[176:179], a[196:199]
  s_add_u32 s26, s26, 7168
  ds_read_b64_tr_b16 v[246:247], v13 offset:9216
  v_mfma_f32_16x16x32_bf16 a[228:231], v[200:203], v[184:187], a[228:231]
  buffer_load_dwordx4 v4, s[4:7], s26 offen offset:3072 lds
  v_mfma_f32_16x16x32_bf16 a[228:231], v[204:207], v[188:191], a[228:231]
  ds_read_b64_tr_b16 v[248:249], v14 offset:0
  v_mfma_f32_16x16x32_bf16 a[224:227], v[196:199], v[188:191], a[224:227]
  v_mfma_f32_16x16x32_bf16 a[224:227], v[192:195], v[184:187], a[224:227]
  ds_read_b64_tr_b16 v[250:251], v14 offset:1024
  v_mfma_f32_16x16x32_bf16 a[8:11], v[208:211], v[128:131], a[8:11]
  s_add_u32 m0, s28, 102400
  v_mfma_f32_16x16x32_bf16 a[8:11], v[212:215], v[132:135], a[8:11]
  s_add_u32 s26, s26, 502784
  ds_read_b64_tr_b16 v[252:253], v14 offset:8192
  v_mfma_f32_16x16x32_bf16 a[12:15], v[220:223], v[132:135], a[12:15]
  buffer_load_dwordx4 v3, s[4:7], s26 offen lds
  v_mfma_f32_16x16x32_bf16 a[12:15], v[216:219], v[128:131], a[12:15]
  ds_read_b64_tr_b16 v[254:255], v14 offset:9216
  v_mfma_f32_16x16x32_bf16 a[44:47], v[216:219], v[136:139], a[44:47]
  v_mfma_f32_16x16x32_bf16 a[44:47], v[220:223], v[140:143], a[44:47]
  v_mfma_f32_16x16x32_bf16 a[40:43], v[212:215], v[140:143], a[40:43]
  v_mfma_f32_16x16x32_bf16 a[40:43], v[208:211], v[136:139], a[40:43]
  v_mfma_f32_16x16x32_bf16 a[72:75], v[208:211], v[144:147], a[72:75]
  s_add_u32 s26, s26, 7168
  v_mfma_f32_16x16x32_bf16 a[72:75], v[212:215], v[148:151], a[72:75]
  buffer_load_dwordx4 v4, s[4:7], s26 offen offset:1024 lds
  v_mfma_f32_16x16x32_bf16 a[76:79], v[220:223], v[148:151], a[76:79]
  s_lshl_b32 s23, s2, 1
  v_mfma_f32_16x16x32_bf16 a[76:79], v[216:219], v[144:147], a[76:79]
  s_and_b32 s24, s20, 1
  v_mfma_f32_16x16x32_bf16 a[108:111], v[216:219], v[152:155], a[108:111]
  s_add_u32 s23, s23, s24
  v_mfma_f32_16x16x32_bf16 a[108:111], v[220:223], v[156:159], a[108:111]
  s_lshl_b32 s64, s23, 11
  v_mfma_f32_16x16x32_bf16 a[104:107], v[212:215], v[156:159], a[104:107]
  s_add_u32 s64, s64, 58720256
  v_mfma_f32_16x16x32_bf16 a[104:107], v[208:211], v[152:155], a[104:107]
  s_add_u32 s26, s26, 7168
  v_mfma_f32_16x16x32_bf16 a[136:139], v[208:211], v[160:163], a[136:139]
  buffer_load_dwordx4 v3, s[4:7], s26 offen offset:2048 lds
  v_mfma_f32_16x16x32_bf16 a[136:139], v[212:215], v[164:167], a[136:139]
  s_mul_i32 s24, s23, 1525
  v_mfma_f32_16x16x32_bf16 a[140:143], v[220:223], v[164:167], a[140:143]
  s_lshr_b32 s24, s24, 16
  v_mfma_f32_16x16x32_bf16 a[140:143], v[216:219], v[160:163], a[140:143]
  s_mul_i32 s24, s24, 85312
  v_mfma_f32_16x16x32_bf16 a[172:175], v[216:219], v[168:171], a[172:175]
  s_lshl_b32 s23, s23, 6
  v_mfma_f32_16x16x32_bf16 a[172:175], v[220:223], v[172:175], a[172:175]
  s_add_u32 s52, s23, s24
  v_mfma_f32_16x16x32_bf16 a[168:171], v[212:215], v[172:175], a[168:171]
  s_add_u32 s26, s26, 7168
  v_mfma_f32_16x16x32_bf16 a[168:171], v[208:211], v[168:171], a[168:171]
  buffer_load_dwordx4 v4, s[4:7], s26 offen offset:3072 lds
  v_mfma_f32_16x16x32_bf16 a[200:203], v[208:211], v[176:179], a[200:203]
  v_add_u32 v5, 0xfffe0000, v5
  v_add_u32 v6, 0xfffe0000, v6
  v_mfma_f32_16x16x32_bf16 a[200:203], v[212:215], v[180:183], a[200:203]
  v_add_u32 v7, 0x10000, v7
  v_add_u32 v8, 0x10000, v8
  v_mfma_f32_16x16x32_bf16 a[204:207], v[220:223], v[180:183], a[204:207]
  v_add_u32 v9, 0x10000, v9
  v_add_u32 v10, 0x10000, v10
  v_mfma_f32_16x16x32_bf16 a[204:207], v[216:219], v[176:179], a[204:207]
  v_add_u32 v11, 0x10000, v11
  v_add_u32 v12, 0x10000, v12
  v_mfma_f32_16x16x32_bf16 a[236:239], v[216:219], v[184:187], a[236:239]
  v_add_u32 v13, 0x10000, v13
  v_add_u32 v14, 0x10000, v14
  v_mfma_f32_16x16x32_bf16 a[236:239], v[220:223], v[188:191], a[236:239]
  v_mfma_f32_16x16x32_bf16 a[232:235], v[212:215], v[188:191], a[232:235]
  v_mfma_f32_16x16x32_bf16 a[232:235], v[208:211], v[184:187], a[232:235]
  s_waitcnt vmcnt(7) lgkmcnt(0)
  s_barrier
  v_mfma_f32_16x16x32_bf16 a[16:19], v[224:227], v[128:131], a[16:19]
  s_add_u32 m0, s28, 131072
  ds_read_b64_tr_b16 v[192:193], v7 offset:0
  v_mfma_f32_16x16x32_bf16 a[16:19], v[228:231], v[132:135], a[16:19]
  s_add_u32 s27, s30, s32
  ds_read_b64_tr_b16 v[194:195], v7 offset:1024
  v_mfma_f32_16x16x32_bf16 a[20:23], v[236:239], v[132:135], a[20:23]
  buffer_load_dwordx4 v15, s[12:15], s27 offen lds
  v_mfma_f32_16x16x32_bf16 a[20:23], v[232:235], v[128:131], a[20:23]
  ds_read_b64_tr_b16 v[196:197], v7 offset:8192
  v_mfma_f32_16x16x32_bf16 a[52:55], v[232:235], v[136:139], a[52:55]
  s_add_u32 s32, s32, 524288
  ds_read_b64_tr_b16 v[198:199], v7 offset:9216
  v_mfma_f32_16x16x32_bf16 a[52:55], v[236:239], v[140:143], a[52:55]
  s_add_u32 s27, s27, 31744
  ds_read_b64_tr_b16 v[200:201], v8 offset:0
  v_mfma_f32_16x16x32_bf16 a[48:51], v[228:231], v[140:143], a[48:51]
  buffer_load_dwordx4 v15, s[12:15], s27 offen offset:1024 lds
  v_mfma_f32_16x16x32_bf16 a[48:51], v[224:227], v[136:139], a[48:51]
  ds_read_b64_tr_b16 v[202:203], v8 offset:1024
  v_mfma_f32_16x16x32_bf16 a[80:83], v[224:227], v[144:147], a[80:83]
  s_and_b32 s32, s32, 0x3fffff
  ds_read_b64_tr_b16 v[204:205], v8 offset:8192
  v_mfma_f32_16x16x32_bf16 a[80:83], v[228:231], v[148:151], a[80:83]
  s_add_u32 s27, s27, 31744
  ds_read_b64_tr_b16 v[206:207], v8 offset:9216
  v_mfma_f32_16x16x32_bf16 a[84:87], v[236:239], v[148:151], a[84:87]
  buffer_load_dwordx4 v16, s[12:15], s27 offen offset:2048 lds
  v_mfma_f32_16x16x32_bf16 a[84:87], v[232:235], v[144:147], a[84:87]
  ds_read_b64_tr_b16 v[208:209], v9 offset:0
  v_mfma_f32_16x16x32_bf16 a[116:119], v[232:235], v[152:155], a[116:119]
  ds_read_b64_tr_b16 v[210:211], v9 offset:1024
  v_mfma_f32_16x16x32_bf16 a[116:119], v[236:239], v[156:159], a[116:119]
  s_add_u32 s27, s27, 31744
  ds_read_b64_tr_b16 v[212:213], v9 offset:8192
  v_mfma_f32_16x16x32_bf16 a[112:115], v[228:231], v[156:159], a[112:115]
  buffer_load_dwordx4 v16, s[12:15], s27 offen offset:3072 lds
  v_mfma_f32_16x16x32_bf16 a[112:115], v[224:227], v[152:155], a[112:115]
  ds_read_b64_tr_b16 v[214:215], v9 offset:9216
  v_mfma_f32_16x16x32_bf16 a[144:147], v[224:227], v[160:163], a[144:147]
  s_add_u32 m0, s28, 135168
  ds_read_b64_tr_b16 v[216:217], v10 offset:0
  v_mfma_f32_16x16x32_bf16 a[144:147], v[228:231], v[164:167], a[144:147]
  s_add_u32 s27, s27, 35840
  ds_read_b64_tr_b16 v[218:219], v10 offset:1024
  v_mfma_f32_16x16x32_bf16 a[148:151], v[236:239], v[164:167], a[148:151]
  buffer_load_dwordx4 v15, s[12:15], s27 offen lds
  v_mfma_f32_16x16x32_bf16 a[148:151], v[232:235], v[160:163], a[148:151]
  ds_read_b64_tr_b16 v[220:221], v10 offset:8192
  v_mfma_f32_16x16x32_bf16 a[180:183], v[232:235], v[168:171], a[180:183]
  ds_read_b64_tr_b16 v[222:223], v10 offset:9216
  v_mfma_f32_16x16x32_bf16 a[180:183], v[236:239], v[172:175], a[180:183]
  s_add_u32 s27, s27, 31744
  v_mfma_f32_16x16x32_bf16 a[176:179], v[228:231], v[172:175], a[176:179]
  buffer_load_dwordx4 v15, s[12:15], s27 offen offset:1024 lds
  v_mfma_f32_16x16x32_bf16 a[176:179], v[224:227], v[168:171], a[176:179]
  s_bitcmp0_b32 s22, 0
  s_cbranch_scc1 L_s0_1
  s_cmp_lg_u32 s20, 0
  s_cbranch_scc1 L_nosig_2
  v_mov_b32 v22, s3
  s_mov_b64 exec, 1
  buffer_atomic_add v22, off, s[16:19], s35 sc1
  s_mov_b64 exec, -1
L_nosig_2:
L_s0_1:
  v_mfma_f32_16x16x32_bf16 a[208:211], v[224:227], v[176:179], a[208:211]
  v_mfma_f32_16x16x32_bf16 a[208:211], v[228:231], v[180:183], a[208:211]
  s_add_u32 s27, s27, 31744
  v_mfma_f32_16x16x32_bf16 a[212:215], v[236:239], v[180:183], a[212:215]
  buffer_load_dwordx4 v16, s[12:15], s27 offen offset:2048 lds
  v_mfma_f32_16x16x32_bf16 a[212:215], v[232:235], v[176:179], a[212:215]
  v_mfma_f32_16x16x32_bf16 a[244:247], v[232:235], v[184:187], a[244:247]
  v_mfma_f32_16x16x32_bf16 a[244:247], v[236:239], v[188:191], a[244:247]
  s_add_u32 s27, s27, 31744
  v_mfma_f32_16x16x32_bf16 a[240:243], v[228:231], v[188:191], a[240:243]
  buffer_load_dwordx4 v16, s[12:15], s27 offen offset:3072 lds
  v_mfma_f32_16x16x32_bf16 a[240:243], v[224:227], v[184:187], a[240:243]
  v_mfma_f32_16x16x32_bf16 a[24:27], v[240:243], v[128:131], a[24:27]
  buffer_load_dwordx4 v[32:35], v30, s[72:75], s52 offen
  v_mfma_f32_16x16x32_bf16 a[24:27], v[244:247], v[132:135], a[24:27]
  buffer_load_dwordx4 v[36:39], v25, s[72:75], s52 offen
  v_mfma_f32_16x16x32_bf16 a[28:31], v[252:255], v[132:135], a[28:31]
  v_mfma_f32_16x16x32_bf16 a[28:31], v[248:251], v[128:131], a[28:31]
  ds_read_b128 v[128:131], v5 offset:32768
  v_mfma_f32_16x16x32_bf16 a[60:63], v[248:251], v[136:139], a[60:63]
  ds_read_b128 v[132:135], v6 offset:32768
  v_mfma_f32_16x16x32_bf16 a[60:63], v[252:255], v[140:143], a[60:63]
  v_mfma_f32_16x16x32_bf16 a[56:59], v[244:247], v[140:143], a[56:59]
  v_mfma_f32_16x16x32_bf16 a[56:59], v[240:243], v[136:139], a[56:59]
  ds_read_b128 v[136:139], v5 offset:34816
  v_mfma_f32_16x16x32_bf16 a[88:91], v[240:243], v[144:147], a[88:91]
  ds_read_b128 v[140:143], v6 offset:34816
  v_mfma_f32_16x16x32_bf16 a[88:91], v[244:247], v[148:151], a[88:91]
  v_mfma_f32_16x16x32_bf16 a[92:95], v[252:255], v[148:151], a[92:95]
  v_mfma_f32_16x16x32_bf16 a[92:95], v[248:251], v[144:147], a[92:95]
  ds_read_b128 v[144:147], v5 offset:36864
  v_mfma_f32_16x16x32_bf16 a[124:127], v[248:251], v[152:155], a[124:127]
  ds_read_b128 v[148:151], v6 offset:36864
  v_mfma_f32_16x16x32_bf16 a[124:127], v[252:255], v[156:159], a[124:127]
  v_mfma_f32_16x16x32_bf16 a[120:123], v[244:247], v[156:159], a[120:123]
  v_mfma_f32_16x16x32_bf16 a[120:123], v[240:243], v[152:155], a[120:123]
  ds_read_b128 v[152:155], v5 offset:38912
  v_mfma_f32_16x16x32_bf16 a[152:155], v[240:243], v[160:163], a[152:155]
  ds_read_b128 v[156:159], v6 offset:38912
  v_mfma_f32_16x16x32_bf16 a[152:155], v[244:247], v[164:167], a[152:155]
  v_mfma_f32_16x16x32_bf16 a[156:159], v[252:255], v[164:167], a[156:159]
  v_mfma_f32_16x16x32_bf16 a[156:159], v[248:251], v[160:163], a[156:159]
  ds_read_b128 v[160:163], v5 offset:40960
  v_mfma_f32_16x16x32_bf16 a[188:191], v[248:251], v[168:171], a[188:191]
  ds_read_b128 v[164:167], v6 offset:40960
  v_mfma_f32_16x16x32_bf16 a[188:191], v[252:255], v[172:175], a[188:191]
  v_mfma_f32_16x16x32_bf16 a[184:187], v[244:247], v[172:175], a[184:187]
  v_mfma_f32_16x16x32_bf16 a[184:187], v[240:243], v[168:171], a[184:187]
  ds_read_b128 v[168:171], v5 offset:43008
  v_mfma_f32_16x16x32_bf16 a[216:219], v[240:243], v[176:179], a[216:219]
  ds_read_b128 v[172:175], v6 offset:43008
  v_mfma_f32_16x16x32_bf16 a[216:219], v[244:247], v[180:183], a[216:219]
  v_mfma_f32_16x16x32_bf16 a[220:223], v[252:255], v[180:183], a[220:223]
  v_mfma_f32_16x16x32_bf16 a[220:223], v[248:251], v[176:179], a[220:223]
  ds_read_b128 v[176:179], v5 offset:45056
  v_mfma_f32_16x16x32_bf16 a[252:255], v[248:251], v[184:187], a[252:255]
  ds_read_b128 v[180:183], v6 offset:45056
  v_mfma_f32_16x16x32_bf16 a[252:255], v[252:255], v[188:191], a[252:255]
  v_mfma_f32_16x16x32_bf16 a[248:251], v[244:247], v[188:191], a[248:251]
  v_mfma_f32_16x16x32_bf16 a[248:251], v[240:243], v[184:187], a[248:251]
  s_waitcnt lgkmcnt(10)
  v_mfma_f32_16x16x32_bf16 a[0:3], v[192:195], v[128:131], a[0:3]
  ds_read_b128 v[184:187], v5 offset:47104
  v_mfma_f32_16x16x32_bf16 a[0:3], v[196:199], v[132:135], a[0:3]
  ds_read_b128 v[188:191], v6 offset:47104
  v_mfma_f32_16x16x32_bf16 a[4:7], v[204:207], v[132:135], a[4:7]
  ds_read_b64_tr_b16 v[224:225], v11 offset:0
  v_mfma_f32_16x16x32_bf16 a[4:7], v[200:203], v[128:131], a[4:7]
  v_mfma_f32_16x16x32_bf16 a[36:39], v[200:203], v[136:139], a[36:39]
  s_add_u32 m0, s28, 0
  ds_read_b64_tr_b16 v[226:227], v11 offset:1024
  v_mfma_f32_16x16x32_bf16 a[36:39], v[204:207], v[140:143], a[36:39]
  s_add_u32 s26, s29, s31
  v_mfma_f32_16x16x32_bf16 a[32:35], v[196:199], v[140:143], a[32:35]
  buffer_load_dwordx4 v3, s[4:7], s26 offen lds
  v_mfma_f32_16x16x32_bf16 a[32:35], v[192:195], v[136:139], a[32:35]
  s_waitcnt lgkmcnt(10)
  ds_read_b64_tr_b16 v[228:229], v11 offset:8192
  v_mfma_f32_16x16x32_bf16 a[64:67], v[192:195], v[144:147], a[64:67]
  s_bitcmp1_b32 s22, 0
  s_cbranch_scc1 L_s0_3
  s_cmp_lg_u32 s20, 0
  s_cbranch_scc1 L_nosig_4
  v_mov_b32 v22, s3
  s_mov_b64 exec, 1
  buffer_atomic_add v22, off, s[16:19], s35 sc1
  s_mov_b64 exec, -1
L_nosig_4:
L_s0_3:
  v_mfma_f32_16x16x32_bf16 a[64:67], v[196:199], v[148:151], a[64:67]
  ds_read_b64_tr_b16 v[230:231], v11 offset:9216
  v_mfma_f32_16x16x32_bf16 a[68:71], v[204:207], v[148:151], a[68:71]
  v_mfma_f32_16x16x32_bf16 a[68:71], v[200:203], v[144:147], a[68:71]
  s_add_u32 s31, s31, 128
  ds_read_b64_tr_b16 v[232:233], v12 offset:0
  v_mfma_f32_16x16x32_bf16 a[100:103], v[200:203], v[152:155], a[100:103]
  s_add_u32 s26, s26, 7168
  v_mfma_f32_16x16x32_bf16 a[100:103], v[204:207], v[156:159], a[100:103]
  buffer_load_dwordx4 v4, s[4:7], s26 offen offset:1024 lds
  v_mfma_f32_16x16x32_bf16 a[96:99], v[196:199], v[156:159], a[96:99]
  ds_read_b64_tr_b16 v[234:235], v12 offset:1024
  v_mfma_f32_16x16x32_bf16 a[96:99], v[192:195], v[152:155], a[96:99]
  s_waitcnt lgkmcnt(10)
  v_mfma_f32_16x16x32_bf16 a[128:131], v[192:195], v[160:163], a[128:131]
  ds_read_b64_tr_b16 v[236:237], v12 offset:8192
  v_mfma_f32_16x16x32_bf16 a[128:131], v[196:199], v[164:167], a[128:131]
  v_mfma_f32_16x16x32_bf16 a[132:135], v[204:207], v[164:167], a[132:135]
  s_and_b32 s31, s31, 0x3ff
  ds_read_b64_tr_b16 v[238:239], v12 offset:9216
  v_mfma_f32_16x16x32_bf16 a[132:135], v[200:203], v[160:163], a[132:135]
  s_add_u32 s26, s26, 7168
  v_mfma_f32_16x16x32_bf16 a[164:167], v[200:203], v[168:171], a[164:167]
  buffer_load_dwordx4 v3, s[4:7], s26 offen offset:2048 lds
  v_mfma_f32_16x16x32_bf16 a[164:167], v[204:207], v[172:175], a[164:167]
  ds_read_b64_tr_b16 v[240:241], v13 offset:0
  v_mfma_f32_16x16x32_bf16 a[160:163], v[196:199], v[172:175], a[160:163]
  v_mfma_f32_16x16x32_bf16 a[160:163], v[192:195], v[168:171], a[160:163]
  s_waitcnt lgkmcnt(9)
  ds_read_b64_tr_b16 v[242:243], v13 offset:1024
  v_mfma_f32_16x16x32_bf16 a[192:195], v[192:195], v[176:179], a[192:195]
  v_mfma_f32_16x16x32_bf16 a[192:195], v[196:199], v[180:183], a[192:195]
  ds_read_b64_tr_b16 v[244:245], v13 offset:8192
  v_mfma_f32_16x16x32_bf16 a[196:199], v[204:207], v[180:183], a[196:199]
  v_mfma_f32_16x16x32_bf16 a[196:199], v[200:203], v[176:179], a[196:199]
  s_add_u32 s26, s26, 7168
  ds_read_b64_tr_b16 v[246:247], v13 offset:9216
  v_mfma_f32_16x16x32_bf16 a[228:231], v[200:203], v[184:187], a[228:231]
  buffer_load_dwordx4 v4, s[4:7], s26 offen offset:3072 lds
  v_mfma_f32_16x16x32_bf16 a[228:231], v[204:207], v[188:191], a[228:231]
  ds_read_b64_tr_b16 v[248:249], v14 offset:0
  v_mfma_f32_16x16x32_bf16 a[224:227], v[196:199], v[188:191], a[224:227]
  v_mfma_f32_16x16x32_bf16 a[224:227], v[192:195], v[184:187], a[224:227]
  ds_read_b64_tr_b16 v[250:251], v14 offset:1024
  v_mfma_f32_16x16x32_bf16 a[8:11], v[208:211], v[128:131], a[8:11]
  s_add_u32 m0, s28, 4096
  v_mfma_f32_16x16x32_bf16 a[8:11], v[212:215], v[132:135], a[8:11]
  s_add_u32 s26, s26, 502784
  ds_read_b64_tr_b16 v[252:253], v14 offset:8192
  v_mfma_f32_16x16x32_bf16 a[12:15], v[220:223], v[132:135], a[12:15]
  buffer_load_dwordx4 v3, s[4:7], s26 offen lds
  v_mfma_f32_16x16x32_bf16 a[12:15], v[216:219], v[128:131], a[12:15]
  ds_read_b64_tr_b16 v[254:255], v14 offset:9216
  v_mfma_f32_16x16x32_bf16 a[44:47], v[216:219], v[136:139], a[44:47]
  v_mfma_f32_16x16x32_bf16 a[44:47], v[220:223], v[140:143], a[44:47]
  v_mfma_f32_16x16x32_bf16 a[40:43], v[212:215], v[140:143], a[40:43]
  v_mfma_f32_16x16x32_bf16 a[40:43], v[208:211], v[136:139], a[40:43]
  v_mfma_f32_16x16x32_bf16 a[72:75], v[208:211], v[144:147], a[72:75]
  s_add_u32 s26, s26, 7168
  v_mfma_f32_16x16x32_bf16 a[72:75], v[212:215], v[148:151], a[72:75]
  buffer_load_dwordx4 v4, s[4:7], s26 offen offset:1024 lds
  v_mfma_f32_16x16x32_bf16 a[76:79], v[220:223], v[148:151], a[76:79]
  s_lshl_b32 s23, s2, 1
  v_mfma_f32_16x16x32_bf16 a[76:79], v[216:219], v[144:147], a[76:79]
  s_and_b32 s24, s20, 1
  v_mfma_f32_16x16x32_bf16 a[108:111], v[216:219], v[152:155], a[108:111]
  s_add_u32 s23, s23, s24
  v_mfma_f32_16x16x32_bf16 a[108:111], v[220:223], v[156:159], a[108:111]
  s_add_u32 s23, s23, 512
  v_mfma_f32_16x16x32_bf16 a[104:107], v[212:215], v[156:159], a[104:107]
  s_lshl_b32 s65, s23, 11
  v_mfma_f32_16x16x32_bf16 a[104:107], v[208:211], v[152:155], a[104:107]
  s_add_u32 s26, s26, 7168
  v_mfma_f32_16x16x32_bf16 a[136:139], v[208:211], v[160:163], a[136:139]
  buffer_load_dwordx4 v3, s[4:7], s26 offen offset:2048 lds
  v_mfma_f32_16x16x32_bf16 a[136:139], v[212:215], v[164:167], a[136:139]
  s_add_u32 s65, s65, 58720256
  v_mfma_f32_16x16x32_bf16 a[140:143], v[220:223], v[164:167], a[140:143]
  s_min_u32 s23, s23, 687
  v_mfma_f32_16x16x32_bf16 a[140:143], v[216:219], v[160:163], a[140:143]
  s_mul_i32 s24, s23, 1525
  v_mfma_f32_16x16x32_bf16 a[172:175], v[216:219], v[168:171], a[172:175]
  s_lshr_b32 s24, s24, 16
  v_mfma_f32_16x16x32_bf16 a[172:175], v[220:223], v[172:175], a[172:175]
  s_mul_i32 s24, s24, 85312
  v_mfma_f32_16x16x32_bf16 a[168:171], v[212:215], v[172:175], a[168:171]
  s_add_u32 s26, s26, 7168
  v_mfma_f32_16x16x32_bf16 a[168:171], v[208:211], v[168:171], a[168:171]
  buffer_load_dwordx4 v4, s[4:7], s26 offen offset:3072 lds
  v_mfma_f32_16x16x32_bf16 a[200:203], v[208:211], v[176:179], a[200:203]
  s_lshl_b32 s23, s23, 6
  v_add_u32 v5, 0x10000, v5
  v_add_u32 v6, 0x10000, v6
  v_mfma_f32_16x16x32_bf16 a[200:203], v[212:215], v[180:183], a[200:203]
  s_add_u32 s53, s23, s24
  v_add_u32 v7, 0x10000, v7
  v_add_u32 v8, 0x10000, v8
  v_mfma_f32_16x16x32_bf16 a[204:207], v[220:223], v[180:183], a[204:207]
  v_add_u32 v9, 0x10000, v9
  v_add_u32 v10, 0x10000, v10
  v_mfma_f32_16x16x32_bf16 a[204:207], v[216:219], v[176:179], a[204:207]
  v_add_u32 v11, 0x10000, v11
  v_add_u32 v12, 0x10000, v12
  v_mfma_f32_16x16x32_bf16 a[236:239], v[216:219], v[184:187], a[236:239]
  v_add_u32 v13, 0x10000, v13
  v_add_u32 v14, 0x10000, v14
  v_mfma_f32_16x16x32_bf16 a[236:239], v[220:223], v[188:191], a[236:239]
  v_mfma_f32_16x16x32_bf16 a[232:235], v[212:215], v[188:191], a[232:235]
  v_mfma_f32_16x16x32_bf16 a[232:235], v[208:211], v[184:187], a[232:235]
  s_waitcnt vmcnt(10) lgkmcnt(0)
  s_barrier
  v_mfma_f32_16x16x32_bf16 a[16:19], v[224:227], v[128:131], a[16:19]
  s_add_u32 m0, s28, 32768
  ds_read_b64_tr_b16 v[192:193], v7 offset:0
  v_mfma_f32_16x16x32_bf16 a[16:19], v[228:231], v[132:135], a[16:19]
  s_add_u32 s27, s30, s32
  ds_read_b64_tr_b16 v[194:195], v7 offset:1024
  v_mfma_f32_16x16x32_bf16 a[20:23], v[236:239], v[132:135], a[20:23]
  buffer_load_dwordx4 v15, s[12:15], s27 offen lds
  v_mfma_f32_16x16x32_bf16 a[20:23], v[232:235], v[128:131], a[20:23]
  ds_read_b64_tr_b16 v[196:197], v7 offset:8192
  v_mfma_f32_16x16x32_bf16 a[52:55], v[232:235], v[136:139], a[52:55]
  s_add_u32 s32, s32, 524288
  ds_read_b64_tr_b16 v[198:199], v7 offset:9216
  v_mfma_f32_16x16x32_bf16 a[52:55], v[236:239], v[140:143], a[52:55]
  s_add_u32 s27, s27, 31744
  ds_read_b64_tr_b16 v[200:201], v8 offset:0
  v_mfma_f32_16x16x32_bf16 a[48:51], v[228:231], v[140:143], a[48:51]
  buffer_load_dwordx4 v15, s[12:15], s27 offen offset:1024 lds
  v_mfma_f32_16x16x32_bf16 a[48:51], v[224:227], v[136:139], a[48:51]
  ds_read_b64_tr_b16 v[202:203], v8 offset:1024
  v_mfma_f32_16x16x32_bf16 a[80:83], v[224:227], v[144:147], a[80:83]
  s_and_b32 s32, s32, 0x3fffff
  ds_read_b64_tr_b16 v[204:205], v8 offset:8192
  v_mfma_f32_16x16x32_bf16 a[80:83], v[228:231], v[148:151], a[80:83]
  s_add_u32 s27, s27, 31744
  ds_read_b64_tr_b16 v[206:207], v8 offset:9216
  v_mfma_f32_16x16x32_bf16 a[84:87], v[236:239], v[148:151], a[84:87]
  buffer_load_dwordx4 v16, s[12:15], s27 offen offset:2048 lds
  v_mfma_f32_16x16x32_bf16 a[84:87], v[232:235], v[144:147], a[84:87]
  ds_read_b64_tr_b16 v[208:209], v9 offset:0
  v_mfma_f32_16x16x32_bf16 a[116:119], v[232:235], v[152:155], a[116:119]
  ds_read_b64_tr_b16 v[210:211], v9 offset:1024
  v_mfma_f32_16x16x32_bf16 a[116:119], v[236:239], v[156:159], a[116:119]
  s_add_u32 s27, s27, 31744
  ds_read_b64_tr_b16 v[212:213], v9 offset:8192
  v_mfma_f32_16x16x32_bf16 a[112:115], v[228:231], v[156:159], a[112:115]
  buffer_load_dwordx4 v16, s[12:15], s27 offen offset:3072 lds
  v_mfma_f32_16x16x32_bf16 a[112:115], v[224:227], v[152:155], a[112:115]
  ds_read_b64_tr_b16 v[214:215], v9 offset:9216
  v_mfma_f32_16x16x32_bf16 a[144:147], v[224:227], v[160:163], a[144:147]
  s_add_u32 m0, s28, 36864
  ds_read_b64_tr_b16 v[216:217], v10 offset:0
  v_mfma_f32_16x16x32_bf16 a[144:147], v[228:231], v[164:167], a[144:147]
  s_add_u32 s27, s27, 35840
  ds_read_b64_tr_b16 v[218:219], v10 offset:1024
  v_mfma_f32_16x16x32_bf16 a[148:151], v[236:239], v[164:167], a[148:151]
  buffer_load_dwordx4 v15, s[12:15], s27 offen lds
  v_mfma_f32_16x16x32_bf16 a[148:151], v[232:235], v[160:163], a[148:151]
  ds_read_b64_tr_b16 v[220:221], v10 offset:8192
  v_mfma_f32_16x16x32_bf16 a[180:183], v[232:235], v[168:171], a[180:183]
  ds_read_b64_tr_b16 v[222:223], v10 offset:9216
  v_mfma_f32_16x16x32_bf16 a[180:183], v[236:239], v[172:175], a[180:183]
  s_add_u32 s27, s27, 31744
  v_mfma_f32_16x16x32_bf16 a[176:179], v[228:231], v[172:175], a[176:179]
  buffer_load_dwordx4 v15, s[12:15], s27 offen offset:1024 lds
  v_mfma_f32_16x16x32_bf16 a[176:179], v[224:227], v[168:171], a[176:179]
  v_mfma_f32_16x16x32_bf16 a[208:211], v[224:227], v[176:179], a[208:211]
  v_mfma_f32_16x16x32_bf16 a[208:211], v[228:231], v[180:183], a[208:211]
  s_add_u32 s27, s27, 31744
  v_mfma_f32_16x16x32_bf16 a[212:215], v[236:239], v[180:183], a[212:215]
  buffer_load_dwordx4 v16, s[12:15], s27 offen offset:2048 lds
  v_mfma_f32_16x16x32_bf16 a[212:215], v[232:235], v[176:179], a[212:215]
  v_mfma_f32_16x16x32_bf16 a[244:247], v[232:235], v[184:187], a[244:247]
  v_mfma_f32_16x16x32_bf16 a[244:247], v[236:239], v[188:191], a[244:247]
  s_add_u32 s27, s27, 31744
  v_mfma_f32_16x16x32_bf16 a[240:243], v[228:231], v[188:191], a[240:243]
  buffer_load_dwordx4 v16, s[12:15], s27 offen offset:3072 lds
  v_mfma_f32_16x16x32_bf16 a[240:243], v[224:227], v[184:187], a[240:243]
  v_mfma_f32_16x16x32_bf16 a[24:27], v[240:243], v[128:131], a[24:27]
  buffer_load_dwordx4 v[40:43], v30, s[72:75], s53 offen
  v_mfma_f32_16x16x32_bf16 a[24:27], v[244:247], v[132:135], a[24:27]
  buffer_load_dwordx4 v[44:47], v25, s[72:75], s53 offen
  v_mfma_f32_16x16x32_bf16 a[28:31], v[252:255], v[132:135], a[28:31]
  v_mfma_f32_16x16x32_bf16 a[28:31], v[248:251], v[128:131], a[28:31]
  ds_read_b128 v[128:131], v5 offset:32768
  v_mfma_f32_16x16x32_bf16 a[60:63], v[248:251], v[136:139], a[60:63]
  ds_read_b128 v[132:135], v6 offset:32768
  v_mfma_f32_16x16x32_bf16 a[60:63], v[252:255], v[140:143], a[60:63]
  v_mfma_f32_16x16x32_bf16 a[56:59], v[244:247], v[140:143], a[56:59]
  v_mfma_f32_16x16x32_bf16 a[56:59], v[240:243], v[136:139], a[56:59]
  ds_read_b128 v[136:139], v5 offset:34816
  v_mfma_f32_16x16x32_bf16 a[88:91], v[240:243], v[144:147], a[88:91]
  ds_read_b128 v[140:143], v6 offset:34816
  v_mfma_f32_16x16x32_bf16 a[88:91], v[244:247], v[148:151], a[88:91]
  s_cmp_ge_u32 s65, 60129280
  s_cselect_b32 s65, 0x7ff00000, s65
  v_mfma_f32_16x16x32_bf16 a[92:95], v[252:255], v[148:151], a[92:95]
  v_mfma_f32_16x16x32_bf16 a[92:95], v[248:251], v[144:147], a[92:95]
  ds_read_b128 v[144:147], v5 offset:36864
  v_mfma_f32_16x16x32_bf16 a[124:127], v[248:251], v[152:155], a[124:127]
  ds_read_b128 v[148:151], v6 offset:36864
  v_mfma_f32_16x16x32_bf16 a[124:127], v[252:255], v[156:159], a[124:127]
  v_mfma_f32_16x16x32_bf16 a[120:123], v[244:247], v[156:159], a[120:123]
  v_mfma_f32_16x16x32_bf16 a[120:123], v[240:243], v[152:155], a[120:123]
  ds_read_b128 v[152:155], v5 offset:38912
  v_mfma_f32_16x16x32_bf16 a[152:155], v[240:243], v[160:163], a[152:155]
  ds_read_b128 v[156:159], v6 offset:38912
  v_mfma_f32_16x16x32_bf16 a[152:155], v[244:247], v[164:167], a[152:155]
  v_mfma_f32_16x16x32_bf16 a[156:159], v[252:255], v[164:167], a[156:159]
  v_mfma_f32_16x16x32_bf16 a[156:159], v[248:251], v[160:163], a[156:159]
  ds_read_b128 v[160:163], v5 offset:40960
  v_mfma_f32_16x16x32_bf16 a[188:191], v[248:251], v[168:171], a[188:191]
  ds_read_b128 v[164:167], v6 offset:40960
  v_mfma_f32_16x16x32_bf16 a[188:191], v[252:255], v[172:175], a[188:191]
  v_mfma_f32_16x16x32_bf16 a[184:187], v[244:247], v[172:175], a[184:187]
  v_mfma_f32_16x16x32_bf16 a[184:187], v[240:243], v[168:171], a[184:187]
  ds_read_b128 v[168:171], v5 offset:43008
  v_mfma_f32_16x16x32_bf16 a[216:219], v[240:243], v[176:179], a[216:219]
  ds_read_b128 v[172:175], v6 offset:43008
  v_mfma_f32_16x16x32_bf16 a[216:219], v[244:247], v[180:183], a[216:219]
  v_mfma_f32_16x16x32_bf16 a[220:223], v[252:255], v[180:183], a[220:223]
  v_mfma_f32_16x16x32_bf16 a[220:223], v[248:251], v[176:179], a[220:223]
  ds_read_b128 v[176:179], v5 offset:45056
  v_mfma_f32_16x16x32_bf16 a[252:255], v[248:251], v[184:187], a[252:255]
  ds_read_b128 v[180:183], v6 offset:45056
  v_mfma_f32_16x16x32_bf16 a[252:255], v[252:255], v[188:191], a[252:255]
  v_mfma_f32_16x16x32_bf16 a[248:251], v[244:247], v[188:191], a[248:251]
  v_mfma_f32_16x16x32_bf16 a[248:251], v[240:243], v[184:187], a[248:251]
  s_waitcnt lgkmcnt(10)
  v_mfma_f32_16x16x32_bf16 a[0:3], v[192:195], v[128:131], a[0:3]
  s_lshl_b32 s23, s20, 18
  ds_read_b128 v[184:187], v5 offset:47104
  v_mfma_f32_16x16x32_bf16 a[0:3], v[196:199], v[132:135], a[0:3]
  s_lshl_b32 s24, s21, 8
  ds_read_b128 v[188:191], v6 offset:47104
  v_mfma_f32_16x16x32_bf16 a[4:7], v[204:207], v[132:135], a[4:7]
  s_add_u32 s23, s23, s24
  ds_read_b64_tr_b16 v[224:225], v11 offset:0
  v_mfma_f32_16x16x32_bf16 a[4:7], v[200:203], v[128:131], a[4:7]
  s_lshl_b32 s24, s22, 15
  v_mfma_f32_16x16x32_bf16 a[36:39], v[200:203], v[136:139], a[36:39]
  s_add_u32 m0, s28, 65536
  ds_read_b64_tr_b16 v[226:227], v11 offset:1024
  v_mfma_f32_16x16x32_bf16 a[36:39], v[204:207], v[140:143], a[36:39]
  s_add_u32 s26, s29, s31
  v_mfma_f32_16x16x32_bf16 a[32:35], v[196:199], v[140:143], a[32:35]
  buffer_load_dwordx4 v3, s[4:7], s26 offen lds
  v_mfma_f32_16x16x32_bf16 a[32:35], v[192:195], v[136:139], a[32:35]
  s_waitcnt lgkmcnt(10)
  ds_read_b64_tr_b16 v[228:229], v11 offset:8192
  v_mfma_f32_16x16x32_bf16 a[64:67], v[192:195], v[144:147], a[64:67]
  s_add_u32 s23, s23, s24
  v_mfma_f32_16x16x32_bf16 a[64:67], v[196:199], v[148:151], a[64:67]
  ds_read_b64_tr_b16 v[230:231], v11 offset:9216
  v_mfma_f32_16x16x32_bf16 a[68:71], v[204:207], v[148:151], a[68:71]
  s_waitcnt vmcnt(19)
  v_mfma_f32_16x16x32_bf16 v[112:115], v[32:35], v[48:51], 0
  v_mfma_f32_16x16x32_bf16 v[116:119], v[36:39], v[48:51], 0
  v_mfma_f32_16x16x32_bf16 v[120:123], v[32:35], v[52:55], 0
  v_mfma_f32_16x16x32_bf16 v[124:127], v[36:39], v[52:55], 0
  v_mfma_f32_16x16x32_bf16 a[68:71], v[200:203], v[144:147], a[68:71]
  s_add_u32 s31, s31, 128
  ds_read_b64_tr_b16 v[232:233], v12 offset:0
  v_mfma_f32_16x16x32_bf16 a[100:103], v[200:203], v[152:155], a[100:103]
  s_add_u32 s26, s26, 7168
  v_mfma_f32_16x16x32_bf16 a[100:103], v[204:207], v[156:159], a[100:103]
  buffer_load_dwordx4 v4, s[4:7], s26 offen offset:1024 lds
  v_mfma_f32_16x16x32_bf16 a[96:99], v[196:199], v[156:159], a[96:99]
  ds_read_b64_tr_b16 v[234:235], v12 offset:1024
  v_mfma_f32_16x16x32_bf16 a[96:99], v[192:195], v[152:155], a[96:99]
  s_waitcnt lgkmcnt(10)
  v_cvt_pk_bf16_f32 v56, v112, v113
  v_cvt_pk_bf16_f32 v57, v114, v115
  v_mfma_f32_16x16x32_bf16 a[128:131], v[192:195], v[160:163], a[128:131]
  ds_read_b64_tr_b16 v[236:237], v12 offset:8192
  v_cvt_pk_bf16_f32 v58, v116, v117
  v_mfma_f32_16x16x32_bf16 a[128:131], v[196:199], v[164:167], a[128:131]
  v_cvt_pk_bf16_f32 v59, v118, v119
  v_mfma_f32_16x16x32_bf16 a[132:135], v[204:207], v[164:167], a[132:135]
  s_and_b32 s31, s31, 0x3ff
  ds_read_b64_tr_b16 v[238:239], v12 offset:9216
  v_mfma_f32_16x16x32_bf16 a[132:135], v[200:203], v[160:163], a[132:135]
  s_add_u32 s26, s26, 7168
  v_mfma_f32_16x16x32_bf16 a[164:167], v[200:203], v[168:171], a[164:167]
  buffer_load_dwordx4 v3, s[4:7], s26 offen offset:2048 lds
  v_mfma_f32_16x16x32_bf16 a[164:167], v[204:207], v[172:175], a[164:167]
  ds_read_b64_tr_b16 v[240:241], v13 offset:0
  v_mfma_f32_16x16x32_bf16 a[160:163], v[196:199], v[172:175], a[160:163]
  buffer_store_dwordx4 v[56:59], v2, s[8:11], s64 offen sc1
  v_mfma_f32_16x16x32_bf16 a[160:163], v[192:195], v[168:171], a[160:163]
  s_waitcnt lgkmcnt(9)
  ds_read_b64_tr_b16 v[242:243], v13 offset:1024
  v_cvt_pk_bf16_f32 v60, v120, v121
  v_mfma_f32_16x16x32_bf16 a[192:195], v[192:195], v[176:179], a[192:195]
  v_cvt_pk_bf16_f32 v61, v122, v123
  v_cvt_pk_bf16_f32 v62, v124, v125
  v_mfma_f32_16x16x32_bf16 a[192:195], v[196:199], v[180:183], a[192:195]
  ds_read_b64_tr_b16 v[244:245], v13 offset:8192
  v_cvt_pk_bf16_f32 v63, v126, v127
  v_mfma_f32_16x16x32_bf16 a[196:199], v[204:207], v[180:183], a[196:199]
  buffer_store_dwordx4 v[60:63], v2, s[8:11], s64 offen offset:1024 sc1
  v_mfma_f32_16x16x32_bf16 a[196:199], v[200:203], v[176:179], a[196:199]
  s_add_u32 s26, s26, 7168
  ds_read_b64_tr_b16 v[246:247], v13 offset:9216
  v_mfma_f32_16x16x32_bf16 a[228:231], v[200:203], v[184:187], a[228:231]
  buffer_load_dwordx4 v4, s[4:7], s26 offen offset:3072 lds
  v_mfma_f32_16x16x32_bf16 a[228:231], v[204:207], v[188:191], a[228:231]
  ds_read_b64_tr_b16 v[248:249], v14 offset:0
  v_bfe_u32 v23, v1, 1, 2
  v_mfma_f32_16x16x32_bf16 a[224:227], v[196:199], v[188:191], a[224:227]
  v_lshlrev_b32 v23, 13, v23
  v_and_b32 v24, 1, v1
  v_mfma_f32_16x16x32_bf16 a[224:227], v[192:195], v[184:187], a[224:227]
  ds_read_b64_tr_b16 v[250:251], v14 offset:1024
  v_lshl_add_u32 v23, v24, 7, v23
  v_mfma_f32_16x16x32_bf16 a[8:11], v[208:211], v[128:131], a[8:11]
  s_add_u32 m0, s28, 69632
  v_bfe_u32 v24, v1, 3, 2
  v_lshlrev_b32 v24, 20, v24
  v_mfma_f32_16x16x32_bf16 a[8:11], v[212:215], v[132:135], a[8:11]
  s_add_u32 s26, s26, 502784
  ds_read_b64_tr_b16 v[252:253], v14 offset:8192
  v_add3_u32 v24, v24, v23, s23
  v_mfma_f32_16x16x32_bf16 a[12:15], v[220:223], v[132:135], a[12:15]
  buffer_load_dwordx4 v3, s[4:7], s26 offen lds
  v_mfma_f32_16x16x32_bf16 a[12:15], v[216:219], v[128:131], a[12:15]
  ds_read_b64_tr_b16 v[254:255], v14 offset:9216
  v_mfma_f32_16x16x32_bf16 a[44:47], v[216:219], v[136:139], a[44:47]
  v_mfma_f32_16x16x32_bf16 a[44:47], v[220:223], v[140:143], a[44:47]
  v_mfma_f32_16x16x32_bf16 a[40:43], v[212:215], v[140:143], a[40:43]
  v_mfma_f32_16x16x32_bf16 a[40:43], v[208:211], v[136:139], a[40:43]
  v_mfma_f32_16x16x32_bf16 a[72:75], v[208:211], v[144:147], a[72:75]
  s_add_u32 s26, s26, 7168
  v_mfma_f32_16x16x32_bf16 a[72:75], v[212:215], v[148:151], a[72:75]
  buffer_load_dwordx4 v4, s[4:7], s26 offen offset:1024 lds
  v_mfma_f32_16x16x32_bf16 a[76:79], v[220:223], v[148:151], a[76:79]
  v_mfma_f32_16x16x32_bf16 a[76:79], v[216:219], v[144:147], a[76:79]
  v_mfma_f32_16x16x32_bf16 a[108:111], v[216:219], v[152:155], a[108:111]
  v_mfma_f32_16x16x32_bf16 a[108:111], v[220:223], v[156:159], a[108:111]
  v_mfma_f32_16x16x32_bf16 a[104:107], v[212:215], v[156:159], a[104:107]
  v_mfma_f32_16x16x32_bf16 a[104:107], v[208:211], v[152:155], a[104:107]
  s_add_u32 s26, s26, 7168
  v_mfma_f32_16x16x32_bf16 a[136:139], v[208:211], v[160:163], a[136:139]
  buffer_load_dwordx4 v3, s[4:7], s26 offen offset:2048 lds
  v_mfma_f32_16x16x32_bf16 a[136:139], v[212:215], v[164:167], a[136:139]
  v_mfma_f32_16x16x32_bf16 a[140:143], v[220:223], v[164:167], a[140:143]
  v_mfma_f32_16x16x32_bf16 a[140:143], v[216:219], v[160:163], a[140:143]
  v_mfma_f32_16x16x32_bf16 a[172:175], v[216:219], v[168:171], a[172:175]
  v_mfma_f32_16x16x32_bf16 a[172:175], v[220:223], v[172:175], a[172:175]
  v_mfma_f32_16x16x32_bf16 a[168:171], v[212:215], v[172:175], a[168:171]
  s_add_u32 s26, s26, 7168
  v_mfma_f32_16x16x32_bf16 a[168:171], v[208:211], v[168:171], a[168:171]
  buffer_load_dwordx4 v4, s[4:7], s26 offen offset:3072 lds
  v_mfma_f32_16x16x32_bf16 a[200:203], v[208:211], v[176:179], a[200:203]
  v_add_u32 v5, 0xffff0000, v5
  v_add_u32 v6, 0xffff0000, v6
  v_mfma_f32_16x16x32_bf16 a[200:203], v[212:215], v[180:183], a[200:203]
  v_add_u32 v7, 0xfffe0000, v7
  v_add_u32 v8, 0xfffe0000, v8
  v_mfma_f32_16x16x32_bf16 a[204:207], v[220:223], v[180:183], a[204:207]
  v_add_u32 v9, 0xfffe0000, v9
  v_add_u32 v10, 0xfffe0000, v10
  v_mfma_f32_16x16x32_bf16 a[204:207], v[216:219], v[176:179], a[204:207]
  v_add_u32 v11, 0xfffe0000, v11
  v_add_u32 v12, 0xfffe0000, v12
  v_mfma_f32_16x16x32_bf16 a[236:239], v[216:219], v[184:187], a[236:239]
  v_add_u32 v13, 0xfffe0000, v13
  v_add_u32 v14, 0xfffe0000, v14
  v_mfma_f32_16x16x32_bf16 a[236:239], v[220:223], v[188:191], a[236:239]
  v_mfma_f32_16x16x32_bf16 a[232:235], v[212:215], v[188:191], a[232:235]
  v_mfma_f32_16x16x32_bf16 a[232:235], v[208:211], v[184:187], a[232:235]
  s_waitcnt vmcnt(12) lgkmcnt(0)
  s_barrier
  v_mfma_f32_16x16x32_bf16 a[16:19], v[224:227], v[128:131], a[16:19]
  s_add_u32 m0, s28, 98304
  ds_read_b64_tr_b16 v[192:193], v7 offset:32768
  v_mfma_f32_16x16x32_bf16 a[16:19], v[228:231], v[132:135], a[16:19]
  s_add_u32 s27, s30, s32
  ds_read_b64_tr_b16 v[194:195], v7 offset:33792
  v_mfma_f32_16x16x32_bf16 a[20:23], v[236:239], v[132:135], a[20:23]
  buffer_load_dwordx4 v15, s[12:15], s27 offen lds
  v_mfma_f32_16x16x32_bf16 a[20:23], v[232:235], v[128:131], a[20:23]
  ds_read_b64_tr_b16 v[196:197], v7 offset:40960
  v_mfma_f32_16x16x32_bf16 a[52:55], v[232:235], v[136:139], a[52:55]
  s_add_u32 s32, s32, 524288
  ds_read_b64_tr_b16 v[198:199], v7 offset:41984
  v_mfma_f32_16x16x32_bf16 a[52:55], v[236:239], v[140:143], a[52:55]
  s_add_u32 s27, s27, 31744
  ds_read_b64_tr_b16 v[200:201], v8 offset:32768
  v_mfma_f32_16x16x32_bf16 a[48:51], v[228:231], v[140:143], a[48:51]
  buffer_load_dwordx4 v15, s[12:15], s27 offen offset:1024 lds
  v_mfma_f32_16x16x32_bf16 a[48:51], v[224:227], v[136:139], a[48:51]
  ds_read_b64_tr_b16 v[202:203], v8 offset:33792
  v_mfma_f32_16x16x32_bf16 a[80:83], v[224:227], v[144:147], a[80:83]
  s_and_b32 s32, s32, 0x3fffff
  ds_read_b64_tr_b16 v[204:205], v8 offset:40960
  v_mfma_f32_16x16x32_bf16 a[80:83], v[228:231], v[148:151], a[80:83]
  s_add_u32 s27, s27, 31744
  ds_read_b64_tr_b16 v[206:207], v8 offset:41984
  v_mfma_f32_16x16x32_bf16 a[84:87], v[236:239], v[148:151], a[84:87]
  buffer_load_dwordx4 v16, s[12:15], s27 offen offset:2048 lds
  v_mfma_f32_16x16x32_bf16 a[84:87], v[232:235], v[144:147], a[84:87]
  ds_read_b64_tr_b16 v[208:209], v9 offset:32768
  v_mfma_f32_16x16x32_bf16 a[116:119], v[232:235], v[152:155], a[116:119]
  ds_read_b64_tr_b16 v[210:211], v9 offset:33792
  v_mfma_f32_16x16x32_bf16 a[116:119], v[236:239], v[156:159], a[116:119]
  s_add_u32 s27, s27, 31744
  ds_read_b64_tr_b16 v[212:213], v9 offset:40960
  v_mfma_f32_16x16x32_bf16 a[112:115], v[228:231], v[156:159], a[112:115]
  buffer_load_dwordx4 v16, s[12:15], s27 offen offset:3072 lds
  v_mfma_f32_16x16x32_bf16 a[112:115], v[224:227], v[152:155], a[112:115]
  ds_read_b64_tr_b16 v[214:215], v9 offset:41984
  v_mfma_f32_16x16x32_bf16 a[144:147], v[224:227], v[160:163], a[144:147]
  s_add_u32 m0, s28, 102400
  ds_read_b64_tr_b16 v[216:217], v10 offset:32768
  v_mfma_f32_16x16x32_bf16 a[144:147], v[228:231], v[164:167], a[144:147]
  s_add_u32 s27, s27, 35840
  ds_read_b64_tr_b16 v[218:219], v10 offset:33792
  v_mfma_f32_16x16x32_bf16 a[148:151], v[236:239], v[164:167], a[148:151]
  buffer_load_dwordx4 v15, s[12:15], s27 offen lds
  v_mfma_f32_16x16x32_bf16 a[148:151], v[232:235], v[160:163], a[148:151]
  ds_read_b64_tr_b16 v[220:221], v10 offset:40960
  v_mfma_f32_16x16x32_bf16 a[180:183], v[232:235], v[168:171], a[180:183]
  ds_read_b64_tr_b16 v[222:223], v10 offset:41984
  v_mfma_f32_16x16x32_bf16 a[180:183], v[236:239], v[172:175], a[180:183]
  s_add_u32 s27, s27, 31744
  v_mfma_f32_16x16x32_bf16 a[176:179], v[228:231], v[172:175], a[176:179]
  buffer_load_dwordx4 v15, s[12:15], s27 offen offset:1024 lds
  v_mfma_f32_16x16x32_bf16 a[176:179], v[224:227], v[168:171], a[176:179]
  v_mfma_f32_16x16x32_bf16 a[208:211], v[224:227], v[176:179], a[208:211]
  v_mfma_f32_16x16x32_bf16 a[208:211], v[228:231], v[180:183], a[208:211]
  s_add_u32 s27, s27, 31744
  v_mfma_f32_16x16x32_bf16 a[212:215], v[236:239], v[180:183], a[212:215]
  buffer_load_dwordx4 v16, s[12:15], s27 offen offset:2048 lds
  v_mfma_f32_16x16x32_bf16 a[212:215], v[232:235], v[176:179], a[212:215]
  v_mfma_f32_16x16x32_bf16 a[244:247], v[232:235], v[184:187], a[244:247]
  v_mfma_f32_16x16x32_bf16 a[244:247], v[236:239], v[188:191], a[244:247]
  s_add_u32 s27, s27, 31744
  v_mfma_f32_16x16x32_bf16 a[240:243], v[228:231], v[188:191], a[240:243]
  buffer_load_dwordx4 v16, s[12:15], s27 offen offset:3072 lds
  v_mfma_f32_16x16x32_bf16 a[240:243], v[224:227], v[184:187], a[240:243]
  v_mfma_f32_16x16x32_bf16 a[24:27], v[240:243], v[128:131], a[24:27]
  buffer_load_dword v0, v24, s[76:79], 0 offen
  v_mfma_f32_16x16x32_bf16 a[24:27], v[244:247], v[132:135], a[24:27]
  v_mfma_f32_16x16x32_bf16 a[28:31], v[252:255], v[132:135], a[28:31]
  v_mfma_f32_16x16x32_bf16 a[28:31], v[248:251], v[128:131], a[28:31]
  ds_read_b128 v[128:131], v5 offset:0
  v_mfma_f32_16x16x32_bf16 a[60:63], v[248:251], v[136:139], a[60:63]
  ds_read_b128 v[132:135], v6 offset:0
  v_mfma_f32_16x16x32_bf16 a[60:63], v[252:255], v[140:143], a[60:63]
  v_mfma_f32_16x16x32_bf16 a[56:59], v[244:247], v[140:143], a[56:59]
  v_mfma_f32_16x16x32_bf16 a[56:59], v[240:243], v[136:139], a[56:59]
  ds_read_b128 v[136:139], v5 offset:2048
  v_mfma_f32_16x16x32_bf16 a[88:91], v[240:243], v[144:147], a[88:91]
  ds_read_b128 v[140:143], v6 offset:2048
  v_mfma_f32_16x16x32_bf16 a[88:91], v[244:247], v[148:151], a[88:91]
  v_mfma_f32_16x16x32_bf16 a[92:95], v[252:255], v[148:151], a[92:95]
  v_mfma_f32_16x16x32_bf16 a[92:95], v[248:251], v[144:147], a[92:95]
  ds_read_b128 v[144:147], v5 offset:4096
  v_mfma_f32_16x16x32_bf16 a[124:127], v[248:251], v[152:155], a[124:127]
  ds_read_b128 v[148:151], v6 offset:4096
  v_mfma_f32_16x16x32_bf16 a[124:127], v[252:255], v[156:159], a[124:127]
  v_mfma_f32_16x16x32_bf16 a[120:123], v[244:247], v[156:159], a[120:123]
  v_mfma_f32_16x16x32_bf16 a[120:123], v[240:243], v[152:155], a[120:123]
  ds_read_b128 v[152:155], v5 offset:6144
  v_mfma_f32_16x16x32_bf16 a[152:155], v[240:243], v[160:163], a[152:155]
  ds_read_b128 v[156:159], v6 offset:6144
  v_mfma_f32_16x16x32_bf16 a[152:155], v[244:247], v[164:167], a[152:155]
  v_mfma_f32_16x16x32_bf16 a[156:159], v[252:255], v[164:167], a[156:159]
  v_mfma_f32_16x16x32_bf16 a[156:159], v[248:251], v[160:163], a[156:159]
  ds_read_b128 v[160:163], v5 offset:8192
  v_mfma_f32_16x16x32_bf16 a[188:191], v[248:251], v[168:171], a[188:191]
  ds_read_b128 v[164:167], v6 offset:8192
  v_mfma_f32_16x16x32_bf16 a[188:191], v[252:255], v[172:175], a[188:191]
  v_mfma_f32_16x16x32_bf16 a[184:187], v[244:247], v[172:175], a[184:187]
  v_mfma_f32_16x16x32_bf16 a[184:187], v[240:243], v[168:171], a[184:187]
  ds_read_b128 v[168:171], v5 offset:10240
  v_mfma_f32_16x16x32_bf16 a[216:219], v[240:243], v[176:179], a[216:219]
  ds_read_b128 v[172:175], v6 offset:10240
  v_mfma_f32_16x16x32_bf16 a[216:219], v[244:247], v[180:183], a[216:219]
  v_mfma_f32_16x16x32_bf16 a[220:223], v[252:255], v[180:183], a[220:223]
  v_mfma_f32_16x16x32_bf16 a[220:223], v[248:251], v[176:179], a[220:223]
  ds_read_b128 v[176:179], v5 offset:12288
  v_mfma_f32_16x16x32_bf16 a[252:255], v[248:251], v[184:187], a[252:255]
  ds_read_b128 v[180:183], v6 offset:12288
  v_mfma_f32_16x16x32_bf16 a[252:255], v[252:255], v[188:191], a[252:255]
  v_mfma_f32_16x16x32_bf16 a[248:251], v[244:247], v[188:191], a[248:251]
  v_mfma_f32_16x16x32_bf16 a[248:251], v[240:243], v[184:187], a[248:251]
  s_waitcnt lgkmcnt(10)
  v_mfma_f32_16x16x32_bf16 a[0:3], v[192:195], v[128:131], a[0:3]
  s_lshl_b32 s23, s22, 2
  ds_read_b128 v[184:187], v5 offset:14336
  v_bfe_u32 v22, v1, 2, 2
  v_mfma_f32_16x16x32_bf16 a[0:3], v[196:199], v[132:135], a[0:3]
  s_add_u32 s23, s23, s20
  ds_read_b128 v[188:191], v6 offset:14336
  v_lshrrev_b32 v23, 4, v1
  v_mfma_f32_16x16x32_bf16 a[4:7], v[204:207], v[132:135], a[4:7]
  s_sub_u32 s24, 63, s23
  ds_read_b64_tr_b16 v[224:225], v11 offset:32768
  v_lshl_add_u32 v22, v22, 2, v23
  v_mfma_f32_16x16x32_bf16 a[4:7], v[200:203], v[128:131], a[4:7]
  s_mul_i32 s23, s23, 34816
  v_and_b32 v23, 3, v1
  v_lshl_add_u32 v22, v22, 2, v23
  v_mfma_f32_16x16x32_bf16 a[36:39], v[200:203], v[136:139], a[36:39]
  s_add_u32 m0, s28, 131072
  ds_read_b64_tr_b16 v[226:227], v11 offset:33792
  v_mfma_f32_16x16x32_bf16 a[36:39], v[204:207], v[140:143], a[36:39]
  s_add_u32 s26, s29, s31
  v_mfma_f32_16x16x32_bf16 a[32:35], v[196:199], v[140:143], a[32:35]
  buffer_load_dwordx4 v3, s[4:7], s26 offen lds
  v_mfma_f32_16x16x32_bf16 a[32:35], v[192:195], v[136:139], a[32:35]
  s_waitcnt lgkmcnt(10)
  ds_read_b64_tr_b16 v[228:229], v11 offset:40960
  v_mfma_f32_16x16x32_bf16 a[64:67], v[192:195], v[144:147], a[64:67]
  s_mul_i32 s24, s24, 34816
  v_mfma_f32_16x16x32_bf16 a[64:67], v[196:199], v[148:151], a[64:67]
  s_add_u32 s36, s23, 33554432
  ds_read_b64_tr_b16 v[230:231], v11 offset:41984
  v_mfma_f32_16x16x32_bf16 a[68:71], v[204:207], v[148:151], a[68:71]
  s_add_u32 s37, s23, 33571840
  v_mfma_f32_16x16x32_bf16 a[68:71], v[200:203], v[144:147], a[68:71]
  s_add_u32 s31, s31, 128
  ds_read_b64_tr_b16 v[232:233], v12 offset:32768
  v_mfma_f32_16x16x32_bf16 a[100:103], v[200:203], v[152:155], a[100:103]
  s_add_u32 s26, s26, 7168
  v_mfma_f32_16x16x32_bf16 a[100:103], v[204:207], v[156:159], a[100:103]
  buffer_load_dwordx4 v4, s[4:7], s26 offen offset:1024 lds
  v_mfma_f32_16x16x32_bf16 a[96:99], v[196:199], v[156:159], a[96:99]
  s_add_u32 s38, s24, 33554432
  ds_read_b64_tr_b16 v[234:235], v12 offset:33792
  v_mfma_f32_16x16x32_bf16 a[96:99], v[192:195], v[152:155], a[96:99]
  s_waitcnt lgkmcnt(10)
  v_mfma_f32_16x16x32_bf16 a[128:131], v[192:195], v[160:163], a[128:131]
  s_add_u32 s39, s24, 33571840
  ds_read_b64_tr_b16 v[236:237], v12 offset:40960
  v_mfma_f32_16x16x32_bf16 a[128:131], v[196:199], v[164:167], a[128:131]
  buffer_load_dword v19, v26, s[16:19], 0 offen sc1
  v_mfma_f32_16x16x32_bf16 a[132:135], v[204:207], v[164:167], a[132:135]
  s_and_b32 s31, s31, 0x3ff
  ds_read_b64_tr_b16 v[238:239], v12 offset:41984
  v_mfma_f32_16x16x32_bf16 a[132:135], v[200:203], v[160:163], a[132:135]
  s_add_u32 s26, s26, 7168
  v_mfma_f32_16x16x32_bf16 a[164:167], v[200:203], v[168:171], a[164:167]
  buffer_load_dwordx4 v3, s[4:7], s26 offen offset:2048 lds
  v_mfma_f32_16x16x32_bf16 a[164:167], v[204:207], v[172:175], a[164:167]
  s_bfe_u32 s34, s2, 0x20003
  ds_read_b64_tr_b16 v[240:241], v13 offset:32768
  v_mfma_f32_16x16x32_bf16 a[160:163], v[196:199], v[172:175], a[160:163]
  s_mul_i32 s34, s34, 4096
  v_mfma_f32_16x16x32_bf16 a[160:163], v[192:195], v[168:171], a[160:163]
  s_waitcnt lgkmcnt(9)
  ds_read_b64_tr_b16 v[242:243], v13 offset:33792
  v_mfma_f32_16x16x32_bf16 a[192:195], v[192:195], v[176:179], a[192:195]
  s_lshl_b32 s3, s3, 3
  v_mfma_f32_16x16x32_bf16 a[192:195], v[196:199], v[180:183], a[192:195]
  s_and_b32 s23, s2, 7
  ds_read_b64_tr_b16 v[244:245], v13 offset:40960
  v_mfma_f32_16x16x32_bf16 a[196:199], v[204:207], v[180:183], a[196:199]
  s_lshl_b32 s23, 0x01010101, s23
  v_mfma_f32_16x16x32_bf16 a[196:199], v[200:203], v[176:179], a[196:199]
  s_add_u32 s26, s26, 7168
  ds_read_b64_tr_b16 v[246:247], v13 offset:41984
  v_mfma_f32_16x16x32_bf16 a[228:231], v[200:203], v[184:187], a[228:231]
  buffer_load_dwordx4 v4, s[4:7], s26 offen offset:3072 lds
  v_mfma_f32_16x16x32_bf16 a[228:231], v[204:207], v[188:191], a[228:231]
  ds_read_b64_tr_b16 v[248:249], v14 offset:32768
  v_mfma_f32_16x16x32_bf16 a[224:227], v[196:199], v[188:191], a[224:227]
  s_waitcnt vmcnt(24)
  v_mfma_f32_16x16x32_bf16 v[112:115], v[40:43], v[48:51], 0
  v_mfma_f32_16x16x32_bf16 v[116:119], v[44:47], v[48:51], 0
  v_mfma_f32_16x16x32_bf16 v[120:123], v[40:43], v[52:55], 0
  v_mfma_f32_16x16x32_bf16 v[124:127], v[44:47], v[52:55], 0
  v_mfma_f32_16x16x32_bf16 a[224:227], v[192:195], v[184:187], a[224:227]
  ds_read_b64_tr_b16 v[250:251], v14 offset:33792
  v_mfma_f32_16x16x32_bf16 a[8:11], v[208:211], v[128:131], a[8:11]
  s_add_u32 m0, s28, 135168
  v_mfma_f32_16x16x32_bf16 a[8:11], v[212:215], v[132:135], a[8:11]
  s_add_u32 s26, s26, 502784
  ds_read_b64_tr_b16 v[252:253], v14 offset:40960
  v_mfma_f32_16x16x32_bf16 a[12:15], v[220:223], v[132:135], a[12:15]
  buffer_load_dwordx4 v3, s[4:7], s26 offen lds
  v_mfma_f32_16x16x32_bf16 a[12:15], v[216:219], v[128:131], a[12:15]
  ds_read_b64_tr_b16 v[254:255], v14 offset:41984
  v_cvt_pk_bf16_f32 v56, v112, v113
  v_mfma_f32_16x16x32_bf16 a[44:47], v[216:219], v[136:139], a[44:47]
  v_cvt_pk_bf16_f32 v57, v114, v115
  v_cvt_pk_bf16_f32 v58, v116, v117
  v_mfma_f32_16x16x32_bf16 a[44:47], v[220:223], v[140:143], a[44:47]
  v_cvt_pk_bf16_f32 v59, v118, v119
  v_mfma_f32_16x16x32_bf16 a[40:43], v[212:215], v[140:143], a[40:43]
  buffer_store_dwordx4 v[56:59], v2, s[8:11], s65 offen sc1
  v_mfma_f32_16x16x32_bf16 a[40:43], v[208:211], v[136:139], a[40:43]
  v_cvt_pk_bf16_f32 v60, v120, v121
  v_cvt_pk_bf16_f32 v61, v122, v123
  v_mfma_f32_16x16x32_bf16 a[72:75], v[208:211], v[144:147], a[72:75]
  s_add_u32 s26, s26, 7168
  v_cvt_pk_bf16_f32 v62, v124, v125
  v_cvt_pk_bf16_f32 v63, v126, v127
  v_mfma_f32_16x16x32_bf16 a[72:75], v[212:215], v[148:151], a[72:75]
  buffer_load_dwordx4 v4, s[4:7], s26 offen offset:1024 lds
  v_mfma_f32_16x16x32_bf16 a[76:79], v[220:223], v[148:151], a[76:79]
  buffer_store_dwordx4 v[60:63], v2, s[8:11], s65 offen offset:1024 sc1
  v_mfma_f32_16x16x32_bf16 a[76:79], v[216:219], v[144:147], a[76:79]
  v_mfma_f32_16x16x32_bf16 a[108:111], v[216:219], v[152:155], a[108:111]
  v_mfma_f32_16x16x32_bf16 a[108:111], v[220:223], v[156:159], a[108:111]
  v_mfma_f32_16x16x32_bf16 a[104:107], v[212:215], v[156:159], a[104:107]
  v_mfma_f32_16x16x32_bf16 a[104:107], v[208:211], v[152:155], a[104:107]
  s_add_u32 s26, s26, 7168
  v_mfma_f32_16x16x32_bf16 a[136:139], v[208:211], v[160:163], a[136:139]
  buffer_load_dwordx4 v3, s[4:7], s26 offen offset:2048 lds
  v_mfma_f32_16x16x32_bf16 a[136:139], v[212:215], v[164:167], a[136:139]
  v_mfma_f32_16x16x32_bf16 a[140:143], v[220:223], v[164:167], a[140:143]
  v_lshl_add_u32 v17, v22, 4, s34
  v_mfma_f32_16x16x32_bf16 a[140:143], v[216:219], v[160:163], a[140:143]
  v_mfma_f32_16x16x32_bf16 a[172:175], v[216:219], v[168:171], a[172:175]
  v_mfma_f32_16x16x32_bf16 a[172:175], v[220:223], v[172:175], a[172:175]
  v_mfma_f32_16x16x32_bf16 a[168:171], v[212:215], v[172:175], a[168:171]
  s_add_u32 s26, s26, 7168
  v_mfma_f32_16x16x32_bf16 a[168:171], v[208:211], v[168:171], a[168:171]
  buffer_load_dwordx4 v4, s[4:7], s26 offen offset:3072 lds
  v_mfma_f32_16x16x32_bf16 a[200:203], v[208:211], v[176:179], a[200:203]
  v_add_u32 v5, 0x10000, v5
  v_add_u32 v6, 0x10000, v6
  v_mfma_f32_16x16x32_bf16 a[200:203], v[212:215], v[180:183], a[200:203]
  v_add_u32 v7, 0x10000, v7
  v_add_u32 v8, 0x10000, v8
  v_mfma_f32_16x16x32_bf16 a[204:207], v[220:223], v[180:183], a[204:207]
  v_add_u32 v9, 0x10000, v9
  v_add_u32 v10, 0x10000, v10
  v_mfma_f32_16x16x32_bf16 a[204:207], v[216:219], v[176:179], a[204:207]
  v_add_u32 v11, 0x10000, v11
  v_add_u32 v12, 0x10000, v12
  v_mfma_f32_16x16x32_bf16 a[236:239], v[216:219], v[184:187], a[236:239]
  v_add_u32 v13, 0x10000, v13
  v_add_u32 v14, 0x10000, v14
  v_mfma_f32_16x16x32_bf16 a[236:239], v[220:223], v[188:191], a[236:239]
  v_mfma_f32_16x16x32_bf16 a[232:235], v[212:215], v[188:191], a[232:235]
  v_mfma_f32_16x16x32_bf16 a[232:235], v[208:211], v[184:187], a[232:235]
  s_waitcnt vmcnt(12) lgkmcnt(0)
  s_barrier
  v_mfma_f32_16x16x32_bf16 a[16:19], v[224:227], v[128:131], a[16:19]
  s_add_u32 m0, s28, 0
  ds_read_b64_tr_b16 v[192:193], v7 offset:32768
  v_mfma_f32_16x16x32_bf16 a[16:19], v[228:231], v[132:135], a[16:19]
  s_add_u32 s27, s30, s32
  ds_read_b64_tr_b16 v[194:195], v7 offset:33792
  v_mfma_f32_16x16x32_bf16 a[20:23], v[236:239], v[132:135], a[20:23]
  buffer_load_dwordx4 v15, s[12:15], s27 offen lds
  v_mfma_f32_16x16x32_bf16 a[20:23], v[232:235], v[128:131], a[20:23]
  ds_read_b64_tr_b16 v[196:197], v7 offset:40960
  v_mfma_f32_16x16x32_bf16 a[52:55], v[232:235], v[136:139], a[52:55]
  s_add_u32 s32, s32, 524288
  ds_read_b64_tr_b16 v[198:199], v7 offset:41984
  v_mfma_f32_16x16x32_bf16 a[52:55], v[236:239], v[140:143], a[52:55]
  s_add_u32 s27, s27, 31744
  ds_read_b64_tr_b16 v[200:201], v8 offset:32768
  v_mfma_f32_16x16x32_bf16 a[48:51], v[228:231], v[140:143], a[48:51]
  buffer_load_dwordx4 v15, s[12:15], s27 offen offset:1024 lds
  v_mfma_f32_16x16x32_bf16 a[48:51], v[224:227], v[136:139], a[48:51]
  ds_read_b64_tr_b16 v[202:203], v8 offset:33792
  v_mfma_f32_16x16x32_bf16 a[80:83], v[224:227], v[144:147], a[80:83]
  s_and_b32 s32, s32, 0x3fffff
  ds_read_b64_tr_b16 v[204:205], v8 offset:40960
  v_mfma_f32_16x16x32_bf16 a[80:83], v[228:231], v[148:151], a[80:83]
  s_add_u32 s27, s27, 31744
  ds_read_b64_tr_b16 v[206:207], v8 offset:41984
  v_mfma_f32_16x16x32_bf16 a[84:87], v[236:239], v[148:151], a[84:87]
  buffer_load_dwordx4 v16, s[12:15], s27 offen offset:2048 lds
  v_mfma_f32_16x16x32_bf16 a[84:87], v[232:235], v[144:147], a[84:87]
  ds_read_b64_tr_b16 v[208:209], v9 offset:32768
  v_mfma_f32_16x16x32_bf16 a[116:119], v[232:235], v[152:155], a[116:119]
  ds_read_b64_tr_b16 v[210:211], v9 offset:33792
  v_mfma_f32_16x16x32_bf16 a[116:119], v[236:239], v[156:159], a[116:119]
  s_add_u32 s27, s27, 31744
  ds_read_b64_tr_b16 v[212:213], v9 offset:40960
  v_mfma_f32_16x16x32_bf16 a[112:115], v[228:231], v[156:159], a[112:115]
  buffer_load_dwordx4 v16, s[12:15], s27 offen offset:3072 lds
  v_mfma_f32_16x16x32_bf16 a[112:115], v[224:227], v[152:155], a[112:115]
  ds_read_b64_tr_b16 v[214:215], v9 offset:41984
  v_mfma_f32_16x16x32_bf16 a[144:147], v[224:227], v[160:163], a[144:147]
  s_add_u32 m0, s28, 4096
  ds_read_b64_tr_b16 v[216:217], v10 offset:32768
  v_mfma_f32_16x16x32_bf16 a[144:147], v[228:231], v[164:167], a[144:147]
  s_add_u32 s27, s27, 35840
  ds_read_b64_tr_b16 v[218:219], v10 offset:33792
  v_mfma_f32_16x16x32_bf16 a[148:151], v[236:239], v[164:167], a[148:151]
  buffer_load_dwordx4 v15, s[12:15], s27 offen lds
  v_mfma_f32_16x16x32_bf16 a[148:151], v[232:235], v[160:163], a[148:151]
  ds_read_b64_tr_b16 v[220:221], v10 offset:40960
  v_mfma_f32_16x16x32_bf16 a[180:183], v[232:235], v[168:171], a[180:183]
  ds_read_b64_tr_b16 v[222:223], v10 offset:41984
  v_mfma_f32_16x16x32_bf16 a[180:183], v[236:239], v[172:175], a[180:183]
  s_add_u32 s27, s27, 31744
  v_mfma_f32_16x16x32_bf16 a[176:179], v[228:231], v[172:175], a[176:179]
  buffer_load_dwordx4 v15, s[12:15], s27 offen offset:1024 lds
  v_mfma_f32_16x16x32_bf16 a[176:179], v[224:227], v[168:171], a[176:179]
  s_waitcnt vmcnt(14)
  v_lshrrev_b32 v20, 4, v19
  v_and_b32 v21, 0x0f0f0f0f, v19
  v_and_b32 v20, 0x0f0f0f0f, v20
  v_sad_u8 v21, v21, 0, 0
  v_sad_u8 v20, v20, 0, v21
  v_cmp_ne_u32 vcc, 8, v20
  s_cbranch_vccnz L_spin_5
L_back_6:
  v_cmp_ne_u32 vcc, s3, v19
  v_mfma_f32_16x16x32_bf16 a[208:211], v[224:227], v[176:179], a[208:211]
  s_and_b32 s23, s23, vcc_lo
  s_cselect_b32 s3, 0, 1
  v_mfma_f32_16x16x32_bf16 a[208:211], v[228:231], v[180:183], a[208:211]
  s_add_u32 s27, s27, 31744
  v_mfma_f32_16x16x32_bf16 a[212:215], v[236:239], v[180:183], a[212:215]
  buffer_load_dwordx4 v16, s[12:15], s27 offen offset:2048 lds
  v_mfma_f32_16x16x32_bf16 a[212:215], v[232:235], v[176:179], a[212:215]
  v_mfma_f32_16x16x32_bf16 a[244:247], v[232:235], v[184:187], a[244:247]
  v_mfma_f32_16x16x32_bf16 a[244:247], v[236:239], v[188:191], a[244:247]
  s_add_u32 s27, s27, 31744
  v_mfma_f32_16x16x32_bf16 a[240:243], v[228:231], v[188:191], a[240:243]
  buffer_load_dwordx4 v16, s[12:15], s27 offen offset:3072 lds
  v_mfma_f32_16x16x32_bf16 a[240:243], v[224:227], v[184:187], a[240:243]
  s_mov_b32 s4, s44
  v_mfma_f32_16x16x32_bf16 a[24:27], v[240:243], v[128:131], a[24:27]
  s_mov_b32 s5, s45
  v_mfma_f32_16x16x32_bf16 a[24:27], v[244:247], v[132:135], a[24:27]
  buffer_load_dwordx4 v[64:67], v17, s[8:11], s36 offen sc1
  v_mfma_f32_16x16x32_bf16 a[28:31], v[252:255], v[132:135], a[28:31]
  s_mov_b32 s6, 0x400000
  v_mfma_f32_16x16x32_bf16 a[28:31], v[248:251], v[128:131], a[28:31]
  s_lshl_b32 s29, s20, 18
  ds_read_b128 v[128:131], v5 offset:0
  v_mfma_f32_16x16x32_bf16 a[60:63], v[248:251], v[136:139], a[60:63]
  s_lshl_b32 s23, s21, 8
  ds_read_b128 v[132:135], v6 offset:0
  v_mfma_f32_16x16x32_bf16 a[60:63], v[252:255], v[140:143], a[60:63]
  buffer_load_dwordx4 v[68:71], v17, s[8:11], s37 offen sc1
  v_mfma_f32_16x16x32_bf16 a[56:59], v[244:247], v[140:143], a[56:59]
  s_add_u32 s29, s29, s23
  v_mfma_f32_16x16x32_bf16 a[56:59], v[240:243], v[136:139], a[56:59]
  s_lshl_b32 s31, s34, 8
  ds_read_b128 v[136:139], v5 offset:2048
  v_mfma_f32_16x16x32_bf16 a[88:91], v[240:243], v[144:147], a[88:91]
  ds_read_b128 v[140:143], v6 offset:2048
  v_mfma_f32_16x16x32_bf16 a[88:91], v[244:247], v[148:151], a[88:91]
  buffer_load_dwordx4 v[72:75], v17, s[8:11], s38 offen sc1
  v_mfma_f32_16x16x32_bf16 a[92:95], v[252:255], v[148:151], a[92:95]
  v_mfma_f32_16x16x32_bf16 a[92:95], v[248:251], v[144:147], a[92:95]
  ds_read_b128 v[144:147], v5 offset:4096
  v_mfma_f32_16x16x32_bf16 a[124:127], v[248:251], v[152:155], a[124:127]
  ds_read_b128 v[148:151], v6 offset:4096
  v_mfma_f32_16x16x32_bf16 a[124:127], v[252:255], v[156:159], a[124:127]
  buffer_load_dwordx4 v[76:79], v17, s[8:11], s39 offen sc1
  v_mfma_f32_16x16x32_bf16 a[120:123], v[244:247], v[156:159], a[120:123]
  v_mfma_f32_16x16x32_bf16 a[120:123], v[240:243], v[152:155], a[120:123]
  ds_read_b128 v[152:155], v5 offset:6144
  v_mfma_f32_16x16x32_bf16 a[152:155], v[240:243], v[160:163], a[152:155]
  ds_read_b128 v[156:159], v6 offset:6144
  v_mfma_f32_16x16x32_bf16 a[152:155], v[244:247], v[164:167], a[152:155]
  buffer_load_dwordx4 v[80:83], v17, s[8:11], s36 offen offset:1024 sc1
  v_mfma_f32_16x16x32_bf16 a[156:159], v[252:255], v[164:167], a[156:159]
  v_mfma_f32_16x16x32_bf16 a[156:159], v[248:251], v[160:163], a[156:159]
  ds_read_b128 v[160:163], v5 offset:8192
  v_mfma_f32_16x16x32_bf16 a[188:191], v[248:251], v[168:171], a[188:191]
  ds_read_b128 v[164:167], v6 offset:8192
  v_mfma_f32_16x16x32_bf16 a[188:191], v[252:255], v[172:175], a[188:191]
  buffer_load_dwordx4 v[84:87], v17, s[8:11], s37 offen offset:1024 sc1
  v_mfma_f32_16x16x32_bf16 a[184:187], v[244:247], v[172:175], a[184:187]
  v_mfma_f32_16x16x32_bf16 a[184:187], v[240:243], v[168:171], a[184:187]
  ds_read_b128 v[168:171], v5 offset:10240
  v_mfma_f32_16x16x32_bf16 a[216:219], v[240:243], v[176:179], a[216:219]
  ds_read_b128 v[172:175], v6 offset:10240
  v_mfma_f32_16x16x32_bf16 a[216:219], v[244:247], v[180:183], a[216:219]
  buffer_load_dwordx4 v[88:91], v17, s[8:11], s38 offen offset:1024 sc1
  v_mfma_f32_16x16x32_bf16 a[220:223], v[252:255], v[180:183], a[220:223]
  v_mfma_f32_16x16x32_bf16 a[220:223], v[248:251], v[176:179], a[220:223]
  ds_read_b128 v[176:179], v5 offset:12288
  v_mfma_f32_16x16x32_bf16 a[252:255], v[248:251], v[184:187], a[252:255]
  ds_read_b128 v[180:183], v6 offset:12288
  v_mfma_f32_16x16x32_bf16 a[252:255], v[252:255], v[188:191], a[252:255]
  buffer_load_dwordx4 v[92:95], v17, s[8:11], s39 offen offset:1024 sc1
  v_mfma_f32_16x16x32_bf16 a[248:251], v[244:247], v[188:191], a[248:251]
  v_mfma_f32_16x16x32_bf16 a[248:251], v[240:243], v[184:187], a[248:251]
  s_waitcnt lgkmcnt(10)
  v_mfma_f32_16x16x32_bf16 a[0:3], v[192:195], v[128:131], a[0:3]
  ds_read_b128 v[184:187], v5 offset:14336
  v_mfma_f32_16x16x32_bf16 a[0:3], v[196:199], v[132:135], a[0:3]
  ds_read_b128 v[188:191], v6 offset:14336
  v_mfma_f32_16x16x32_bf16 a[4:7], v[204:207], v[132:135], a[4:7]
  ds_read_b64_tr_b16 v[224:225], v11 offset:32768
  v_mfma_f32_16x16x32_bf16 a[4:7], v[200:203], v[128:131], a[4:7]
  v_mfma_f32_16x16x32_bf16 a[36:39], v[200:203], v[136:139], a[36:39]
  s_add_u32 m0, s28, 32768
  ds_read_b64_tr_b16 v[226:227], v11 offset:33792
  v_mfma_f32_16x16x32_bf16 a[36:39], v[204:207], v[140:143], a[36:39]
  s_add_u32 s26, s29, s31
  v_mfma_f32_16x16x32_bf16 a[32:35], v[196:199], v[140:143], a[32:35]
  buffer_load_dwordx4 v15, s[4:7], s26 offen lds
  v_mfma_f32_16x16x32_bf16 a[32:35], v[192:195], v[136:139], a[32:35]
  s_waitcnt lgkmcnt(10)
  ds_read_b64_tr_b16 v[228:229], v11 offset:40960
  v_mfma_f32_16x16x32_bf16 a[64:67], v[192:195], v[144:147], a[64:67]
  v_mfma_f32_16x16x32_bf16 a[64:67], v[196:199], v[148:151], a[64:67]
  ds_read_b64_tr_b16 v[230:231], v11 offset:41984
  v_mfma_f32_16x16x32_bf16 a[68:71], v[204:207], v[148:151], a[68:71]
  v_mfma_f32_16x16x32_bf16 a[68:71], v[200:203], v[144:147], a[68:71]
  s_add_u32 s31, s31, 1048576
  ds_read_b64_tr_b16 v[232:233], v12 offset:32768
  v_mfma_f32_16x16x32_bf16 a[100:103], v[200:203], v[152:155], a[100:103]
  s_add_u32 s26, s26, 31744
  v_mfma_f32_16x16x32_bf16 a[100:103], v[204:207], v[156:159], a[100:103]
  buffer_load_dwordx4 v15, s[4:7], s26 offen offset:1024 lds
  v_mfma_f32_16x16x32_bf16 a[96:99], v[196:199], v[156:159], a[96:99]
  ds_read_b64_tr_b16 v[234:235], v12 offset:33792
  v_mfma_f32_16x16x32_bf16 a[96:99], v[192:195], v[152:155], a[96:99]
  s_waitcnt lgkmcnt(10)
  v_mfma_f32_16x16x32_bf16 a[128:131], v[192:195], v[160:163], a[128:131]
  ds_read_b64_tr_b16 v[236:237], v12 offset:40960
  v_mfma_f32_16x16x32_bf16 a[128:131], v[196:199], v[164:167], a[128:131]
  v_mfma_f32_16x16x32_bf16 a[132:135], v[204:207], v[164:167], a[132:135]
  s_and_b32 s31, s31, 0x3fffff
  ds_read_b64_tr_b16 v[238:239], v12 offset:41984
  v_mfma_f32_16x16x32_bf16 a[132:135], v[200:203], v[160:163], a[132:135]
  s_add_u32 s26, s26, 31744
  v_mfma_f32_16x16x32_bf16 a[164:167], v[200:203], v[168:171], a[164:167]
  buffer_load_dwordx4 v16, s[4:7], s26 offen offset:2048 lds
  v_mfma_f32_16x16x32_bf16 a[164:167], v[204:207], v[172:175], a[164:167]
  ds_read_b64_tr_b16 v[240:241], v13 offset:32768
  v_mfma_f32_16x16x32_bf16 a[160:163], v[196:199], v[172:175], a[160:163]
  v_mfma_f32_16x16x32_bf16 a[160:163], v[192:195], v[168:171], a[160:163]
  s_waitcnt lgkmcnt(9)
  ds_read_b64_tr_b16 v[242:243], v13 offset:33792
  v_mfma_f32_16x16x32_bf16 a[192:195], v[192:195], v[176:179], a[192:195]
  v_mfma_f32_16x16x32_bf16 a[192:195], v[196:199], v[180:183], a[192:195]
  ds_read_b64_tr_b16 v[244:245], v13 offset:40960
  v_mfma_f32_16x16x32_bf16 a[196:199], v[204:207], v[180:183], a[196:199]
  v_mfma_f32_16x16x32_bf16 a[196:199], v[200:203], v[176:179], a[196:199]
  s_add_u32 s26, s26, 31744
  ds_read_b64_tr_b16 v[246:247], v13 offset:41984
  v_mfma_f32_16x16x32_bf16 a[228:231], v[200:203], v[184:187], a[228:231]
  buffer_load_dwordx4 v16, s[4:7], s26 offen offset:3072 lds
  v_mfma_f32_16x16x32_bf16 a[228:231], v[204:207], v[188:191], a[228:231]
  ds_read_b64_tr_b16 v[248:249], v14 offset:32768
  v_mfma_f32_16x16x32_bf16 a[224:227], v[196:199], v[188:191], a[224:227]
  v_mfma_f32_16x16x32_bf16 a[224:227], v[192:195], v[184:187], a[224:227]
  ds_read_b64_tr_b16 v[250:251], v14 offset:33792
  v_mfma_f32_16x16x32_bf16 a[8:11], v[208:211], v[128:131], a[8:11]
  s_add_u32 m0, s28, 36864
  v_mfma_f32_16x16x32_bf16 a[8:11], v[212:215], v[132:135], a[8:11]
  s_add_u32 s26, s26, 35840
  ds_read_b64_tr_b16 v[252:253], v14 offset:40960
  v_mfma_f32_16x16x32_bf16 a[12:15], v[220:223], v[132:135], a[12:15]
  buffer_load_dwordx4 v15, s[4:7], s26 offen lds
  v_mfma_f32_16x16x32_bf16 a[12:15], v[216:219], v[128:131], a[12:15]
  ds_read_b64_tr_b16 v[254:255], v14 offset:41984
  v_mfma_f32_16x16x32_bf16 a[44:47], v[216:219], v[136:139], a[44:47]
  v_mfma_f32_16x16x32_bf16 a[44:47], v[220:223], v[140:143], a[44:47]
  v_mfma_f32_16x16x32_bf16 a[40:43], v[212:215], v[140:143], a[40:43]
  v_mfma_f32_16x16x32_bf16 a[40:43], v[208:211], v[136:139], a[40:43]
  v_mfma_f32_16x16x32_bf16 a[72:75], v[208:211], v[144:147], a[72:75]
  s_add_u32 s26, s26, 31744
  v_mfma_f32_16x16x32_bf16 a[72:75], v[212:215], v[148:151], a[72:75]
  buffer_load_dwordx4 v15, s[4:7], s26 offen offset:1024 lds
  v_mfma_f32_16x16x32_bf16 a[76:79], v[220:223], v[148:151], a[76:79]
  v_mfma_f32_16x16x32_bf16 a[76:79], v[216:219], v[144:147], a[76:79]
  v_mfma_f32_16x16x32_bf16 a[108:111], v[216:219], v[152:155], a[108:111]
  v_mfma_f32_16x16x32_bf16 a[108:111], v[220:223], v[156:159], a[108:111]
  v_mfma_f32_16x16x32_bf16 a[104:107], v[212:215], v[156:159], a[104:107]
  v_mfma_f32_16x16x32_bf16 a[104:107], v[208:211], v[152:155], a[104:107]
  s_add_u32 s26, s26, 31744
  v_mfma_f32_16x16x32_bf16 a[136:139], v[208:211], v[160:163], a[136:139]
  buffer_load_dwordx4 v16, s[4:7], s26 offen offset:2048 lds
  v_mfma_f32_16x16x32_bf16 a[136:139], v[212:215], v[164:167], a[136:139]
  v_mfma_f32_16x16x32_bf16 a[140:143], v[220:223], v[164:167], a[140:143]
  v_mfma_f32_16x16x32_bf16 a[140:143], v[216:219], v[160:163], a[140:143]
  v_mfma_f32_16x16x32_bf16 a[172:175], v[216:219], v[168:171], a[172:175]
  v_mfma_f32_16x16x32_bf16 a[172:175], v[220:223], v[172:175], a[172:175]
  v_mfma_f32_16x16x32_bf16 a[168:171], v[212:215], v[172:175], a[168:171]
  s_add_u32 s26, s26, 31744
  v_mfma_f32_16x16x32_bf16 a[168:171], v[208:211], v[168:171], a[168:171]
  buffer_load_dwordx4 v16, s[4:7], s26 offen offset:3072 lds
  v_mfma_f32_16x16x32_bf16 a[200:203], v[208:211], v[176:179], a[200:203]
  v_add_u32 v5, 0x10000, v5
  v_add_u32 v6, 0x10000, v6
  v_mfma_f32_16x16x32_bf16 a[200:203], v[212:215], v[180:183], a[200:203]
  v_add_u32 v7, 0xffff0000, v7
  v_add_u32 v8, 0xffff0000, v8
  v_mfma_f32_16x16x32_bf16 a[204:207], v[220:223], v[180:183], a[204:207]
  v_add_u32 v9, 0xffff0000, v9
  v_add_u32 v10, 0xffff0000, v10
  v_mfma_f32_16x16x32_bf16 a[204:207], v[216:219], v[176:179], a[204:207]
  v_add_u32 v11, 0xffff0000, v11
  v_add_u32 v12, 0xffff0000, v12
  v_mfma_f32_16x16x32_bf16 a[236:239], v[216:219], v[184:187], a[236:239]
  v_add_u32 v13, 0xffff0000, v13
  v_add_u32 v14, 0xffff0000, v14
  v_mfma_f32_16x16x32_bf16 a[236:239], v[220:223], v[188:191], a[236:239]
  v_mfma_f32_16x16x32_bf16 a[232:235], v[212:215], v[188:191], a[232:235]
  v_mfma_f32_16x16x32_bf16 a[232:235], v[208:211], v[184:187], a[232:235]
  s_waitcnt vmcnt(16) lgkmcnt(0)
  s_barrier
  v_mfma_f32_16x16x32_bf16 a[16:19], v[224:227], v[128:131], a[16:19]
  s_add_u32 m0, s28, 65536
  ds_read_b64_tr_b16 v[192:193], v7 offset:0
  v_mfma_f32_16x16x32_bf16 a[16:19], v[228:231], v[132:135], a[16:19]
  s_add_u32 s26, s29, s31
  ds_read_b64_tr_b16 v[194:195], v7 offset:1024
  v_mfma_f32_16x16x32_bf16 a[20:23], v[236:239], v[132:135], a[20:23]
  buffer_load_dwordx4 v15, s[4:7], s26 offen lds
  v_mfma_f32_16x16x32_bf16 a[20:23], v[232:235], v[128:131], a[20:23]
  ds_read_b64_tr_b16 v[196:197], v7 offset:8192
  v_mfma_f32_16x16x32_bf16 a[52:55], v[232:235], v[136:139], a[52:55]
  s_add_u32 s31, s31, 1048576
  ds_read_b64_tr_b16 v[198:199], v7 offset:9216
  v_mfma_f32_16x16x32_bf16 a[52:55], v[236:239], v[140:143], a[52:55]
  s_add_u32 s26, s26, 31744
  ds_read_b64_tr_b16 v[200:201], v8 offset:0
  v_mfma_f32_16x16x32_bf16 a[48:51], v[228:231], v[140:143], a[48:51]
  buffer_load_dwordx4 v15, s[4:7], s26 offen offset:1024 lds
  v_mfma_f32_16x16x32_bf16 a[48:51], v[224:227], v[136:139], a[48:51]
  ds_read_b64_tr_b16 v[202:203], v8 offset:1024
  v_mfma_f32_16x16x32_bf16 a[80:83], v[224:227], v[144:147], a[80:83]
  s_and_b32 s31, s31, 0x3fffff
  ds_read_b64_tr_b16 v[204:205], v8 offset:8192
  v_mfma_f32_16x16x32_bf16 a[80:83], v[228:231], v[148:151], a[80:83]
  s_add_u32 s26, s26, 31744
  ds_read_b64_tr_b16 v[206:207], v8 offset:9216
  v_mfma_f32_16x16x32_bf16 a[84:87], v[236:239], v[148:151], a[84:87]
  buffer_load_dwordx4 v16, s[4:7], s26 offen offset:2048 lds
  v_mfma_f32_16x16x32_bf16 a[84:87], v[232:235], v[144:147], a[84:87]
  ds_read_b64_tr_b16 v[208:209], v9 offset:0
  v_mfma_f32_16x16x32_bf16 a[116:119], v[232:235], v[152:155], a[116:119]
  ds_read_b64_tr_b16 v[210:211], v9 offset:1024
  v_mfma_f32_16x16x32_bf16 a[116:119], v[236:239], v[156:159], a[116:119]
  s_add_u32 s26, s26, 31744
  ds_read_b64_tr_b16 v[212:213], v9 offset:8192
  v_mfma_f32_16x16x32_bf16 a[112:115], v[228:231], v[156:159], a[112:115]
  buffer_load_dwordx4 v16, s[4:7], s26 offen offset:3072 lds
  v_mfma_f32_16x16x32_bf16 a[112:115], v[224:227], v[152:155], a[112:115]
  ds_read_b64_tr_b16 v[214:215], v9 offset:9216
  v_mfma_f32_16x16x32_bf16 a[144:147], v[224:227], v[160:163], a[144:147]
  s_add_u32 m0, s28, 69632
  ds_read_b64_tr_b16 v[216:217], v10 offset:0
  v_mfma_f32_16x16x32_bf16 a[144:147], v[228:231], v[164:167], a[144:147]
  s_add_u32 s26, s26, 35840
  ds_read_b64_tr_b16 v[218:219], v10 offset:1024
  v_mfma_f32_16x16x32_bf16 a[148:151], v[236:239], v[164:167], a[148:151]
  buffer_load_dwordx4 v15, s[4:7], s26 offen lds
  v_mfma_f32_16x16x32_bf16 a[148:151], v[232:235], v[160:163], a[148:151]
  ds_read_b64_tr_b16 v[220:221], v10 offset:8192
  v_mfma_f32_16x16x32_bf16 a[180:183], v[232:235], v[168:171], a[180:183]
  ds_read_b64_tr_b16 v[222:223], v10 offset:9216
  v_mfma_f32_16x16x32_bf16 a[180:183], v[236:239], v[172:175], a[180:183]
  s_add_u32 s26, s26, 31744
  v_mfma_f32_16x16x32_bf16 a[176:179], v[228:231], v[172:175], a[176:179]
  buffer_load_dwordx4 v15, s[4:7], s26 offen offset:1024 lds
  v_mfma_f32_16x16x32_bf16 a[176:179], v[224:227], v[168:171], a[176:179]
  v_mfma_f32_16x16x32_bf16 a[208:211], v[224:227], v[176:179], a[208:211]
  v_mfma_f32_16x16x32_bf16 a[208:211], v[228:231], v[180:183], a[208:211]
  s_add_u32 s26, s26, 31744
  v_mfma_f32_16x16x32_bf16 a[212:215], v[236:239], v[180:183], a[212:215]
  buffer_load_dwordx4 v16, s[4:7], s26 offen offset:2048 lds
  v_mfma_f32_16x16x32_bf16 a[212:215], v[232:235], v[176:179], a[212:215]
  v_mfma_f32_16x16x32_bf16 a[244:247], v[232:235], v[184:187], a[244:247]
  v_mfma_f32_16x16x32_bf16 a[244:247], v[236:239], v[188:191], a[244:247]
  s_add_u32 s26, s26, 31744
  v_mfma_f32_16x16x32_bf16 a[240:243], v[228:231], v[188:191], a[240:243]
  buffer_load_dwordx4 v16, s[4:7], s26 offen offset:3072 lds
  v_mfma_f32_16x16x32_bf16 a[240:243], v[224:227], v[184:187], a[240:243]
  s_lshr_b32 s23, s20, 1
  v_mfma_f32_16x16x32_bf16 a[24:27], v[240:243], v[128:131], a[24:27]
  s_lshl_b32 s23, s23, 14
  ds_read_b64_tr_b16 v[224:225], v11 offset:0
  v_mfma_f32_16x16x32_bf16 a[24:27], v[244:247], v[132:135], a[24:27]
  s_sub_u32 s30, 32768, s23
  ds_read_b64_tr_b16 v[226:227], v11 offset:1024
  v_mfma_f32_16x16x32_bf16 a[28:31], v[252:255], v[132:135], a[28:31]
  s_lshl_b32 s33, s21, 20
  ds_read_b64_tr_b16 v[228:229], v11 offset:8192
  v_mfma_f32_16x16x32_bf16 a[28:31], v[248:251], v[128:131], a[28:31]
  s_lshl_b32 s23, s22, 14
  ds_read_b128 v[128:131], v5 offset:0
  v_mfma_f32_16x16x32_bf16 a[60:63], v[248:251], v[136:139], a[60:63]
  s_add_u32 s33, s33, s23
  ds_read_b128 v[132:135], v6 offset:0
  v_mfma_f32_16x16x32_bf16 a[60:63], v[252:255], v[140:143], a[60:63]
  s_and_b32 s23, s20, 1
  ds_read_b64_tr_b16 v[230:231], v11 offset:9216
  v_mfma_f32_16x16x32_bf16 a[56:59], v[244:247], v[140:143], a[56:59]
  s_lshl_b32 s23, s23, 17
  ds_read_b64_tr_b16 v[232:233], v12 offset:0
  v_mfma_f32_16x16x32_bf16 a[56:59], v[240:243], v[136:139], a[56:59]
  s_add_u32 s33, s33, s23
  ds_read_b128 v[136:139], v5 offset:2048
  v_mfma_f32_16x16x32_bf16 a[88:91], v[240:243], v[144:147], a[88:91]
  ds_read_b128 v[140:143], v6 offset:2048
  v_mfma_f32_16x16x32_bf16 a[88:91], v[244:247], v[148:151], a[88:91]
  ds_read_b64_tr_b16 v[234:235], v12 offset:1024
  v_mfma_f32_16x16x32_bf16 a[92:95], v[252:255], v[148:151], a[92:95]
  ds_read_b64_tr_b16 v[236:237], v12 offset:8192
  v_mfma_f32_16x16x32_bf16 a[92:95], v[248:251], v[144:147], a[92:95]
  ds_read_b128 v[144:147], v5 offset:4096
  v_mfma_f32_16x16x32_bf16 a[124:127], v[248:251], v[152:155], a[124:127]
  ds_read_b128 v[148:151], v6 offset:4096
  v_mfma_f32_16x16x32_bf16 a[124:127], v[252:255], v[156:159], a[124:127]
  ds_read_b64_tr_b16 v[238:239], v12 offset:9216
  v_mfma_f32_16x16x32_bf16 a[120:123], v[244:247], v[156:159], a[120:123]
  buffer_load_dwordx4 v[96:99], v17, s[8:11], s36 offen offset:2048 sc1
  v_mfma_f32_16x16x32_bf16 a[120:123], v[240:243], v[152:155], a[120:123]
  ds_read_b128 v[152:155], v5 offset:6144
  v_mfma_f32_16x16x32_bf16 a[152:155], v[240:243], v[160:163], a[152:155]
  ds_read_b128 v[156:159], v6 offset:6144
  v_mfma_f32_16x16x32_bf16 a[152:155], v[244:247], v[164:167], a[152:155]
  buffer_load_dwordx4 v[100:103], v17, s[8:11], s37 offen offset:2048 sc1
  v_mfma_f32_16x16x32_bf16 a[156:159], v[252:255], v[164:167], a[156:159]
  buffer_load_dwordx4 v[104:107], v17, s[8:11], s38 offen offset:2048 sc1
  v_mfma_f32_16x16x32_bf16 a[156:159], v[248:251], v[160:163], a[156:159]
  ds_read_b128 v[160:163], v5 offset:8192
  v_mfma_f32_16x16x32_bf16 a[188:191], v[248:251], v[168:171], a[188:191]
  ds_read_b128 v[164:167], v6 offset:8192
  v_mfma_f32_16x16x32_bf16 a[188:191], v[252:255], v[172:175], a[188:191]
  buffer_load_dwordx4 v[108:111], v17, s[8:11], s39 offen offset:2048 sc1
  v_mfma_f32_16x16x32_bf16 a[184:187], v[244:247], v[172:175], a[184:187]
  buffer_load_dwordx4 v[112:115], v17, s[8:11], s36 offen offset:3072 sc1
  v_mfma_f32_16x16x32_bf16 a[184:187], v[240:243], v[168:171], a[184:187]
  ds_read_b128 v[168:171], v5 offset:10240
  v_mfma_f32_16x16x32_bf16 a[216:219], v[240:243], v[176:179], a[216:219]
  ds_read_b128 v[172:175], v6 offset:10240
  v_mfma_f32_16x16x32_bf16 a[216:219], v[244:247], v[180:183], a[216:219]
  buffer_load_dwordx4 v[116:119], v17, s[8:11], s37 offen offset:3072 sc1
  v_mfma_f32_16x16x32_bf16 a[220:223], v[252:255], v[180:183], a[220:223]
  buffer_load_dwordx4 v[120:123], v17, s[8:11], s38 offen offset:3072 sc1
  v_mfma_f32_16x16x32_bf16 a[220:223], v[248:251], v[176:179], a[220:223]
  ds_read_b128 v[176:179], v5 offset:12288
  v_mfma_f32_16x16x32_bf16 a[252:255], v[248:251], v[184:187], a[252:255]
  ds_read_b128 v[180:183], v6 offset:12288
  v_mfma_f32_16x16x32_bf16 a[252:255], v[252:255], v[188:191], a[252:255]
  buffer_load_dwordx4 v[124:127], v17, s[8:11], s39 offen offset:3072 sc1
  v_mfma_f32_16x16x32_bf16 a[248:251], v[244:247], v[188:191], a[248:251]
  v_mfma_f32_16x16x32_bf16 a[248:251], v[240:243], v[184:187], a[248:251]
  s_waitcnt lgkmcnt(8)
  v_mfma_f32_16x16x32_bf16 a[0:3], v[192:195], v[128:131], a[0:3]
  ds_read_b128 v[184:187], v5 offset:14336
  v_mfma_f32_16x16x32_bf16 a[0:3], v[196:199], v[132:135], a[0:3]
  ds_read_b128 v[188:191], v6 offset:14336
  v_mfma_f32_16x16x32_bf16 a[4:7], v[204:207], v[132:135], a[4:7]
  ds_read_b64_tr_b16 v[240:241], v13 offset:0
  v_mfma_f32_16x16x32_bf16 a[4:7], v[200:203], v[128:131], a[4:7]
  ds_read_b64_tr_b16 v[242:243], v13 offset:1024
  v_mfma_f32_16x16x32_bf16 a[32:35], v[192:195], v[136:139], a[32:35]
  s_add_u32 m0, s28, 98304
  ds_read_b64_tr_b16 v[244:245], v13 offset:8192
  v_mfma_f32_16x16x32_bf16 a[32:35], v[196:199], v[140:143], a[32:35]
  s_add_u32 s26, s29, s31
  ds_read_b64_tr_b16 v[246:247], v13 offset:9216
  v_mfma_f32_16x16x32_bf16 a[36:39], v[204:207], v[140:143], a[36:39]
  buffer_load_dwordx4 v15, s[4:7], s26 offen lds
  v_mfma_f32_16x16x32_bf16 a[36:39], v[200:203], v[136:139], a[36:39]
  ds_read_b64_tr_b16 v[248:249], v14 offset:0
  v_mfma_f32_16x16x32_bf16 a[8:11], v[208:211], v[128:131], a[8:11]
  ds_read_b64_tr_b16 v[250:251], v14 offset:1024
  v_mfma_f32_16x16x32_bf16 a[8:11], v[212:215], v[132:135], a[8:11]
  ds_read_b64_tr_b16 v[252:253], v14 offset:8192
  v_mfma_f32_16x16x32_bf16 a[12:15], v[220:223], v[132:135], a[12:15]
  ds_read_b64_tr_b16 v[254:255], v14 offset:9216
  v_accvgpr_read_b32 v20, a0
  v_mfma_f32_16x16x32_bf16 a[12:15], v[216:219], v[128:131], a[12:15]
  s_add_u32 s31, s31, 1048576
  v_accvgpr_read_b32 v21, a1
  v_cvt_pk_bf16_f32 v24, v20, v21
  v_mfma_f32_16x16x32_bf16 a[40:43], v[208:211], v[136:139], a[40:43]
  s_add_u32 s26, s26, 31744
  v_add_u32 v7, s30, v7
  v_add_u32 v8, s30, v8
  v_mfma_f32_16x16x32_bf16 a[40:43], v[212:215], v[140:143], a[40:43]
  buffer_load_dwordx4 v15, s[4:7], s26 offen offset:1024 lds
  v_mfma_f32_16x16x32_bf16 a[44:47], v[220:223], v[140:143], a[44:47]
  v_add_u32 v9, s30, v9
  v_add_u32 v10, s30, v10
  v_mfma_f32_16x16x32_bf16 a[44:47], v[216:219], v[136:139], a[44:47]
  v_add_u32 v11, s30, v11
  v_add_u32 v12, s30, v12
  v_mfma_f32_16x16x32_bf16 a[16:19], v[224:227], v[128:131], a[16:19]
  v_add_u32 v13, s30, v13
  v_add_u32 v14, s30, v14
  v_mfma_f32_16x16x32_bf16 a[16:19], v[228:231], v[132:135], a[16:19]
  v_accvgpr_read_b32 v22, a2
  v_accvgpr_read_b32 v23, a3
  v_mfma_f32_16x16x32_bf16 a[20:23], v[236:239], v[132:135], a[20:23]
  s_and_b32 s31, s31, 0x3fffff
  v_cvt_pk_bf16_f32 v25, v22, v23
  v_accvgpr_read_b32 v20, a4
  v_mfma_f32_16x16x32_bf16 a[20:23], v[232:235], v[128:131], a[20:23]
  s_add_u32 s26, s26, 31744
  v_accvgpr_read_b32 v21, a5
  v_cvt_pk_bf16_f32 v26, v20, v21
  v_mfma_f32_16x16x32_bf16 a[48:51], v[224:227], v[136:139], a[48:51]
  buffer_load_dwordx4 v16, s[4:7], s26 offen offset:2048 lds
  v_mfma_f32_16x16x32_bf16 a[48:51], v[228:231], v[140:143], a[48:51]
  v_accvgpr_read_b32 v22, a6
  v_accvgpr_read_b32 v23, a7
  v_mfma_f32_16x16x32_bf16 a[52:55], v[236:239], v[140:143], a[52:55]
  v_cvt_pk_bf16_f32 v27, v22, v23
  v_mfma_f32_16x16x32_bf16 a[52:55], v[232:235], v[136:139], a[52:55]
  s_waitcnt lgkmcnt(0)
  v_mfma_f32_16x16x32_bf16 a[24:27], v[240:243], v[128:131], a[24:27]
  buffer_store_dwordx4 v[24:27], v2, s[8:11], s33 offen
  v_mfma_f32_16x16x32_bf16 a[24:27], v[244:247], v[132:135], a[24:27]
  v_mfma_f32_16x16x32_bf16 a[28:31], v[252:255], v[132:135], a[28:31]
  v_mfma_f32_16x16x32_bf16 a[28:31], v[248:251], v[128:131], a[28:31]
  s_add_u32 s26, s26, 31744
  v_mfma_f32_16x16x32_bf16 a[56:59], v[240:243], v[136:139], a[56:59]
  buffer_load_dwordx4 v16, s[4:7], s26 offen offset:3072 lds
  v_mfma_f32_16x16x32_bf16 a[56:59], v[244:247], v[140:143], a[56:59]
  v_mfma_f32_16x16x32_bf16 a[60:63], v[252:255], v[140:143], a[60:63]
  v_accvgpr_read_b32 v20, a8
  v_accvgpr_read_b32 v21, a9
  v_mfma_f32_16x16x32_bf16 a[60:63], v[248:251], v[136:139], a[60:63]
  v_cvt_pk_bf16_f32 v28, v20, v21
  v_accvgpr_read_b32 v22, a10
  v_mfma_f32_16x16x32_bf16 a[64:67], v[192:195], v[144:147], a[64:67]
  s_add_u32 m0, s28, 102400
  v_accvgpr_read_b32 v23, a11
  v_cvt_pk_bf16_f32 v29, v22, v23
  v_mfma_f32_16x16x32_bf16 a[64:67], v[196:199], v[148:151], a[64:67]
  s_add_u32 s26, s26, 35840
  v_accvgpr_read_b32 v20, a12
  v_accvgpr_read_b32 v21, a13
  v_mfma_f32_16x16x32_bf16 a[68:71], v[204:207], v[148:151], a[68:71]
  buffer_load_dwordx4 v15, s[4:7], s26 offen lds
  v_mfma_f32_16x16x32_bf16 a[68:71], v[200:203], v[144:147], a[68:71]
  v_cvt_pk_bf16_f32 v30, v20, v21
  v_accvgpr_read_b32 v22, a14
  v_mfma_f32_16x16x32_bf16 a[96:99], v[192:195], v[152:155], a[96:99]
  v_accvgpr_read_b32 v23, a15
  v_cvt_pk_bf16_f32 v31, v22, v23
  v_mfma_f32_16x16x32_bf16 a[96:99], v[196:199], v[156:159], a[96:99]
  buffer_store_dwordx4 v[28:31], v2, s[8:11], s33 offen offset:1024
  v_mfma_f32_16x16x32_bf16 a[100:103], v[204:207], v[156:159], a[100:103]
  v_mfma_f32_16x16x32_bf16 a[100:103], v[200:203], v[152:155], a[100:103]
  v_mfma_f32_16x16x32_bf16 a[72:75], v[208:211], v[144:147], a[72:75]
  s_add_u32 s26, s26, 31744
  v_mfma_f32_16x16x32_bf16 a[72:75], v[212:215], v[148:151], a[72:75]
  buffer_load_dwordx4 v15, s[4:7], s26 offen offset:1024 lds
  v_mfma_f32_16x16x32_bf16 a[76:79], v[220:223], v[148:151], a[76:79]
  v_mfma_f32_16x16x32_bf16 a[76:79], v[216:219], v[144:147], a[76:79]
  v_mfma_f32_16x16x32_bf16 a[104:107], v[208:211], v[152:155], a[104:107]
  v_mfma_f32_16x16x32_bf16 a[104:107], v[212:215], v[156:159], a[104:107]
  v_mfma_f32_16x16x32_bf16 a[108:111], v[220:223], v[156:159], a[108:111]
  v_mfma_f32_16x16x32_bf16 a[108:111], v[216:219], v[152:155], a[108:111]
  s_add_u32 s26, s26, 31744
  v_mfma_f32_16x16x32_bf16 a[80:83], v[224:227], v[144:147], a[80:83]
  buffer_load_dwordx4 v16, s[4:7], s26 offen offset:2048 lds
  v_mfma_f32_16x16x32_bf16 a[80:83], v[228:231], v[148:151], a[80:83]
  v_mfma_f32_16x16x32_bf16 a[84:87], v[236:239], v[148:151], a[84:87]
  v_mfma_f32_16x16x32_bf16 a[84:87], v[232:235], v[144:147], a[84:87]
  v_mfma_f32_16x16x32_bf16 a[112:115], v[224:227], v[152:155], a[112:115]
  v_mfma_f32_16x16x32_bf16 a[112:115], v[228:231], v[156:159], a[112:115]
  v_mfma_f32_16x16x32_bf16 a[116:119], v[236:239], v[156:159], a[116:119]
  s_add_u32 s26, s26, 31744
  v_mfma_f32_16x16x32_bf16 a[116:119], v[232:235], v[152:155], a[116:119]
  buffer_load_dwordx4 v16, s[4:7], s26 offen offset:3072 lds
  v_mfma_f32_16x16x32_bf16 a[88:91], v[240:243], v[144:147], a[88:91]
  v_mfma_f32_16x16x32_bf16 a[88:91], v[244:247], v[148:151], a[88:91]
  v_mfma_f32_16x16x32_bf16 a[92:95], v[252:255], v[148:151], a[92:95]
  v_accvgpr_read_b32 v20, a16
  v_accvgpr_read_b32 v21, a17
  v_mfma_f32_16x16x32_bf16 a[92:95], v[248:251], v[144:147], a[92:95]
  v_cvt_pk_bf16_f32 v24, v20, v21
  v_accvgpr_read_b32 v22, a18
  v_mfma_f32_16x16x32_bf16 a[120:123], v[240:243], v[152:155], a[120:123]
  v_accvgpr_read_b32 v23, a19
  v_cvt_pk_bf16_f32 v25, v22, v23
  v_mfma_f32_16x16x32_bf16 a[120:123], v[244:247], v[156:159], a[120:123]
  v_accvgpr_read_b32 v20, a20
  v_accvgpr_read_b32 v21, a21
  v_mfma_f32_16x16x32_bf16 a[124:127], v[252:255], v[156:159], a[124:127]
  v_cvt_pk_bf16_f32 v26, v20, v21
  v_accvgpr_read_b32 v22, a22
  v_mfma_f32_16x16x32_bf16 a[124:127], v[248:251], v[152:155], a[124:127]
  s_waitcnt vmcnt(26) lgkmcnt(0)
  s_barrier
  v_mfma_f32_16x16x32_bf16 a[128:131], v[192:195], v[160:163], a[128:131]
  s_add_u32 m0, s28, 131072
  v_accvgpr_read_b32 v23, a23
  v_cvt_pk_bf16_f32 v27, v22, v23
  v_mfma_f32_16x16x32_bf16 a[128:131], v[196:199], v[164:167], a[128:131]
  s_add_u32 s26, s29, s31
  v_mfma_f32_16x16x32_bf16 a[132:135], v[204:207], v[164:167], a[132:135]
  buffer_load_dwordx4 v15, s[4:7], s26 offen lds
  v_mfma_f32_16x16x32_bf16 a[132:135], v[200:203], v[160:163], a[132:135]
  buffer_store_dwordx4 v[24:27], v2, s[8:11], s33 offen offset:2048
  v_mfma_f32_16x16x32_bf16 a[160:163], v[192:195], v[168:171], a[160:163]
  v_mfma_f32_16x16x32_bf16 a[160:163], v[196:199], v[172:175], a[160:163]
  v_mfma_f32_16x16x32_bf16 a[164:167], v[204:207], v[172:175], a[164:167]
  v_mfma_f32_16x16x32_bf16 a[164:167], v[200:203], v[168:171], a[164:167]
  s_add_u32 s31, s31, 1048576
  v_mfma_f32_16x16x32_bf16 a[136:139], v[208:211], v[160:163], a[136:139]
  s_add_u32 s26, s26, 31744
  v_mfma_f32_16x16x32_bf16 a[136:139], v[212:215], v[164:167], a[136:139]
  buffer_load_dwordx4 v15, s[4:7], s26 offen offset:1024 lds
  v_mfma_f32_16x16x32_bf16 a[140:143], v[220:223], v[164:167], a[140:143]
  v_mfma_f32_16x16x32_bf16 a[140:143], v[216:219], v[160:163], a[140:143]
  v_mfma_f32_16x16x32_bf16 a[168:171], v[208:211], v[168:171], a[168:171]
  v_mfma_f32_16x16x32_bf16 a[168:171], v[212:215], v[172:175], a[168:171]
  v_mfma_f32_16x16x32_bf16 a[172:175], v[220:223], v[172:175], a[172:175]
  s_and_b32 s31, s31, 0x3fffff
  v_mfma_f32_16x16x32_bf16 a[172:175], v[216:219], v[168:171], a[172:175]
  s_add_u32 s26, s26, 31744
  v_mfma_f32_16x16x32_bf16 a[144:147], v[224:227], v[160:163], a[144:147]
  buffer_load_dwordx4 v16, s[4:7], s26 offen offset:2048 lds
  v_mfma_f32_16x16x32_bf16 a[144:147], v[228:231], v[164:167], a[144:147]
  v_mfma_f32_16x16x32_bf16 a[148:151], v[236:239], v[164:167], a[148:151]
  v_mfma_f32_16x16x32_bf16 a[148:151], v[232:235], v[160:163], a[148:151]
  v_mfma_f32_16x16x32_bf16 a[176:179], v[224:227], v[168:171], a[176:179]
  v_mfma_f32_16x16x32_bf16 a[176:179], v[228:231], v[172:175], a[176:179]
  v_mfma_f32_16x16x32_bf16 a[180:183], v[236:239], v[172:175], a[180:183]
  s_add_u32 s26, s26, 31744
  v_accvgpr_read_b32 v20, a24
  v_accvgpr_read_b32 v21, a25
  v_mfma_f32_16x16x32_bf16 a[180:183], v[232:235], v[168:171], a[180:183]
  buffer_load_dwordx4 v16, s[4:7], s26 offen offset:3072 lds
  v_mfma_f32_16x16x32_bf16 a[152:155], v[240:243], v[160:163], a[152:155]
  ds_read_b64_tr_b16 v[32:33], v7 offset:0
  v_cvt_pk_bf16_f32 v28, v20, v21
  v_mfma_f32_16x16x32_bf16 a[152:155], v[244:247], v[164:167], a[152:155]
  v_accvgpr_read_b32 v22, a26
  v_accvgpr_read_b32 v23, a27
  v_mfma_f32_16x16x32_bf16 a[156:159], v[252:255], v[164:167], a[156:159]
  ds_read_b64_tr_b16 v[34:35], v7 offset:1024
  v_cvt_pk_bf16_f32 v29, v22, v23
  v_mfma_f32_16x16x32_bf16 a[156:159], v[248:251], v[160:163], a[156:159]
  v_accvgpr_read_b32 v20, a28
  v_accvgpr_read_b32 v21, a29
  v_mfma_f32_16x16x32_bf16 a[184:187], v[240:243], v[168:171], a[184:187]
  s_add_u32 m0, s28, 135168
  ds_read_b64_tr_b16 v[36:37], v8 offset:0
  v_cvt_pk_bf16_f32 v30, v20, v21
  v_mfma_f32_16x16x32_bf16 a[184:187], v[244:247], v[172:175], a[184:187]
  s_add_u32 s26, s26, 35840
  v_accvgpr_read_b32 v22, a30
  v_accvgpr_read_b32 v23, a31
  v_mfma_f32_16x16x32_bf16 a[188:191], v[252:255], v[172:175], a[188:191]
  buffer_load_dwordx4 v15, s[4:7], s26 offen lds
  v_mfma_f32_16x16x32_bf16 a[188:191], v[248:251], v[168:171], a[188:191]
  ds_read_b64_tr_b16 v[38:39], v8 offset:1024
  v_cvt_pk_bf16_f32 v31, v22, v23
  v_mfma_f32_16x16x32_bf16 a[192:195], v[192:195], v[176:179], a[192:195]
  buffer_store_dwordx4 v[28:31], v2, s[8:11], s33 offen offset:3072
  v_mfma_f32_16x16x32_bf16 a[192:195], v[196:199], v[180:183], a[192:195]
  ds_read_b64_tr_b16 v[40:41], v9 offset:0
  v_mfma_f32_16x16x32_bf16 a[196:199], v[204:207], v[180:183], a[196:199]
  v_mfma_f32_16x16x32_bf16 a[196:199], v[200:203], v[176:179], a[196:199]
  ds_read_b64_tr_b16 v[42:43], v9 offset:1024
  v_mfma_f32_16x16x32_bf16 a[224:227], v[192:195], v[184:187], a[224:227]
  s_add_u32 s26, s26, 31744
  v_mfma_f32_16x16x32_bf16 a[224:227], v[196:199], v[188:191], a[224:227]
  buffer_load_dwordx4 v15, s[4:7], s26 offen offset:1024 lds
  v_mfma_f32_16x16x32_bf16 a[228:231], v[204:207], v[188:191], a[228:231]
  ds_read_b64_tr_b16 v[44:45], v10 offset:0
  v_mfma_f32_16x16x32_bf16 a[228:231], v[200:203], v[184:187], a[228:231]
  v_mfma_f32_16x16x32_bf16 a[200:203], v[208:211], v[176:179], a[200:203]
  ds_read_b64_tr_b16 v[46:47], v10 offset:1024
  v_mfma_f32_16x16x32_bf16 a[200:203], v[212:215], v[180:183], a[200:203]
  v_mfma_f32_16x16x32_bf16 a[204:207], v[220:223], v[180:183], a[204:207]
  ds_read_b64_tr_b16 v[48:49], v11 offset:0
  v_mfma_f32_16x16x32_bf16 a[204:207], v[216:219], v[176:179], a[204:207]
  s_add_u32 s26, s26, 31744
  v_mfma_f32_16x16x32_bf16 a[232:235], v[208:211], v[184:187], a[232:235]
  buffer_load_dwordx4 v16, s[4:7], s26 offen offset:2048 lds
  v_mfma_f32_16x16x32_bf16 a[232:235], v[212:215], v[188:191], a[232:235]
  ds_read_b64_tr_b16 v[50:51], v11 offset:1024
  v_mfma_f32_16x16x32_bf16 a[236:239], v[220:223], v[188:191], a[236:239]
  v_mfma_f32_16x16x32_bf16 a[236:239], v[216:219], v[184:187], a[236:239]
  ds_read_b64_tr_b16 v[52:53], v12 offset:0
  v_mfma_f32_16x16x32_bf16 a[208:211], v[224:227], v[176:179], a[208:211]
  v_mfma_f32_16x16x32_bf16 a[208:211], v[228:231], v[180:183], a[208:211]
  ds_read_b64_tr_b16 v[54:55], v12 offset:1024
  v_mfma_f32_16x16x32_bf16 a[212:215], v[236:239], v[180:183], a[212:215]
  s_add_u32 s26, s26, 31744
  v_mfma_f32_16x16x32_bf16 a[212:215], v[232:235], v[176:179], a[212:215]
  buffer_load_dwordx4 v16, s[4:7], s26 offen offset:3072 lds
  v_mfma_f32_16x16x32_bf16 a[240:243], v[224:227], v[184:187], a[240:243]
  ds_read_b64_tr_b16 v[56:57], v13 offset:0
  v_mfma_f32_16x16x32_bf16 a[240:243], v[228:231], v[188:191], a[240:243]
  v_mfma_f32_16x16x32_bf16 a[244:247], v[236:239], v[188:191], a[244:247]
  ds_read_b64_tr_b16 v[58:59], v13 offset:1024
  v_mfma_f32_16x16x32_bf16 a[244:247], v[232:235], v[184:187], a[244:247]
  v_mfma_f32_16x16x32_bf16 a[216:219], v[240:243], v[176:179], a[216:219]
  v_mfma_f32_16x16x32_bf16 a[216:219], v[244:247], v[180:183], a[216:219]
  v_mfma_f32_16x16x32_bf16 a[220:223], v[252:255], v[180:183], a[220:223]
  v_mfma_f32_16x16x32_bf16 a[220:223], v[248:251], v[176:179], a[220:223]
  v_mfma_f32_16x16x32_bf16 a[248:251], v[240:243], v[184:187], a[248:251]
  v_mfma_f32_16x16x32_bf16 a[248:251], v[244:247], v[188:191], a[248:251]
  v_mfma_f32_16x16x32_bf16 a[252:255], v[252:255], v[188:191], a[252:255]
  v_mfma_f32_16x16x32_bf16 a[252:255], v[248:251], v[184:187], a[252:255]
  s_waitcnt vmcnt(48) lgkmcnt(6)
  s_branch L_q
L_kv_v:
  ds_read_b64_tr_b16 v[192:193], v7 offset:32768
  ds_read_b64_tr_b16 v[194:195], v7 offset:33792
  ds_read_b64_tr_b16 v[196:197], v7 offset:40960
  ds_read_b64_tr_b16 v[198:199], v7 offset:41984
  ds_read_b64_tr_b16 v[200:201], v8 offset:32768
  ds_read_b64_tr_b16 v[202:203], v8 offset:33792
  ds_read_b64_tr_b16 v[204:205], v8 offset:40960
  ds_read_b64_tr_b16 v[206:207], v8 offset:41984
  ds_read_b128 v[128:131], v5 offset:0
  ds_read_b128 v[132:135], v6 offset:0
  s_mov_b32 s72, s58
  s_mov_b32 s73, s59
  s_waitcnt lgkmcnt(0)
  v_mfma_f32_16x16x32_bf16 a[0:3], v[128:131], v[192:195], 0
  s_add_u32 m0, s28, 98304
  v_mov_b32 v20, 0
  v_and_b32 v21, 31, v1
  v_mfma_f32_16x16x32_bf16 a[0:3], v[132:135], v[196:199], a[0:3]
  s_add_u32 s27, s30, s32
  v_lshlrev_b32 v18, 2, v21
  v_lshlrev_b32 v26, 3, v21
  v_mfma_f32_16x16x32_bf16 a[8:11], v[132:135], v[204:207], 0
  buffer_load_dwordx4 v15, s[12:15], s27 offen lds
  s_add_u32 s32, s32, 524288
  v_mfma_f32_16x16x32_bf16 a[8:11], v[128:131], v[200:203], a[8:11]
  s_add_u32 s27, s27, 31744
  ds_read_b128 v[136:139], v5 offset:2048
  ds_read_b128 v[140:143], v6 offset:2048
  s_waitcnt lgkmcnt(0)
  v_mfma_f32_16x16x32_bf16 a[12:15], v[136:139], v[200:203], 0
  buffer_load_dwordx4 v15, s[12:15], s27 offen offset:1024 lds
  s_and_b32 s32, s32, 0x3fffff
  v_mfma_f32_16x16x32_bf16 a[12:15], v[140:143], v[204:207], a[12:15]
  s_add_u32 s27, s27, 31744
  v_mfma_f32_16x16x32_bf16 a[4:7], v[140:143], v[196:199], 0
  buffer_load_dwordx4 v16, s[12:15], s27 offen offset:2048 lds
  v_mfma_f32_16x16x32_bf16 a[4:7], v[136:139], v[192:195], a[4:7]
  s_add_u32 s27, s27, 31744
  ds_read_b128 v[144:147], v5 offset:4096
  ds_read_b128 v[148:151], v6 offset:4096
  s_waitcnt lgkmcnt(0)
  v_mfma_f32_16x16x32_bf16 a[64:67], v[144:147], v[192:195], 0
  buffer_load_dwordx4 v16, s[12:15], s27 offen offset:3072 lds
  s_add_u32 m0, s28, 102400
  v_mfma_f32_16x16x32_bf16 a[64:67], v[148:151], v[196:199], a[64:67]
  s_add_u32 s27, s27, 35840
  v_mfma_f32_16x16x32_bf16 a[72:75], v[148:151], v[204:207], 0
  buffer_load_dwordx4 v15, s[12:15], s27 offen lds
  v_mfma_f32_16x16x32_bf16 a[72:75], v[144:147], v[200:203], a[72:75]
  s_add_u32 s27, s27, 31744
  ds_read_b128 v[152:155], v5 offset:6144
  ds_read_b128 v[156:159], v6 offset:6144
  s_waitcnt lgkmcnt(0)
  v_mfma_f32_16x16x32_bf16 a[76:79], v[152:155], v[200:203], 0
  buffer_load_dwordx4 v15, s[12:15], s27 offen offset:1024 lds
  v_mfma_f32_16x16x32_bf16 a[76:79], v[156:159], v[204:207], a[76:79]
  s_add_u32 s27, s27, 31744
  v_mfma_f32_16x16x32_bf16 a[68:71], v[156:159], v[196:199], 0
  buffer_load_dwordx4 v16, s[12:15], s27 offen offset:2048 lds
  v_mfma_f32_16x16x32_bf16 a[68:71], v[152:155], v[192:195], a[68:71]
  s_add_u32 s27, s27, 31744
  ds_read_b128 v[160:163], v5 offset:8192
  ds_read_b128 v[164:167], v6 offset:8192
  s_waitcnt lgkmcnt(0)
  v_mfma_f32_16x16x32_bf16 a[128:131], v[160:163], v[192:195], 0
  buffer_load_dwordx4 v16, s[12:15], s27 offen offset:3072 lds
  s_add_u32 m0, s28, 131072
  v_mfma_f32_16x16x32_bf16 a[128:131], v[164:167], v[196:199], a[128:131]
  s_add_u32 s26, s29, s31
  v_mfma_f32_16x16x32_bf16 a[136:139], v[164:167], v[204:207], 0
  buffer_load_dwordx4 v3, s[4:7], s26 offen lds
  v_mfma_f32_16x16x32_bf16 a[136:139], v[160:163], v[200:203], a[136:139]
  s_lshl_b32 s25, s2, 7
  ds_read_b128 v[168:171], v5 offset:10240
  ds_read_b128 v[172:175], v6 offset:10240
  s_waitcnt lgkmcnt(0)
  v_mfma_f32_16x16x32_bf16 a[140:143], v[168:171], v[200:203], 0
  s_add_u32 s31, s31, 128
  v_mfma_f32_16x16x32_bf16 a[140:143], v[172:175], v[204:207], a[140:143]
  s_add_u32 s26, s26, 7168
  v_mfma_f32_16x16x32_bf16 a[132:135], v[172:175], v[196:199], 0
  buffer_load_dwordx4 v4, s[4:7], s26 offen offset:1024 lds
  v_mfma_f32_16x16x32_bf16 a[132:135], v[168:171], v[192:195], a[132:135]
  s_add_u32 s25, s25, 73400320
  ds_read_b128 v[176:179], v5 offset:12288
  ds_read_b128 v[180:183], v6 offset:12288
  s_waitcnt lgkmcnt(0)
  v_mfma_f32_16x16x32_bf16 a[192:195], v[176:179], v[192:195], 0
  s_and_b32 s31, s31, 0x3ff
  v_mfma_f32_16x16x32_bf16 a[192:195], v[180:183], v[196:199], a[192:195]
  s_add_u32 s26, s26, 7168
  v_mfma_f32_16x16x32_bf16 a[200:203], v[180:183], v[204:207], 0
  buffer_load_dwordx4 v3, s[4:7], s26 offen offset:2048 lds
  v_mfma_f32_16x16x32_bf16 a[200:203], v[176:179], v[200:203], a[200:203]
  s_and_b32 s35, s2, 31
  ds_read_b128 v[184:187], v5 offset:14336
  ds_read_b128 v[188:191], v6 offset:14336
  s_waitcnt lgkmcnt(0)
  v_mfma_f32_16x16x32_bf16 a[204:207], v[184:187], v[200:203], 0
  s_lshl_b32 s35, s35, 3
  v_mfma_f32_16x16x32_bf16 a[204:207], v[188:191], v[204:207], a[204:207]
  s_add_u32 s26, s26, 7168
  v_mfma_f32_16x16x32_bf16 a[196:199], v[188:191], v[196:199], 0
  buffer_load_dwordx4 v4, s[4:7], s26 offen offset:3072 lds
  v_mfma_f32_16x16x32_bf16 a[196:199], v[184:187], v[192:195], a[196:199]
  s_getreg_b32 s3, hwreg(HW_REG_XCC_ID, 0, 3)
  ds_read_b64_tr_b16 v[208:209], v9 offset:32768
  ds_read_b64_tr_b16 v[210:211], v9 offset:33792
  ds_read_b64_tr_b16 v[212:213], v9 offset:40960
  ds_read_b64_tr_b16 v[214:215], v9 offset:41984
  ds_read_b64_tr_b16 v[216:217], v10 offset:32768
  ds_read_b64_tr_b16 v[218:219], v10 offset:33792
  ds_read_b64_tr_b16 v[220:221], v10 offset:40960
  ds_read_b64_tr_b16 v[222:223], v10 offset:41984
  s_waitcnt lgkmcnt(0)
  v_mfma_f32_16x16x32_bf16 a[16:19], v[128:131], v[208:211], 0
  s_add_u32 m0, s28, 135168
  v_mfma_f32_16x16x32_bf16 a[16:19], v[132:135], v[212:215], a[16:19]
  s_add_u32 s26, s26, 502784
  v_mfma_f32_16x16x32_bf16 a[24:27], v[132:135], v[220:223], 0
  buffer_load_dwordx4 v3, s[4:7], s26 offen lds
  v_mfma_f32_16x16x32_bf16 a[24:27], v[128:131], v[216:219], a[24:27]
  s_lshl_b32 s3, s3, 2
  v_mfma_f32_16x16x32_bf16 a[28:31], v[136:139], v[216:219], 0
  s_lshl_b32 s3, 1, s3
  v_mfma_f32_16x16x32_bf16 a[28:31], v[140:143], v[220:223], a[28:31]
  s_add_u32 s26, s26, 7168
  v_mfma_f32_16x16x32_bf16 a[20:23], v[140:143], v[212:215], 0
  buffer_load_dwordx4 v4, s[4:7], s26 offen offset:1024 lds
  v_mfma_f32_16x16x32_bf16 a[20:23], v[136:139], v[208:211], a[20:23]
  v_mfma_f32_16x16x32_bf16 a[80:83], v[144:147], v[208:211], 0
  v_mfma_f32_16x16x32_bf16 a[80:83], v[148:151], v[212:215], a[80:83]
  s_add_u32 s26, s26, 7168
  v_mfma_f32_16x16x32_bf16 a[88:91], v[148:151], v[220:223], 0
  buffer_load_dwordx4 v3, s[4:7], s26 offen offset:2048 lds
  v_mfma_f32_16x16x32_bf16 a[88:91], v[144:147], v[216:219], a[88:91]
  ds_read_b64_tr_b16 v[224:225], v11 offset:32768
  ds_read_b64_tr_b16 v[226:227], v11 offset:33792
  ds_read_b64_tr_b16 v[228:229], v11 offset:40960
  ds_read_b64_tr_b16 v[230:231], v11 offset:41984
  ds_read_b64_tr_b16 v[232:233], v12 offset:32768
  ds_read_b64_tr_b16 v[234:235], v12 offset:33792
  ds_read_b64_tr_b16 v[236:237], v12 offset:40960
  ds_read_b64_tr_b16 v[238:239], v12 offset:41984
  s_waitcnt lgkmcnt(0)
  v_mfma_f32_16x16x32_bf16 a[92:95], v[152:155], v[216:219], 0
  v_mfma_f32_16x16x32_bf16 a[92:95], v[156:159], v[220:223], a[92:95]
  s_add_u32 s26, s26, 7168
  v_mfma_f32_16x16x32_bf16 a[84:87], v[156:159], v[212:215], 0
  buffer_load_dwordx4 v4, s[4:7], s26 offen offset:3072 lds
  v_mfma_f32_16x16x32_bf16 a[84:87], v[152:155], v[208:211], a[84:87]
  v_mfma_f32_16x16x32_bf16 a[144:147], v[160:163], v[208:211], 0
  v_mfma_f32_16x16x32_bf16 a[144:147], v[164:167], v[212:215], a[144:147]
  v_mfma_f32_16x16x32_bf16 a[152:155], v[164:167], v[220:223], 0
  v_mfma_f32_16x16x32_bf16 a[152:155], v[160:163], v[216:219], a[152:155]
  v_mfma_f32_16x16x32_bf16 a[156:159], v[168:171], v[216:219], 0
  ds_read_b64_tr_b16 v[240:241], v13 offset:32768
  ds_read_b64_tr_b16 v[242:243], v13 offset:33792
  ds_read_b64_tr_b16 v[244:245], v13 offset:40960
  ds_read_b64_tr_b16 v[246:247], v13 offset:41984
  ds_read_b64_tr_b16 v[248:249], v14 offset:32768
  ds_read_b64_tr_b16 v[250:251], v14 offset:33792
  ds_read_b64_tr_b16 v[252:253], v14 offset:40960
  ds_read_b64_tr_b16 v[254:255], v14 offset:41984
  s_waitcnt lgkmcnt(0)
  v_mfma_f32_16x16x32_bf16 a[156:159], v[172:175], v[220:223], a[156:159]
  v_mfma_f32_16x16x32_bf16 a[148:151], v[172:175], v[212:215], 0
  v_mfma_f32_16x16x32_bf16 a[148:151], v[168:171], v[208:211], a[148:151]
  v_mfma_f32_16x16x32_bf16 a[208:211], v[176:179], v[208:211], 0
  v_add_u32 v5, 0x10000, v5
  v_add_u32 v6, 0x10000, v6
  v_mfma_f32_16x16x32_bf16 a[208:211], v[180:183], v[212:215], a[208:211]
  v_add_u32 v7, 0x10000, v7
  v_add_u32 v8, 0x10000, v8
  v_mfma_f32_16x16x32_bf16 a[216:219], v[180:183], v[220:223], 0
  v_add_u32 v9, 0x10000, v9
  v_add_u32 v10, 0x10000, v10
  v_mfma_f32_16x16x32_bf16 a[216:219], v[176:179], v[216:219], a[216:219]
  v_add_u32 v11, 0x10000, v11
  v_add_u32 v12, 0x10000, v12
  v_mfma_f32_16x16x32_bf16 a[220:223], v[184:187], v[216:219], 0
  v_add_u32 v13, 0x10000, v13
  v_add_u32 v14, 0x10000, v14
  v_mfma_f32_16x16x32_bf16 a[220:223], v[188:191], v[220:223], a[220:223]
  v_mfma_f32_16x16x32_bf16 a[212:215], v[188:191], v[212:215], 0
  v_mfma_f32_16x16x32_bf16 a[212:215], v[184:187], v[208:211], a[212:215]
  s_waitcnt vmcnt(8) lgkmcnt(0)
  s_barrier
  v_mfma_f32_16x16x32_bf16 a[32:35], v[128:131], v[224:227], 0
  s_add_u32 m0, s28, 0
  ds_read_b64_tr_b16 v[192:193], v7 offset:32768
  v_and_b32 v27, 15, v1
  v_mfma_f32_16x16x32_bf16 a[32:35], v[132:135], v[228:231], a[32:35]
  s_add_u32 s27, s30, s32
  ds_read_b64_tr_b16 v[194:195], v7 offset:33792
  v_lshrrev_b32 v28, 4, v1
  v_mfma_f32_16x16x32_bf16 a[40:43], v[132:135], v[236:239], 0
  buffer_load_dwordx4 v15, s[12:15], s27 offen lds
  v_mfma_f32_16x16x32_bf16 a[40:43], v[128:131], v[232:235], a[40:43]
  ds_read_b64_tr_b16 v[196:197], v7 offset:40960
  v_mul_u32_u24 v30, 1024, v27
  v_mfma_f32_16x16x32_bf16 a[44:47], v[136:139], v[232:235], 0
  s_add_u32 s32, s32, 524288
  ds_read_b64_tr_b16 v[198:199], v7 offset:41984
  v_lshl_add_u32 v30, v28, 4, v30
  v_mfma_f32_16x16x32_bf16 a[44:47], v[140:143], v[236:239], a[44:47]
  s_add_u32 s27, s27, 31744
  ds_read_b64_tr_b16 v[200:201], v8 offset:32768
  v_add_u32 v25, 16384, v30
  v_mfma_f32_16x16x32_bf16 a[36:39], v[140:143], v[228:231], 0
  buffer_load_dwordx4 v15, s[12:15], s27 offen offset:1024 lds
  v_mfma_f32_16x16x32_bf16 a[36:39], v[136:139], v[224:227], a[36:39]
  ds_read_b64_tr_b16 v[202:203], v8 offset:33792
  v_mfma_f32_16x16x32_bf16 a[96:99], v[144:147], v[224:227], 0
  s_and_b32 s32, s32, 0x3fffff
  ds_read_b64_tr_b16 v[204:205], v8 offset:40960
  v_mfma_f32_16x16x32_bf16 a[96:99], v[148:151], v[228:231], a[96:99]
  s_add_u32 s27, s27, 31744
  ds_read_b64_tr_b16 v[206:207], v8 offset:41984
  v_mfma_f32_16x16x32_bf16 a[104:107], v[148:151], v[236:239], 0
  buffer_load_dwordx4 v16, s[12:15], s27 offen offset:2048 lds
  v_mfma_f32_16x16x32_bf16 a[104:107], v[144:147], v[232:235], a[104:107]
  ds_read_b64_tr_b16 v[208:209], v9 offset:32768
  v_mfma_f32_16x16x32_bf16 a[108:111], v[152:155], v[232:235], 0
  ds_read_b64_tr_b16 v[210:211], v9 offset:33792
  v_mfma_f32_16x16x32_bf16 a[108:111], v[156:159], v[236:239], a[108:111]
  s_add_u32 s27, s27, 31744
  ds_read_b64_tr_b16 v[212:213], v9 offset:40960
  v_mfma_f32_16x16x32_bf16 a[100:103], v[156:159], v[228:231], 0
  buffer_load_dwordx4 v16, s[12:15], s27 offen offset:3072 lds
  v_mfma_f32_16x16x32_bf16 a[100:103], v[152:155], v[224:227], a[100:103]
  ds_read_b64_tr_b16 v[214:215], v9 offset:41984
  v_mfma_f32_16x16x32_bf16 a[160:163], v[160:163], v[224:227], 0
  s_add_u32 m0, s28, 4096
  ds_read_b64_tr_b16 v[216:217], v10 offset:32768
  v_mfma_f32_16x16x32_bf16 a[160:163], v[164:167], v[228:231], a[160:163]
  s_add_u32 s27, s27, 35840
  ds_read_b64_tr_b16 v[218:219], v10 offset:33792
  v_lshlrev_b32 v28, 3, v28
  v_mfma_f32_16x16x32_bf16 a[168:171], v[164:167], v[236:239], 0
  buffer_load_dwordx4 v15, s[12:15], s27 offen lds
  v_mfma_f32_16x16x32_bf16 a[168:171], v[160:163], v[232:235], a[168:171]
  ds_read_b64_tr_b16 v[220:221], v10 offset:40960
  v_sub_u32 v28, v27, v28
  v_mfma_f32_16x16x32_bf16 a[172:175], v[168:171], v[232:235], 0
  ds_read_b64_tr_b16 v[222:223], v10 offset:41984
  v_and_b32 v27, 1, v27
  v_mfma_f32_16x16x32_bf16 a[172:175], v[172:175], v[236:239], a[172:175]
  s_add_u32 s27, s27, 31744
  v_lshlrev_b32 v27, 4, v27
  v_mov_b32 v29, 0x3f80
  v_mfma_f32_16x16x32_bf16 a[164:167], v[172:175], v[228:231], 0
  buffer_load_dwordx4 v15, s[12:15], s27 offen offset:1024 lds
  v_mfma_f32_16x16x32_bf16 a[164:167], v[168:171], v[224:227], a[164:167]
  v_lshlrev_b32 v27, v27, v29
  v_ashrrev_i32 v28, 1, v28
  v_mfma_f32_16x16x32_bf16 a[224:227], v[176:179], v[224:227], 0
  v_cmp_eq_i32 vcc, 0, v28
  s_nop 1
  v_mfma_f32_16x16x32_bf16 a[224:227], v[180:183], v[228:231], a[224:227]
  s_add_u32 s27, s27, 31744
  v_cndmask_b32 v48, 0, v27, vcc
  v_cmp_eq_i32 vcc, 1, v28
  v_mfma_f32_16x16x32_bf16 a[232:235], v[180:183], v[236:239], 0
  buffer_load_dwordx4 v16, s[12:15], s27 offen offset:2048 lds
  v_mfma_f32_16x16x32_bf16 a[232:235], v[176:179], v[232:235], a[232:235]
  buffer_store_dword v20, v18, s[8:11], s25 offen sc1
  v_mfma_f32_16x16x32_bf16 a[236:239], v[184:187], v[232:235], 0
  s_nop 1
  v_cndmask_b32 v49, 0, v27, vcc
  v_cmp_eq_i32 vcc, 2, v28
  v_mfma_f32_16x16x32_bf16 a[236:239], v[188:191], v[236:239], a[236:239]
  s_add_u32 s27, s27, 31744
  s_nop 1
  v_cndmask_b32 v50, 0, v27, vcc
  v_mfma_f32_16x16x32_bf16 a[228:231], v[188:191], v[228:231], 0
  buffer_load_dwordx4 v16, s[12:15], s27 offen offset:3072 lds
  v_mfma_f32_16x16x32_bf16 a[228:231], v[184:187], v[224:227], a[228:231]
  v_cmp_eq_i32 vcc, 3, v28
  s_nop 1
  v_mfma_f32_16x16x32_bf16 a[48:51], v[128:131], v[240:243], 0
  v_cndmask_b32 v51, 0, v27, vcc
  v_cmp_eq_i32 vcc, -8, v28
  v_mfma_f32_16x16x32_bf16 a[48:51], v[132:135], v[244:247], a[48:51]
  s_nop 1
  v_cndmask_b32 v52, 0, v27, vcc
  v_cmp_eq_i32 vcc, -7, v28
  v_mfma_f32_16x16x32_bf16 a[56:59], v[132:135], v[252:255], 0
  s_nop 1
  v_cndmask_b32 v53, 0, v27, vcc
  v_cmp_eq_i32 vcc, -6, v28
  v_mfma_f32_16x16x32_bf16 a[56:59], v[128:131], v[248:251], a[56:59]
  ds_read_b128 v[128:131], v5 offset:0
  ds_read_b128 v[132:135], v6 offset:0
  s_waitcnt lgkmcnt(0)
  v_mfma_f32_16x16x32_bf16 a[60:63], v[136:139], v[248:251], 0
  s_nop 1
  v_cndmask_b32 v54, 0, v27, vcc
  v_cmp_eq_i32 vcc, -5, v28
  v_mfma_f32_16x16x32_bf16 a[60:63], v[140:143], v[252:255], a[60:63]
  s_nop 1
  v_cndmask_b32 v55, 0, v27, vcc
  v_mfma_f32_16x16x32_bf16 a[52:55], v[140:143], v[244:247], 0
  v_mfma_f32_16x16x32_bf16 a[52:55], v[136:139], v[240:243], a[52:55]
  ds_read_b128 v[136:139], v5 offset:2048
  ds_read_b128 v[140:143], v6 offset:2048
  s_waitcnt lgkmcnt(0)
  v_mfma_f32_16x16x32_bf16 a[112:115], v[144:147], v[240:243], 0
  v_mfma_f32_16x16x32_bf16 a[112:115], v[148:151], v[244:247], a[112:115]
  v_mfma_f32_16x16x32_bf16 a[120:123], v[148:151], v[252:255], 0
  v_mfma_f32_16x16x32_bf16 a[120:123], v[144:147], v[248:251], a[120:123]
  ds_read_b128 v[144:147], v5 offset:4096
  ds_read_b128 v[148:151], v6 offset:4096
  s_waitcnt lgkmcnt(0)
  v_mfma_f32_16x16x32_bf16 a[124:127], v[152:155], v[248:251], 0
  v_mfma_f32_16x16x32_bf16 a[124:127], v[156:159], v[252:255], a[124:127]
  v_mfma_f32_16x16x32_bf16 a[116:119], v[156:159], v[244:247], 0
  v_mfma_f32_16x16x32_bf16 a[116:119], v[152:155], v[240:243], a[116:119]
  ds_read_b128 v[152:155], v5 offset:6144
  ds_read_b128 v[156:159], v6 offset:6144
  s_waitcnt lgkmcnt(0)
  v_mfma_f32_16x16x32_bf16 a[176:179], v[160:163], v[240:243], 0
  v_mfma_f32_16x16x32_bf16 a[176:179], v[164:167], v[244:247], a[176:179]
  v_mfma_f32_16x16x32_bf16 a[184:187], v[164:167], v[252:255], 0
  v_mfma_f32_16x16x32_bf16 a[184:187], v[160:163], v[248:251], a[184:187]
  ds_read_b128 v[160:163], v5 offset:8192
  ds_read_b128 v[164:167], v6 offset:8192
  s_waitcnt lgkmcnt(0)
  v_mfma_f32_16x16x32_bf16 a[188:191], v[168:171], v[248:251], 0
  v_mfma_f32_16x16x32_bf16 a[188:191], v[172:175], v[252:255], a[188:191]
  v_mfma_f32_16x16x32_bf16 a[180:183], v[172:175], v[244:247], 0
  v_mfma_f32_16x16x32_bf16 a[180:183], v[168:171], v[240:243], a[180:183]
  ds_read_b128 v[168:171], v5 offset:10240
  ds_read_b128 v[172:175], v6 offset:10240
  s_waitcnt lgkmcnt(0)
  v_mfma_f32_16x16x32_bf16 a[240:243], v[176:179], v[240:243], 0
  v_mfma_f32_16x16x32_bf16 a[240:243], v[180:183], v[244:247], a[240:243]
  v_mfma_f32_16x16x32_bf16 a[248:251], v[180:183], v[252:255], 0
  v_mfma_f32_16x16x32_bf16 a[248:251], v[176:179], v[248:251], a[248:251]
  ds_read_b128 v[176:179], v5 offset:12288
  ds_read_b128 v[180:183], v6 offset:12288
  s_waitcnt lgkmcnt(0)
  v_mfma_f32_16x16x32_bf16 a[252:255], v[184:187], v[248:251], 0
  v_mfma_f32_16x16x32_bf16 a[252:255], v[188:191], v[252:255], a[252:255]
  v_mfma_f32_16x16x32_bf16 a[244:247], v[188:191], v[244:247], 0
  v_mfma_f32_16x16x32_bf16 a[244:247], v[184:187], v[240:243], a[244:247]
  s_waitcnt lgkmcnt(10)
  v_mfma_f32_16x16x32_bf16 a[0:3], v[128:131], v[192:195], a[0:3]
  ds_read_b128 v[184:187], v5 offset:14336
  v_mfma_f32_16x16x32_bf16 a[0:3], v[132:135], v[196:199], a[0:3]
  ds_read_b128 v[188:191], v6 offset:14336
  v_mfma_f32_16x16x32_bf16 a[8:11], v[132:135], v[204:207], a[8:11]
  ds_read_b64_tr_b16 v[224:225], v11 offset:32768
  v_mfma_f32_16x16x32_bf16 a[8:11], v[128:131], v[200:203], a[8:11]
  v_mfma_f32_16x16x32_bf16 a[12:15], v[136:139], v[200:203], a[12:15]
  s_add_u32 m0, s28, 32768
  ds_read_b64_tr_b16 v[226:227], v11 offset:33792
  v_mfma_f32_16x16x32_bf16 a[12:15], v[140:143], v[204:207], a[12:15]
  s_add_u32 s26, s29, s31
  v_mfma_f32_16x16x32_bf16 a[4:7], v[140:143], v[196:199], a[4:7]
  buffer_load_dwordx4 v3, s[4:7], s26 offen lds
  v_mfma_f32_16x16x32_bf16 a[4:7], v[136:139], v[192:195], a[4:7]
  s_waitcnt lgkmcnt(10)
  ds_read_b64_tr_b16 v[228:229], v11 offset:40960
  v_mfma_f32_16x16x32_bf16 a[64:67], v[144:147], v[192:195], a[64:67]
  v_mfma_f32_16x16x32_bf16 a[64:67], v[148:151], v[196:199], a[64:67]
  ds_read_b64_tr_b16 v[230:231], v11 offset:41984
  v_mfma_f32_16x16x32_bf16 a[72:75], v[148:151], v[204:207], a[72:75]
  v_mfma_f32_16x16x32_bf16 a[72:75], v[144:147], v[200:203], a[72:75]
  s_add_u32 s31, s31, 128
  ds_read_b64_tr_b16 v[232:233], v12 offset:32768
  v_mfma_f32_16x16x32_bf16 a[76:79], v[152:155], v[200:203], a[76:79]
  s_add_u32 s26, s26, 7168
  v_mfma_f32_16x16x32_bf16 a[76:79], v[156:159], v[204:207], a[76:79]
  buffer_load_dwordx4 v4, s[4:7], s26 offen offset:1024 lds
  v_mfma_f32_16x16x32_bf16 a[68:71], v[156:159], v[196:199], a[68:71]
  ds_read_b64_tr_b16 v[234:235], v12 offset:33792
  v_mfma_f32_16x16x32_bf16 a[68:71], v[152:155], v[192:195], a[68:71]
  s_waitcnt lgkmcnt(10)
  v_mfma_f32_16x16x32_bf16 a[128:131], v[160:163], v[192:195], a[128:131]
  ds_read_b64_tr_b16 v[236:237], v12 offset:40960
  v_mfma_f32_16x16x32_bf16 a[128:131], v[164:167], v[196:199], a[128:131]
  v_mfma_f32_16x16x32_bf16 a[136:139], v[164:167], v[204:207], a[136:139]
  s_and_b32 s31, s31, 0x3ff
  ds_read_b64_tr_b16 v[238:239], v12 offset:41984
  v_mfma_f32_16x16x32_bf16 a[136:139], v[160:163], v[200:203], a[136:139]
  s_add_u32 s26, s26, 7168
  v_mfma_f32_16x16x32_bf16 a[140:143], v[168:171], v[200:203], a[140:143]
  buffer_load_dwordx4 v3, s[4:7], s26 offen offset:2048 lds
  v_mfma_f32_16x16x32_bf16 a[140:143], v[172:175], v[204:207], a[140:143]
  ds_read_b64_tr_b16 v[240:241], v13 offset:32768
  v_mfma_f32_16x16x32_bf16 a[132:135], v[172:175], v[196:199], a[132:135]
  v_mfma_f32_16x16x32_bf16 a[132:135], v[168:171], v[192:195], a[132:135]
  s_waitcnt lgkmcnt(9)
  ds_read_b64_tr_b16 v[242:243], v13 offset:33792
  v_mfma_f32_16x16x32_bf16 a[192:195], v[176:179], v[192:195], a[192:195]
  v_mfma_f32_16x16x32_bf16 a[192:195], v[180:183], v[196:199], a[192:195]
  ds_read_b64_tr_b16 v[244:245], v13 offset:40960
  v_mfma_f32_16x16x32_bf16 a[200:203], v[180:183], v[204:207], a[200:203]
  v_mfma_f32_16x16x32_bf16 a[200:203], v[176:179], v[200:203], a[200:203]
  s_add_u32 s26, s26, 7168
  ds_read_b64_tr_b16 v[246:247], v13 offset:41984
  v_mfma_f32_16x16x32_bf16 a[204:207], v[184:187], v[200:203], a[204:207]
  buffer_load_dwordx4 v4, s[4:7], s26 offen offset:3072 lds
  v_mfma_f32_16x16x32_bf16 a[204:207], v[188:191], v[204:207], a[204:207]
  ds_read_b64_tr_b16 v[248:249], v14 offset:32768
  v_mfma_f32_16x16x32_bf16 a[196:199], v[188:191], v[196:199], a[196:199]
  v_mfma_f32_16x16x32_bf16 a[196:199], v[184:187], v[192:195], a[196:199]
  ds_read_b64_tr_b16 v[250:251], v14 offset:33792
  v_mfma_f32_16x16x32_bf16 a[16:19], v[128:131], v[208:211], a[16:19]
  s_add_u32 m0, s28, 36864
  v_mfma_f32_16x16x32_bf16 a[16:19], v[132:135], v[212:215], a[16:19]
  s_add_u32 s26, s26, 502784
  ds_read_b64_tr_b16 v[252:253], v14 offset:40960
  v_mfma_f32_16x16x32_bf16 a[24:27], v[132:135], v[220:223], a[24:27]
  buffer_load_dwordx4 v3, s[4:7], s26 offen lds
  v_mfma_f32_16x16x32_bf16 a[24:27], v[128:131], v[216:219], a[24:27]
  ds_read_b64_tr_b16 v[254:255], v14 offset:41984
  v_mfma_f32_16x16x32_bf16 a[28:31], v[136:139], v[216:219], a[28:31]
  v_mfma_f32_16x16x32_bf16 a[28:31], v[140:143], v[220:223], a[28:31]
  v_mfma_f32_16x16x32_bf16 a[20:23], v[140:143], v[212:215], a[20:23]
  v_mfma_f32_16x16x32_bf16 a[20:23], v[136:139], v[208:211], a[20:23]
  v_mfma_f32_16x16x32_bf16 a[80:83], v[144:147], v[208:211], a[80:83]
  s_add_u32 s26, s26, 7168
  v_mfma_f32_16x16x32_bf16 a[80:83], v[148:151], v[212:215], a[80:83]
  buffer_load_dwordx4 v4, s[4:7], s26 offen offset:1024 lds
  v_mfma_f32_16x16x32_bf16 a[88:91], v[148:151], v[220:223], a[88:91]
  v_mfma_f32_16x16x32_bf16 a[88:91], v[144:147], v[216:219], a[88:91]
  v_mfma_f32_16x16x32_bf16 a[92:95], v[152:155], v[216:219], a[92:95]
  v_mfma_f32_16x16x32_bf16 a[92:95], v[156:159], v[220:223], a[92:95]
  v_mfma_f32_16x16x32_bf16 a[84:87], v[156:159], v[212:215], a[84:87]
  v_mfma_f32_16x16x32_bf16 a[84:87], v[152:155], v[208:211], a[84:87]
  s_add_u32 s26, s26, 7168
  v_mfma_f32_16x16x32_bf16 a[144:147], v[160:163], v[208:211], a[144:147]
  buffer_load_dwordx4 v3, s[4:7], s26 offen offset:2048 lds
  v_mfma_f32_16x16x32_bf16 a[144:147], v[164:167], v[212:215], a[144:147]
  v_mfma_f32_16x16x32_bf16 a[152:155], v[164:167], v[220:223], a[152:155]
  v_mfma_f32_16x16x32_bf16 a[152:155], v[160:163], v[216:219], a[152:155]
  v_mfma_f32_16x16x32_bf16 a[156:159], v[168:171], v[216:219], a[156:159]
  v_mfma_f32_16x16x32_bf16 a[156:159], v[172:175], v[220:223], a[156:159]
  v_mfma_f32_16x16x32_bf16 a[148:151], v[172:175], v[212:215], a[148:151]
  s_add_u32 s26, s26, 7168
  v_mfma_f32_16x16x32_bf16 a[148:151], v[168:171], v[208:211], a[148:151]
  buffer_load_dwordx4 v4, s[4:7], s26 offen offset:3072 lds
  v_mfma_f32_16x16x32_bf16 a[208:211], v[176:179], v[208:211], a[208:211]
  v_add_u32 v5, 0x10000, v5
  v_add_u32 v6, 0x10000, v6
  v_mfma_f32_16x16x32_bf16 a[208:211], v[180:183], v[212:215], a[208:211]
  v_add_u32 v7, 0xffff0000, v7
  v_add_u32 v8, 0xffff0000, v8
  v_mfma_f32_16x16x32_bf16 a[216:219], v[180:183], v[220:223], a[216:219]
  v_add_u32 v9, 0xffff0000, v9
  v_add_u32 v10, 0xffff0000, v10
  v_mfma_f32_16x16x32_bf16 a[216:219], v[176:179], v[216:219], a[216:219]
  v_add_u32 v11, 0xffff0000, v11
  v_add_u32 v12, 0xffff0000, v12
  v_mfma_f32_16x16x32_bf16 a[220:223], v[184:187], v[216:219], a[220:223]
  v_add_u32 v13, 0xffff0000, v13
  v_add_u32 v14, 0xffff0000, v14
  v_mfma_f32_16x16x32_bf16 a[220:223], v[188:191], v[220:223], a[220:223]
  v_mfma_f32_16x16x32_bf16 a[212:215], v[188:191], v[212:215], a[212:215]
  v_mfma_f32_16x16x32_bf16 a[212:215], v[184:187], v[208:211], a[212:215]
  s_waitcnt vmcnt(8) lgkmcnt(0)
  s_barrier
  v_mfma_f32_16x16x32_bf16 a[32:35], v[128:131], v[224:227], a[32:35]
  s_add_u32 m0, s28, 65536
  ds_read_b64_tr_b16 v[192:193], v7 offset:0
  v_mfma_f32_16x16x32_bf16 a[32:35], v[132:135], v[228:231], a[32:35]
  s_add_u32 s27, s30, s32
  ds_read_b64_tr_b16 v[194:195], v7 offset:1024
  v_mfma_f32_16x16x32_bf16 a[40:43], v[132:135], v[236:239], a[40:43]
  buffer_load_dwordx4 v15, s[12:15], s27 offen lds
  v_mfma_f32_16x16x32_bf16 a[40:43], v[128:131], v[232:235], a[40:43]
  ds_read_b64_tr_b16 v[196:197], v7 offset:8192
  v_mfma_f32_16x16x32_bf16 a[44:47], v[136:139], v[232:235], a[44:47]
  s_add_u32 s32, s32, 524288
  ds_read_b64_tr_b16 v[198:199], v7 offset:9216
  v_mfma_f32_16x16x32_bf16 a[44:47], v[140:143], v[236:239], a[44:47]
  s_add_u32 s27, s27, 31744
  ds_read_b64_tr_b16 v[200:201], v8 offset:0
  v_mfma_f32_16x16x32_bf16 a[36:39], v[140:143], v[228:231], a[36:39]
  buffer_load_dwordx4 v15, s[12:15], s27 offen offset:1024 lds
  v_mfma_f32_16x16x32_bf16 a[36:39], v[136:139], v[224:227], a[36:39]
  ds_read_b64_tr_b16 v[202:203], v8 offset:1024
  v_mfma_f32_16x16x32_bf16 a[96:99], v[144:147], v[224:227], a[96:99]
  s_and_b32 s32, s32, 0x3fffff
  ds_read_b64_tr_b16 v[204:205], v8 offset:8192
  v_mfma_f32_16x16x32_bf16 a[96:99], v[148:151], v[228:231], a[96:99]
  s_add_u32 s27, s27, 31744
  ds_read_b64_tr_b16 v[206:207], v8 offset:9216
  v_mfma_f32_16x16x32_bf16 a[104:107], v[148:151], v[236:239], a[104:107]
  buffer_load_dwordx4 v16, s[12:15], s27 offen offset:2048 lds
  v_mfma_f32_16x16x32_bf16 a[104:107], v[144:147], v[232:235], a[104:107]
  ds_read_b64_tr_b16 v[208:209], v9 offset:0
  v_mfma_f32_16x16x32_bf16 a[108:111], v[152:155], v[232:235], a[108:111]
  ds_read_b64_tr_b16 v[210:211], v9 offset:1024
  v_mfma_f32_16x16x32_bf16 a[108:111], v[156:159], v[236:239], a[108:111]
  s_add_u32 s27, s27, 31744
  ds_read_b64_tr_b16 v[212:213], v9 offset:8192
  v_mfma_f32_16x16x32_bf16 a[100:103], v[156:159], v[228:231], a[100:103]
  buffer_load_dwordx4 v16, s[12:15], s27 offen offset:3072 lds
  v_mfma_f32_16x16x32_bf16 a[100:103], v[152:155], v[224:227], a[100:103]
  ds_read_b64_tr_b16 v[214:215], v9 offset:9216
  v_mfma_f32_16x16x32_bf16 a[160:163], v[160:163], v[224:227], a[160:163]
  s_add_u32 m0, s28, 69632
  ds_read_b64_tr_b16 v[216:217], v10 offset:0
  v_mfma_f32_16x16x32_bf16 a[160:163], v[164:167], v[228:231], a[160:163]
  s_add_u32 s27, s27, 35840
  ds_read_b64_tr_b16 v[218:219], v10 offset:1024
  v_mfma_f32_16x16x32_bf16 a[168:171], v[164:167], v[236:239], a[168:171]
  buffer_load_dwordx4 v15, s[12:15], s27 offen lds
  v_mfma_f32_16x16x32_bf16 a[168:171], v[160:163], v[232:235], a[168:171]
  ds_read_b64_tr_b16 v[220:221], v10 offset:8192
  v_mfma_f32_16x16x32_bf16 a[172:175], v[168:171], v[232:235], a[172:175]
  ds_read_b64_tr_b16 v[222:223], v10 offset:9216
  v_mfma_f32_16x16x32_bf16 a[172:175], v[172:175], v[236:239], a[172:175]
  s_add_u32 s27, s27, 31744
  v_mfma_f32_16x16x32_bf16 a[164:167], v[172:175], v[228:231], a[164:167]
  buffer_load_dwordx4 v15, s[12:15], s27 offen offset:1024 lds
  v_mfma_f32_16x16x32_bf16 a[164:167], v[168:171], v[224:227], a[164:167]
  v_mfma_f32_16x16x32_bf16 a[224:227], v[176:179], v[224:227], a[224:227]
  v_mfma_f32_16x16x32_bf16 a[224:227], v[180:183], v[228:231], a[224:227]
  s_add_u32 s27, s27, 31744
  v_mfma_f32_16x16x32_bf16 a[232:235], v[180:183], v[236:239], a[232:235]
  buffer_load_dwordx4 v16, s[12:15], s27 offen offset:2048 lds
  v_mfma_f32_16x16x32_bf16 a[232:235], v[176:179], v[232:235], a[232:235]
  v_mfma_f32_16x16x32_bf16 a[236:239], v[184:187], v[232:235], a[236:239]
  v_mfma_f32_16x16x32_bf16 a[236:239], v[188:191], v[236:239], a[236:239]
  s_add_u32 s27, s27, 31744
  v_mfma_f32_16x16x32_bf16 a[228:231], v[188:191], v[228:231], a[228:231]
  buffer_load_dwordx4 v16, s[12:15], s27 offen offset:3072 lds
  v_mfma_f32_16x16x32_bf16 a[228:231], v[184:187], v[224:227], a[228:231]
  v_mfma_f32_16x16x32_bf16 a[48:51], v[128:131], v[240:243], a[48:51]
  v_mfma_f32_16x16x32_bf16 a[48:51], v[132:135], v[244:247], a[48:51]
  v_mfma_f32_16x16x32_bf16 a[56:59], v[132:135], v[252:255], a[56:59]
  v_mfma_f32_16x16x32_bf16 a[56:59], v[128:131], v[248:251], a[56:59]
  ds_read_b128 v[128:131], v5 offset:0
  v_mfma_f32_16x16x32_bf16 a[60:63], v[136:139], v[248:251], a[60:63]
  ds_read_b128 v[132:135], v6 offset:0
  v_mfma_f32_16x16x32_bf16 a[60:63], v[140:143], v[252:255], a[60:63]
  v_mfma_f32_16x16x32_bf16 a[52:55], v[140:143], v[244:247], a[52:55]
  v_mfma_f32_16x16x32_bf16 a[52:55], v[136:139], v[240:243], a[52:55]
  ds_read_b128 v[136:139], v5 offset:2048
  v_mfma_f32_16x16x32_bf16 a[112:115], v[144:147], v[240:243], a[112:115]
  ds_read_b128 v[140:143], v6 offset:2048
  v_mfma_f32_16x16x32_bf16 a[112:115], v[148:151], v[244:247], a[112:115]
  v_mfma_f32_16x16x32_bf16 a[120:123], v[148:151], v[252:255], a[120:123]
  v_mfma_f32_16x16x32_bf16 a[120:123], v[144:147], v[248:251], a[120:123]
  ds_read_b128 v[144:147], v5 offset:4096
  v_mfma_f32_16x16x32_bf16 a[124:127], v[152:155], v[248:251], a[124:127]
  ds_read_b128 v[148:151], v6 offset:4096
  v_mfma_f32_16x16x32_bf16 a[124:127], v[156:159], v[252:255], a[124:127]
  v_mfma_f32_16x16x32_bf16 a[116:119], v[156:159], v[244:247], a[116:119]
  v_mfma_f32_16x16x32_bf16 a[116:119], v[152:155], v[240:243], a[116:119]
  ds_read_b128 v[152:155], v5 offset:6144
  v_mfma_f32_16x16x32_bf16 a[176:179], v[160:163], v[240:243], a[176:179]
  ds_read_b128 v[156:159], v6 offset:6144
  v_mfma_f32_16x16x32_bf16 a[176:179], v[164:167], v[244:247], a[176:179]
  v_mfma_f32_16x16x32_bf16 a[184:187], v[164:167], v[252:255], a[184:187]
  v_mfma_f32_16x16x32_bf16 a[184:187], v[160:163], v[248:251], a[184:187]
  ds_read_b128 v[160:163], v5 offset:8192
  v_mfma_f32_16x16x32_bf16 a[188:191], v[168:171], v[248:251], a[188:191]
  ds_read_b128 v[164:167], v6 offset:8192
  v_mfma_f32_16x16x32_bf16 a[188:191], v[172:175], v[252:255], a[188:191]
  v_mfma_f32_16x16x32_bf16 a[180:183], v[172:175], v[244:247], a[180:183]
  v_mfma_f32_16x16x32_bf16 a[180:183], v[168:171], v[240:243], a[180:183]
  ds_read_b128 v[168:171], v5 offset:10240
  v_mfma_f32_16x16x32_bf16 a[240:243], v[176:179], v[240:243], a[240:243]
  ds_read_b128 v[172:175], v6 offset:10240
  v_mfma_f32_16x16x32_bf16 a[240:243], v[180:183], v[244:247], a[240:243]
  v_mfma_f32_16x16x32_bf16 a[248:251], v[180:183], v[252:255], a[248:251]
  v_mfma_f32_16x16x32_bf16 a[248:251], v[176:179], v[248:251], a[248:251]
  ds_read_b128 v[176:179], v5 offset:12288
  v_mfma_f32_16x16x32_bf16 a[252:255], v[184:187], v[248:251], a[252:255]
  ds_read_b128 v[180:183], v6 offset:12288
  v_mfma_f32_16x16x32_bf16 a[252:255], v[188:191], v[252:255], a[252:255]
  v_mfma_f32_16x16x32_bf16 a[244:247], v[188:191], v[244:247], a[244:247]
  v_mfma_f32_16x16x32_bf16 a[244:247], v[184:187], v[240:243], a[244:247]
  s_waitcnt lgkmcnt(10)
  v_mfma_f32_16x16x32_bf16 a[0:3], v[128:131], v[192:195], a[0:3]
  ds_read_b128 v[184:187], v5 offset:14336
  v_mfma_f32_16x16x32_bf16 a[0:3], v[132:135], v[196:199], a[0:3]
  ds_read_b128 v[188:191], v6 offset:14336
  v_mfma_f32_16x16x32_bf16 a[8:11], v[132:135], v[204:207], a[8:11]
  ds_read_b64_tr_b16 v[224:225], v11 offset:0
  v_mfma_f32_16x16x32_bf16 a[8:11], v[128:131], v[200:203], a[8:11]
  v_mfma_f32_16x16x32_bf16 a[12:15], v[136:139], v[200:203], a[12:15]
  s_add_u32 m0, s28, 98304
  ds_read_b64_tr_b16 v[226:227], v11 offset:1024
  v_mfma_f32_16x16x32_bf16 a[12:15], v[140:143], v[204:207], a[12:15]
  s_add_u32 s26, s29, s31
  v_mfma_f32_16x16x32_bf16 a[4:7], v[140:143], v[196:199], a[4:7]
  buffer_load_dwordx4 v3, s[4:7], s26 offen lds
  v_mfma_f32_16x16x32_bf16 a[4:7], v[136:139], v[192:195], a[4:7]
  s_waitcnt lgkmcnt(10)
  ds_read_b64_tr_b16 v[228:229], v11 offset:8192
  v_mfma_f32_16x16x32_bf16 a[64:67], v[144:147], v[192:195], a[64:67]
  v_mfma_f32_16x16x32_bf16 a[64:67], v[148:151], v[196:199], a[64:67]
  ds_read_b64_tr_b16 v[230:231], v11 offset:9216
  v_mfma_f32_16x16x32_bf16 a[72:75], v[148:151], v[204:207], a[72:75]
  v_mfma_f32_16x16x32_bf16 a[72:75], v[144:147], v[200:203], a[72:75]
  s_add_u32 s31, s31, 128
  ds_read_b64_tr_b16 v[232:233], v12 offset:0
  v_mfma_f32_16x16x32_bf16 a[76:79], v[152:155], v[200:203], a[76:79]
  s_add_u32 s26, s26, 7168
  v_mfma_f32_16x16x32_bf16 a[76:79], v[156:159], v[204:207], a[76:79]
  buffer_load_dwordx4 v4, s[4:7], s26 offen offset:1024 lds
  v_mfma_f32_16x16x32_bf16 a[68:71], v[156:159], v[196:199], a[68:71]
  ds_read_b64_tr_b16 v[234:235], v12 offset:1024
  v_mfma_f32_16x16x32_bf16 a[68:71], v[152:155], v[192:195], a[68:71]
  s_waitcnt lgkmcnt(10)
  v_mfma_f32_16x16x32_bf16 a[128:131], v[160:163], v[192:195], a[128:131]
  ds_read_b64_tr_b16 v[236:237], v12 offset:8192
  v_mfma_f32_16x16x32_bf16 a[128:131], v[164:167], v[196:199], a[128:131]
  v_mfma_f32_16x16x32_bf16 a[136:139], v[164:167], v[204:207], a[136:139]
  s_and_b32 s31, s31, 0x3ff
  ds_read_b64_tr_b16 v[238:239], v12 offset:9216
  v_mfma_f32_16x16x32_bf16 a[136:139], v[160:163], v[200:203], a[136:139]
  s_add_u32 s26, s26, 7168
  v_mfma_f32_16x16x32_bf16 a[140:143], v[168:171], v[200:203], a[140:143]
  buffer_load_dwordx4 v3, s[4:7], s26 offen offset:2048 lds
  v_mfma_f32_16x16x32_bf16 a[140:143], v[172:175], v[204:207], a[140:143]
  ds_read_b64_tr_b16 v[240:241], v13 offset:0
  v_mfma_f32_16x16x32_bf16 a[132:135], v[172:175], v[196:199], a[132:135]
  v_mfma_f32_16x16x32_bf16 a[132:135], v[168:171], v[192:195], a[132:135]
  s_waitcnt lgkmcnt(9)
  ds_read_b64_tr_b16 v[242:243], v13 offset:1024
  v_mfma_f32_16x16x32_bf16 a[192:195], v[176:179], v[192:195], a[192:195]
  v_mfma_f32_16x16x32_bf16 a[192:195], v[180:183], v[196:199], a[192:195]
  ds_read_b64_tr_b16 v[244:245], v13 offset:8192
  v_mfma_f32_16x16x32_bf16 a[200:203], v[180:183], v[204:207], a[200:203]
  v_mfma_f32_16x16x32_bf16 a[200:203], v[176:179], v[200:203], a[200:203]
  s_add_u32 s26, s26, 7168
  ds_read_b64_tr_b16 v[246:247], v13 offset:9216
  v_mfma_f32_16x16x32_bf16 a[204:207], v[184:187], v[200:203], a[204:207]
  buffer_load_dwordx4 v4, s[4:7], s26 offen offset:3072 lds
  v_mfma_f32_16x16x32_bf16 a[204:207], v[188:191], v[204:207], a[204:207]
  ds_read_b64_tr_b16 v[248:249], v14 offset:0
  v_mfma_f32_16x16x32_bf16 a[196:199], v[188:191], v[196:199], a[196:199]
  v_mfma_f32_16x16x32_bf16 a[196:199], v[184:187], v[192:195], a[196:199]
  ds_read_b64_tr_b16 v[250:251], v14 offset:1024
  v_mfma_f32_16x16x32_bf16 a[16:19], v[128:131], v[208:211], a[16:19]
  s_add_u32 m0, s28, 102400
  v_mfma_f32_16x16x32_bf16 a[16:19], v[132:135], v[212:215], a[16:19]
  s_add_u32 s26, s26, 502784
  ds_read_b64_tr_b16 v[252:253], v14 offset:8192
  v_mfma_f32_16x16x32_bf16 a[24:27], v[132:135], v[220:223], a[24:27]
  buffer_load_dwordx4 v3, s[4:7], s26 offen lds
  v_mfma_f32_16x16x32_bf16 a[24:27], v[128:131], v[216:219], a[24:27]
  ds_read_b64_tr_b16 v[254:255], v14 offset:9216
  v_mfma_f32_16x16x32_bf16 a[28:31], v[136:139], v[216:219], a[28:31]
  v_mfma_f32_16x16x32_bf16 a[28:31], v[140:143], v[220:223], a[28:31]
  v_mfma_f32_16x16x32_bf16 a[20:23], v[140:143], v[212:215], a[20:23]
  v_mfma_f32_16x16x32_bf16 a[20:23], v[136:139], v[208:211], a[20:23]
  v_mfma_f32_16x16x32_bf16 a[80:83], v[144:147], v[208:211], a[80:83]
  s_add_u32 s26, s26, 7168
  v_mfma_f32_16x16x32_bf16 a[80:83], v[148:151], v[212:215], a[80:83]
  buffer_load_dwordx4 v4, s[4:7], s26 offen offset:1024 lds
  v_mfma_f32_16x16x32_bf16 a[88:91], v[148:151], v[220:223], a[88:91]
  s_lshl_b32 s23, s2, 1
  v_mfma_f32_16x16x32_bf16 a[88:91], v[144:147], v[216:219], a[88:91]
  s_and_b32 s24, s20, 1
  v_mfma_f32_16x16x32_bf16 a[92:95], v[152:155], v[216:219], a[92:95]
  s_add_u32 s23, s23, s24
  v_mfma_f32_16x16x32_bf16 a[92:95], v[156:159], v[220:223], a[92:95]
  s_lshl_b32 s64, s23, 11
  v_mfma_f32_16x16x32_bf16 a[84:87], v[156:159], v[212:215], a[84:87]
  s_add_u32 s64, s64, 60817408
  v_mfma_f32_16x16x32_bf16 a[84:87], v[152:155], v[208:211], a[84:87]
  s_add_u32 s26, s26, 7168
  v_mfma_f32_16x16x32_bf16 a[144:147], v[160:163], v[208:211], a[144:147]
  buffer_load_dwordx4 v3, s[4:7], s26 offen offset:2048 lds
  v_mfma_f32_16x16x32_bf16 a[144:147], v[164:167], v[212:215], a[144:147]
  s_mul_i32 s24, s23, 4096
  v_mfma_f32_16x16x32_bf16 a[152:155], v[164:167], v[220:223], a[152:155]
  s_lshr_b32 s24, s24, 16
  v_mfma_f32_16x16x32_bf16 a[152:155], v[160:163], v[216:219], a[152:155]
  s_mul_i32 s24, s24, 31744
  v_mfma_f32_16x16x32_bf16 a[156:159], v[168:171], v[216:219], a[156:159]
  s_lshl_b32 s23, s23, 6
  v_mfma_f32_16x16x32_bf16 a[156:159], v[172:175], v[220:223], a[156:159]
  s_add_u32 s52, s23, s24
  v_mfma_f32_16x16x32_bf16 a[148:151], v[172:175], v[212:215], a[148:151]
  s_add_u32 s26, s26, 7168
  v_mfma_f32_16x16x32_bf16 a[148:151], v[168:171], v[208:211], a[148:151]
  buffer_load_dwordx4 v4, s[4:7], s26 offen offset:3072 lds
  v_mfma_f32_16x16x32_bf16 a[208:211], v[176:179], v[208:211], a[208:211]
  v_add_u32 v5, 0xfffe0000, v5
  v_add_u32 v6, 0xfffe0000, v6
  v_mfma_f32_16x16x32_bf16 a[208:211], v[180:183], v[212:215], a[208:211]
  v_add_u32 v7, 0x10000, v7
  v_add_u32 v8, 0x10000, v8
  v_mfma_f32_16x16x32_bf16 a[216:219], v[180:183], v[220:223], a[216:219]
  v_add_u32 v9, 0x10000, v9
  v_add_u32 v10, 0x10000, v10
  v_mfma_f32_16x16x32_bf16 a[216:219], v[176:179], v[216:219], a[216:219]
  v_add_u32 v11, 0x10000, v11
  v_add_u32 v12, 0x10000, v12
  v_mfma_f32_16x16x32_bf16 a[220:223], v[184:187], v[216:219], a[220:223]
  v_add_u32 v13, 0x10000, v13
  v_add_u32 v14, 0x10000, v14
  v_mfma_f32_16x16x32_bf16 a[220:223], v[188:191], v[220:223], a[220:223]
  v_mfma_f32_16x16x32_bf16 a[212:215], v[188:191], v[212:215], a[212:215]
  v_mfma_f32_16x16x32_bf16 a[212:215], v[184:187], v[208:211], a[212:215]
  s_waitcnt vmcnt(8) lgkmcnt(0)
  s_barrier
  v_mfma_f32_16x16x32_bf16 a[32:35], v[128:131], v[224:227], a[32:35]
  s_add_u32 m0, s28, 131072
  ds_read_b64_tr_b16 v[192:193], v7 offset:0
  v_mfma_f32_16x16x32_bf16 a[32:35], v[132:135], v[228:231], a[32:35]
  s_add_u32 s27, s30, s32
  ds_read_b64_tr_b16 v[194:195], v7 offset:1024
  v_mfma_f32_16x16x32_bf16 a[40:43], v[132:135], v[236:239], a[40:43]
  buffer_load_dwordx4 v15, s[12:15], s27 offen lds
  v_mfma_f32_16x16x32_bf16 a[40:43], v[128:131], v[232:235], a[40:43]
  ds_read_b64_tr_b16 v[196:197], v7 offset:8192
  v_mfma_f32_16x16x32_bf16 a[44:47], v[136:139], v[232:235], a[44:47]
  s_add_u32 s32, s32, 524288
  ds_read_b64_tr_b16 v[198:199], v7 offset:9216
  v_mfma_f32_16x16x32_bf16 a[44:47], v[140:143], v[236:239], a[44:47]
  s_add_u32 s27, s27, 31744
  ds_read_b64_tr_b16 v[200:201], v8 offset:0
  v_mfma_f32_16x16x32_bf16 a[36:39], v[140:143], v[228:231], a[36:39]
  buffer_load_dwordx4 v15, s[12:15], s27 offen offset:1024 lds
  v_mfma_f32_16x16x32_bf16 a[36:39], v[136:139], v[224:227], a[36:39]
  ds_read_b64_tr_b16 v[202:203], v8 offset:1024
  v_mfma_f32_16x16x32_bf16 a[96:99], v[144:147], v[224:227], a[96:99]
  s_and_b32 s32, s32, 0x3fffff
  ds_read_b64_tr_b16 v[204:205], v8 offset:8192
  v_mfma_f32_16x16x32_bf16 a[96:99], v[148:151], v[228:231], a[96:99]
  s_add_u32 s27, s27, 31744
  ds_read_b64_tr_b16 v[206:207], v8 offset:9216
  v_mfma_f32_16x16x32_bf16 a[104:107], v[148:151], v[236:239], a[104:107]
  buffer_load_dwordx4 v16, s[12:15], s27 offen offset:2048 lds
  v_mfma_f32_16x16x32_bf16 a[104:107], v[144:147], v[232:235], a[104:107]
  ds_read_b64_tr_b16 v[208:209], v9 offset:0
  v_mfma_f32_16x16x32_bf16 a[108:111], v[152:155], v[232:235], a[108:111]
  ds_read_b64_tr_b16 v[210:211], v9 offset:1024
  v_mfma_f32_16x16x32_bf16 a[108:111], v[156:159], v[236:239], a[108:111]
  s_add_u32 s27, s27, 31744
  ds_read_b64_tr_b16 v[212:213], v9 offset:8192
  v_mfma_f32_16x16x32_bf16 a[100:103], v[156:159], v[228:231], a[100:103]
  buffer_load_dwordx4 v16, s[12:15], s27 offen offset:3072 lds
  v_mfma_f32_16x16x32_bf16 a[100:103], v[152:155], v[224:227], a[100:103]
  ds_read_b64_tr_b16 v[214:215], v9 offset:9216
  v_mfma_f32_16x16x32_bf16 a[160:163], v[160:163], v[224:227], a[160:163]
  s_add_u32 m0, s28, 135168
  ds_read_b64_tr_b16 v[216:217], v10 offset:0
  v_mfma_f32_16x16x32_bf16 a[160:163], v[164:167], v[228:231], a[160:163]
  s_add_u32 s27, s27, 35840
  ds_read_b64_tr_b16 v[218:219], v10 offset:1024
  v_mfma_f32_16x16x32_bf16 a[168:171], v[164:167], v[236:239], a[168:171]
  buffer_load_dwordx4 v15, s[12:15], s27 offen lds
  v_mfma_f32_16x16x32_bf16 a[168:171], v[160:163], v[232:235], a[168:171]
  ds_read_b64_tr_b16 v[220:221], v10 offset:8192
  v_mfma_f32_16x16x32_bf16 a[172:175], v[168:171], v[232:235], a[172:175]
  ds_read_b64_tr_b16 v[222:223], v10 offset:9216
  v_mfma_f32_16x16x32_bf16 a[172:175], v[172:175], v[236:239], a[172:175]
  s_add_u32 s27, s27, 31744
  v_mfma_f32_16x16x32_bf16 a[164:167], v[172:175], v[228:231], a[164:167]
  buffer_load_dwordx4 v15, s[12:15], s27 offen offset:1024 lds
  v_mfma_f32_16x16x32_bf16 a[164:167], v[168:171], v[224:227], a[164:167]
  v_mfma_f32_16x16x32_bf16 a[224:227], v[176:179], v[224:227], a[224:227]
  v_mfma_f32_16x16x32_bf16 a[224:227], v[180:183], v[228:231], a[224:227]
  s_add_u32 s27, s27, 31744
  v_mfma_f32_16x16x32_bf16 a[232:235], v[180:183], v[236:239], a[232:235]
  buffer_load_dwordx4 v16, s[12:15], s27 offen offset:2048 lds
  v_mfma_f32_16x16x32_bf16 a[232:235], v[176:179], v[232:235], a[232:235]
  v_mfma_f32_16x16x32_bf16 a[236:239], v[184:187], v[232:235], a[236:239]
  v_mfma_f32_16x16x32_bf16 a[236:239], v[188:191], v[236:239], a[236:239]
  s_add_u32 s27, s27, 31744
  v_mfma_f32_16x16x32_bf16 a[228:231], v[188:191], v[228:231], a[228:231]
  buffer_load_dwordx4 v16, s[12:15], s27 offen offset:3072 lds
  v_mfma_f32_16x16x32_bf16 a[228:231], v[184:187], v[224:227], a[228:231]
  v_mfma_f32_16x16x32_bf16 a[48:51], v[128:131], v[240:243], a[48:51]
  buffer_load_dwordx4 v[32:35], v30, s[72:75], s52 offen
  v_mfma_f32_16x16x32_bf16 a[48:51], v[132:135], v[244:247], a[48:51]
  buffer_load_dwordx4 v[36:39], v25, s[72:75], s52 offen
  v_mfma_f32_16x16x32_bf16 a[56:59], v[132:135], v[252:255], a[56:59]
  v_mfma_f32_16x16x32_bf16 a[56:59], v[128:131], v[248:251], a[56:59]
  ds_read_b128 v[128:131], v5 offset:32768
  v_mfma_f32_16x16x32_bf16 a[60:63], v[136:139], v[248:251], a[60:63]
  ds_read_b128 v[132:135], v6 offset:32768
  v_mfma_f32_16x16x32_bf16 a[60:63], v[140:143], v[252:255], a[60:63]
  v_mfma_f32_16x16x32_bf16 a[52:55], v[140:143], v[244:247], a[52:55]
  v_mfma_f32_16x16x32_bf16 a[52:55], v[136:139], v[240:243], a[52:55]
  ds_read_b128 v[136:139], v5 offset:34816
  v_mfma_f32_16x16x32_bf16 a[112:115], v[144:147], v[240:243], a[112:115]
  ds_read_b128 v[140:143], v6 offset:34816
  v_mfma_f32_16x16x32_bf16 a[112:115], v[148:151], v[244:247], a[112:115]
  v_mfma_f32_16x16x32_bf16 a[120:123], v[148:151], v[252:255], a[120:123]
  v_mfma_f32_16x16x32_bf16 a[120:123], v[144:147], v[248:251], a[120:123]
  ds_read_b128 v[144:147], v5 offset:36864
  v_mfma_f32_16x16x32_bf16 a[124:127], v[152:155], v[248:251], a[124:127]
  ds_read_b128 v[148:151], v6 offset:36864
  v_mfma_f32_16x16x32_bf16 a[124:127], v[156:159], v[252:255], a[124:127]
  v_mfma_f32_16x16x32_bf16 a[116:119], v[156:159], v[244:247], a[116:119]
  v_mfma_f32_16x16x32_bf16 a[116:119], v[152:155], v[240:243], a[116:119]
  ds_read_b128 v[152:155], v5 offset:38912
  v_mfma_f32_16x16x32_bf16 a[176:179], v[160:163], v[240:243], a[176:179]
  ds_read_b128 v[156:159], v6 offset:38912
  v_mfma_f32_16x16x32_bf16 a[176:179], v[164:167], v[244:247], a[176:179]
  v_mfma_f32_16x16x32_bf16 a[184:187], v[164:167], v[252:255], a[184:187]
  v_mfma_f32_16x16x32_bf16 a[184:187], v[160:163], v[248:251], a[184:187]
  ds_read_b128 v[160:163], v5 offset:40960
  v_mfma_f32_16x16x32_bf16 a[188:191], v[168:171], v[248:251], a[188:191]
  ds_read_b128 v[164:167], v6 offset:40960
  v_mfma_f32_16x16x32_bf16 a[188:191], v[172:175], v[252:255], a[188:191]
  v_mfma_f32_16x16x32_bf16 a[180:183], v[172:175], v[244:247], a[180:183]
  v_mfma_f32_16x16x32_bf16 a[180:183], v[168:171], v[240:243], a[180:183]
  ds_read_b128 v[168:171], v5 offset:43008
  v_mfma_f32_16x16x32_bf16 a[240:243], v[176:179], v[240:243], a[240:243]
  ds_read_b128 v[172:175], v6 offset:43008
  v_mfma_f32_16x16x32_bf16 a[240:243], v[180:183], v[244:247], a[240:243]
  v_mfma_f32_16x16x32_bf16 a[248:251], v[180:183], v[252:255], a[248:251]
  v_mfma_f32_16x16x32_bf16 a[248:251], v[176:179], v[248:251], a[248:251]
  ds_read_b128 v[176:179], v5 offset:45056
  v_mfma_f32_16x16x32_bf16 a[252:255], v[184:187], v[248:251], a[252:255]
  ds_read_b128 v[180:183], v6 offset:45056
  v_mfma_f32_16x16x32_bf16 a[252:255], v[188:191], v[252:255], a[252:255]
  v_mfma_f32_16x16x32_bf16 a[244:247], v[188:191], v[244:247], a[244:247]
  v_mfma_f32_16x16x32_bf16 a[244:247], v[184:187], v[240:243], a[244:247]
  s_waitcnt lgkmcnt(10)
  v_mfma_f32_16x16x32_bf16 a[0:3], v[128:131], v[192:195], a[0:3]
  ds_read_b128 v[184:187], v5 offset:47104
  v_mfma_f32_16x16x32_bf16 a[0:3], v[132:135], v[196:199], a[0:3]
  ds_read_b128 v[188:191], v6 offset:47104
  v_mfma_f32_16x16x32_bf16 a[8:11], v[132:135], v[204:207], a[8:11]
  ds_read_b64_tr_b16 v[224:225], v11 offset:0
  v_mfma_f32_16x16x32_bf16 a[8:11], v[128:131], v[200:203], a[8:11]
  v_mfma_f32_16x16x32_bf16 a[12:15], v[136:139], v[200:203], a[12:15]
  s_add_u32 m0, s28, 0
  ds_read_b64_tr_b16 v[226:227], v11 offset:1024
  v_mfma_f32_16x16x32_bf16 a[12:15], v[140:143], v[204:207], a[12:15]
  s_add_u32 s26, s29, s31
  v_mfma_f32_16x16x32_bf16 a[4:7], v[140:143], v[196:199], a[4:7]
  buffer_load_dwordx4 v3, s[4:7], s26 offen lds
  v_mfma_f32_16x16x32_bf16 a[4:7], v[136:139], v[192:195], a[4:7]
  s_waitcnt lgkmcnt(10)
  ds_read_b64_tr_b16 v[228:229], v11 offset:8192
  v_mfma_f32_16x16x32_bf16 a[64:67], v[144:147], v[192:195], a[64:67]
  v_mfma_f32_16x16x32_bf16 a[64:67], v[148:151], v[196:199], a[64:67]
  ds_read_b64_tr_b16 v[230:231], v11 offset:9216
  v_mfma_f32_16x16x32_bf16 a[72:75], v[148:151], v[204:207], a[72:75]
  v_mfma_f32_16x16x32_bf16 a[72:75], v[144:147], v[200:203], a[72:75]
  s_add_u32 s31, s31, 128
  ds_read_b64_tr_b16 v[232:233], v12 offset:0
  v_mfma_f32_16x16x32_bf16 a[76:79], v[152:155], v[200:203], a[76:79]
  s_add_u32 s26, s26, 7168
  v_mfma_f32_16x16x32_bf16 a[76:79], v[156:159], v[204:207], a[76:79]
  buffer_load_dwordx4 v4, s[4:7], s26 offen offset:1024 lds
  v_mfma_f32_16x16x32_bf16 a[68:71], v[156:159], v[196:199], a[68:71]
  ds_read_b64_tr_b16 v[234:235], v12 offset:1024
  v_mfma_f32_16x16x32_bf16 a[68:71], v[152:155], v[192:195], a[68:71]
  s_waitcnt lgkmcnt(10)
  v_mfma_f32_16x16x32_bf16 a[128:131], v[160:163], v[192:195], a[128:131]
  ds_read_b64_tr_b16 v[236:237], v12 offset:8192
  v_mfma_f32_16x16x32_bf16 a[128:131], v[164:167], v[196:199], a[128:131]
  v_mfma_f32_16x16x32_bf16 a[136:139], v[164:167], v[204:207], a[136:139]
  s_and_b32 s31, s31, 0x3ff
  ds_read_b64_tr_b16 v[238:239], v12 offset:9216
  v_mfma_f32_16x16x32_bf16 a[136:139], v[160:163], v[200:203], a[136:139]
  s_add_u32 s26, s26, 7168
  v_mfma_f32_16x16x32_bf16 a[140:143], v[168:171], v[200:203], a[140:143]
  buffer_load_dwordx4 v3, s[4:7], s26 offen offset:2048 lds
  v_mfma_f32_16x16x32_bf16 a[140:143], v[172:175], v[204:207], a[140:143]
  ds_read_b64_tr_b16 v[240:241], v13 offset:0
  v_mfma_f32_16x16x32_bf16 a[132:135], v[172:175], v[196:199], a[132:135]
  v_mfma_f32_16x16x32_bf16 a[132:135], v[168:171], v[192:195], a[132:135]
  s_waitcnt lgkmcnt(9)
  ds_read_b64_tr_b16 v[242:243], v13 offset:1024
  v_mfma_f32_16x16x32_bf16 a[192:195], v[176:179], v[192:195], a[192:195]
  v_mfma_f32_16x16x32_bf16 a[192:195], v[180:183], v[196:199], a[192:195]
  ds_read_b64_tr_b16 v[244:245], v13 offset:8192
  v_mfma_f32_16x16x32_bf16 a[200:203], v[180:183], v[204:207], a[200:203]
  v_mfma_f32_16x16x32_bf16 a[200:203], v[176:179], v[200:203], a[200:203]
  s_add_u32 s26, s26, 7168
  ds_read_b64_tr_b16 v[246:247], v13 offset:9216
  v_mfma_f32_16x16x32_bf16 a[204:207], v[184:187], v[200:203], a[204:207]
  buffer_load_dwordx4 v4, s[4:7], s26 offen offset:3072 lds
  v_mfma_f32_16x16x32_bf16 a[204:207], v[188:191], v[204:207], a[204:207]
  ds_read_b64_tr_b16 v[248:249], v14 offset:0
  v_mfma_f32_16x16x32_bf16 a[196:199], v[188:191], v[196:199], a[196:199]
  v_mfma_f32_16x16x32_bf16 a[196:199], v[184:187], v[192:195], a[196:199]
  ds_read_b64_tr_b16 v[250:251], v14 offset:1024
  v_mfma_f32_16x16x32_bf16 a[16:19], v[128:131], v[208:211], a[16:19]
  s_add_u32 m0, s28, 4096
  v_mfma_f32_16x16x32_bf16 a[16:19], v[132:135], v[212:215], a[16:19]
  s_add_u32 s26, s26, 502784
  ds_read_b64_tr_b16 v[252:253], v14 offset:8192
  v_mfma_f32_16x16x32_bf16 a[24:27], v[132:135], v[220:223], a[24:27]
  buffer_load_dwordx4 v3, s[4:7], s26 offen lds
  v_mfma_f32_16x16x32_bf16 a[24:27], v[128:131], v[216:219], a[24:27]
  ds_read_b64_tr_b16 v[254:255], v14 offset:9216
  v_mfma_f32_16x16x32_bf16 a[28:31], v[136:139], v[216:219], a[28:31]
  v_mfma_f32_16x16x32_bf16 a[28:31], v[140:143], v[220:223], a[28:31]
  v_mfma_f32_16x16x32_bf16 a[20:23], v[140:143], v[212:215], a[20:23]
  v_mfma_f32_16x16x32_bf16 a[20:23], v[136:139], v[208:211], a[20:23]
  v_mfma_f32_16x16x32_bf16 a[80:83], v[144:147], v[208:211], a[80:83]
  s_add_u32 s26, s26, 7168
  v_mfma_f32_16x16x32_bf16 a[80:83], v[148:151], v[212:215], a[80:83]
  buffer_load_dwordx4 v4, s[4:7], s26 offen offset:1024 lds
  v_mfma_f32_16x16x32_bf16 a[88:91], v[148:151], v[220:223], a[88:91]
  s_lshl_b32 s23, s2, 1
  v_mfma_f32_16x16x32_bf16 a[88:91], v[144:147], v[216:219], a[88:91]
  s_and_b32 s24, s20, 1
  v_mfma_f32_16x16x32_bf16 a[92:95], v[152:155], v[216:219], a[92:95]
  s_add_u32 s23, s23, s24
  v_mfma_f32_16x16x32_bf16 a[92:95], v[156:159], v[220:223], a[92:95]
  s_add_u32 s23, s23, 512
  v_mfma_f32_16x16x32_bf16 a[84:87], v[156:159], v[212:215], a[84:87]
  s_lshl_b32 s65, s23, 11
  v_mfma_f32_16x16x32_bf16 a[84:87], v[152:155], v[208:211], a[84:87]
  s_add_u32 s26, s26, 7168
  v_mfma_f32_16x16x32_bf16 a[144:147], v[160:163], v[208:211], a[144:147]
  buffer_load_dwordx4 v3, s[4:7], s26 offen offset:2048 lds
  v_mfma_f32_16x16x32_bf16 a[144:147], v[164:167], v[212:215], a[144:147]
  s_add_u32 s65, s65, 60817408
  v_mfma_f32_16x16x32_bf16 a[152:155], v[164:167], v[220:223], a[152:155]
  s_min_u32 s23, s23, 687
  v_mfma_f32_16x16x32_bf16 a[152:155], v[160:163], v[216:219], a[152:155]
  s_mul_i32 s24, s23, 4096
  v_mfma_f32_16x16x32_bf16 a[156:159], v[168:171], v[216:219], a[156:159]
  s_lshr_b32 s24, s24, 16
  v_mfma_f32_16x16x32_bf16 a[156:159], v[172:175], v[220:223], a[156:159]
  s_mul_i32 s24, s24, 31744
  v_mfma_f32_16x16x32_bf16 a[148:151], v[172:175], v[212:215], a[148:151]
  s_add_u32 s26, s26, 7168
  v_mfma_f32_16x16x32_bf16 a[148:151], v[168:171], v[208:211], a[148:151]
  buffer_load_dwordx4 v4, s[4:7], s26 offen offset:3072 lds
  v_mfma_f32_16x16x32_bf16 a[208:211], v[176:179], v[208:211], a[208:211]
  s_lshl_b32 s23, s23, 6
  v_add_u32 v5, 0x10000, v5
  v_add_u32 v6, 0x10000, v6
  v_mfma_f32_16x16x32_bf16 a[208:211], v[180:183], v[212:215], a[208:211]
  s_add_u32 s53, s23, s24
  v_add_u32 v7, 0x10000, v7
  v_add_u32 v8, 0x10000, v8
  v_mfma_f32_16x16x32_bf16 a[216:219], v[180:183], v[220:223], a[216:219]
  v_add_u32 v9, 0x10000, v9
  v_add_u32 v10, 0x10000, v10
  v_mfma_f32_16x16x32_bf16 a[216:219], v[176:179], v[216:219], a[216:219]
  v_add_u32 v11, 0x10000, v11
  v_add_u32 v12, 0x10000, v12
  v_mfma_f32_16x16x32_bf16 a[220:223], v[184:187], v[216:219], a[220:223]
  v_add_u32 v13, 0x10000, v13
  v_add_u32 v14, 0x10000, v14
  v_mfma_f32_16x16x32_bf16 a[220:223], v[188:191], v[220:223], a[220:223]
  v_mfma_f32_16x16x32_bf16 a[212:215], v[188:191], v[212:215], a[212:215]
  v_mfma_f32_16x16x32_bf16 a[212:215], v[184:187], v[208:211], a[212:215]
  s_waitcnt vmcnt(10) lgkmcnt(0)
  s_barrier
  v_mfma_f32_16x16x32_bf16 a[32:35], v[128:131], v[224:227], a[32:35]
  s_add_u32 m0, s28, 32768
  ds_read_b64_tr_b16 v[192:193], v7 offset:0
  v_mfma_f32_16x16x32_bf16 a[32:35], v[132:135], v[228:231], a[32:35]
  s_add_u32 s27, s30, s32
  ds_read_b64_tr_b16 v[194:195], v7 offset:1024
  v_mfma_f32_16x16x32_bf16 a[40:43], v[132:135], v[236:239], a[40:43]
  buffer_load_dwordx4 v15, s[12:15], s27 offen lds
  v_mfma_f32_16x16x32_bf16 a[40:43], v[128:131], v[232:235], a[40:43]
  ds_read_b64_tr_b16 v[196:197], v7 offset:8192
  v_mfma_f32_16x16x32_bf16 a[44:47], v[136:139], v[232:235], a[44:47]
  s_add_u32 s32, s32, 524288
  ds_read_b64_tr_b16 v[198:199], v7 offset:9216
  v_mfma_f32_16x16x32_bf16 a[44:47], v[140:143], v[236:239], a[44:47]
  s_add_u32 s27, s27, 31744
  ds_read_b64_tr_b16 v[200:201], v8 offset:0
  v_mfma_f32_16x16x32_bf16 a[36:39], v[140:143], v[228:231], a[36:39]
  buffer_load_dwordx4 v15, s[12:15], s27 offen offset:1024 lds
  v_mfma_f32_16x16x32_bf16 a[36:39], v[136:139], v[224:227], a[36:39]
  ds_read_b64_tr_b16 v[202:203], v8 offset:1024
  v_mfma_f32_16x16x32_bf16 a[96:99], v[144:147], v[224:227], a[96:99]
  s_and_b32 s32, s32, 0x3fffff
  ds_read_b64_tr_b16 v[204:205], v8 offset:8192
  v_mfma_f32_16x16x32_bf16 a[96:99], v[148:151], v[228:231], a[96:99]
  s_add_u32 s27, s27, 31744
  ds_read_b64_tr_b16 v[206:207], v8 offset:9216
  v_mfma_f32_16x16x32_bf16 a[104:107], v[148:151], v[236:239], a[104:107]
  buffer_load_dwordx4 v16, s[12:15], s27 offen offset:2048 lds
  v_mfma_f32_16x16x32_bf16 a[104:107], v[144:147], v[232:235], a[104:107]
  ds_read_b64_tr_b16 v[208:209], v9 offset:0
  v_mfma_f32_16x16x32_bf16 a[108:111], v[152:155], v[232:235], a[108:111]
  ds_read_b64_tr_b16 v[210:211], v9 offset:1024
  v_mfma_f32_16x16x32_bf16 a[108:111], v[156:159], v[236:239], a[108:111]
  s_add_u32 s27, s27, 31744
  ds_read_b64_tr_b16 v[212:213], v9 offset:8192
  v_mfma_f32_16x16x32_bf16 a[100:103], v[156:159], v[228:231], a[100:103]
  buffer_load_dwordx4 v16, s[12:15], s27 offen offset:3072 lds
  v_mfma_f32_16x16x32_bf16 a[100:103], v[152:155], v[224:227], a[100:103]
  ds_read_b64_tr_b16 v[214:215], v9 offset:9216
  v_mfma_f32_16x16x32_bf16 a[160:163], v[160:163], v[224:227], a[160:163]
  s_add_u32 m0, s28, 36864
  ds_read_b64_tr_b16 v[216:217], v10 offset:0
  v_mfma_f32_16x16x32_bf16 a[160:163], v[164:167], v[228:231], a[160:163]
  s_add_u32 s27, s27, 35840
  ds_read_b64_tr_b16 v[218:219], v10 offset:1024
  v_mfma_f32_16x16x32_bf16 a[168:171], v[164:167], v[236:239], a[168:171]
  buffer_load_dwordx4 v15, s[12:15], s27 offen lds
  v_mfma_f32_16x16x32_bf16 a[168:171], v[160:163], v[232:235], a[168:171]
  ds_read_b64_tr_b16 v[220:221], v10 offset:8192
  v_mfma_f32_16x16x32_bf16 a[172:175], v[168:171], v[232:235], a[172:175]
  ds_read_b64_tr_b16 v[222:223], v10 offset:9216
  v_mfma_f32_16x16x32_bf16 a[172:175], v[172:175], v[236:239], a[172:175]
  s_add_u32 s27, s27, 31744
  v_mfma_f32_16x16x32_bf16 a[164:167], v[172:175], v[228:231], a[164:167]
  buffer_load_dwordx4 v15, s[12:15], s27 offen offset:1024 lds
  v_mfma_f32_16x16x32_bf16 a[164:167], v[168:171], v[224:227], a[164:167]
  v_mfma_f32_16x16x32_bf16 a[224:227], v[176:179], v[224:227], a[224:227]
  v_mfma_f32_16x16x32_bf16 a[224:227], v[180:183], v[228:231], a[224:227]
  s_add_u32 s27, s27, 31744
  v_mfma_f32_16x16x32_bf16 a[232:235], v[180:183], v[236:239], a[232:235]
  buffer_load_dwordx4 v16, s[12:15], s27 offen offset:2048 lds
  v_mfma_f32_16x16x32_bf16 a[232:235], v[176:179], v[232:235], a[232:235]
  v_mfma_f32_16x16x32_bf16 a[236:239], v[184:187], v[232:235], a[236:239]
  v_mfma_f32_16x16x32_bf16 a[236:239], v[188:191], v[236:239], a[236:239]
  s_add_u32 s27, s27, 31744
  v_mfma_f32_16x16x32_bf16 a[228:231], v[188:191], v[228:231], a[228:231]
  buffer_load_dwordx4 v16, s[12:15], s27 offen offset:3072 lds
  v_mfma_f32_16x16x32_bf16 a[228:231], v[184:187], v[224:227], a[228:231]
  v_mfma_f32_16x16x32_bf16 a[48:51], v[128:131], v[240:243], a[48:51]
  buffer_load_dwordx4 v[40:43], v30, s[72:75], s53 offen
  v_mfma_f32_16x16x32_bf16 a[48:51], v[132:135], v[244:247], a[48:51]
  buffer_load_dwordx4 v[44:47], v25, s[72:75], s53 offen
  v_mfma_f32_16x16x32_bf16 a[56:59], v[132:135], v[252:255], a[56:59]
  v_mfma_f32_16x16x32_bf16 a[56:59], v[128:131], v[248:251], a[56:59]
  ds_read_b128 v[128:131], v5 offset:32768
  v_mfma_f32_16x16x32_bf16 a[60:63], v[136:139], v[248:251], a[60:63]
  ds_read_b128 v[132:135], v6 offset:32768
  v_mfma_f32_16x16x32_bf16 a[60:63], v[140:143], v[252:255], a[60:63]
  v_mfma_f32_16x16x32_bf16 a[52:55], v[140:143], v[244:247], a[52:55]
  v_mfma_f32_16x16x32_bf16 a[52:55], v[136:139], v[240:243], a[52:55]
  ds_read_b128 v[136:139], v5 offset:34816
  v_mfma_f32_16x16x32_bf16 a[112:115], v[144:147], v[240:243], a[112:115]
  ds_read_b128 v[140:143], v6 offset:34816
  v_mfma_f32_16x16x32_bf16 a[112:115], v[148:151], v[244:247], a[112:115]
  s_cmp_ge_u32 s65, 62226432
  s_cselect_b32 s65, 0x7ff00000, s65
  v_mfma_f32_16x16x32_bf16 a[120:123], v[148:151], v[252:255], a[120:123]
  v_mfma_f32_16x16x32_bf16 a[120:123], v[144:147], v[248:251], a[120:123]
  ds_read_b128 v[144:147], v5 offset:36864
  v_mfma_f32_16x16x32_bf16 a[124:127], v[152:155], v[248:251], a[124:127]
  ds_read_b128 v[148:151], v6 offset:36864
  v_mfma_f32_16x16x32_bf16 a[124:127], v[156:159], v[252:255], a[124:127]
  v_mfma_f32_16x16x32_bf16 a[116:119], v[156:159], v[244:247], a[116:119]
  v_mfma_f32_16x16x32_bf16 a[116:119], v[152:155], v[240:243], a[116:119]
  ds_read_b128 v[152:155], v5 offset:38912
  v_mfma_f32_16x16x32_bf16 a[176:179], v[160:163], v[240:243], a[176:179]
  ds_read_b128 v[156:159], v6 offset:38912
  v_mfma_f32_16x16x32_bf16 a[176:179], v[164:167], v[244:247], a[176:179]
  v_mfma_f32_16x16x32_bf16 a[184:187], v[164:167], v[252:255], a[184:187]
  v_mfma_f32_16x16x32_bf16 a[184:187], v[160:163], v[248:251], a[184:187]
  ds_read_b128 v[160:163], v5 offset:40960
  v_mfma_f32_16x16x32_bf16 a[188:191], v[168:171], v[248:251], a[188:191]
  ds_read_b128 v[164:167], v6 offset:40960
  v_mfma_f32_16x16x32_bf16 a[188:191], v[172:175], v[252:255], a[188:191]
  v_mfma_f32_16x16x32_bf16 a[180:183], v[172:175], v[244:247], a[180:183]
  v_mfma_f32_16x16x32_bf16 a[180:183], v[168:171], v[240:243], a[180:183]
  ds_read_b128 v[168:171], v5 offset:43008
  v_mfma_f32_16x16x32_bf16 a[240:243], v[176:179], v[240:243], a[240:243]
  ds_read_b128 v[172:175], v6 offset:43008
  v_mfma_f32_16x16x32_bf16 a[240:243], v[180:183], v[244:247], a[240:243]
  v_mfma_f32_16x16x32_bf16 a[248:251], v[180:183], v[252:255], a[248:251]
  v_mfma_f32_16x16x32_bf16 a[248:251], v[176:179], v[248:251], a[248:251]
  ds_read_b128 v[176:179], v5 offset:45056
  v_mfma_f32_16x16x32_bf16 a[252:255], v[184:187], v[248:251], a[252:255]
  ds_read_b128 v[180:183], v6 offset:45056
  v_mfma_f32_16x16x32_bf16 a[252:255], v[188:191], v[252:255], a[252:255]
  v_mfma_f32_16x16x32_bf16 a[244:247], v[188:191], v[244:247], a[244:247]
  v_mfma_f32_16x16x32_bf16 a[244:247], v[184:187], v[240:243], a[244:247]
  s_waitcnt lgkmcnt(10)
  v_mfma_f32_16x16x32_bf16 a[0:3], v[128:131], v[192:195], a[0:3]
  s_lshl_b32 s23, s20, 18
  ds_read_b128 v[184:187], v5 offset:47104
  v_mfma_f32_16x16x32_bf16 a[0:3], v[132:135], v[196:199], a[0:3]
  s_lshl_b32 s24, s21, 8
  ds_read_b128 v[188:191], v6 offset:47104
  v_mfma_f32_16x16x32_bf16 a[8:11], v[132:135], v[204:207], a[8:11]
  s_add_u32 s23, s23, s24
  ds_read_b64_tr_b16 v[224:225], v11 offset:0
  v_mfma_f32_16x16x32_bf16 a[8:11], v[128:131], v[200:203], a[8:11]
  s_lshl_b32 s24, s22, 15
  v_mfma_f32_16x16x32_bf16 a[12:15], v[136:139], v[200:203], a[12:15]
  s_add_u32 m0, s28, 65536
  ds_read_b64_tr_b16 v[226:227], v11 offset:1024
  v_mfma_f32_16x16x32_bf16 a[12:15], v[140:143], v[204:207], a[12:15]
  s_add_u32 s26, s29, s31
  v_mfma_f32_16x16x32_bf16 a[4:7], v[140:143], v[196:199], a[4:7]
  buffer_load_dwordx4 v3, s[4:7], s26 offen lds
  v_mfma_f32_16x16x32_bf16 a[4:7], v[136:139], v[192:195], a[4:7]
  s_waitcnt lgkmcnt(10)
  ds_read_b64_tr_b16 v[228:229], v11 offset:8192
  v_mfma_f32_16x16x32_bf16 a[64:67], v[144:147], v[192:195], a[64:67]
  s_add_u32 s23, s23, s24
  v_mfma_f32_16x16x32_bf16 a[64:67], v[148:151], v[196:199], a[64:67]
  ds_read_b64_tr_b16 v[230:231], v11 offset:9216
  v_mfma_f32_16x16x32_bf16 a[72:75], v[148:151], v[204:207], a[72:75]
  s_waitcnt vmcnt(19)
  v_mfma_f32_16x16x32_bf16 v[112:115], v[32:35], v[48:51], 0
  v_mfma_f32_16x16x32_bf16 v[116:119], v[36:39], v[48:51], 0
  v_mfma_f32_16x16x32_bf16 v[120:123], v[32:35], v[52:55], 0
  v_mfma_f32_16x16x32_bf16 v[124:127], v[36:39], v[52:55], 0
  v_mfma_f32_16x16x32_bf16 a[72:75], v[144:147], v[200:203], a[72:75]
  s_add_u32 s31, s31, 128
  ds_read_b64_tr_b16 v[232:233], v12 offset:0
  v_mfma_f32_16x16x32_bf16 a[76:79], v[152:155], v[200:203], a[76:79]
  s_add_u32 s26, s26, 7168
  v_mfma_f32_16x16x32_bf16 a[76:79], v[156:159], v[204:207], a[76:79]
  buffer_load_dwordx4 v4, s[4:7], s26 offen offset:1024 lds
  v_mfma_f32_16x16x32_bf16 a[68:71], v[156:159], v[196:199], a[68:71]
  ds_read_b64_tr_b16 v[234:235], v12 offset:1024
  v_mfma_f32_16x16x32_bf16 a[68:71], v[152:155], v[192:195], a[68:71]
  s_waitcnt lgkmcnt(10)
  v_cvt_pk_bf16_f32 v56, v112, v113
  v_cvt_pk_bf16_f32 v57, v114, v115
  v_mfma_f32_16x16x32_bf16 a[128:131], v[160:163], v[192:195], a[128:131]
  ds_read_b64_tr_b16 v[236:237], v12 offset:8192
  v_cvt_pk_bf16_f32 v58, v116, v117
  v_mfma_f32_16x16x32_bf16 a[128:131], v[164:167], v[196:199], a[128:131]
  v_cvt_pk_bf16_f32 v59, v118, v119
  v_mfma_f32_16x16x32_bf16 a[136:139], v[164:167], v[204:207], a[136:139]
  s_and_b32 s31, s31, 0x3ff
  ds_read_b64_tr_b16 v[238:239], v12 offset:9216
  v_mfma_f32_16x16x32_bf16 a[136:139], v[160:163], v[200:203], a[136:139]
  s_add_u32 s26, s26, 7168
  v_mfma_f32_16x16x32_bf16 a[140:143], v[168:171], v[200:203], a[140:143]
  buffer_load_dwordx4 v3, s[4:7], s26 offen offset:2048 lds
  v_mfma_f32_16x16x32_bf16 a[140:143], v[172:175], v[204:207], a[140:143]
  ds_read_b64_tr_b16 v[240:241], v13 offset:0
  v_mfma_f32_16x16x32_bf16 a[132:135], v[172:175], v[196:199], a[132:135]
  buffer_store_dwordx4 v[56:59], v2, s[8:11], s64 offen sc1
  v_mfma_f32_16x16x32_bf16 a[132:135], v[168:171], v[192:195], a[132:135]
  s_waitcnt lgkmcnt(9)
  ds_read_b64_tr_b16 v[242:243], v13 offset:1024
  v_cvt_pk_bf16_f32 v60, v120, v121
  v_mfma_f32_16x16x32_bf16 a[192:195], v[176:179], v[192:195], a[192:195]
  v_cvt_pk_bf16_f32 v61, v122, v123
  v_cvt_pk_bf16_f32 v62, v124, v125
  v_mfma_f32_16x16x32_bf16 a[192:195], v[180:183], v[196:199], a[192:195]
  ds_read_b64_tr_b16 v[244:245], v13 offset:8192
  v_cvt_pk_bf16_f32 v63, v126, v127
  v_mfma_f32_16x16x32_bf16 a[200:203], v[180:183], v[204:207], a[200:203]
  buffer_store_dwordx4 v[60:63], v2, s[8:11], s64 offen offset:1024 sc1
  v_mfma_f32_16x16x32_bf16 a[200:203], v[176:179], v[200:203], a[200:203]
  s_add_u32 s26, s26, 7168
  ds_read_b64_tr_b16 v[246:247], v13 offset:9216
  v_mfma_f32_16x16x32_bf16 a[204:207], v[184:187], v[200:203], a[204:207]
  buffer_load_dwordx4 v4, s[4:7], s26 offen offset:3072 lds
  v_mfma_f32_16x16x32_bf16 a[204:207], v[188:191], v[204:207], a[204:207]
  ds_read_b64_tr_b16 v[248:249], v14 offset:0
  v_bfe_u32 v23, v1, 1, 2
  v_mfma_f32_16x16x32_bf16 a[196:199], v[188:191], v[196:199], a[196:199]
  v_lshlrev_b32 v23, 13, v23
  v_and_b32 v24, 1, v1
  v_mfma_f32_16x16x32_bf16 a[196:199], v[184:187], v[192:195], a[196:199]
  ds_read_b64_tr_b16 v[250:251], v14 offset:1024
  v_lshl_add_u32 v23, v24, 7, v23
  v_mfma_f32_16x16x32_bf16 a[16:19], v[128:131], v[208:211], a[16:19]
  s_add_u32 m0, s28, 69632
  v_bfe_u32 v24, v1, 3, 2
  v_lshlrev_b32 v24, 20, v24
  v_mfma_f32_16x16x32_bf16 a[16:19], v[132:135], v[212:215], a[16:19]
  s_add_u32 s26, s26, 502784
  ds_read_b64_tr_b16 v[252:253], v14 offset:8192
  v_add3_u32 v24, v24, v23, s23
  v_mfma_f32_16x16x32_bf16 a[24:27], v[132:135], v[220:223], a[24:27]
  buffer_load_dwordx4 v3, s[4:7], s26 offen lds
  v_mfma_f32_16x16x32_bf16 a[24:27], v[128:131], v[216:219], a[24:27]
  ds_read_b64_tr_b16 v[254:255], v14 offset:9216
  v_mfma_f32_16x16x32_bf16 a[28:31], v[136:139], v[216:219], a[28:31]
  v_mfma_f32_16x16x32_bf16 a[28:31], v[140:143], v[220:223], a[28:31]
  v_mfma_f32_16x16x32_bf16 a[20:23], v[140:143], v[212:215], a[20:23]
  v_mfma_f32_16x16x32_bf16 a[20:23], v[136:139], v[208:211], a[20:23]
  v_mfma_f32_16x16x32_bf16 a[80:83], v[144:147], v[208:211], a[80:83]
  s_add_u32 s26, s26, 7168
  v_mfma_f32_16x16x32_bf16 a[80:83], v[148:151], v[212:215], a[80:83]
  buffer_load_dwordx4 v4, s[4:7], s26 offen offset:1024 lds
  v_mfma_f32_16x16x32_bf16 a[88:91], v[148:151], v[220:223], a[88:91]
  v_mfma_f32_16x16x32_bf16 a[88:91], v[144:147], v[216:219], a[88:91]
  v_mfma_f32_16x16x32_bf16 a[92:95], v[152:155], v[216:219], a[92:95]
  v_mfma_f32_16x16x32_bf16 a[92:95], v[156:159], v[220:223], a[92:95]
  v_mfma_f32_16x16x32_bf16 a[84:87], v[156:159], v[212:215], a[84:87]
  v_mfma_f32_16x16x32_bf16 a[84:87], v[152:155], v[208:211], a[84:87]
  s_add_u32 s26, s26, 7168
  v_mfma_f32_16x16x32_bf16 a[144:147], v[160:163], v[208:211], a[144:147]
  buffer_load_dwordx4 v3, s[4:7], s26 offen offset:2048 lds
  v_mfma_f32_16x16x32_bf16 a[144:147], v[164:167], v[212:215], a[144:147]
  v_mfma_f32_16x16x32_bf16 a[152:155], v[164:167], v[220:223], a[152:155]
  v_mfma_f32_16x16x32_bf16 a[152:155], v[160:163], v[216:219], a[152:155]
  v_mfma_f32_16x16x32_bf16 a[156:159], v[168:171], v[216:219], a[156:159]
  v_mfma_f32_16x16x32_bf16 a[156:159], v[172:175], v[220:223], a[156:159]
  v_mfma_f32_16x16x32_bf16 a[148:151], v[172:175], v[212:215], a[148:151]
  s_add_u32 s26, s26, 7168
  v_mfma_f32_16x16x32_bf16 a[148:151], v[168:171], v[208:211], a[148:151]
  buffer_load_dwordx4 v4, s[4:7], s26 offen offset:3072 lds
  v_mfma_f32_16x16x32_bf16 a[208:211], v[176:179], v[208:211], a[208:211]
  v_add_u32 v5, 0xffff0000, v5
  v_add_u32 v6, 0xffff0000, v6
  v_mfma_f32_16x16x32_bf16 a[208:211], v[180:183], v[212:215], a[208:211]
  v_add_u32 v7, 0xfffe0000, v7
  v_add_u32 v8, 0xfffe0000, v8
  v_mfma_f32_16x16x32_bf16 a[216:219], v[180:183], v[220:223], a[216:219]
  v_add_u32 v9, 0xfffe0000, v9
  v_add_u32 v10, 0xfffe0000, v10
  v_mfma_f32_16x16x32_bf16 a[216:219], v[176:179], v[216:219], a[216:219]
  v_add_u32 v11, 0xfffe0000, v11
  v_add_u32 v12, 0xfffe0000, v12
  v_mfma_f32_16x16x32_bf16 a[220:223], v[184:187], v[216:219], a[220:223]
  v_add_u32 v13, 0xfffe0000, v13
  v_add_u32 v14, 0xfffe0000, v14
  v_mfma_f32_16x16x32_bf16 a[220:223], v[188:191], v[220:223], a[220:223]
  v_mfma_f32_16x16x32_bf16 a[212:215], v[188:191], v[212:215], a[212:215]
  v_mfma_f32_16x16x32_bf16 a[212:215], v[184:187], v[208:211], a[212:215]
  s_waitcnt vmcnt(12) lgkmcnt(0)
  s_barrier
  v_mfma_f32_16x16x32_bf16 a[32:35], v[128:131], v[224:227], a[32:35]
  s_add_u32 m0, s28, 98304
  ds_read_b64_tr_b16 v[192:193], v7 offset:32768
  v_mfma_f32_16x16x32_bf16 a[32:35], v[132:135], v[228:231], a[32:35]
  s_add_u32 s27, s30, s32
  ds_read_b64_tr_b16 v[194:195], v7 offset:33792
  v_mfma_f32_16x16x32_bf16 a[40:43], v[132:135], v[236:239], a[40:43]
  buffer_load_dwordx4 v15, s[12:15], s27 offen lds
  v_mfma_f32_16x16x32_bf16 a[40:43], v[128:131], v[232:235], a[40:43]
  ds_read_b64_tr_b16 v[196:197], v7 offset:40960
  v_mfma_f32_16x16x32_bf16 a[44:47], v[136:139], v[232:235], a[44:47]
  s_add_u32 s32, s32, 524288
  ds_read_b64_tr_b16 v[198:199], v7 offset:41984
  v_mfma_f32_16x16x32_bf16 a[44:47], v[140:143], v[236:239], a[44:47]
  s_add_u32 s27, s27, 31744
  ds_read_b64_tr_b16 v[200:201], v8 offset:32768
  v_mfma_f32_16x16x32_bf16 a[36:39], v[140:143], v[228:231], a[36:39]
  buffer_load_dwordx4 v15, s[12:15], s27 offen offset:1024 lds
  v_mfma_f32_16x16x32_bf16 a[36:39], v[136:139], v[224:227], a[36:39]
  ds_read_b64_tr_b16 v[202:203], v8 offset:33792
  v_mfma_f32_16x16x32_bf16 a[96:99], v[144:147], v[224:227], a[96:99]
  s_and_b32 s32, s32, 0x3fffff
  ds_read_b64_tr_b16 v[204:205], v8 offset:40960
  v_mfma_f32_16x16x32_bf16 a[96:99], v[148:151], v[228:231], a[96:99]
  s_add_u32 s27, s27, 31744
  ds_read_b64_tr_b16 v[206:207], v8 offset:41984
  v_mfma_f32_16x16x32_bf16 a[104:107], v[148:151], v[236:239], a[104:107]
  buffer_load_dwordx4 v16, s[12:15], s27 offen offset:2048 lds
  v_mfma_f32_16x16x32_bf16 a[104:107], v[144:147], v[232:235], a[104:107]
  ds_read_b64_tr_b16 v[208:209], v9 offset:32768
  v_mfma_f32_16x16x32_bf16 a[108:111], v[152:155], v[232:235], a[108:111]
  ds_read_b64_tr_b16 v[210:211], v9 offset:33792
  v_mfma_f32_16x16x32_bf16 a[108:111], v[156:159], v[236:239], a[108:111]
  s_add_u32 s27, s27, 31744
  ds_read_b64_tr_b16 v[212:213], v9 offset:40960
  v_mfma_f32_16x16x32_bf16 a[100:103], v[156:159], v[228:231], a[100:103]
  buffer_load_dwordx4 v16, s[12:15], s27 offen offset:3072 lds
  v_mfma_f32_16x16x32_bf16 a[100:103], v[152:155], v[224:227], a[100:103]
  ds_read_b64_tr_b16 v[214:215], v9 offset:41984
  v_mfma_f32_16x16x32_bf16 a[160:163], v[160:163], v[224:227], a[160:163]
  s_add_u32 m0, s28, 102400
  ds_read_b64_tr_b16 v[216:217], v10 offset:32768
  v_mfma_f32_16x16x32_bf16 a[160:163], v[164:167], v[228:231], a[160:163]
  s_add_u32 s27, s27, 35840
  ds_read_b64_tr_b16 v[218:219], v10 offset:33792
  v_mfma_f32_16x16x32_bf16 a[168:171], v[164:167], v[236:239], a[168:171]
  buffer_load_dwordx4 v15, s[12:15], s27 offen lds
  v_mfma_f32_16x16x32_bf16 a[168:171], v[160:163], v[232:235], a[168:171]
  ds_read_b64_tr_b16 v[220:221], v10 offset:40960
  v_mfma_f32_16x16x32_bf16 a[172:175], v[168:171], v[232:235], a[172:175]
  ds_read_b64_tr_b16 v[222:223], v10 offset:41984
  v_mfma_f32_16x16x32_bf16 a[172:175], v[172:175], v[236:239], a[172:175]
  s_add_u32 s27, s27, 31744
  v_mfma_f32_16x16x32_bf16 a[164:167], v[172:175], v[228:231], a[164:167]
  buffer_load_dwordx4 v15, s[12:15], s27 offen offset:1024 lds
  v_mfma_f32_16x16x32_bf16 a[164:167], v[168:171], v[224:227], a[164:167]
  v_mfma_f32_16x16x32_bf16 a[224:227], v[176:179], v[224:227], a[224:227]
  v_mfma_f32_16x16x32_bf16 a[224:227], v[180:183], v[228:231], a[224:227]
  s_add_u32 s27, s27, 31744
  v_mfma_f32_16x16x32_bf16 a[232:235], v[180:183], v[236:239], a[232:235]
  buffer_load_dwordx4 v16, s[12:15], s27 offen offset:2048 lds
  v_mfma_f32_16x16x32_bf16 a[232:235], v[176:179], v[232:235], a[232:235]
  v_mfma_f32_16x16x32_bf16 a[236:239], v[184:187], v[232:235], a[236:239]
  v_mfma_f32_16x16x32_bf16 a[236:239], v[188:191], v[236:239], a[236:239]
  s_add_u32 s27, s27, 31744
  v_mfma_f32_16x16x32_bf16 a[228:231], v[188:191], v[228:231], a[228:231]
  buffer_load_dwordx4 v16, s[12:15], s27 offen offset:3072 lds
  v_mfma_f32_16x16x32_bf16 a[228:231], v[184:187], v[224:227], a[228:231]
  v_mfma_f32_16x16x32_bf16 a[48:51], v[128:131], v[240:243], a[48:51]
  buffer_load_dword v0, v24, s[76:79], 0 offen
  v_mfma_f32_16x16x32_bf16 a[48:51], v[132:135], v[244:247], a[48:51]
  v_mfma_f32_16x16x32_bf16 a[56:59], v[132:135], v[252:255], a[56:59]
  v_mfma_f32_16x16x32_bf16 a[56:59], v[128:131], v[248:251], a[56:59]
  ds_read_b128 v[128:131], v5 offset:0
  v_mfma_f32_16x16x32_bf16 a[60:63], v[136:139], v[248:251], a[60:63]
  ds_read_b128 v[132:135], v6 offset:0
  v_mfma_f32_16x16x32_bf16 a[60:63], v[140:143], v[252:255], a[60:63]
  v_mfma_f32_16x16x32_bf16 a[52:55], v[140:143], v[244:247], a[52:55]
  v_mfma_f32_16x16x32_bf16 a[52:55], v[136:139], v[240:243], a[52:55]
  ds_read_b128 v[136:139], v5 offset:2048
  v_mfma_f32_16x16x32_bf16 a[112:115], v[144:147], v[240:243], a[112:115]
  ds_read_b128 v[140:143], v6 offset:2048
  v_mfma_f32_16x16x32_bf16 a[112:115], v[148:151], v[244:247], a[112:115]
  v_mfma_f32_16x16x32_bf16 a[120:123], v[148:151], v[252:255], a[120:123]
  v_mfma_f32_16x16x32_bf16 a[120:123], v[144:147], v[248:251], a[120:123]
  ds_read_b128 v[144:147], v5 offset:4096
  v_mfma_f32_16x16x32_bf16 a[124:127], v[152:155], v[248:251], a[124:127]
  ds_read_b128 v[148:151], v6 offset:4096
  v_mfma_f32_16x16x32_bf16 a[124:127], v[156:159], v[252:255], a[124:127]
  v_mfma_f32_16x16x32_bf16 a[116:119], v[156:159], v[244:247], a[116:119]
  v_mfma_f32_16x16x32_bf16 a[116:119], v[152:155], v[240:243], a[116:119]
  ds_read_b128 v[152:155], v5 offset:6144
  v_mfma_f32_16x16x32_bf16 a[176:179], v[160:163], v[240:243], a[176:179]
  ds_read_b128 v[156:159], v6 offset:6144
  v_mfma_f32_16x16x32_bf16 a[176:179], v[164:167], v[244:247], a[176:179]
  v_mfma_f32_16x16x32_bf16 a[184:187], v[164:167], v[252:255], a[184:187]
  v_mfma_f32_16x16x32_bf16 a[184:187], v[160:163], v[248:251], a[184:187]
  ds_read_b128 v[160:163], v5 offset:8192
  v_mfma_f32_16x16x32_bf16 a[188:191], v[168:171], v[248:251], a[188:191]
  ds_read_b128 v[164:167], v6 offset:8192
  v_mfma_f32_16x16x32_bf16 a[188:191], v[172:175], v[252:255], a[188:191]
  v_mfma_f32_16x16x32_bf16 a[180:183], v[172:175], v[244:247], a[180:183]
  v_mfma_f32_16x16x32_bf16 a[180:183], v[168:171], v[240:243], a[180:183]
  ds_read_b128 v[168:171], v5 offset:10240
  v_mfma_f32_16x16x32_bf16 a[240:243], v[176:179], v[240:243], a[240:243]
  ds_read_b128 v[172:175], v6 offset:10240
  v_mfma_f32_16x16x32_bf16 a[240:243], v[180:183], v[244:247], a[240:243]
  v_mfma_f32_16x16x32_bf16 a[248:251], v[180:183], v[252:255], a[248:251]
  v_mfma_f32_16x16x32_bf16 a[248:251], v[176:179], v[248:251], a[248:251]
  ds_read_b128 v[176:179], v5 offset:12288
  v_mfma_f32_16x16x32_bf16 a[252:255], v[184:187], v[248:251], a[252:255]
  ds_read_b128 v[180:183], v6 offset:12288
  v_mfma_f32_16x16x32_bf16 a[252:255], v[188:191], v[252:255], a[252:255]
  v_mfma_f32_16x16x32_bf16 a[244:247], v[188:191], v[244:247], a[244:247]
  v_mfma_f32_16x16x32_bf16 a[244:247], v[184:187], v[240:243], a[244:247]
  s_waitcnt lgkmcnt(10)
  v_mfma_f32_16x16x32_bf16 a[0:3], v[128:131], v[192:195], a[0:3]
  s_lshl_b32 s23, s22, 2
  ds_read_b128 v[184:187], v5 offset:14336
  v_bfe_u32 v22, v1, 2, 2
  v_mfma_f32_16x16x32_bf16 a[0:3], v[132:135], v[196:199], a[0:3]
  s_add_u32 s23, s23, s20
  ds_read_b128 v[188:191], v6 offset:14336
  v_lshrrev_b32 v23, 4, v1
  v_mfma_f32_16x16x32_bf16 a[8:11], v[132:135], v[204:207], a[8:11]
  s_sub_u32 s24, 63, s23
  ds_read_b64_tr_b16 v[224:225], v11 offset:32768
  v_lshl_add_u32 v22, v22, 2, v23
  v_mfma_f32_16x16x32_bf16 a[8:11], v[128:131], v[200:203], a[8:11]
  s_mul_i32 s23, s23, 34816
  v_and_b32 v23, 3, v1
  v_lshl_add_u32 v22, v22, 2, v23
  v_mfma_f32_16x16x32_bf16 a[12:15], v[136:139], v[200:203], a[12:15]
  s_add_u32 m0, s28, 131072
  ds_read_b64_tr_b16 v[226:227], v11 offset:33792
  v_mfma_f32_16x16x32_bf16 a[12:15], v[140:143], v[204:207], a[12:15]
  s_add_u32 s26, s29, s31
  v_mfma_f32_16x16x32_bf16 a[4:7], v[140:143], v[196:199], a[4:7]
  buffer_load_dwordx4 v3, s[4:7], s26 offen lds
  v_mfma_f32_16x16x32_bf16 a[4:7], v[136:139], v[192:195], a[4:7]
  s_waitcnt lgkmcnt(10)
  ds_read_b64_tr_b16 v[228:229], v11 offset:40960
  v_mfma_f32_16x16x32_bf16 a[64:67], v[144:147], v[192:195], a[64:67]
  s_mul_i32 s24, s24, 34816
  v_mfma_f32_16x16x32_bf16 a[64:67], v[148:151], v[196:199], a[64:67]
  s_add_u32 s36, s23, 33554432
  ds_read_b64_tr_b16 v[230:231], v11 offset:41984
  v_mfma_f32_16x16x32_bf16 a[72:75], v[148:151], v[204:207], a[72:75]
  s_add_u32 s37, s23, 33571840
  v_mfma_f32_16x16x32_bf16 a[72:75], v[144:147], v[200:203], a[72:75]
  s_add_u32 s31, s31, 128
  ds_read_b64_tr_b16 v[232:233], v12 offset:32768
  v_mfma_f32_16x16x32_bf16 a[76:79], v[152:155], v[200:203], a[76:79]
  s_add_u32 s26, s26, 7168
  v_mfma_f32_16x16x32_bf16 a[76:79], v[156:159], v[204:207], a[76:79]
  buffer_load_dwordx4 v4, s[4:7], s26 offen offset:1024 lds
  v_mfma_f32_16x16x32_bf16 a[68:71], v[156:159], v[196:199], a[68:71]
  s_add_u32 s38, s24, 33554432
  ds_read_b64_tr_b16 v[234:235], v12 offset:33792
  v_mfma_f32_16x16x32_bf16 a[68:71], v[152:155], v[192:195], a[68:71]
  s_waitcnt lgkmcnt(10)
  v_mfma_f32_16x16x32_bf16 a[128:131], v[160:163], v[192:195], a[128:131]
  s_add_u32 s39, s24, 33571840
  ds_read_b64_tr_b16 v[236:237], v12 offset:40960
  v_mfma_f32_16x16x32_bf16 a[128:131], v[164:167], v[196:199], a[128:131]
  buffer_load_dword v19, v26, s[16:19], 0 offen sc1
  v_mfma_f32_16x16x32_bf16 a[136:139], v[164:167], v[204:207], a[136:139]
  s_and_b32 s31, s31, 0x3ff
  ds_read_b64_tr_b16 v[238:239], v12 offset:41984
  v_mfma_f32_16x16x32_bf16 a[136:139], v[160:163], v[200:203], a[136:139]
  s_add_u32 s26, s26, 7168
  v_mfma_f32_16x16x32_bf16 a[140:143], v[168:171], v[200:203], a[140:143]
  buffer_load_dwordx4 v3, s[4:7], s26 offen offset:2048 lds
  v_mfma_f32_16x16x32_bf16 a[140:143], v[172:175], v[204:207], a[140:143]
  s_bfe_u32 s34, s2, 0x20003
  ds_read_b64_tr_b16 v[240:241], v13 offset:32768
  v_mfma_f32_16x16x32_bf16 a[132:135], v[172:175], v[196:199], a[132:135]
  s_mul_i32 s34, s34, 4096
  v_mfma_f32_16x16x32_bf16 a[132:135], v[168:171], v[192:195], a[132:135]
  s_waitcnt lgkmcnt(9)
  ds_read_b64_tr_b16 v[242:243], v13 offset:33792
  v_mfma_f32_16x16x32_bf16 a[192:195], v[176:179], v[192:195], a[192:195]
  s_lshl_b32 s3, s3, 3
  v_mfma_f32_16x16x32_bf16 a[192:195], v[180:183], v[196:199], a[192:195]
  s_and_b32 s23, s2, 7
  ds_read_b64_tr_b16 v[244:245], v13 offset:40960
  v_mfma_f32_16x16x32_bf16 a[200:203], v[180:183], v[204:207], a[200:203]
  s_lshl_b32 s23, 0x01010101, s23
  v_mfma_f32_16x16x32_bf16 a[200:203], v[176:179], v[200:203], a[200:203]
  s_add_u32 s26, s26, 7168
  ds_read_b64_tr_b16 v[246:247], v13 offset:41984
  v_mfma_f32_16x16x32_bf16 a[204:207], v[184:187], v[200:203], a[204:207]
  buffer_load_dwordx4 v4, s[4:7], s26 offen offset:3072 lds
  v_mfma_f32_16x16x32_bf16 a[204:207], v[188:191], v[204:207], a[204:207]
  ds_read_b64_tr_b16 v[248:249], v14 offset:32768
  v_mfma_f32_16x16x32_bf16 a[196:199], v[188:191], v[196:199], a[196:199]
  s_waitcnt vmcnt(24)
  v_mfma_f32_16x16x32_bf16 v[112:115], v[40:43], v[48:51], 0
  v_mfma_f32_16x16x32_bf16 v[116:119], v[44:47], v[48:51], 0
  v_mfma_f32_16x16x32_bf16 v[120:123], v[40:43], v[52:55], 0
  v_mfma_f32_16x16x32_bf16 v[124:127], v[44:47], v[52:55], 0
  v_mfma_f32_16x16x32_bf16 a[196:199], v[184:187], v[192:195], a[196:199]
  ds_read_b64_tr_b16 v[250:251], v14 offset:33792
  v_mfma_f32_16x16x32_bf16 a[16:19], v[128:131], v[208:211], a[16:19]
  s_add_u32 m0, s28, 135168
  v_mfma_f32_16x16x32_bf16 a[16:19], v[132:135], v[212:215], a[16:19]
  s_add_u32 s26, s26, 502784
  ds_read_b64_tr_b16 v[252:253], v14 offset:40960
  v_mfma_f32_16x16x32_bf16 a[24:27], v[132:135], v[220:223], a[24:27]
  buffer_load_dwordx4 v3, s[4:7], s26 offen lds
  v_mfma_f32_16x16x32_bf16 a[24:27], v[128:131], v[216:219], a[24:27]
  ds_read_b64_tr_b16 v[254:255], v14 offset:41984
  v_cvt_pk_bf16_f32 v56, v112, v113
  v_mfma_f32_16x16x32_bf16 a[28:31], v[136:139], v[216:219], a[28:31]
  v_cvt_pk_bf16_f32 v57, v114, v115
  v_cvt_pk_bf16_f32 v58, v116, v117
  v_mfma_f32_16x16x32_bf16 a[28:31], v[140:143], v[220:223], a[28:31]
  v_cvt_pk_bf16_f32 v59, v118, v119
  v_mfma_f32_16x16x32_bf16 a[20:23], v[140:143], v[212:215], a[20:23]
  buffer_store_dwordx4 v[56:59], v2, s[8:11], s65 offen sc1
  v_mfma_f32_16x16x32_bf16 a[20:23], v[136:139], v[208:211], a[20:23]
  v_cvt_pk_bf16_f32 v60, v120, v121
  v_cvt_pk_bf16_f32 v61, v122, v123
  v_mfma_f32_16x16x32_bf16 a[80:83], v[144:147], v[208:211], a[80:83]
  s_add_u32 s26, s26, 7168
  v_cvt_pk_bf16_f32 v62, v124, v125
  v_cvt_pk_bf16_f32 v63, v126, v127
  v_mfma_f32_16x16x32_bf16 a[80:83], v[148:151], v[212:215], a[80:83]
  buffer_load_dwordx4 v4, s[4:7], s26 offen offset:1024 lds
  v_mfma_f32_16x16x32_bf16 a[88:91], v[148:151], v[220:223], a[88:91]
  buffer_store_dwordx4 v[60:63], v2, s[8:11], s65 offen offset:1024 sc1
  v_mfma_f32_16x16x32_bf16 a[88:91], v[144:147], v[216:219], a[88:91]
  v_mfma_f32_16x16x32_bf16 a[92:95], v[152:155], v[216:219], a[92:95]
  v_mfma_f32_16x16x32_bf16 a[92:95], v[156:159], v[220:223], a[92:95]
  v_mfma_f32_16x16x32_bf16 a[84:87], v[156:159], v[212:215], a[84:87]
  v_mfma_f32_16x16x32_bf16 a[84:87], v[152:155], v[208:211], a[84:87]
  s_add_u32 s26, s26, 7168
  v_mfma_f32_16x16x32_bf16 a[144:147], v[160:163], v[208:211], a[144:147]
  buffer_load_dwordx4 v3, s[4:7], s26 offen offset:2048 lds
  v_mfma_f32_16x16x32_bf16 a[144:147], v[164:167], v[212:215], a[144:147]
  v_mfma_f32_16x16x32_bf16 a[152:155], v[164:167], v[220:223], a[152:155]
  v_lshl_add_u32 v17, v22, 4, s34
  v_mfma_f32_16x16x32_bf16 a[152:155], v[160:163], v[216:219], a[152:155]
  v_mfma_f32_16x16x32_bf16 a[156:159], v[168:171], v[216:219], a[156:159]
  v_mfma_f32_16x16x32_bf16 a[156:159], v[172:175], v[220:223], a[156:159]
  v_mfma_f32_16x16x32_bf16 a[148:151], v[172:175], v[212:215], a[148:151]
  s_add_u32 s26, s26, 7168
  v_mfma_f32_16x16x32_bf16 a[148:151], v[168:171], v[208:211], a[148:151]
  buffer_load_dwordx4 v4, s[4:7], s26 offen offset:3072 lds
  v_mfma_f32_16x16x32_bf16 a[208:211], v[176:179], v[208:211], a[208:211]
  v_add_u32 v5, 0x10000, v5
  v_add_u32 v6, 0x10000, v6
  v_mfma_f32_16x16x32_bf16 a[208:211], v[180:183], v[212:215], a[208:211]
  v_add_u32 v7, 0x10000, v7
  v_add_u32 v8, 0x10000, v8
  v_mfma_f32_16x16x32_bf16 a[216:219], v[180:183], v[220:223], a[216:219]
  v_add_u32 v9, 0x10000, v9
  v_add_u32 v10, 0x10000, v10
  v_mfma_f32_16x16x32_bf16 a[216:219], v[176:179], v[216:219], a[216:219]
  v_add_u32 v11, 0x10000, v11
  v_add_u32 v12, 0x10000, v12
  v_mfma_f32_16x16x32_bf16 a[220:223], v[184:187], v[216:219], a[220:223]
  v_add_u32 v13, 0x10000, v13
  v_add_u32 v14, 0x10000, v14
  v_mfma_f32_16x16x32_bf16 a[220:223], v[188:191], v[220:223], a[220:223]
  v_mfma_f32_16x16x32_bf16 a[212:215], v[188:191], v[212:215], a[212:215]
  v_mfma_f32_16x16x32_bf16 a[212:215], v[184:187], v[208:211], a[212:215]
  s_waitcnt vmcnt(12) lgkmcnt(0)
  s_barrier
  v_mfma_f32_16x16x32_bf16 a[32:35], v[128:131], v[224:227], a[32:35]
  s_add_u32 m0, s28, 0
  ds_read_b64_tr_b16 v[192:193], v7 offset:32768
  v_mfma_f32_16x16x32_bf16 a[32:35], v[132:135], v[228:231], a[32:35]
  s_add_u32 s27, s30, s32
  ds_read_b64_tr_b16 v[194:195], v7 offset:33792
  v_mfma_f32_16x16x32_bf16 a[40:43], v[132:135], v[236:239], a[40:43]
  buffer_load_dwordx4 v15, s[12:15], s27 offen lds
  v_mfma_f32_16x16x32_bf16 a[40:43], v[128:131], v[232:235], a[40:43]
  ds_read_b64_tr_b16 v[196:197], v7 offset:40960
  v_mfma_f32_16x16x32_bf16 a[44:47], v[136:139], v[232:235], a[44:47]
  s_add_u32 s32, s32, 524288
  ds_read_b64_tr_b16 v[198:199], v7 offset:41984
  v_mfma_f32_16x16x32_bf16 a[44:47], v[140:143], v[236:239], a[44:47]
  s_add_u32 s27, s27, 31744
  ds_read_b64_tr_b16 v[200:201], v8 offset:32768
  v_mfma_f32_16x16x32_bf16 a[36:39], v[140:143], v[228:231], a[36:39]
  buffer_load_dwordx4 v15, s[12:15], s27 offen offset:1024 lds
  v_mfma_f32_16x16x32_bf16 a[36:39], v[136:139], v[224:227], a[36:39]
  ds_read_b64_tr_b16 v[202:203], v8 offset:33792
  v_mfma_f32_16x16x32_bf16 a[96:99], v[144:147], v[224:227], a[96:99]
  s_and_b32 s32, s32, 0x3fffff
  ds_read_b64_tr_b16 v[204:205], v8 offset:40960
  v_mfma_f32_16x16x32_bf16 a[96:99], v[148:151], v[228:231], a[96:99]
  s_add_u32 s27, s27, 31744
  ds_read_b64_tr_b16 v[206:207], v8 offset:41984
  v_mfma_f32_16x16x32_bf16 a[104:107], v[148:151], v[236:239], a[104:107]
  buffer_load_dwordx4 v16, s[12:15], s27 offen offset:2048 lds
  v_mfma_f32_16x16x32_bf16 a[104:107], v[144:147], v[232:235], a[104:107]
  ds_read_b64_tr_b16 v[208:209], v9 offset:32768
  v_mfma_f32_16x16x32_bf16 a[108:111], v[152:155], v[232:235], a[108:111]
  ds_read_b64_tr_b16 v[210:211], v9 offset:33792
  v_mfma_f32_16x16x32_bf16 a[108:111], v[156:159], v[236:239], a[108:111]
  s_add_u32 s27, s27, 31744
  ds_read_b64_tr_b16 v[212:213], v9 offset:40960
  v_mfma_f32_16x16x32_bf16 a[100:103], v[156:159], v[228:231], a[100:103]
  buffer_load_dwordx4 v16, s[12:15], s27 offen offset:3072 lds
  v_mfma_f32_16x16x32_bf16 a[100:103], v[152:155], v[224:227], a[100:103]
  ds_read_b64_tr_b16 v[214:215], v9 offset:41984
  v_mfma_f32_16x16x32_bf16 a[160:163], v[160:163], v[224:227], a[160:163]
  s_add_u32 m0, s28, 4096
  ds_read_b64_tr_b16 v[216:217], v10 offset:32768
  v_mfma_f32_16x16x32_bf16 a[160:163], v[164:167], v[228:231], a[160:163]
  s_add_u32 s27, s27, 35840
  ds_read_b64_tr_b16 v[218:219], v10 offset:33792
  v_mfma_f32_16x16x32_bf16 a[168:171], v[164:167], v[236:239], a[168:171]
  buffer_load_dwordx4 v15, s[12:15], s27 offen lds
  v_mfma_f32_16x16x32_bf16 a[168:171], v[160:163], v[232:235], a[168:171]
  ds_read_b64_tr_b16 v[220:221], v10 offset:40960
  v_mfma_f32_16x16x32_bf16 a[172:175], v[168:171], v[232:235], a[172:175]
  ds_read_b64_tr_b16 v[222:223], v10 offset:41984
  v_mfma_f32_16x16x32_bf16 a[172:175], v[172:175], v[236:239], a[172:175]
  s_add_u32 s27, s27, 31744
  v_mfma_f32_16x16x32_bf16 a[164:167], v[172:175], v[228:231], a[164:167]
  buffer_load_dwordx4 v15, s[12:15], s27 offen offset:1024 lds
  v_mfma_f32_16x16x32_bf16 a[164:167], v[168:171], v[224:227], a[164:167]
  s_waitcnt vmcnt(14)
  v_lshrrev_b32 v20, 4, v19
  v_and_b32 v21, 0x0f0f0f0f, v19
  v_and_b32 v20, 0x0f0f0f0f, v20
  v_sad_u8 v21, v21, 0, 0
  v_sad_u8 v20, v20, 0, v21
  v_cmp_ne_u32 vcc, 8, v20
  s_cbranch_vccnz L_spin_11
L_back_12:
  v_cmp_ne_u32 vcc, s3, v19
  v_mfma_f32_16x16x32_bf16 a[224:227], v[176:179], v[224:227], a[224:227]
  s_and_b32 s23, s23, vcc_lo
  s_cselect_b32 s3, 0, 1
  v_mfma_f32_16x16x32_bf16 a[224:227], v[180:183], v[228:231], a[224:227]
  s_add_u32 s27, s27, 31744
  v_mfma_f32_16x16x32_bf16 a[232:235], v[180:183], v[236:239], a[232:235]
  buffer_load_dwordx4 v16, s[12:15], s27 offen offset:2048 lds
  v_mfma_f32_16x16x32_bf16 a[232:235], v[176:179], v[232:235], a[232:235]
  v_mfma_f32_16x16x32_bf16 a[236:239], v[184:187], v[232:235], a[236:239]
  v_mfma_f32_16x16x32_bf16 a[236:239], v[188:191], v[236:239], a[236:239]
  s_add_u32 s27, s27, 31744
  v_mfma_f32_16x16x32_bf16 a[228:231], v[188:191], v[228:231], a[228:231]
  buffer_load_dwordx4 v16, s[12:15], s27 offen offset:3072 lds
  v_mfma_f32_16x16x32_bf16 a[228:231], v[184:187], v[224:227], a[228:231]
  s_mov_b32 s4, s44
  v_mfma_f32_16x16x32_bf16 a[48:51], v[128:131], v[240:243], a[48:51]
  s_mov_b32 s5, s45
  v_mfma_f32_16x16x32_bf16 a[48:51], v[132:135], v[244:247], a[48:51]
  buffer_load_dwordx4 v[64:67], v17, s[8:11], s36 offen sc1
  v_mfma_f32_16x16x32_bf16 a[56:59], v[132:135], v[252:255], a[56:59]
  s_mov_b32 s6, 0x400000
  v_mfma_f32_16x16x32_bf16 a[56:59], v[128:131], v[248:251], a[56:59]
  s_lshl_b32 s29, s20, 18
  ds_read_b128 v[128:131], v5 offset:0
  v_mfma_f32_16x16x32_bf16 a[60:63], v[136:139], v[248:251], a[60:63]
  s_lshl_b32 s23, s21, 8
  ds_read_b128 v[132:135], v6 offset:0
  v_mfma_f32_16x16x32_bf16 a[60:63], v[140:143], v[252:255], a[60:63]
  buffer_load_dwordx4 v[68:71], v17, s[8:11], s37 offen sc1
  v_mfma_f32_16x16x32_bf16 a[52:55], v[140:143], v[244:247], a[52:55]
  s_add_u32 s29, s29, s23
  v_mfma_f32_16x16x32_bf16 a[52:55], v[136:139], v[240:243], a[52:55]
  s_lshl_b32 s31, s34, 8
  ds_read_b128 v[136:139], v5 offset:2048
  v_mfma_f32_16x16x32_bf16 a[112:115], v[144:147], v[240:243], a[112:115]
  ds_read_b128 v[140:143], v6 offset:2048
  v_mfma_f32_16x16x32_bf16 a[112:115], v[148:151], v[244:247], a[112:115]
  buffer_load_dwordx4 v[72:75], v17, s[8:11], s38 offen sc1
  v_mfma_f32_16x16x32_bf16 a[120:123], v[148:151], v[252:255], a[120:123]
  v_mfma_f32_16x16x32_bf16 a[120:123], v[144:147], v[248:251], a[120:123]
  ds_read_b128 v[144:147], v5 offset:4096
  v_mfma_f32_16x16x32_bf16 a[124:127], v[152:155], v[248:251], a[124:127]
  ds_read_b128 v[148:151], v6 offset:4096
  v_mfma_f32_16x16x32_bf16 a[124:127], v[156:159], v[252:255], a[124:127]
  buffer_load_dwordx4 v[76:79], v17, s[8:11], s39 offen sc1
  v_mfma_f32_16x16x32_bf16 a[116:119], v[156:159], v[244:247], a[116:119]
  v_mfma_f32_16x16x32_bf16 a[116:119], v[152:155], v[240:243], a[116:119]
  ds_read_b128 v[152:155], v5 offset:6144
  v_mfma_f32_16x16x32_bf16 a[176:179], v[160:163], v[240:243], a[176:179]
  ds_read_b128 v[156:159], v6 offset:6144
  v_mfma_f32_16x16x32_bf16 a[176:179], v[164:167], v[244:247], a[176:179]
  buffer_load_dwordx4 v[80:83], v17, s[8:11], s36 offen offset:1024 sc1
  v_mfma_f32_16x16x32_bf16 a[184:187], v[164:167], v[252:255], a[184:187]
  v_mfma_f32_16x16x32_bf16 a[184:187], v[160:163], v[248:251], a[184:187]
  ds_read_b128 v[160:163], v5 offset:8192
  v_mfma_f32_16x16x32_bf16 a[188:191], v[168:171], v[248:251], a[188:191]
  ds_read_b128 v[164:167], v6 offset:8192
  v_mfma_f32_16x16x32_bf16 a[188:191], v[172:175], v[252:255], a[188:191]
  buffer_load_dwordx4 v[84:87], v17, s[8:11], s37 offen offset:1024 sc1
  v_mfma_f32_16x16x32_bf16 a[180:183], v[172:175], v[244:247], a[180:183]
  v_mfma_f32_16x16x32_bf16 a[180:183], v[168:171], v[240:243], a[180:183]
  ds_read_b128 v[168:171], v5 offset:10240
  v_mfma_f32_16x16x32_bf16 a[240:243], v[176:179], v[240:243], a[240:243]
  ds_read_b128 v[172:175], v6 offset:10240
  v_mfma_f32_16x16x32_bf16 a[240:243], v[180:183], v[244:247], a[240:243]
  buffer_load_dwordx4 v[88:91], v17, s[8:11], s38 offen offset:1024 sc1
  v_mfma_f32_16x16x32_bf16 a[248:251], v[180:183], v[252:255], a[248:251]
  v_mfma_f32_16x16x32_bf16 a[248:251], v[176:179], v[248:251], a[248:251]
  ds_read_b128 v[176:179], v5 offset:12288
  v_mfma_f32_16x16x32_bf16 a[252:255], v[184:187], v[248:251], a[252:255]
  ds_read_b128 v[180:183], v6 offset:12288
  v_mfma_f32_16x16x32_bf16 a[252:255], v[188:191], v[252:255], a[252:255]
  buffer_load_dwordx4 v[92:95], v17, s[8:11], s39 offen offset:1024 sc1
  v_mfma_f32_16x16x32_bf16 a[244:247], v[188:191], v[244:247], a[244:247]
  v_mfma_f32_16x16x32_bf16 a[244:247], v[184:187], v[240:243], a[244:247]
  s_waitcnt lgkmcnt(10)
  v_mfma_f32_16x16x32_bf16 a[0:3], v[128:131], v[192:195], a[0:3]
  ds_read_b128 v[184:187], v5 offset:14336
  v_mfma_f32_16x16x32_bf16 a[0:3], v[132:135], v[196:199], a[0:3]
  ds_read_b128 v[188:191], v6 offset:14336
  v_mfma_f32_16x16x32_bf16 a[8:11], v[132:135], v[204:207], a[8:11]
  ds_read_b64_tr_b16 v[224:225], v11 offset:32768
  v_mfma_f32_16x16x32_bf16 a[8:11], v[128:131], v[200:203], a[8:11]
  v_mfma_f32_16x16x32_bf16 a[12:15], v[136:139], v[200:203], a[12:15]
  s_add_u32 m0, s28, 32768
  ds_read_b64_tr_b16 v[226:227], v11 offset:33792
  v_mfma_f32_16x16x32_bf16 a[12:15], v[140:143], v[204:207], a[12:15]
  s_add_u32 s26, s29, s31
  v_mfma_f32_16x16x32_bf16 a[4:7], v[140:143], v[196:199], a[4:7]
  buffer_load_dwordx4 v15, s[4:7], s26 offen lds
  v_mfma_f32_16x16x32_bf16 a[4:7], v[136:139], v[192:195], a[4:7]
  s_waitcnt lgkmcnt(10)
  ds_read_b64_tr_b16 v[228:229], v11 offset:40960
  v_mfma_f32_16x16x32_bf16 a[64:67], v[144:147], v[192:195], a[64:67]
  v_mfma_f32_16x16x32_bf16 a[64:67], v[148:151], v[196:199], a[64:67]
  ds_read_b64_tr_b16 v[230:231], v11 offset:41984
  v_mfma_f32_16x16x32_bf16 a[72:75], v[148:151], v[204:207], a[72:75]
  v_mfma_f32_16x16x32_bf16 a[72:75], v[144:147], v[200:203], a[72:75]
  s_add_u32 s31, s31, 1048576
  ds_read_b64_tr_b16 v[232:233], v12 offset:32768
  v_mfma_f32_16x16x32_bf16 a[76:79], v[152:155], v[200:203], a[76:79]
  s_add_u32 s26, s26, 31744
  v_mfma_f32_16x16x32_bf16 a[76:79], v[156:159], v[204:207], a[76:79]
  buffer_load_dwordx4 v15, s[4:7], s26 offen offset:1024 lds
  v_mfma_f32_16x16x32_bf16 a[68:71], v[156:159], v[196:199], a[68:71]
  ds_read_b64_tr_b16 v[234:235], v12 offset:33792
  v_mfma_f32_16x16x32_bf16 a[68:71], v[152:155], v[192:195], a[68:71]
  s_waitcnt lgkmcnt(10)
  v_mfma_f32_16x16x32_bf16 a[128:131], v[160:163], v[192:195], a[128:131]
  ds_read_b64_tr_b16 v[236:237], v12 offset:40960
  v_mfma_f32_16x16x32_bf16 a[128:131], v[164:167], v[196:199], a[128:131]
  v_mfma_f32_16x16x32_bf16 a[136:139], v[164:167], v[204:207], a[136:139]
  s_and_b32 s31, s31, 0x3fffff
  ds_read_b64_tr_b16 v[238:239], v12 offset:41984
  v_mfma_f32_16x16x32_bf16 a[136:139], v[160:163], v[200:203], a[136:139]
  s_add_u32 s26, s26, 31744
  v_mfma_f32_16x16x32_bf16 a[140:143], v[168:171], v[200:203], a[140:143]
  buffer_load_dwordx4 v16, s[4:7], s26 offen offset:2048 lds
  v_mfma_f32_16x16x32_bf16 a[140:143], v[172:175], v[204:207], a[140:143]
  ds_read_b64_tr_b16 v[240:241], v13 offset:32768
  v_mfma_f32_16x16x32_bf16 a[132:135], v[172:175], v[196:199], a[132:135]
  v_mfma_f32_16x16x32_bf16 a[132:135], v[168:171], v[192:195], a[132:135]
  s_waitcnt lgkmcnt(9)
  ds_read_b64_tr_b16 v[242:243], v13 offset:33792
  v_mfma_f32_16x16x32_bf16 a[192:195], v[176:179], v[192:195], a[192:195]
  v_mfma_f32_16x16x32_bf16 a[192:195], v[180:183], v[196:199], a[192:195]
  ds_read_b64_tr_b16 v[244:245], v13 offset:40960
  v_mfma_f32_16x16x32_bf16 a[200:203], v[180:183], v[204:207], a[200:203]
  v_mfma_f32_16x16x32_bf16 a[200:203], v[176:179], v[200:203], a[200:203]
  s_add_u32 s26, s26, 31744
  ds_read_b64_tr_b16 v[246:247], v13 offset:41984
  v_mfma_f32_16x16x32_bf16 a[204:207], v[184:187], v[200:203], a[204:207]
  buffer_load_dwordx4 v16, s[4:7], s26 offen offset:3072 lds
  v_mfma_f32_16x16x32_bf16 a[204:207], v[188:191], v[204:207], a[204:207]
  ds_read_b64_tr_b16 v[248:249], v14 offset:32768
  v_mfma_f32_16x16x32_bf16 a[196:199], v[188:191], v[196:199], a[196:199]
  v_mfma_f32_16x16x32_bf16 a[196:199], v[184:187], v[192:195], a[196:199]
  ds_read_b64_tr_b16 v[250:251], v14 offset:33792
  v_mfma_f32_16x16x32_bf16 a[16:19], v[128:131], v[208:211], a[16:19]
  s_add_u32 m0, s28, 36864
  v_mfma_f32_16x16x32_bf16 a[16:19], v[132:135], v[212:215], a[16:19]
  s_add_u32 s26, s26, 35840
  ds_read_b64_tr_b16 v[252:253], v14 offset:40960
  v_mfma_f32_16x16x32_bf16 a[24:27], v[132:135], v[220:223], a[24:27]
  buffer_load_dwordx4 v15, s[4:7], s26 offen lds
  v_mfma_f32_16x16x32_bf16 a[24:27], v[128:131], v[216:219], a[24:27]
  ds_read_b64_tr_b16 v[254:255], v14 offset:41984
  v_mfma_f32_16x16x32_bf16 a[28:31], v[136:139], v[216:219], a[28:31]
  v_mfma_f32_16x16x32_bf16 a[28:31], v[140:143], v[220:223], a[28:31]
  v_mfma_f32_16x16x32_bf16 a[20:23], v[140:143], v[212:215], a[20:23]
  v_mfma_f32_16x16x32_bf16 a[20:23], v[136:139], v[208:211], a[20:23]
  v_mfma_f32_16x16x32_bf16 a[80:83], v[144:147], v[208:211], a[80:83]
  s_add_u32 s26, s26, 31744
  v_mfma_f32_16x16x32_bf16 a[80:83], v[148:151], v[212:215], a[80:83]
  buffer_load_dwordx4 v15, s[4:7], s26 offen offset:1024 lds
  v_mfma_f32_16x16x32_bf16 a[88:91], v[148:151], v[220:223], a[88:91]
  v_mfma_f32_16x16x32_bf16 a[88:91], v[144:147], v[216:219], a[88:91]
  v_mfma_f32_16x16x32_bf16 a[92:95], v[152:155], v[216:219], a[92:95]
  v_mfma_f32_16x16x32_bf16 a[92:95], v[156:159], v[220:223], a[92:95]
  v_mfma_f32_16x16x32_bf16 a[84:87], v[156:159], v[212:215], a[84:87]
  v_mfma_f32_16x16x32_bf16 a[84:87], v[152:155], v[208:211], a[84:87]
  s_add_u32 s26, s26, 31744
  v_mfma_f32_16x16x32_bf16 a[144:147], v[160:163], v[208:211], a[144:147]
  buffer_load_dwordx4 v16, s[4:7], s26 offen offset:2048 lds
  v_mfma_f32_16x16x32_bf16 a[144:147], v[164:167], v[212:215], a[144:147]
  v_mfma_f32_16x16x32_bf16 a[152:155], v[164:167], v[220:223], a[152:155]
  v_mfma_f32_16x16x32_bf16 a[152:155], v[160:163], v[216:219], a[152:155]
  v_mfma_f32_16x16x32_bf16 a[156:159], v[168:171], v[216:219], a[156:159]
  v_mfma_f32_16x16x32_bf16 a[156:159], v[172:175], v[220:223], a[156:159]
  v_mfma_f32_16x16x32_bf16 a[148:151], v[172:175], v[212:215], a[148:151]
  s_add_u32 s26, s26, 31744
  v_mfma_f32_16x16x32_bf16 a[148:151], v[168:171], v[208:211], a[148:151]
  buffer_load_dwordx4 v16, s[4:7], s26 offen offset:3072 lds
  v_mfma_f32_16x16x32_bf16 a[208:211], v[176:179], v[208:211], a[208:211]
  v_add_u32 v5, 0x10000, v5
  v_add_u32 v6, 0x10000, v6
  v_mfma_f32_16x16x32_bf16 a[208:211], v[180:183], v[212:215], a[208:211]
  v_add_u32 v7, 0xffff0000, v7
  v_add_u32 v8, 0xffff0000, v8
  v_mfma_f32_16x16x32_bf16 a[216:219], v[180:183], v[220:223], a[216:219]
  v_add_u32 v9, 0xffff0000, v9
  v_add_u32 v10, 0xffff0000, v10
  v_mfma_f32_16x16x32_bf16 a[216:219], v[176:179], v[216:219], a[216:219]
  v_add_u32 v11, 0xffff0000, v11
  v_add_u32 v12, 0xffff0000, v12
  v_mfma_f32_16x16x32_bf16 a[220:223], v[184:187], v[216:219], a[220:223]
  v_add_u32 v13, 0xffff0000, v13
  v_add_u32 v14, 0xffff0000, v14
  v_mfma_f32_16x16x32_bf16 a[220:223], v[188:191], v[220:223], a[220:223]
  v_mfma_f32_16x16x32_bf16 a[212:215], v[188:191], v[212:215], a[212:215]
  v_mfma_f32_16x16x32_bf16 a[212:215], v[184:187], v[208:211], a[212:215]
  s_waitcnt vmcnt(16) lgkmcnt(0)
  s_barrier
  v_mfma_f32_16x16x32_bf16 a[32:35], v[128:131], v[224:227], a[32:35]
  s_add_u32 m0, s28, 65536
  ds_read_b64_tr_b16 v[192:193], v7 offset:0
  v_mfma_f32_16x16x32_bf16 a[32:35], v[132:135], v[228:231], a[32:35]
  s_add_u32 s26, s29, s31
  ds_read_b64_tr_b16 v[194:195], v7 offset:1024
  v_mfma_f32_16x16x32_bf16 a[40:43], v[132:135], v[236:239], a[40:43]
  buffer_load_dwordx4 v15, s[4:7], s26 offen lds
  v_mfma_f32_16x16x32_bf16 a[40:43], v[128:131], v[232:235], a[40:43]
  ds_read_b64_tr_b16 v[196:197], v7 offset:8192
  v_mfma_f32_16x16x32_bf16 a[44:47], v[136:139], v[232:235], a[44:47]
  s_add_u32 s31, s31, 1048576
  ds_read_b64_tr_b16 v[198:199], v7 offset:9216
  v_mfma_f32_16x16x32_bf16 a[44:47], v[140:143], v[236:239], a[44:47]
  s_add_u32 s26, s26, 31744
  ds_read_b64_tr_b16 v[200:201], v8 offset:0
  v_mfma_f32_16x16x32_bf16 a[36:39], v[140:143], v[228:231], a[36:39]
  buffer_load_dwordx4 v15, s[4:7], s26 offen offset:1024 lds
  v_mfma_f32_16x16x32_bf16 a[36:39], v[136:139], v[224:227], a[36:39]
  ds_read_b64_tr_b16 v[202:203], v8 offset:1024
  v_mfma_f32_16x16x32_bf16 a[96:99], v[144:147], v[224:227], a[96:99]
  s_and_b32 s31, s31, 0x3fffff
  ds_read_b64_tr_b16 v[204:205], v8 offset:8192
  v_mfma_f32_16x16x32_bf16 a[96:99], v[148:151], v[228:231], a[96:99]
  s_add_u32 s26, s26, 31744
  ds_read_b64_tr_b16 v[206:207], v8 offset:9216
  v_mfma_f32_16x16x32_bf16 a[104:107], v[148:151], v[236:239], a[104:107]
  buffer_load_dwordx4 v16, s[4:7], s26 offen offset:2048 lds
  v_mfma_f32_16x16x32_bf16 a[104:107], v[144:147], v[232:235], a[104:107]
  ds_read_b64_tr_b16 v[208:209], v9 offset:0
  v_mfma_f32_16x16x32_bf16 a[108:111], v[152:155], v[232:235], a[108:111]
  ds_read_b64_tr_b16 v[210:211], v9 offset:1024
  v_mfma_f32_16x16x32_bf16 a[108:111], v[156:159], v[236:239], a[108:111]
  s_add_u32 s26, s26, 31744
  ds_read_b64_tr_b16 v[212:213], v9 offset:8192
  v_mfma_f32_16x16x32_bf16 a[100:103], v[156:159], v[228:231], a[100:103]
  buffer_load_dwordx4 v16, s[4:7], s26 offen offset:3072 lds
  v_mfma_f32_16x16x32_bf16 a[100:103], v[152:155], v[224:227], a[100:103]
  ds_read_b64_tr_b16 v[214:215], v9 offset:9216
  v_mfma_f32_16x16x32_bf16 a[160:163], v[160:163], v[224:227], a[160:163]
  s_add_u32 m0, s28, 69632
  ds_read_b64_tr_b16 v[216:217], v10 offset:0
  v_mfma_f32_16x16x32_bf16 a[160:163], v[164:167], v[228:231], a[160:163]
  s_add_u32 s26, s26, 35840
  ds_read_b64_tr_b16 v[218:219], v10 offset:1024
  v_mfma_f32_16x16x32_bf16 a[168:171], v[164:167], v[236:239], a[168:171]
  buffer_load_dwordx4 v15, s[4:7], s26 offen lds
  v_mfma_f32_16x16x32_bf16 a[168:171], v[160:163], v[232:235], a[168:171]
  ds_read_b64_tr_b16 v[220:221], v10 offset:8192
  v_mfma_f32_16x16x32_bf16 a[172:175], v[168:171], v[232:235], a[172:175]
  ds_read_b64_tr_b16 v[222:223], v10 offset:9216
  v_mfma_f32_16x16x32_bf16 a[172:175], v[172:175], v[236:239], a[172:175]
  s_add_u32 s26, s26, 31744
  v_mfma_f32_16x16x32_bf16 a[164:167], v[172:175], v[228:231], a[164:167]
  buffer_load_dwordx4 v15, s[4:7], s26 offen offset:1024 lds
  v_mfma_f32_16x16x32_bf16 a[164:167], v[168:171], v[224:227], a[164:167]
  v_mfma_f32_16x16x32_bf16 a[224:227], v[176:179], v[224:227], a[224:227]
  v_mfma_f32_16x16x32_bf16 a[224:227], v[180:183], v[228:231], a[224:227]
  s_add_u32 s26, s26, 31744
  v_mfma_f32_16x16x32_bf16 a[232:235], v[180:183], v[236:239], a[232:235]
  buffer_load_dwordx4 v16, s[4:7], s26 offen offset:2048 lds
  v_mfma_f32_16x16x32_bf16 a[232:235], v[176:179], v[232:235], a[232:235]
  v_mfma_f32_16x16x32_bf16 a[236:239], v[184:187], v[232:235], a[236:239]
  v_mfma_f32_16x16x32_bf16 a[236:239], v[188:191], v[236:239], a[236:239]
  s_add_u32 s26, s26, 31744
  v_mfma_f32_16x16x32_bf16 a[228:231], v[188:191], v[228:231], a[228:231]
  buffer_load_dwordx4 v16, s[4:7], s26 offen offset:3072 lds
  v_mfma_f32_16x16x32_bf16 a[228:231], v[184:187], v[224:227], a[228:231]
  s_lshr_b32 s23, s20, 1
  v_mfma_f32_16x16x32_bf16 a[48:51], v[128:131], v[240:243], a[48:51]
  s_lshl_b32 s23, s23, 14
  ds_read_b64_tr_b16 v[224:225], v11 offset:0
  v_mfma_f32_16x16x32_bf16 a[48:51], v[132:135], v[244:247], a[48:51]
  s_sub_u32 s30, 32768, s23
  ds_read_b64_tr_b16 v[226:227], v11 offset:1024
  v_mfma_f32_16x16x32_bf16 a[56:59], v[132:135], v[252:255], a[56:59]
  s_lshl_b32 s33, s21, 20
  ds_read_b64_tr_b16 v[228:229], v11 offset:8192
  v_mfma_f32_16x16x32_bf16 a[56:59], v[128:131], v[248:251], a[56:59]
  s_lshl_b32 s23, s22, 14
  ds_read_b128 v[128:131], v5 offset:0
  v_mfma_f32_16x16x32_bf16 a[60:63], v[136:139], v[248:251], a[60:63]
  s_add_u32 s33, s33, s23
  ds_read_b128 v[132:135], v6 offset:0
  v_mfma_f32_16x16x32_bf16 a[60:63], v[140:143], v[252:255], a[60:63]
  s_and_b32 s23, s20, 1
  ds_read_b64_tr_b16 v[230:231], v11 offset:9216
  v_mfma_f32_16x16x32_bf16 a[52:55], v[140:143], v[244:247], a[52:55]
  s_lshl_b32 s23, s23, 17
  ds_read_b64_tr_b16 v[232:233], v12 offset:0
  v_mfma_f32_16x16x32_bf16 a[52:55], v[136:139], v[240:243], a[52:55]
  s_add_u32 s33, s33, s23
  ds_read_b128 v[136:139], v5 offset:2048
  v_mfma_f32_16x16x32_bf16 a[112:115], v[144:147], v[240:243], a[112:115]
  s_add_u32 s33, s33, 8192
  ds_read_b128 v[140:143], v6 offset:2048
  v_mfma_f32_16x16x32_bf16 a[112:115], v[148:151], v[244:247], a[112:115]
  ds_read_b64_tr_b16 v[234:235], v12 offset:1024
  v_mfma_f32_16x16x32_bf16 a[120:123], v[148:151], v[252:255], a[120:123]
  ds_read_b64_tr_b16 v[236:237], v12 offset:8192
  v_mfma_f32_16x16x32_bf16 a[120:123], v[144:147], v[248:251], a[120:123]
  ds_read_b128 v[144:147], v5 offset:4096
  v_mfma_f32_16x16x32_bf16 a[124:127], v[152:155], v[248:251], a[124:127]
  ds_read_b128 v[148:151], v6 offset:4096
  v_mfma_f32_16x16x32_bf16 a[124:127], v[156:159], v[252:255], a[124:127]
  ds_read_b64_tr_b16 v[238:239], v12 offset:9216
  v_mfma_f32_16x16x32_bf16 a[116:119], v[156:159], v[244:247], a[116:119]
  s_bitcmp0_b32 s22, 0
  s_cbranch_scc1 L_s1_7
  s_cmp_lg_u32 s20, 2
  s_cbranch_scc1 L_nosig_8
  v_mov_b32 v19, 1
  s_mov_b64 exec, 1
  buffer_atomic_add v19, off, s[16:19], s35 offset:4 sc1
  s_mov_b64 exec, -1
L_nosig_8:
L_s1_7:
  v_mfma_f32_16x16x32_bf16 a[116:119], v[152:155], v[240:243], a[116:119]
  ds_read_b128 v[152:155], v5 offset:6144
  v_mfma_f32_16x16x32_bf16 a[176:179], v[160:163], v[240:243], a[176:179]
  ds_read_b128 v[156:159], v6 offset:6144
  v_mfma_f32_16x16x32_bf16 a[176:179], v[164:167], v[244:247], a[176:179]
  buffer_load_dwordx4 v[96:99], v17, s[8:11], s36 offen offset:2048 sc1
  v_mfma_f32_16x16x32_bf16 a[184:187], v[164:167], v[252:255], a[184:187]
  buffer_load_dwordx4 v[100:103], v17, s[8:11], s37 offen offset:2048 sc1
  v_mfma_f32_16x16x32_bf16 a[184:187], v[160:163], v[248:251], a[184:187]
  ds_read_b128 v[160:163], v5 offset:8192
  v_mfma_f32_16x16x32_bf16 a[188:191], v[168:171], v[248:251], a[188:191]
  ds_read_b128 v[164:167], v6 offset:8192
  v_mfma_f32_16x16x32_bf16 a[188:191], v[172:175], v[252:255], a[188:191]
  s_bitcmp1_b32 s22, 0
  s_cbranch_scc1 L_s1_9
  s_cmp_lg_u32 s20, 2
  s_cbranch_scc1 L_nosig_10
  v_mov_b32 v19, 1
  s_mov_b64 exec, 1
  buffer_atomic_add v19, off, s[16:19], s35 offset:4 sc1
  s_mov_b64 exec, -1
L_nosig_10:
L_s1_9:
  v_mfma_f32_16x16x32_bf16 a[180:183], v[172:175], v[244:247], a[180:183]
  buffer_load_dwordx4 v[104:107], v17, s[8:11], s38 offen offset:2048 sc1
  v_mfma_f32_16x16x32_bf16 a[180:183], v[168:171], v[240:243], a[180:183]
  ds_read_b128 v[168:171], v5 offset:10240
  v_mfma_f32_16x16x32_bf16 a[240:243], v[176:179], v[240:243], a[240:243]
  ds_read_b128 v[172:175], v6 offset:10240
  v_mfma_f32_16x16x32_bf16 a[240:243], v[180:183], v[244:247], a[240:243]
  buffer_load_dwordx4 v[108:111], v17, s[8:11], s39 offen offset:2048 sc1
  v_mfma_f32_16x16x32_bf16 a[248:251], v[180:183], v[252:255], a[248:251]
  buffer_load_dwordx4 v[112:115], v17, s[8:11], s36 offen offset:3072 sc1
  v_mfma_f32_16x16x32_bf16 a[248:251], v[176:179], v[248:251], a[248:251]
  ds_read_b128 v[176:179], v5 offset:12288
  v_mfma_f32_16x16x32_bf16 a[252:255], v[184:187], v[248:251], a[252:255]
  ds_read_b128 v[180:183], v6 offset:12288
  v_mfma_f32_16x16x32_bf16 a[252:255], v[188:191], v[252:255], a[252:255]
  buffer_load_dwordx4 v[116:119], v17, s[8:11], s37 offen offset:3072 sc1
  v_mfma_f32_16x16x32_bf16 a[244:247], v[188:191], v[244:247], a[244:247]
  buffer_load_dwordx4 v[120:123], v17, s[8:11], s38 offen offset:3072 sc1
  v_mfma_f32_16x16x32_bf16 a[244:247], v[184:187], v[240:243], a[244:247]
  s_waitcnt lgkmcnt(8)
  v_mfma_f32_16x16x32_bf16 a[0:3], v[128:131], v[192:195], a[0:3]
  ds_read_b128 v[184:187], v5 offset:14336
  v_mfma_f32_16x16x32_bf16 a[0:3], v[132:135], v[196:199], a[0:3]
  ds_read_b128 v[188:191], v6 offset:14336
  v_mfma_f32_16x16x32_bf16 a[4:7], v[140:143], v[196:199], a[4:7]
  ds_read_b64_tr_b16 v[240:241], v13 offset:0
  v_mfma_f32_16x16x32_bf16 a[4:7], v[136:139], v[192:195], a[4:7]
  ds_read_b64_tr_b16 v[242:243], v13 offset:1024
  v_mfma_f32_16x16x32_bf16 a[8:11], v[128:131], v[200:203], a[8:11]
  s_add_u32 m0, s28, 98304
  ds_read_b64_tr_b16 v[244:245], v13 offset:8192
  v_mfma_f32_16x16x32_bf16 a[8:11], v[132:135], v[204:207], a[8:11]
  s_add_u32 s26, s29, s31
  ds_read_b64_tr_b16 v[246:247], v13 offset:9216
  v_mfma_f32_16x16x32_bf16 a[12:15], v[140:143], v[204:207], a[12:15]
  buffer_load_dwordx4 v15, s[4:7], s26 offen lds
  v_mfma_f32_16x16x32_bf16 a[12:15], v[136:139], v[200:203], a[12:15]
  ds_read_b64_tr_b16 v[248:249], v14 offset:0
  v_mfma_f32_16x16x32_bf16 a[16:19], v[128:131], v[208:211], a[16:19]
  ds_read_b64_tr_b16 v[250:251], v14 offset:1024
  v_mfma_f32_16x16x32_bf16 a[16:19], v[132:135], v[212:215], a[16:19]
  ds_read_b64_tr_b16 v[252:253], v14 offset:8192
  v_mfma_f32_16x16x32_bf16 a[20:23], v[140:143], v[212:215], a[20:23]
  ds_read_b64_tr_b16 v[254:255], v14 offset:9216
  v_accvgpr_read_b32 v20, a0
  v_mfma_f32_16x16x32_bf16 a[20:23], v[136:139], v[208:211], a[20:23]
  s_add_u32 s31, s31, 1048576
  v_accvgpr_read_b32 v21, a1
  v_cvt_pk_bf16_f32 v24, v20, v21
  v_mfma_f32_16x16x32_bf16 a[24:27], v[128:131], v[216:219], a[24:27]
  s_add_u32 s26, s26, 31744
  v_add_u32 v7, s30, v7
  v_add_u32 v8, s30, v8
  v_mfma_f32_16x16x32_bf16 a[24:27], v[132:135], v[220:223], a[24:27]
  buffer_load_dwordx4 v15, s[4:7], s26 offen offset:1024 lds
  v_mfma_f32_16x16x32_bf16 a[28:31], v[140:143], v[220:223], a[28:31]
  buffer_load_dwordx4 v[124:127], v17, s[8:11], s39 offen offset:3072 sc1
  v_mfma_f32_16x16x32_bf16 a[28:31], v[136:139], v[216:219], a[28:31]
  v_add_u32 v9, s30, v9
  v_add_u32 v10, s30, v10
  v_mfma_f32_16x16x32_bf16 a[32:35], v[128:131], v[224:227], a[32:35]
  v_add_u32 v11, s30, v11
  v_add_u32 v12, s30, v12
  v_mfma_f32_16x16x32_bf16 a[32:35], v[132:135], v[228:231], a[32:35]
  v_add_u32 v13, s30, v13
  v_add_u32 v14, s30, v14
  v_mfma_f32_16x16x32_bf16 a[36:39], v[140:143], v[228:231], a[36:39]
  s_and_b32 s31, s31, 0x3fffff
  v_accvgpr_read_b32 v22, a2
  v_accvgpr_read_b32 v23, a3
  v_mfma_f32_16x16x32_bf16 a[36:39], v[136:139], v[224:227], a[36:39]
  s_add_u32 s26, s26, 31744
  v_cvt_pk_bf16_f32 v25, v22, v23
  v_accvgpr_read_b32 v20, a4
  v_mfma_f32_16x16x32_bf16 a[40:43], v[128:131], v[232:235], a[40:43]
  buffer_load_dwordx4 v16, s[4:7], s26 offen offset:2048 lds
  v_mfma_f32_16x16x32_bf16 a[40:43], v[132:135], v[236:239], a[40:43]
  v_accvgpr_read_b32 v21, a5
  v_cvt_pk_bf16_f32 v26, v20, v21
  v_mfma_f32_16x16x32_bf16 a[44:47], v[140:143], v[236:239], a[44:47]
  v_accvgpr_read_b32 v22, a6
  v_accvgpr_read_b32 v23, a7
  v_mfma_f32_16x16x32_bf16 a[44:47], v[136:139], v[232:235], a[44:47]
  s_waitcnt lgkmcnt(0)
  v_cvt_pk_bf16_f32 v27, v22, v23
  v_mfma_f32_16x16x32_bf16 a[48:51], v[128:131], v[240:243], a[48:51]
  buffer_store_dwordx4 v[24:27], v2, s[8:11], s33 offen
  v_mfma_f32_16x16x32_bf16 a[48:51], v[132:135], v[244:247], a[48:51]
  v_mfma_f32_16x16x32_bf16 a[52:55], v[140:143], v[244:247], a[52:55]
  v_mfma_f32_16x16x32_bf16 a[52:55], v[136:139], v[240:243], a[52:55]
  s_add_u32 s26, s26, 31744
  v_mfma_f32_16x16x32_bf16 a[56:59], v[128:131], v[248:251], a[56:59]
  buffer_load_dwordx4 v16, s[4:7], s26 offen offset:3072 lds
  v_mfma_f32_16x16x32_bf16 a[56:59], v[132:135], v[252:255], a[56:59]
  v_mfma_f32_16x16x32_bf16 a[60:63], v[140:143], v[252:255], a[60:63]
  v_accvgpr_read_b32 v20, a8
  v_accvgpr_read_b32 v21, a9
  v_mfma_f32_16x16x32_bf16 a[60:63], v[136:139], v[248:251], a[60:63]
  v_cvt_pk_bf16_f32 v28, v20, v21
  v_accvgpr_read_b32 v22, a10
  v_mfma_f32_16x16x32_bf16 a[64:67], v[144:147], v[192:195], a[64:67]
  s_add_u32 m0, s28, 102400
  v_accvgpr_read_b32 v23, a11
  v_cvt_pk_bf16_f32 v29, v22, v23
  v_mfma_f32_16x16x32_bf16 a[64:67], v[148:151], v[196:199], a[64:67]
  s_add_u32 s26, s26, 35840
  v_accvgpr_read_b32 v20, a12
  v_accvgpr_read_b32 v21, a13
  v_mfma_f32_16x16x32_bf16 a[68:71], v[156:159], v[196:199], a[68:71]
  buffer_load_dwordx4 v15, s[4:7], s26 offen lds
  v_mfma_f32_16x16x32_bf16 a[68:71], v[152:155], v[192:195], a[68:71]
  v_cvt_pk_bf16_f32 v30, v20, v21
  v_accvgpr_read_b32 v22, a14
  v_mfma_f32_16x16x32_bf16 a[72:75], v[144:147], v[200:203], a[72:75]
  v_accvgpr_read_b32 v23, a15
  v_cvt_pk_bf16_f32 v31, v22, v23
  v_mfma_f32_16x16x32_bf16 a[72:75], v[148:151], v[204:207], a[72:75]
  buffer_store_dwordx4 v[28:31], v2, s[8:11], s33 offen offset:1024
  v_mfma_f32_16x16x32_bf16 a[76:79], v[156:159], v[204:207], a[76:79]
  v_mfma_f32_16x16x32_bf16 a[76:79], v[152:155], v[200:203], a[76:79]
  v_mfma_f32_16x16x32_bf16 a[80:83], v[144:147], v[208:211], a[80:83]
  s_add_u32 s26, s26, 31744
  v_mfma_f32_16x16x32_bf16 a[80:83], v[148:151], v[212:215], a[80:83]
  buffer_load_dwordx4 v15, s[4:7], s26 offen offset:1024 lds
  v_mfma_f32_16x16x32_bf16 a[84:87], v[156:159], v[212:215], a[84:87]
  v_mfma_f32_16x16x32_bf16 a[84:87], v[152:155], v[208:211], a[84:87]
  v_mfma_f32_16x16x32_bf16 a[88:91], v[144:147], v[216:219], a[88:91]
  v_mfma_f32_16x16x32_bf16 a[88:91], v[148:151], v[220:223], a[88:91]
  v_mfma_f32_16x16x32_bf16 a[92:95], v[156:159], v[220:223], a[92:95]
  v_mfma_f32_16x16x32_bf16 a[92:95], v[152:155], v[216:219], a[92:95]
  s_add_u32 s26, s26, 31744
  v_mfma_f32_16x16x32_bf16 a[96:99], v[144:147], v[224:227], a[96:99]
  buffer_load_dwordx4 v16, s[4:7], s26 offen offset:2048 lds
  v_mfma_f32_16x16x32_bf16 a[96:99], v[148:151], v[228:231], a[96:99]
  v_mfma_f32_16x16x32_bf16 a[100:103], v[156:159], v[228:231], a[100:103]
  v_mfma_f32_16x16x32_bf16 a[100:103], v[152:155], v[224:227], a[100:103]
  v_mfma_f32_16x16x32_bf16 a[104:107], v[144:147], v[232:235], a[104:107]
  v_mfma_f32_16x16x32_bf16 a[104:107], v[148:151], v[236:239], a[104:107]
  v_mfma_f32_16x16x32_bf16 a[108:111], v[156:159], v[236:239], a[108:111]
  s_add_u32 s26, s26, 31744
  v_mfma_f32_16x16x32_bf16 a[108:111], v[152:155], v[232:235], a[108:111]
  buffer_load_dwordx4 v16, s[4:7], s26 offen offset:3072 lds
  v_mfma_f32_16x16x32_bf16 a[112:115], v[144:147], v[240:243], a[112:115]
  v_mfma_f32_16x16x32_bf16 a[112:115], v[148:151], v[244:247], a[112:115]
  v_mfma_f32_16x16x32_bf16 a[116:119], v[156:159], v[244:247], a[116:119]
  v_accvgpr_read_b32 v20, a16
  v_accvgpr_read_b32 v21, a17
  v_mfma_f32_16x16x32_bf16 a[116:119], v[152:155], v[240:243], a[116:119]
  v_cvt_pk_bf16_f32 v24, v20, v21
  v_accvgpr_read_b32 v22, a18
  v_mfma_f32_16x16x32_bf16 a[120:123], v[144:147], v[248:251], a[120:123]
  v_accvgpr_read_b32 v23, a19
  v_cvt_pk_bf16_f32 v25, v22, v23
  v_mfma_f32_16x16x32_bf16 a[120:123], v[148:151], v[252:255], a[120:123]
  v_accvgpr_read_b32 v20, a20
  v_accvgpr_read_b32 v21, a21
  v_mfma_f32_16x16x32_bf16 a[124:127], v[156:159], v[252:255], a[124:127]
  v_cvt_pk_bf16_f32 v26, v20, v21
  v_accvgpr_read_b32 v22, a22
  v_mfma_f32_16x16x32_bf16 a[124:127], v[152:155], v[248:251], a[124:127]
  s_waitcnt vmcnt(26) lgkmcnt(0)
  s_barrier
  v_mfma_f32_16x16x32_bf16 a[128:131], v[160:163], v[192:195], a[128:131]
  s_add_u32 m0, s28, 131072
  v_accvgpr_read_b32 v23, a23
  v_cvt_pk_bf16_f32 v27, v22, v23
  v_mfma_f32_16x16x32_bf16 a[128:131], v[164:167], v[196:199], a[128:131]
  s_add_u32 s26, s29, s31
  v_mfma_f32_16x16x32_bf16 a[132:135], v[172:175], v[196:199], a[132:135]
  buffer_load_dwordx4 v15, s[4:7], s26 offen lds
  v_mfma_f32_16x16x32_bf16 a[132:135], v[168:171], v[192:195], a[132:135]
  buffer_store_dwordx4 v[24:27], v2, s[8:11], s33 offen offset:2048
  v_mfma_f32_16x16x32_bf16 a[136:139], v[160:163], v[200:203], a[136:139]
  v_mfma_f32_16x16x32_bf16 a[136:139], v[164:167], v[204:207], a[136:139]
  v_mfma_f32_16x16x32_bf16 a[140:143], v[172:175], v[204:207], a[140:143]
  v_mfma_f32_16x16x32_bf16 a[140:143], v[168:171], v[200:203], a[140:143]
  s_add_u32 s31, s31, 1048576
  v_mfma_f32_16x16x32_bf16 a[144:147], v[160:163], v[208:211], a[144:147]
  s_add_u32 s26, s26, 31744
  v_mfma_f32_16x16x32_bf16 a[144:147], v[164:167], v[212:215], a[144:147]
  buffer_load_dwordx4 v15, s[4:7], s26 offen offset:1024 lds
  v_mfma_f32_16x16x32_bf16 a[148:151], v[172:175], v[212:215], a[148:151]
  v_mfma_f32_16x16x32_bf16 a[148:151], v[168:171], v[208:211], a[148:151]
  v_mfma_f32_16x16x32_bf16 a[152:155], v[160:163], v[216:219], a[152:155]
  v_mfma_f32_16x16x32_bf16 a[152:155], v[164:167], v[220:223], a[152:155]
  v_mfma_f32_16x16x32_bf16 a[156:159], v[172:175], v[220:223], a[156:159]
  s_and_b32 s31, s31, 0x3fffff
  v_mfma_f32_16x16x32_bf16 a[156:159], v[168:171], v[216:219], a[156:159]
  s_add_u32 s26, s26, 31744
  v_mfma_f32_16x16x32_bf16 a[160:163], v[160:163], v[224:227], a[160:163]
  buffer_load_dwordx4 v16, s[4:7], s26 offen offset:2048 lds
  v_mfma_f32_16x16x32_bf16 a[160:163], v[164:167], v[228:231], a[160:163]
  v_mfma_f32_16x16x32_bf16 a[164:167], v[172:175], v[228:231], a[164:167]
  v_mfma_f32_16x16x32_bf16 a[164:167], v[168:171], v[224:227], a[164:167]
  v_mfma_f32_16x16x32_bf16 a[168:171], v[160:163], v[232:235], a[168:171]
  v_mfma_f32_16x16x32_bf16 a[168:171], v[164:167], v[236:239], a[168:171]
  v_mfma_f32_16x16x32_bf16 a[172:175], v[172:175], v[236:239], a[172:175]
  s_add_u32 s26, s26, 31744
  v_accvgpr_read_b32 v20, a24
  v_accvgpr_read_b32 v21, a25
  v_mfma_f32_16x16x32_bf16 a[172:175], v[168:171], v[232:235], a[172:175]
  buffer_load_dwordx4 v16, s[4:7], s26 offen offset:3072 lds
  v_mfma_f32_16x16x32_bf16 a[176:179], v[160:163], v[240:243], a[176:179]
  ds_read_b64_tr_b16 v[32:33], v7 offset:0
  v_cvt_pk_bf16_f32 v28, v20, v21
  v_mfma_f32_16x16x32_bf16 a[176:179], v[164:167], v[244:247], a[176:179]
  v_accvgpr_read_b32 v22, a26
  v_accvgpr_read_b32 v23, a27
  v_mfma_f32_16x16x32_bf16 a[180:183], v[172:175], v[244:247], a[180:183]
  ds_read_b64_tr_b16 v[34:35], v7 offset:1024
  v_cvt_pk_bf16_f32 v29, v22, v23
  v_mfma_f32_16x16x32_bf16 a[180:183], v[168:171], v[240:243], a[180:183]
  v_accvgpr_read_b32 v20, a28
  v_accvgpr_read_b32 v21, a29
  v_mfma_f32_16x16x32_bf16 a[184:187], v[160:163], v[248:251], a[184:187]
  s_add_u32 m0, s28, 135168
  ds_read_b64_tr_b16 v[36:37], v8 offset:0
  v_cvt_pk_bf16_f32 v30, v20, v21
  v_mfma_f32_16x16x32_bf16 a[184:187], v[164:167], v[252:255], a[184:187]
  s_add_u32 s26, s26, 35840
  v_accvgpr_read_b32 v22, a30
  v_accvgpr_read_b32 v23, a31
  v_mfma_f32_16x16x32_bf16 a[188:191], v[172:175], v[252:255], a[188:191]
  buffer_load_dwordx4 v15, s[4:7], s26 offen lds
  v_mfma_f32_16x16x32_bf16 a[188:191], v[168:171], v[248:251], a[188:191]
  ds_read_b64_tr_b16 v[38:39], v8 offset:1024
  v_cvt_pk_bf16_f32 v31, v22, v23
  v_mfma_f32_16x16x32_bf16 a[192:195], v[176:179], v[192:195], a[192:195]
  buffer_store_dwordx4 v[28:31], v2, s[8:11], s33 offen offset:3072
  v_mfma_f32_16x16x32_bf16 a[192:195], v[180:183], v[196:199], a[192:195]
  ds_read_b64_tr_b16 v[40:41], v9 offset:0
  v_mfma_f32_16x16x32_bf16 a[196:199], v[188:191], v[196:199], a[196:199]
  v_mfma_f32_16x16x32_bf16 a[196:199], v[184:187], v[192:195], a[196:199]
  ds_read_b64_tr_b16 v[42:43], v9 offset:1024
  v_mfma_f32_16x16x32_bf16 a[200:203], v[176:179], v[200:203], a[200:203]
  s_add_u32 s26, s26, 31744
  v_mfma_f32_16x16x32_bf16 a[200:203], v[180:183], v[204:207], a[200:203]
  buffer_load_dwordx4 v15, s[4:7], s26 offen offset:1024 lds
  v_mfma_f32_16x16x32_bf16 a[204:207], v[188:191], v[204:207], a[204:207]
  ds_read_b64_tr_b16 v[44:45], v10 offset:0
  v_mfma_f32_16x16x32_bf16 a[204:207], v[184:187], v[200:203], a[204:207]
  v_mfma_f32_16x16x32_bf16 a[208:211], v[176:179], v[208:211], a[208:211]
  ds_read_b64_tr_b16 v[46:47], v10 offset:1024
  v_mfma_f32_16x16x32_bf16 a[208:211], v[180:183], v[212:215], a[208:211]
  v_mfma_f32_16x16x32_bf16 a[212:215], v[188:191], v[212:215], a[212:215]
  ds_read_b64_tr_b16 v[48:49], v11 offset:0
  v_mfma_f32_16x16x32_bf16 a[212:215], v[184:187], v[208:211], a[212:215]
  s_add_u32 s26, s26, 31744
  v_mfma_f32_16x16x32_bf16 a[216:219], v[176:179], v[216:219], a[216:219]
  buffer_load_dwordx4 v16, s[4:7], s26 offen offset:2048 lds
  v_mfma_f32_16x16x32_bf16 a[216:219], v[180:183], v[220:223], a[216:219]
  ds_read_b64_tr_b16 v[50:51], v11 offset:1024
  v_mfma_f32_16x16x32_bf16 a[220:223], v[188:191], v[220:223], a[220:223]
  v_mfma_f32_16x16x32_bf16 a[220:223], v[184:187], v[216:219], a[220:223]
  ds_read_b64_tr_b16 v[52:53], v12 offset:0
  v_mfma_f32_16x16x32_bf16 a[224:227], v[176:179], v[224:227], a[224:227]
  v_mfma_f32_16x16x32_bf16 a[224:227], v[180:183], v[228:231], a[224:227]
  ds_read_b64_tr_b16 v[54:55], v12 offset:1024
  v_mfma_f32_16x16x32_bf16 a[228:231], v[188:191], v[228:231], a[228:231]
  s_add_u32 s26, s26, 31744
  v_mfma_f32_16x16x32_bf16 a[228:231], v[184:187], v[224:227], a[228:231]
  buffer_load_dwordx4 v16, s[4:7], s26 offen offset:3072 lds
  v_mfma_f32_16x16x32_bf16 a[232:235], v[176:179], v[232:235], a[232:235]
  ds_read_b64_tr_b16 v[56:57], v13 offset:0
  v_mfma_f32_16x16x32_bf16 a[232:235], v[180:183], v[236:239], a[232:235]
  v_mfma_f32_16x16x32_bf16 a[236:239], v[188:191], v[236:239], a[236:239]
  ds_read_b64_tr_b16 v[58:59], v13 offset:1024
  v_mfma_f32_16x16x32_bf16 a[236:239], v[184:187], v[232:235], a[236:239]
  v_mfma_f32_16x16x32_bf16 a[240:243], v[176:179], v[240:243], a[240:243]
  v_mfma_f32_16x16x32_bf16 a[240:243], v[180:183], v[244:247], a[240:243]
  v_mfma_f32_16x16x32_bf16 a[244:247], v[188:191], v[244:247], a[244:247]
  v_mfma_f32_16x16x32_bf16 a[244:247], v[184:187], v[240:243], a[244:247]
  v_mfma_f32_16x16x32_bf16 a[248:251], v[176:179], v[248:251], a[248:251]
  v_mfma_f32_16x16x32_bf16 a[248:251], v[180:183], v[252:255], a[248:251]
  v_mfma_f32_16x16x32_bf16 a[252:255], v[188:191], v[252:255], a[252:255]
  v_mfma_f32_16x16x32_bf16 a[252:255], v[184:187], v[248:251], a[252:255]
  s_waitcnt vmcnt(48) lgkmcnt(6)
L_q:
  v_mfma_f32_16x16x32_bf16 v[128:131], v[32:35], v[64:67], 0
  ds_read_b64_tr_b16 v[60:61], v14 offset:0
  v_accvgpr_read_b32 v20, a32
  v_mfma_f32_16x16x32_bf16 v[160:163], v[32:35], v[68:71], 0
  ds_read_b64_tr_b16 v[62:63], v14 offset:1024
  v_add_u32 v17, 4096, v17
  v_mfma_f32_16x16x32_bf16 v[192:195], v[32:35], v[72:75], 0
  v_accvgpr_read_b32 v21, a33
  v_cvt_pk_bf16_f32 v24, v20, v21
  v_mfma_f32_16x16x32_bf16 v[224:227], v[32:35], v[76:79], 0
  s_add_u32 s33, s33, 4096
  v_accvgpr_read_b32 v22, a34
  v_accvgpr_read_b32 v23, a35
  v_mfma_f32_16x16x32_bf16 v[228:231], v[36:39], v[76:79], 0
  s_lshl_b32 s26, s21, 7
  ds_read_b64_tr_b16 v[32:33], v7 offset:8192
  v_and_b32 v17, 0x3fff, v17
  v_mfma_f32_16x16x32_bf16 v[196:199], v[36:39], v[72:75], 0
  s_add_u32 s26, s26, 73400320
  ds_read_b64_tr_b16 v[34:35], v7 offset:9216
  v_cvt_pk_bf16_f32 v25, v22, v23
  v_mfma_f32_16x16x32_bf16 v[164:167], v[36:39], v[68:71], 0
  v_accvgpr_read_b32 v20, a36
  v_accvgpr_read_b32 v21, a37
  v_mfma_f32_16x16x32_bf16 v[132:135], v[36:39], v[64:67], 0
  buffer_load_dwordx4 a[0:3], v17, s[8:11], s36 offen sc1
  v_mfma_f32_16x16x32_bf16 v[136:139], v[40:43], v[64:67], 0
  s_mov_b32 s12, s66
  ds_read_b64_tr_b16 v[36:37], v8 offset:8192
  v_cvt_pk_bf16_f32 v26, v20, v21
  v_mfma_f32_16x16x32_bf16 v[168:171], v[40:43], v[68:71], 0
  s_mov_b32 s13, s67
  ds_read_b64_tr_b16 v[38:39], v8 offset:9216
  v_accvgpr_read_b32 v22, a38
  v_mfma_f32_16x16x32_bf16 v[200:203], v[40:43], v[72:75], 0
  v_accvgpr_read_b32 v23, a39
  v_cvt_pk_bf16_f32 v27, v22, v23
  v_mfma_f32_16x16x32_bf16 v[232:235], v[40:43], v[76:79], 0
  buffer_store_dwordx4 v[24:27], v2, s[8:11], s33 offen
  v_mfma_f32_16x16x32_bf16 v[236:239], v[44:47], v[76:79], 0
  s_mov_b32 s14, 0x2000000
  ds_read_b64_tr_b16 v[40:41], v9 offset:8192
  v_mfma_f32_16x16x32_bf16 v[204:207], v[44:47], v[72:75], 0
  s_lshl_b32 s30, s20, 13
  ds_read_b64_tr_b16 v[42:43], v9 offset:9216
  v_accvgpr_read_b32 v20, a40
  v_mfma_f32_16x16x32_bf16 v[172:175], v[44:47], v[68:71], 0
  s_waitcnt lgkmcnt(6)
  v_accvgpr_read_b32 v21, a41
  v_cvt_pk_bf16_f32 v28, v20, v21
  v_mfma_f32_16x16x32_bf16 v[140:143], v[44:47], v[64:67], 0
  buffer_load_dwordx4 a[4:7], v17, s[8:11], s37 offen sc1
  v_mfma_f32_16x16x32_bf16 v[144:147], v[48:51], v[64:67], 0
  s_lshl_b32 s29, s21, 20
  ds_read_b64_tr_b16 v[44:45], v10 offset:8192
  v_accvgpr_read_b32 v22, a42
  v_mfma_f32_16x16x32_bf16 v[176:179], v[48:51], v[68:71], 0
  s_add_u32 s29, s29, s30
  ds_read_b64_tr_b16 v[46:47], v10 offset:9216
  v_accvgpr_read_b32 v23, a43
  v_mfma_f32_16x16x32_bf16 v[208:211], v[48:51], v[72:75], 0
  v_cvt_pk_bf16_f32 v29, v22, v23
  v_accvgpr_read_b32 v20, a44
  v_mfma_f32_16x16x32_bf16 v[240:243], v[48:51], v[76:79], 0
  v_accvgpr_read_b32 v21, a45
  v_cvt_pk_bf16_f32 v30, v20, v21
  v_mfma_f32_16x16x32_bf16 v[244:247], v[52:55], v[76:79], 0
  s_movk_i32 s48, 4096
  ds_read_b64_tr_b16 v[48:49], v11 offset:8192
  v_accvgpr_read_b32 v22, a46
  v_mfma_f32_16x16x32_bf16 v[212:215], v[52:55], v[72:75], 0
  s_movk_i32 s49, 28672
  ds_read_b64_tr_b16 v[50:51], v11 offset:9216
  v_accvgpr_read_b32 v23, a47
  v_mfma_f32_16x16x32_bf16 v[180:183], v[52:55], v[68:71], 0
  v_cvt_pk_bf16_f32 v31, v22, v23
  v_mfma_f32_16x16x32_bf16 v[148:151], v[52:55], v[64:67], 0
  buffer_load_dwordx4 a[8:11], v17, s[8:11], s38 offen sc1
  v_mfma_f32_16x16x32_bf16 v[152:155], v[56:59], v[64:67], 0
  s_lshl_b32 s44, s22, 2
  ds_read_b64_tr_b16 v[52:53], v12 offset:8192
  v_mfma_f32_16x16x32_bf16 v[184:187], v[56:59], v[68:71], 0
  s_add_u32 s44, s44, s20
  ds_read_b64_tr_b16 v[54:55], v12 offset:9216
  v_mfma_f32_16x16x32_bf16 v[216:219], v[56:59], v[72:75], 0
  buffer_store_dwordx4 v[28:31], v2, s[8:11], s33 offen offset:1024
  v_mfma_f32_16x16x32_bf16 v[248:251], v[56:59], v[76:79], 0
  v_accvgpr_read_b32 v20, a48
  v_accvgpr_read_b32 v21, a49
  v_mfma_f32_16x16x32_bf16 v[252:255], v[60:63], v[76:79], 0
  s_sub_u32 s45, 63, s44
  ds_read_b64_tr_b16 v[56:57], v13 offset:8192
  v_cvt_pk_bf16_f32 v24, v20, v21
  v_mfma_f32_16x16x32_bf16 v[220:223], v[60:63], v[72:75], 0
  s_lshl_b32 s28, s44, 2
  ds_read_b64_tr_b16 v[58:59], v13 offset:9216
  v_accvgpr_read_b32 v22, a50
  v_mfma_f32_16x16x32_bf16 v[188:191], v[60:63], v[68:71], 0
  s_waitcnt vmcnt(49) lgkmcnt(6)
  v_accvgpr_read_b32 v23, a51
  v_cvt_pk_bf16_f32 v25, v22, v23
  v_mfma_f32_16x16x32_bf16 v[156:159], v[60:63], v[64:67], 0
  buffer_load_dwordx4 a[12:15], v17, s[8:11], s39 offen sc1
  v_mfma_f32_16x16x32_bf16 v[128:131], v[32:35], v[80:83], v[128:131]
  s_add_u32 s28, s28, s26
  ds_read_b64_tr_b16 v[60:61], v14 offset:8192
  v_accvgpr_read_b32 v20, a52
  v_mfma_f32_16x16x32_bf16 v[160:163], v[32:35], v[84:87], v[160:163]
  s_lshr_b32 s42, s44, 1
  ds_read_b64_tr_b16 v[62:63], v14 offset:9216
  v_accvgpr_read_b32 v21, a53
  v_mfma_f32_16x16x32_bf16 v[192:195], v[32:35], v[88:91], v[192:195]
  v_cvt_pk_bf16_f32 v26, v20, v21
  v_accvgpr_read_b32 v22, a54
  v_mfma_f32_16x16x32_bf16 v[224:227], v[32:35], v[92:95], v[224:227]
  v_accvgpr_read_b32 v23, a55
  v_cvt_pk_bf16_f32 v27, v22, v23
  v_mfma_f32_16x16x32_bf16 v[228:231], v[36:39], v[92:95], v[228:231]
  s_lshr_b32 s43, s45, 1
  ds_read_b64_tr_b16 v[32:33], v7 offset:16384
  v_mfma_f32_16x16x32_bf16 v[196:199], v[36:39], v[88:91], v[196:199]
  s_lshl_b32 s23, s22, 1
  ds_read_b64_tr_b16 v[34:35], v7 offset:17408
  v_mfma_f32_16x16x32_bf16 v[164:167], v[36:39], v[84:87], v[164:167]
  buffer_store_dwordx4 v[24:27], v2, s[8:11], s33 offen offset:2048
  v_mfma_f32_16x16x32_bf16 v[132:135], v[36:39], v[80:83], v[132:135]
  buffer_load_dwordx4 a[16:19], v17, s[8:11], s36 offen offset:1024 sc1
  v_mfma_f32_16x16x32_bf16 v[136:139], v[40:43], v[80:83], v[136:139]
  s_sub_u32 s27, 28, s23
  ds_read_b64_tr_b16 v[36:37], v8 offset:16384
  v_accvgpr_read_b32 v20, a56
  v_mfma_f32_16x16x32_bf16 v[168:171], v[40:43], v[84:87], v[168:171]
  s_mov_b64 s[46:47], 0
  ds_read_b64_tr_b16 v[38:39], v8 offset:17408
  v_accvgpr_read_b32 v21, a57
  v_mfma_f32_16x16x32_bf16 v[200:203], v[40:43], v[88:91], v[200:203]
  v_cvt_pk_bf16_f32 v28, v20, v21
  v_accvgpr_read_b32 v22, a58
  v_mfma_f32_16x16x32_bf16 v[232:235], v[40:43], v[92:95], v[232:235]
  v_accvgpr_read_b32 v23, a59
  v_cvt_pk_bf16_f32 v29, v22, v23
  v_mfma_f32_16x16x32_bf16 v[236:239], v[44:47], v[92:95], v[236:239]
  s_bitset1_b64 s[46:47], s42
  ds_read_b64_tr_b16 v[40:41], v9 offset:16384
  v_accvgpr_read_b32 v20, a60
  v_mfma_f32_16x16x32_bf16 v[204:207], v[44:47], v[88:91], v[204:207]
  s_bitset1_b64 s[46:47], s43
  ds_read_b64_tr_b16 v[42:43], v9 offset:17408
  v_accvgpr_read_b32 v21, a61
  v_mfma_f32_16x16x32_bf16 v[172:175], v[44:47], v[84:87], v[172:175]
  s_waitcnt lgkmcnt(6)
  v_cvt_pk_bf16_f32 v30, v20, v21
  v_accvgpr_read_b32 v22, a62
  v_mfma_f32_16x16x32_bf16 v[140:143], v[44:47], v[80:83], v[140:143]
  buffer_load_dwordx4 a[20:23], v17, s[8:11], s37 offen offset:1024 sc1
  v_mfma_f32_16x16x32_bf16 v[144:147], v[48:51], v[80:83], v[144:147]
  s_bitset1_b64 s[46:47], s27
  ds_read_b64_tr_b16 v[44:45], v10 offset:16384
  v_accvgpr_read_b32 v23, a63
  v_mfma_f32_16x16x32_bf16 v[176:179], v[48:51], v[84:87], v[176:179]
  s_add_u32 s42, s42, 1
  ds_read_b64_tr_b16 v[46:47], v10 offset:17408
  v_cvt_pk_bf16_f32 v31, v22, v23
  v_mfma_f32_16x16x32_bf16 v[208:211], v[48:51], v[88:91], v[208:211]
  buffer_store_dwordx4 v[28:31], v2, s[8:11], s33 offen offset:3072
  v_mfma_f32_16x16x32_bf16 v[240:243], v[48:51], v[92:95], v[240:243]
  v_mfma_f32_16x16x32_bf16 v[244:247], v[52:55], v[92:95], v[244:247]
  s_add_u32 s43, s43, 1
  ds_read_b64_tr_b16 v[48:49], v11 offset:16384
  v_mfma_f32_16x16x32_bf16 v[212:215], v[52:55], v[88:91], v[212:215]
  s_bitset1_b64 s[46:47], s42
  ds_read_b64_tr_b16 v[50:51], v11 offset:17408
  v_mfma_f32_16x16x32_bf16 v[180:183], v[52:55], v[84:87], v[180:183]
  v_accvgpr_read_b32 v20, a64
  v_accvgpr_read_b32 v21, a65
  v_mfma_f32_16x16x32_bf16 v[148:151], v[52:55], v[80:83], v[148:151]
  buffer_load_dwordx4 a[24:27], v17, s[8:11], s38 offen offset:1024 sc1
  v_mfma_f32_16x16x32_bf16 v[152:155], v[56:59], v[80:83], v[152:155]
  s_bitset1_b64 s[46:47], s43
  ds_read_b64_tr_b16 v[52:53], v12 offset:16384
  v_cvt_pk_bf16_f32 v24, v20, v21
  v_mfma_f32_16x16x32_bf16 v[184:187], v[56:59], v[84:87], v[184:187]
  s_mov_b32 s31, 0
  ds_read_b64_tr_b16 v[54:55], v12 offset:17408
  s_add_u32 s33, s33, 258048
  v_mfma_f32_16x16x32_bf16 v[216:219], v[56:59], v[88:91], v[216:219]
  v_accvgpr_read_b32 v22, a66
  v_accvgpr_read_b32 v23, a67
  v_mfma_f32_16x16x32_bf16 v[248:251], v[56:59], v[92:95], v[248:251]
  v_cvt_pk_bf16_f32 v25, v22, v23
  v_accvgpr_read_b32 v20, a68
  v_mfma_f32_16x16x32_bf16 v[252:255], v[60:63], v[92:95], v[252:255]
  s_mov_b32 s32, 0
  ds_read_b64_tr_b16 v[56:57], v13 offset:16384
  v_accvgpr_read_b32 v21, a69
  v_mfma_f32_16x16x32_bf16 v[220:223], v[60:63], v[88:91], v[220:223]
  s_bfe_u32 s23, s2, 0x10003
  ds_read_b64_tr_b16 v[58:59], v13 offset:17408
  v_cvt_pk_bf16_f32 v26, v20, v21
  v_mfma_f32_16x16x32_bf16 v[188:191], v[60:63], v[84:87], v[188:191]
  s_waitcnt vmcnt(35) lgkmcnt(6)
  v_accvgpr_read_b32 v22, a70
  v_accvgpr_read_b32 v23, a71
  v_mfma_f32_16x16x32_bf16 v[156:159], v[60:63], v[80:83], v[156:159]
  buffer_load_dwordx4 a[28:31], v17, s[8:11], s39 offen offset:1024 sc1
  v_mfma_f32_16x16x32_bf16 v[128:131], v[32:35], v[96:99], v[128:131]
  s_lshl_b32 s23, s23, 1
  ds_read_b64_tr_b16 v[60:61], v14 offset:16384
  v_cvt_pk_bf16_f32 v27, v22, v23
  v_mfma_f32_16x16x32_bf16 v[160:163], v[32:35], v[100:103], v[160:163]
  s_lshr_b32 s24, s22, 2
  ds_read_b64_tr_b16 v[62:63], v14 offset:17408
  v_mfma_f32_16x16x32_bf16 v[192:195], v[32:35], v[104:107], v[192:195]
  buffer_store_dwordx4 v[24:27], v2, s[8:11], s33 offen
  v_mfma_f32_16x16x32_bf16 v[224:227], v[32:35], v[108:111], v[224:227]
  v_accvgpr_read_b32 v20, a72
  v_accvgpr_read_b32 v21, a73
  v_mfma_f32_16x16x32_bf16 v[228:231], v[36:39], v[108:111], v[228:231]
  s_add_u32 s23, s23, s24
  ds_read_b64_tr_b16 v[32:33], v7 offset:24576
  v_cvt_pk_bf16_f32 v28, v20, v21
  v_mfma_f32_16x16x32_bf16 v[196:199], v[36:39], v[104:107], v[196:199]
  s_lshl_b32 s35, s23, 20
  ds_read_b64_tr_b16 v[34:35], v7 offset:25600
  v_accvgpr_read_b32 v22, a74
  v_mfma_f32_16x16x32_bf16 v[164:167], v[36:39], v[100:103], v[164:167]
  v_accvgpr_read_b32 v23, a75
  v_cvt_pk_bf16_f32 v29, v22, v23
  v_mfma_f32_16x16x32_bf16 v[132:135], v[36:39], v[96:99], v[132:135]
  buffer_load_dwordx4 a[32:35], v17, s[8:11], s36 offen offset:2048 sc1
  v_mfma_f32_16x16x32_bf16 v[136:139], v[40:43], v[96:99], v[136:139]
  s_lshl_b32 s23, s20, 15
  ds_read_b64_tr_b16 v[36:37], v8 offset:24576
  v_accvgpr_read_b32 v20, a76
  v_mfma_f32_16x16x32_bf16 v[168:171], v[40:43], v[100:103], v[168:171]
  s_add_u32 s35, s35, s23
  ds_read_b64_tr_b16 v[38:39], v8 offset:25600
  v_accvgpr_read_b32 v21, a77
  v_mfma_f32_16x16x32_bf16 v[200:203], v[40:43], v[104:107], v[200:203]
  v_cvt_pk_bf16_f32 v30, v20, v21
  v_accvgpr_read_b32 v22, a78
  v_mfma_f32_16x16x32_bf16 v[232:235], v[40:43], v[108:111], v[232:235]
  v_accvgpr_read_b32 v23, a79
  v_cvt_pk_bf16_f32 v31, v22, v23
  v_mfma_f32_16x16x32_bf16 v[236:239], v[44:47], v[108:111], v[236:239]
  s_and_b32 s23, s22, 3
  ds_read_b64_tr_b16 v[40:41], v9 offset:24576
  v_mfma_f32_16x16x32_bf16 v[204:207], v[44:47], v[104:107], v[204:207]
  s_lshl_b32 s23, s23, 8
  ds_read_b64_tr_b16 v[42:43], v9 offset:25600
  v_mfma_f32_16x16x32_bf16 v[172:175], v[44:47], v[100:103], v[172:175]
  s_waitcnt lgkmcnt(6)
  buffer_store_dwordx4 v[28:31], v2, s[8:11], s33 offen offset:1024
  v_mfma_f32_16x16x32_bf16 v[140:143], v[44:47], v[96:99], v[140:143]
  buffer_load_dwordx4 a[36:39], v17, s[8:11], s37 offen offset:2048 sc1
  v_mfma_f32_16x16x32_bf16 v[144:147], v[48:51], v[96:99], v[144:147]
  s_add_u32 s35, s35, s23
  ds_read_b64_tr_b16 v[44:45], v10 offset:24576
  v_mfma_f32_16x16x32_bf16 v[176:179], v[48:51], v[100:103], v[176:179]
  ds_read_b64_tr_b16 v[46:47], v10 offset:25600
  v_accvgpr_read_b32 v20, a80
  v_mfma_f32_16x16x32_bf16 v[208:211], v[48:51], v[104:107], v[208:211]
  v_accvgpr_read_b32 v21, a81
  v_cvt_pk_bf16_f32 v24, v20, v21
  v_mfma_f32_16x16x32_bf16 v[240:243], v[48:51], v[108:111], v[240:243]
  v_accvgpr_read_b32 v22, a82
  v_accvgpr_read_b32 v23, a83
  v_mfma_f32_16x16x32_bf16 v[244:247], v[52:55], v[108:111], v[244:247]
  ds_read_b64_tr_b16 v[48:49], v11 offset:24576
  v_cvt_pk_bf16_f32 v25, v22, v23
  v_mfma_f32_16x16x32_bf16 v[212:215], v[52:55], v[104:107], v[212:215]
  ds_read_b64_tr_b16 v[50:51], v11 offset:25600
  v_accvgpr_read_b32 v20, a84
  v_mfma_f32_16x16x32_bf16 v[180:183], v[52:55], v[100:103], v[180:183]
  v_accvgpr_read_b32 v21, a85
  v_cvt_pk_bf16_f32 v26, v20, v21
  v_mfma_f32_16x16x32_bf16 v[148:151], v[52:55], v[96:99], v[148:151]
  buffer_load_dwordx4 a[40:43], v17, s[8:11], s38 offen offset:2048 sc1
  v_mfma_f32_16x16x32_bf16 v[152:155], v[56:59], v[96:99], v[152:155]
  ds_read_b64_tr_b16 v[52:53], v12 offset:24576
  v_accvgpr_read_b32 v22, a86
  v_mfma_f32_16x16x32_bf16 v[184:187], v[56:59], v[100:103], v[184:187]
  ds_read_b64_tr_b16 v[54:55], v12 offset:25600
  v_accvgpr_read_b32 v23, a87
  v_mfma_f32_16x16x32_bf16 v[216:219], v[56:59], v[104:107], v[216:219]
  v_cvt_pk_bf16_f32 v27, v22, v23
  v_mfma_f32_16x16x32_bf16 v[248:251], v[56:59], v[108:111], v[248:251]
  buffer_store_dwordx4 v[24:27], v2, s[8:11], s33 offen offset:2048
  v_mfma_f32_16x16x32_bf16 v[252:255], v[60:63], v[108:111], v[252:255]
  ds_read_b64_tr_b16 v[56:57], v13 offset:24576
  v_mfma_f32_16x16x32_bf16 v[220:223], v[60:63], v[104:107], v[220:223]
  ds_read_b64_tr_b16 v[58:59], v13 offset:25600
  v_mfma_f32_16x16x32_bf16 v[188:191], v[60:63], v[100:103], v[188:191]
  s_waitcnt vmcnt(36) lgkmcnt(6)
  v_accvgpr_read_b32 v20, a88
  v_accvgpr_read_b32 v21, a89
  v_mfma_f32_16x16x32_bf16 v[156:159], v[60:63], v[96:99], v[156:159]
  buffer_load_dwordx4 a[44:47], v17, s[8:11], s39 offen offset:2048 sc1
  v_mfma_f32_16x16x32_bf16 v[128:131], v[32:35], v[112:115], v[128:131]
  ds_read_b64_tr_b16 v[60:61], v14 offset:24576
  v_cvt_pk_bf16_f32 v28, v20, v21
  v_mfma_f32_16x16x32_bf16 v[160:163], v[32:35], v[116:119], v[160:163]
  ds_read_b64_tr_b16 v[62:63], v14 offset:25600
  v_accvgpr_read_b32 v22, a90
  v_mfma_f32_16x16x32_bf16 v[192:195], v[32:35], v[120:123], v[192:195]
  s_waitcnt vmcnt(47)
  s_barrier
  v_mfma_f32_16x16x32_bf16 v[224:227], v[32:35], v[124:127], v[224:227]
  v_accvgpr_read_b32 v23, a91
  v_cvt_pk_bf16_f32 v29, v22, v23
  v_mfma_f32_16x16x32_bf16 v[228:231], v[36:39], v[124:127], v[228:231]
  ds_read_b64_tr_b16 v[32:33], v7 offset:32768
  v_accvgpr_read_b32 v20, a92
  v_mfma_f32_16x16x32_bf16 v[196:199], v[36:39], v[120:123], v[196:199]
  ds_read_b64_tr_b16 v[34:35], v7 offset:33792
  v_accvgpr_read_b32 v21, a93
  v_mfma_f32_16x16x32_bf16 v[164:167], v[36:39], v[116:119], v[164:167]
  v_cvt_pk_bf16_f32 v30, v20, v21
  v_accvgpr_read_b32 v22, a94
  v_mfma_f32_16x16x32_bf16 v[132:135], v[36:39], v[112:115], v[132:135]
  buffer_load_dwordx4 a[48:51], v17, s[8:11], s36 offen offset:3072 sc1
  v_mfma_f32_16x16x32_bf16 v[136:139], v[40:43], v[112:115], v[136:139]
  ds_read_b64_tr_b16 v[36:37], v8 offset:32768
  v_accvgpr_read_b32 v23, a95
  v_mfma_f32_16x16x32_bf16 v[168:171], v[40:43], v[116:119], v[168:171]
  ds_read_b64_tr_b16 v[38:39], v8 offset:33792
  v_cvt_pk_bf16_f32 v31, v22, v23
  v_mfma_f32_16x16x32_bf16 v[200:203], v[40:43], v[120:123], v[200:203]
  buffer_store_dwordx4 v[28:31], v2, s[8:11], s33 offen offset:3072
  v_mfma_f32_16x16x32_bf16 v[232:235], v[40:43], v[124:127], v[232:235]
  v_mfma_f32_16x16x32_bf16 v[236:239], v[44:47], v[124:127], v[236:239]
  ds_read_b64_tr_b16 v[40:41], v9 offset:32768
  v_accvgpr_read_b32 v20, a96
  v_mfma_f32_16x16x32_bf16 v[204:207], v[44:47], v[120:123], v[204:207]
  ds_read_b64_tr_b16 v[42:43], v9 offset:33792
  v_accvgpr_read_b32 v21, a97
  v_mfma_f32_16x16x32_bf16 v[172:175], v[44:47], v[116:119], v[172:175]
  s_waitcnt lgkmcnt(6)
  v_cvt_pk_bf16_f32 v24, v20, v21
  s_add_u32 s33, s33, 4096
  v_mfma_f32_16x16x32_bf16 v[140:143], v[44:47], v[112:115], v[140:143]
  buffer_load_dwordx4 a[52:55], v17, s[8:11], s37 offen offset:3072 sc1
  v_mfma_f32_16x16x32_bf16 v[144:147], v[48:51], v[112:115], v[144:147]
  ds_read_b64_tr_b16 v[44:45], v10 offset:32768
  v_accvgpr_read_b32 v22, a98
  v_mfma_f32_16x16x32_bf16 v[176:179], v[48:51], v[116:119], v[176:179]
  ds_read_b64_tr_b16 v[46:47], v10 offset:33792
  v_accvgpr_read_b32 v23, a99
  v_mfma_f32_16x16x32_bf16 v[208:211], v[48:51], v[120:123], v[208:211]
  v_cvt_pk_bf16_f32 v25, v22, v23
  v_accvgpr_read_b32 v20, a100
  v_mfma_f32_16x16x32_bf16 v[240:243], v[48:51], v[124:127], v[240:243]
  v_accvgpr_read_b32 v21, a101
  v_cvt_pk_bf16_f32 v26, v20, v21
  v_mfma_f32_16x16x32_bf16 v[244:247], v[52:55], v[124:127], v[244:247]
  ds_read_b64_tr_b16 v[48:49], v11 offset:32768
  v_accvgpr_read_b32 v22, a102
  v_mfma_f32_16x16x32_bf16 v[212:215], v[52:55], v[120:123], v[212:215]
  ds_read_b64_tr_b16 v[50:51], v11 offset:33792
  v_accvgpr_read_b32 v23, a103
  v_mfma_f32_16x16x32_bf16 v[180:183], v[52:55], v[116:119], v[180:183]
  v_cvt_pk_bf16_f32 v27, v22, v23
  v_mfma_f32_16x16x32_bf16 v[148:151], v[52:55], v[112:115], v[148:151]
  buffer_load_dwordx4 a[56:59], v17, s[8:11], s38 offen offset:3072 sc1
  v_mfma_f32_16x16x32_bf16 v[152:155], v[56:59], v[112:115], v[152:155]
  ds_read_b64_tr_b16 v[52:53], v12 offset:32768
  v_mfma_f32_16x16x32_bf16 v[184:187], v[56:59], v[116:119], v[184:187]
  ds_read_b64_tr_b16 v[54:55], v12 offset:33792
  v_mfma_f32_16x16x32_bf16 v[216:219], v[56:59], v[120:123], v[216:219]
  buffer_store_dwordx4 v[24:27], v2, s[8:11], s33 offen
  v_mfma_f32_16x16x32_bf16 v[248:251], v[56:59], v[124:127], v[248:251]
  v_accvgpr_read_b32 v20, a104
  v_accvgpr_read_b32 v21, a105
  v_mfma_f32_16x16x32_bf16 v[252:255], v[60:63], v[124:127], v[252:255]
  ds_read_b64_tr_b16 v[56:57], v13 offset:32768
  v_cvt_pk_bf16_f32 v28, v20, v21
  v_mfma_f32_16x16x32_bf16 v[220:223], v[60:63], v[120:123], v[220:223]
  ds_read_b64_tr_b16 v[58:59], v13 offset:33792
  v_accvgpr_read_b32 v22, a106
  v_mfma_f32_16x16x32_bf16 v[188:191], v[60:63], v[116:119], v[188:191]
  s_waitcnt vmcnt(18) lgkmcnt(6)
  v_accvgpr_read_b32 v23, a107
  v_cvt_pk_bf16_f32 v29, v22, v23
  v_mfma_f32_16x16x32_bf16 v[156:159], v[60:63], v[112:115], v[156:159]
  buffer_load_dwordx4 a[60:63], v17, s[8:11], s39 offen offset:3072 sc1
  v_mfma_f32_16x16x32_bf16 v[128:131], v[32:35], a[0:3], v[128:131]
  ds_read_b64_tr_b16 v[60:61], v14 offset:32768
  v_accvgpr_read_b32 v20, a108
  v_mfma_f32_16x16x32_bf16 v[160:163], v[32:35], a[4:7], v[160:163]
  ds_read_b64_tr_b16 v[62:63], v14 offset:33792
  v_add_u32 v17, 4096, v17
  v_mfma_f32_16x16x32_bf16 v[192:195], v[32:35], a[8:11], v[192:195]
  v_accvgpr_read_b32 v21, a109
  v_cvt_pk_bf16_f32 v30, v20, v21
  v_mfma_f32_16x16x32_bf16 v[224:227], v[32:35], a[12:15], v[224:227]
  v_accvgpr_read_b32 v22, a110
  v_accvgpr_read_b32 v23, a111
  v_mfma_f32_16x16x32_bf16 v[228:231], v[36:39], a[12:15], v[228:231]
  ds_read_b64_tr_b16 v[32:33], v7 offset:40960
  v_and_b32 v17, 0x3fff, v17
  v_mfma_f32_16x16x32_bf16 v[196:199], v[36:39], a[8:11], v[196:199]
  ds_read_b64_tr_b16 v[34:35], v7 offset:41984
  v_cvt_pk_bf16_f32 v31, v22, v23
  v_mfma_f32_16x16x32_bf16 v[164:167], v[36:39], a[4:7], v[164:167]
  buffer_store_dwordx4 v[28:31], v2, s[8:11], s33 offen offset:1024
  v_mfma_f32_16x16x32_bf16 v[132:135], v[36:39], a[0:3], v[132:135]
  buffer_load_dwordx4 a[64:67], v17, s[8:11], s36 offen sc1
  v_mfma_f32_16x16x32_bf16 v[136:139], v[40:43], a[0:3], v[136:139]
  ds_read_b64_tr_b16 v[36:37], v8 offset:40960
  v_accvgpr_read_b32 v20, a112
  v_mfma_f32_16x16x32_bf16 v[168:171], v[40:43], a[4:7], v[168:171]
  ds_read_b64_tr_b16 v[38:39], v8 offset:41984
  v_accvgpr_read_b32 v21, a113
  v_mfma_f32_16x16x32_bf16 v[200:203], v[40:43], a[8:11], v[200:203]
  v_cvt_pk_bf16_f32 v24, v20, v21
  v_accvgpr_read_b32 v22, a114
  v_mfma_f32_16x16x32_bf16 v[232:235], v[40:43], a[12:15], v[232:235]
  v_accvgpr_read_b32 v23, a115
  v_cvt_pk_bf16_f32 v25, v22, v23
  v_mfma_f32_16x16x32_bf16 v[236:239], v[44:47], a[12:15], v[236:239]
  ds_read_b64_tr_b16 v[40:41], v9 offset:40960
  v_accvgpr_read_b32 v20, a116
  v_mfma_f32_16x16x32_bf16 v[204:207], v[44:47], a[8:11], v[204:207]
  ds_read_b64_tr_b16 v[42:43], v9 offset:41984
  v_accvgpr_read_b32 v21, a117
  v_mfma_f32_16x16x32_bf16 v[172:175], v[44:47], a[4:7], v[172:175]
  s_waitcnt lgkmcnt(6)
  v_cvt_pk_bf16_f32 v26, v20, v21
  v_accvgpr_read_b32 v22, a118
  v_mfma_f32_16x16x32_bf16 v[140:143], v[44:47], a[0:3], v[140:143]
  buffer_load_dwordx4 a[68:71], v17, s[8:11], s37 offen sc1
  v_mfma_f32_16x16x32_bf16 v[144:147], v[48:51], a[0:3], v[144:147]
  ds_read_b64_tr_b16 v[44:45], v10 offset:40960
  v_accvgpr_read_b32 v23, a119
  v_mfma_f32_16x16x32_bf16 v[176:179], v[48:51], a[4:7], v[176:179]
  ds_read_b64_tr_b16 v[46:47], v10 offset:41984
  v_cvt_pk_bf16_f32 v27, v22, v23
  v_mfma_f32_16x16x32_bf16 v[208:211], v[48:51], a[8:11], v[208:211]
  buffer_store_dwordx4 v[24:27], v2, s[8:11], s33 offen offset:2048
  v_mfma_f32_16x16x32_bf16 v[240:243], v[48:51], a[12:15], v[240:243]
  s_waitcnt vmcnt(19)
  v_mov_b32 v19, 1
  s_cmp_eq_u32 s3, 0
  s_cbranch_scc1 L_xsig_13
  s_mov_b64 exec, 1
  buffer_store_dword v19, off, s[8:11], s28
  s_mov_b64 exec, -1
L_sigd_14:
  v_mfma_f32_16x16x32_bf16 v[244:247], v[52:55], a[12:15], v[244:247]
  ds_read_b64_tr_b16 v[48:49], v11 offset:40960
  v_accvgpr_read_b32 v20, a120
  v_mfma_f32_16x16x32_bf16 v[212:215], v[52:55], a[8:11], v[212:215]
  ds_read_b64_tr_b16 v[50:51], v11 offset:41984
  v_accvgpr_read_b32 v21, a121
  v_mfma_f32_16x16x32_bf16 v[180:183], v[52:55], a[4:7], v[180:183]
  v_cvt_pk_bf16_f32 v28, v20, v21
  v_accvgpr_read_b32 v22, a122
  v_mfma_f32_16x16x32_bf16 v[148:151], v[52:55], a[0:3], v[148:151]
  buffer_load_dwordx4 a[72:75], v17, s[8:11], s38 offen sc1
  v_mfma_f32_16x16x32_bf16 v[152:155], v[56:59], a[0:3], v[152:155]
  ds_read_b64_tr_b16 v[52:53], v12 offset:40960
  v_accvgpr_read_b32 v23, a123
  v_mfma_f32_16x16x32_bf16 v[184:187], v[56:59], a[4:7], v[184:187]
  ds_read_b64_tr_b16 v[54:55], v12 offset:41984
  v_cvt_pk_bf16_f32 v29, v22, v23
  v_mfma_f32_16x16x32_bf16 v[216:219], v[56:59], a[8:11], v[216:219]
  v_accvgpr_read_b32 v20, a124
  v_accvgpr_read_b32 v21, a125
  v_mfma_f32_16x16x32_bf16 v[248:251], v[56:59], a[12:15], v[248:251]
  v_cvt_pk_bf16_f32 v30, v20, v21
  v_accvgpr_read_b32 v22, a126
  v_mfma_f32_16x16x32_bf16 v[252:255], v[60:63], a[12:15], v[252:255]
  ds_read_b64_tr_b16 v[56:57], v13 offset:40960
  v_accvgpr_read_b32 v23, a127
  v_mfma_f32_16x16x32_bf16 v[220:223], v[60:63], a[8:11], v[220:223]
  ds_read_b64_tr_b16 v[58:59], v13 offset:41984
  v_cvt_pk_bf16_f32 v31, v22, v23
  v_mfma_f32_16x16x32_bf16 v[188:191], v[60:63], a[4:7], v[188:191]
  s_waitcnt vmcnt(19) lgkmcnt(6)
  v_mfma_f32_16x16x32_bf16 v[156:159], v[60:63], a[0:3], v[156:159]
  buffer_load_dwordx4 a[76:79], v17, s[8:11], s39 offen sc1
  v_mfma_f32_16x16x32_bf16 v[128:131], v[32:35], a[16:19], v[128:131]
  ds_read_b64_tr_b16 v[60:61], v14 offset:40960
  v_mfma_f32_16x16x32_bf16 v[160:163], v[32:35], a[20:23], v[160:163]
  ds_read_b64_tr_b16 v[62:63], v14 offset:41984
  v_mfma_f32_16x16x32_bf16 v[192:195], v[32:35], a[24:27], v[192:195]
  s_cmp_eq_u32 s44, 0
  s_cselect_b64 s[64:65], -1, 0
  v_mfma_f32_16x16x32_bf16 v[224:227], v[32:35], a[28:31], v[224:227]
  buffer_store_dwordx4 v[28:31], v2, s[8:11], s33 offen offset:3072
  v_mfma_f32_16x16x32_bf16 v[228:231], v[36:39], a[28:31], v[228:231]
  ds_read_b64_tr_b16 v[32:33], v7 offset:49152
  v_accvgpr_read_b32 v20, a128
  v_mfma_f32_16x16x32_bf16 v[196:199], v[36:39], a[24:27], v[196:199]
  ds_read_b64_tr_b16 v[34:35], v7 offset:50176
  v_accvgpr_read_b32 v21, a129
  v_mfma_f32_16x16x32_bf16 v[164:167], v[36:39], a[20:23], v[164:167]
  v_cvt_pk_bf16_f32 v24, v20, v21
  s_add_u32 s33, s33, 258048
  v_mfma_f32_16x16x32_bf16 v[132:135], v[36:39], a[16:19], v[132:135]
  buffer_load_dwordx4 a[80:83], v17, s[8:11], s36 offen offset:1024 sc1
  v_mfma_f32_16x16x32_bf16 v[136:139], v[40:43], a[16:19], v[136:139]
  ds_read_b64_tr_b16 v[36:37], v8 offset:49152
  v_accvgpr_read_b32 v22, a130
  v_mfma_f32_16x16x32_bf16 v[168:171], v[40:43], a[20:23], v[168:171]
  ds_read_b64_tr_b16 v[38:39], v8 offset:50176
  v_accvgpr_read_b32 v23, a131
  v_mfma_f32_16x16x32_bf16 v[200:203], v[40:43], a[24:27], v[200:203]
  v_cvt_pk_bf16_f32 v25, v22, v23
  v_accvgpr_read_b32 v20, a132
  v_mfma_f32_16x16x32_bf16 v[232:235], v[40:43], a[28:31], v[232:235]
  v_accvgpr_read_b32 v21, a133
  v_cvt_pk_bf16_f32 v26, v20, v21
  v_mfma_f32_16x16x32_bf16 v[236:239], v[44:47], a[28:31], v[236:239]
  ds_read_b64_tr_b16 v[40:41], v9 offset:49152
  v_accvgpr_read_b32 v22, a134
  v_mfma_f32_16x16x32_bf16 v[204:207], v[44:47], a[24:27], v[204:207]
  ds_read_b64_tr_b16 v[42:43], v9 offset:50176
  v_accvgpr_read_b32 v23, a135
  v_mfma_f32_16x16x32_bf16 v[172:175], v[44:47], a[20:23], v[172:175]
  s_waitcnt lgkmcnt(6)
  v_cvt_pk_bf16_f32 v27, v22, v23
  v_mfma_f32_16x16x32_bf16 v[140:143], v[44:47], a[16:19], v[140:143]
  buffer_load_dwordx4 a[84:87], v17, s[8:11], s37 offen offset:1024 sc1
  v_mfma_f32_16x16x32_bf16 v[144:147], v[48:51], a[16:19], v[144:147]
  ds_read_b64_tr_b16 v[44:45], v10 offset:49152
  v_mfma_f32_16x16x32_bf16 v[176:179], v[48:51], a[20:23], v[176:179]
  ds_read_b64_tr_b16 v[46:47], v10 offset:50176
  v_mfma_f32_16x16x32_bf16 v[208:211], v[48:51], a[24:27], v[208:211]
  buffer_store_dwordx4 v[24:27], v2, s[8:11], s33 offen
  v_mfma_f32_16x16x32_bf16 v[240:243], v[48:51], a[28:31], v[240:243]
  v_accvgpr_read_b32 v20, a136
  v_accvgpr_read_b32 v21, a137
  v_mfma_f32_16x16x32_bf16 v[244:247], v[52:55], a[28:31], v[244:247]
  ds_read_b64_tr_b16 v[48:49], v11 offset:49152
  v_cvt_pk_bf16_f32 v28, v20, v21
  v_mfma_f32_16x16x32_bf16 v[212:215], v[52:55], a[24:27], v[212:215]
  ds_read_b64_tr_b16 v[50:51], v11 offset:50176
  v_accvgpr_read_b32 v22, a138
  v_mfma_f32_16x16x32_bf16 v[180:183], v[52:55], a[20:23], v[180:183]
  v_accvgpr_read_b32 v23, a139
  v_cvt_pk_bf16_f32 v29, v22, v23
  v_mfma_f32_16x16x32_bf16 v[148:151], v[52:55], a[16:19], v[148:151]
  buffer_load_dwordx4 a[88:91], v17, s[8:11], s38 offen offset:1024 sc1
  v_mfma_f32_16x16x32_bf16 v[152:155], v[56:59], a[16:19], v[152:155]
  ds_read_b64_tr_b16 v[52:53], v12 offset:49152
  v_accvgpr_read_b32 v20, a140
  v_mfma_f32_16x16x32_bf16 v[184:187], v[56:59], a[20:23], v[184:187]
  ds_read_b64_tr_b16 v[54:55], v12 offset:50176
  v_accvgpr_read_b32 v21, a141
  v_mfma_f32_16x16x32_bf16 v[216:219], v[56:59], a[24:27], v[216:219]
  v_cvt_pk_bf16_f32 v30, v20, v21
  v_accvgpr_read_b32 v22, a142
  v_mfma_f32_16x16x32_bf16 v[248:251], v[56:59], a[28:31], v[248:251]
  v_accvgpr_read_b32 v23, a143
  v_cvt_pk_bf16_f32 v31, v22, v23
  v_mfma_f32_16x16x32_bf16 v[252:255], v[60:63], a[28:31], v[252:255]
  ds_read_b64_tr_b16 v[56:57], v13 offset:49152
  v_mfma_f32_16x16x32_bf16 v[220:223], v[60:63], a[24:27], v[220:223]
  ds_read_b64_tr_b16 v[58:59], v13 offset:50176
  v_mfma_f32_16x16x32_bf16 v[188:191], v[60:63], a[20:23], v[188:191]
  s_waitcnt vmcnt(18) lgkmcnt(6)
  buffer_store_dwordx4 v[28:31], v2, s[8:11], s33 offen offset:1024
  v_mfma_f32_16x16x32_bf16 v[156:159], v[60:63], a[16:19], v[156:159]
  buffer_load_dwordx4 a[92:95], v17, s[8:11], s39 offen offset:1024 sc1
  v_mfma_f32_16x16x32_bf16 v[128:131], v[32:35], a[32:35], v[128:131]
  ds_read_b64_tr_b16 v[60:61], v14 offset:49152
  v_accvgpr_read_b32 v20, a144
  v_mfma_f32_16x16x32_bf16 v[160:163], v[32:35], a[36:39], v[160:163]
  ds_read_b64_tr_b16 v[62:63], v14 offset:50176
  v_accvgpr_read_b32 v21, a145
  v_mfma_f32_16x16x32_bf16 v[192:195], v[32:35], a[40:43], v[192:195]
  v_cvt_pk_bf16_f32 v24, v20, v21
  v_accvgpr_read_b32 v22, a146
  v_mfma_f32_16x16x32_bf16 v[224:227], v[32:35], a[44:47], v[224:227]
  v_accvgpr_read_b32 v23, a147
  v_cvt_pk_bf16_f32 v25, v22, v23
  v_mfma_f32_16x16x32_bf16 v[228:231], v[36:39], a[44:47], v[228:231]
  ds_read_b64_tr_b16 v[32:33], v7 offset:57344
  v_lshlrev_b32 v3, 1, v18
  v_mfma_f32_16x16x32_bf16 v[196:199], v[36:39], a[40:43], v[196:199]
  ds_read_b64_tr_b16 v[34:35], v7 offset:58368
  v_accvgpr_read_b32 v20, a148
  v_mfma_f32_16x16x32_bf16 v[164:167], v[36:39], a[36:39], v[164:167]
  v_accvgpr_read_b32 v21, a149
  v_cvt_pk_bf16_f32 v26, v20, v21
  v_mfma_f32_16x16x32_bf16 v[132:135], v[36:39], a[32:35], v[132:135]
  buffer_load_dwordx4 a[96:99], v17, s[8:11], s36 offen offset:2048 sc1
  v_mfma_f32_16x16x32_bf16 v[136:139], v[40:43], a[32:35], v[136:139]
  ds_read_b64_tr_b16 v[36:37], v8 offset:57344
  v_accvgpr_read_b32 v22, a150
  v_mfma_f32_16x16x32_bf16 v[168:171], v[40:43], a[36:39], v[168:171]
  ds_read_b64_tr_b16 v[38:39], v8 offset:58368
  v_accvgpr_read_b32 v23, a151
  v_mfma_f32_16x16x32_bf16 v[200:203], v[40:43], a[40:43], v[200:203]
  v_cvt_pk_bf16_f32 v27, v22, v23
  v_mfma_f32_16x16x32_bf16 v[232:235], v[40:43], a[44:47], v[232:235]
  buffer_store_dwordx4 v[24:27], v2, s[8:11], s33 offen offset:2048
  v_mfma_f32_16x16x32_bf16 v[236:239], v[44:47], a[44:47], v[236:239]
  ds_read_b64_tr_b16 v[40:41], v9 offset:57344
  v_accvgpr_read_b32 v20, a152
  v_mfma_f32_16x16x32_bf16 v[204:207], v[44:47], a[40:43], v[204:207]
  ds_read_b64_tr_b16 v[42:43], v9 offset:58368
  v_accvgpr_read_b32 v21, a153
  v_mfma_f32_16x16x32_bf16 v[172:175], v[44:47], a[36:39], v[172:175]
  s_waitcnt lgkmcnt(6)
  v_cvt_pk_bf16_f32 v28, v20, v21
  v_accvgpr_read_b32 v22, a154
  v_mfma_f32_16x16x32_bf16 v[140:143], v[44:47], a[32:35], v[140:143]
  buffer_load_dwordx4 a[100:103], v17, s[8:11], s37 offen offset:2048 sc1
  v_mfma_f32_16x16x32_bf16 v[144:147], v[48:51], a[32:35], v[144:147]
  ds_read_b64_tr_b16 v[44:45], v10 offset:57344
  v_accvgpr_read_b32 v23, a155
  v_mfma_f32_16x16x32_bf16 v[176:179], v[48:51], a[36:39], v[176:179]
  ds_read_b64_tr_b16 v[46:47], v10 offset:58368
  v_cvt_pk_bf16_f32 v29, v22, v23
  v_mfma_f32_16x16x32_bf16 v[208:211], v[48:51], a[40:43], v[208:211]
  v_accvgpr_read_b32 v20, a156
  v_accvgpr_read_b32 v21, a157
  v_mfma_f32_16x16x32_bf16 v[240:243], v[48:51], a[44:47], v[240:243]
  v_cvt_pk_bf16_f32 v30, v20, v21
  v_accvgpr_read_b32 v22, a158
  v_mfma_f32_16x16x32_bf16 v[244:247], v[52:55], a[44:47], v[244:247]
  ds_read_b64_tr_b16 v[48:49], v11 offset:57344
  v_accvgpr_read_b32 v23, a159
  v_mfma_f32_16x16x32_bf16 v[212:215], v[52:55], a[40:43], v[212:215]
  ds_read_b64_tr_b16 v[50:51], v11 offset:58368
  v_cvt_pk_bf16_f32 v31, v22, v23
  v_mfma_f32_16x16x32_bf16 v[180:183], v[52:55], a[36:39], v[180:183]
  buffer_store_dwordx4 v[28:31], v2, s[8:11], s33 offen offset:3072
  v_mfma_f32_16x16x32_bf16 v[148:151], v[52:55], a[32:35], v[148:151]
  buffer_load_dwordx4 a[104:107], v17, s[8:11], s38 offen offset:2048 sc1
  v_mfma_f32_16x16x32_bf16 v[152:155], v[56:59], a[32:35], v[152:155]
  ds_read_b64_tr_b16 v[52:53], v12 offset:57344
  v_accvgpr_read_b32 v20, a160
  v_mfma_f32_16x16x32_bf16 v[184:187], v[56:59], a[36:39], v[184:187]
  ds_read_b64_tr_b16 v[54:55], v12 offset:58368
  v_accvgpr_read_b32 v21, a161
  v_mfma_f32_16x16x32_bf16 v[216:219], v[56:59], a[40:43], v[216:219]
  v_cvt_pk_bf16_f32 v24, v20, v21
  s_add_u32 s33, s33, 4096
  v_mfma_f32_16x16x32_bf16 v[248:251], v[56:59], a[44:47], v[248:251]
  buffer_load_dword v19, v3, s[16:19], 0 offen offset:4 sc1
  v_mfma_f32_16x16x32_bf16 v[252:255], v[60:63], a[44:47], v[252:255]
  ds_read_b64_tr_b16 v[56:57], v13 offset:57344
  v_accvgpr_read_b32 v22, a162
  v_mfma_f32_16x16x32_bf16 v[220:223], v[60:63], a[40:43], v[220:223]
  ds_read_b64_tr_b16 v[58:59], v13 offset:58368
  v_accvgpr_read_b32 v23, a163
  v_mfma_f32_16x16x32_bf16 v[188:191], v[60:63], a[36:39], v[188:191]
  s_waitcnt vmcnt(20) lgkmcnt(6)
  v_cvt_pk_bf16_f32 v25, v22, v23
  v_accvgpr_read_b32 v20, a164
  v_mfma_f32_16x16x32_bf16 v[156:159], v[60:63], a[32:35], v[156:159]
  buffer_load_dwordx4 a[108:111], v17, s[8:11], s39 offen offset:2048 sc1
  v_mfma_f32_16x16x32_bf16 v[128:131], v[32:35], a[48:51], v[128:131]
  ds_read_b64_tr_b16 v[60:61], v14 offset:57344
  v_accvgpr_read_b32 v21, a165
  v_mfma_f32_16x16x32_bf16 v[160:163], v[32:35], a[52:55], v[160:163]
  ds_read_b64_tr_b16 v[62:63], v14 offset:58368
  v_add_u32 v7, 65536, v7
  v_add_u32 v14, 65536, v14
  v_mfma_f32_16x16x32_bf16 v[192:195], v[32:35], a[56:59], v[192:195]
  s_waitcnt vmcnt(56)
  s_barrier
  v_mfma_f32_16x16x32_bf16 v[224:227], v[32:35], a[60:63], v[224:227]
  v_cvt_pk_bf16_f32 v26, v20, v21
  v_accvgpr_read_b32 v22, a166
  v_mfma_f32_16x16x32_bf16 v[228:231], v[36:39], a[60:63], v[228:231]
  ds_read_b64_tr_b16 v[32:33], v7 offset:0
  v_accvgpr_read_b32 v23, a167
  v_mfma_f32_16x16x32_bf16 v[196:199], v[36:39], a[56:59], v[196:199]
  ds_read_b64_tr_b16 v[34:35], v7 offset:1024
  v_add_u32 v8, 65536, v8
  v_mfma_f32_16x16x32_bf16 v[164:167], v[36:39], a[52:55], v[164:167]
  v_cvt_pk_bf16_f32 v27, v22, v23
  v_mfma_f32_16x16x32_bf16 v[132:135], v[36:39], a[48:51], v[132:135]
  buffer_load_dwordx4 a[112:115], v17, s[8:11], s36 offen offset:3072 sc1
  v_mfma_f32_16x16x32_bf16 v[136:139], v[40:43], a[48:51], v[136:139]
  ds_read_b64_tr_b16 v[36:37], v8 offset:0
  v_mfma_f32_16x16x32_bf16 v[168:171], v[40:43], a[52:55], v[168:171]
  ds_read_b64_tr_b16 v[38:39], v8 offset:1024
  v_add_u32 v9, 65536, v9
  v_mfma_f32_16x16x32_bf16 v[200:203], v[40:43], a[56:59], v[200:203]
  buffer_store_dwordx4 v[24:27], v2, s[8:11], s33 offen
  v_mfma_f32_16x16x32_bf16 v[232:235], v[40:43], a[60:63], v[232:235]
  v_accvgpr_read_b32 v20, a168
  v_accvgpr_read_b32 v21, a169
  v_mfma_f32_16x16x32_bf16 v[236:239], v[44:47], a[60:63], v[236:239]
  ds_read_b64_tr_b16 v[40:41], v9 offset:0
  v_cvt_pk_bf16_f32 v28, v20, v21
  v_mfma_f32_16x16x32_bf16 v[204:207], v[44:47], a[56:59], v[204:207]
  ds_read_b64_tr_b16 v[42:43], v9 offset:1024
  v_add_u32 v10, 65536, v10
  v_mfma_f32_16x16x32_bf16 v[172:175], v[44:47], a[52:55], v[172:175]
  s_waitcnt lgkmcnt(6)
  v_accvgpr_read_b32 v22, a170
  v_accvgpr_read_b32 v23, a171
  v_mfma_f32_16x16x32_bf16 v[140:143], v[44:47], a[48:51], v[140:143]
  buffer_load_dwordx4 a[116:119], v17, s[8:11], s37 offen offset:3072 sc1
  v_mfma_f32_16x16x32_bf16 v[144:147], v[48:51], a[48:51], v[144:147]
  ds_read_b64_tr_b16 v[44:45], v10 offset:0
  v_cvt_pk_bf16_f32 v29, v22, v23
  v_mfma_f32_16x16x32_bf16 v[176:179], v[48:51], a[52:55], v[176:179]
  ds_read_b64_tr_b16 v[46:47], v10 offset:1024
  v_add_u32 v11, 65536, v11
  v_mfma_f32_16x16x32_bf16 v[208:211], v[48:51], a[56:59], v[208:211]
  v_accvgpr_read_b32 v20, a172
  v_accvgpr_read_b32 v21, a173
  v_mfma_f32_16x16x32_bf16 v[240:243], v[48:51], a[60:63], v[240:243]
  v_cvt_pk_bf16_f32 v30, v20, v21
  v_accvgpr_read_b32 v22, a174
  v_mfma_f32_16x16x32_bf16 v[244:247], v[52:55], a[60:63], v[244:247]
  ds_read_b64_tr_b16 v[48:49], v11 offset:0
  v_accvgpr_read_b32 v23, a175
  v_mfma_f32_16x16x32_bf16 v[212:215], v[52:55], a[56:59], v[212:215]
  ds_read_b64_tr_b16 v[50:51], v11 offset:1024
  v_add_u32 v12, 65536, v12
  v_mfma_f32_16x16x32_bf16 v[180:183], v[52:55], a[52:55], v[180:183]
  v_cvt_pk_bf16_f32 v31, v22, v23
  v_mfma_f32_16x16x32_bf16 v[148:151], v[52:55], a[48:51], v[148:151]
  buffer_load_dwordx4 a[120:123], v17, s[8:11], s38 offen offset:3072 sc1
  v_mfma_f32_16x16x32_bf16 v[152:155], v[56:59], a[48:51], v[152:155]
  ds_read_b64_tr_b16 v[52:53], v12 offset:0
  v_mfma_f32_16x16x32_bf16 v[184:187], v[56:59], a[52:55], v[184:187]
  ds_read_b64_tr_b16 v[54:55], v12 offset:1024
  v_add_u32 v13, 65536, v13
  v_mfma_f32_16x16x32_bf16 v[216:219], v[56:59], a[56:59], v[216:219]
  buffer_store_dwordx4 v[28:31], v2, s[8:11], s33 offen offset:1024
  v_mfma_f32_16x16x32_bf16 v[248:251], v[56:59], a[60:63], v[248:251]
  v_accvgpr_read_b32 v20, a176
  v_accvgpr_read_b32 v21, a177
  v_mfma_f32_16x16x32_bf16 v[252:255], v[60:63], a[60:63], v[252:255]
  ds_read_b64_tr_b16 v[56:57], v13 offset:0
  v_cvt_pk_bf16_f32 v24, v20, v21
  v_mfma_f32_16x16x32_bf16 v[220:223], v[60:63], a[56:59], v[220:223]
  ds_read_b64_tr_b16 v[58:59], v13 offset:1024
  v_accvgpr_read_b32 v22, a178
  v_mfma_f32_16x16x32_bf16 v[188:191], v[60:63], a[52:55], v[188:191]
  s_waitcnt vmcnt(19) lgkmcnt(6)
  v_accvgpr_read_b32 v23, a179
  v_cvt_pk_bf16_f32 v25, v22, v23
  v_mfma_f32_16x16x32_bf16 v[156:159], v[60:63], a[48:51], v[156:159]
  buffer_load_dwordx4 a[124:127], v17, s[8:11], s39 offen offset:3072 sc1
  v_mfma_f32_16x16x32_bf16 v[128:131], v[32:35], a[64:67], v[128:131]
  ds_read_b64_tr_b16 v[60:61], v14 offset:0
  v_accvgpr_read_b32 v20, a180
  v_mfma_f32_16x16x32_bf16 v[160:163], v[32:35], a[68:71], v[160:163]
  ds_read_b64_tr_b16 v[62:63], v14 offset:1024
  v_add_u32 v17, 4096, v17
  v_mfma_f32_16x16x32_bf16 v[192:195], v[32:35], a[72:75], v[192:195]
  v_accvgpr_read_b32 v21, a181
  v_cvt_pk_bf16_f32 v26, v20, v21
  v_mfma_f32_16x16x32_bf16 v[224:227], v[32:35], a[76:79], v[224:227]
  v_accvgpr_read_b32 v22, a182
  v_accvgpr_read_b32 v23, a183
  v_mfma_f32_16x16x32_bf16 v[228:231], v[36:39], a[76:79], v[228:231]
  ds_read_b64_tr_b16 v[32:33], v7 offset:8192
  v_and_b32 v17, 0x3fff, v17
  v_mfma_f32_16x16x32_bf16 v[196:199], v[36:39], a[72:75], v[196:199]
  ds_read_b64_tr_b16 v[34:35], v7 offset:9216
  v_cvt_pk_bf16_f32 v27, v22, v23
  v_mfma_f32_16x16x32_bf16 v[164:167], v[36:39], a[68:71], v[164:167]
  buffer_store_dwordx4 v[24:27], v2, s[8:11], s33 offen offset:2048
  v_mfma_f32_16x16x32_bf16 v[132:135], v[36:39], a[64:67], v[132:135]
  buffer_load_dwordx4 a[128:131], v17, s[8:11], s36 offen sc1
  v_mfma_f32_16x16x32_bf16 v[136:139], v[40:43], a[64:67], v[136:139]
  ds_read_b64_tr_b16 v[36:37], v8 offset:8192
  v_accvgpr_read_b32 v20, a184
  v_mfma_f32_16x16x32_bf16 v[168:171], v[40:43], a[68:71], v[168:171]
  ds_read_b64_tr_b16 v[38:39], v8 offset:9216
  v_accvgpr_read_b32 v21, a185
  v_mfma_f32_16x16x32_bf16 v[200:203], v[40:43], a[72:75], v[200:203]
  v_cvt_pk_bf16_f32 v28, v20, v21
  v_accvgpr_read_b32 v22, a186
  v_mfma_f32_16x16x32_bf16 v[232:235], v[40:43], a[76:79], v[232:235]
  v_accvgpr_read_b32 v23, a187
  v_cvt_pk_bf16_f32 v29, v22, v23
  v_mfma_f32_16x16x32_bf16 v[236:239], v[44:47], a[76:79], v[236:239]
  ds_read_b64_tr_b16 v[40:41], v9 offset:8192
  v_accvgpr_read_b32 v20, a188
  v_mfma_f32_16x16x32_bf16 v[204:207], v[44:47], a[72:75], v[204:207]
  ds_read_b64_tr_b16 v[42:43], v9 offset:9216
  v_accvgpr_read_b32 v21, a189
  v_mfma_f32_16x16x32_bf16 v[172:175], v[44:47], a[68:71], v[172:175]
  s_waitcnt lgkmcnt(6)
  v_cvt_pk_bf16_f32 v30, v20, v21
  v_accvgpr_read_b32 v22, a190
  v_mfma_f32_16x16x32_bf16 v[140:143], v[44:47], a[64:67], v[140:143]
  buffer_load_dwordx4 a[132:135], v17, s[8:11], s37 offen sc1
  v_mfma_f32_16x16x32_bf16 v[144:147], v[48:51], a[64:67], v[144:147]
  ds_read_b64_tr_b16 v[44:45], v10 offset:8192
  v_accvgpr_read_b32 v23, a191
  v_mfma_f32_16x16x32_bf16 v[176:179], v[48:51], a[68:71], v[176:179]
  ds_read_b64_tr_b16 v[46:47], v10 offset:9216
  v_cvt_pk_bf16_f32 v31, v22, v23
  v_mfma_f32_16x16x32_bf16 v[208:211], v[48:51], a[72:75], v[208:211]
  buffer_store_dwordx4 v[28:31], v2, s[8:11], s33 offen offset:3072
  v_mfma_f32_16x16x32_bf16 v[240:243], v[48:51], a[76:79], v[240:243]
  v_accvgpr_read_b32 v20, a192
  v_accvgpr_read_b32 v21, a193
  v_mfma_f32_16x16x32_bf16 v[244:247], v[52:55], a[76:79], v[244:247]
  ds_read_b64_tr_b16 v[48:49], v11 offset:8192
  v_cvt_pk_bf16_f32 v24, v20, v21
  v_mfma_f32_16x16x32_bf16 v[212:215], v[52:55], a[72:75], v[212:215]
  ds_read_b64_tr_b16 v[50:51], v11 offset:9216
  s_add_u32 s33, s33, 258048
  v_mfma_f32_16x16x32_bf16 v[180:183], v[52:55], a[68:71], v[180:183]
  v_accvgpr_read_b32 v22, a194
  v_accvgpr_read_b32 v23, a195
  v_mfma_f32_16x16x32_bf16 v[148:151], v[52:55], a[64:67], v[148:151]
  buffer_load_dwordx4 a[136:139], v17, s[8:11], s38 offen sc1
  v_mfma_f32_16x16x32_bf16 v[152:155], v[56:59], a[64:67], v[152:155]
  ds_read_b64_tr_b16 v[52:53], v12 offset:8192
  v_cvt_pk_bf16_f32 v25, v22, v23
  v_mfma_f32_16x16x32_bf16 v[184:187], v[56:59], a[68:71], v[184:187]
  ds_read_b64_tr_b16 v[54:55], v12 offset:9216
  v_accvgpr_read_b32 v20, a196
  v_mfma_f32_16x16x32_bf16 v[216:219], v[56:59], a[72:75], v[216:219]
  v_accvgpr_read_b32 v21, a197
  v_cvt_pk_bf16_f32 v26, v20, v21
  v_mfma_f32_16x16x32_bf16 v[248:251], v[56:59], a[76:79], v[248:251]
  s_waitcnt vmcnt(12)
  v_cmp_gt_u32 vcc, 8, v19
  s_cbranch_vccnz L_spin_21
L_back_22:
  v_mfma_f32_16x16x32_bf16 v[252:255], v[60:63], a[76:79], v[252:255]
  ds_read_b64_tr_b16 v[56:57], v13 offset:8192
  v_accvgpr_read_b32 v22, a198
  v_mfma_f32_16x16x32_bf16 v[220:223], v[60:63], a[72:75], v[220:223]
  ds_read_b64_tr_b16 v[58:59], v13 offset:9216
  v_accvgpr_read_b32 v23, a199
  v_mfma_f32_16x16x32_bf16 v[188:191], v[60:63], a[68:71], v[188:191]
  s_waitcnt vmcnt(18) lgkmcnt(6)
  v_cvt_pk_bf16_f32 v27, v22, v23
  v_mfma_f32_16x16x32_bf16 v[156:159], v[60:63], a[64:67], v[156:159]
  buffer_load_dwordx4 a[140:143], v17, s[8:11], s39 offen sc1
  v_mfma_f32_16x16x32_bf16 v[128:131], v[32:35], a[80:83], v[128:131]
  ds_read_b64_tr_b16 v[60:61], v14 offset:8192
  v_mfma_f32_16x16x32_bf16 v[160:163], v[32:35], a[84:87], v[160:163]
  ds_read_b64_tr_b16 v[62:63], v14 offset:9216
  v_mfma_f32_16x16x32_bf16 v[192:195], v[32:35], a[88:91], v[192:195]
  s_add_u32 s4, s66, 60817408
  s_addc_u32 s5, s67, 0
  v_mfma_f32_16x16x32_bf16 v[224:227], v[32:35], a[92:95], v[224:227]
  buffer_store_dwordx4 v[24:27], v2, s[8:11], s33 offen
  v_mfma_f32_16x16x32_bf16 v[228:231], v[36:39], a[92:95], v[228:231]
  s_mov_b32 s6, 1409024
  ds_read_b64_tr_b16 v[32:33], v7 offset:16384
  v_accvgpr_read_b32 v20, a200
  v_mfma_f32_16x16x32_bf16 v[196:199], v[36:39], a[88:91], v[196:199]
  s_mul_i32 s34, s20, 360448
  ds_read_b64_tr_b16 v[34:35], v7 offset:17408
  v_accvgpr_read_b32 v21, a201
  v_mfma_f32_16x16x32_bf16 v[164:167], v[36:39], a[84:87], v[164:167]
  v_cvt_pk_bf16_f32 v28, v20, v21
  v_accvgpr_read_b32 v22, a202
  v_mfma_f32_16x16x32_bf16 v[132:135], v[36:39], a[80:83], v[132:135]
  buffer_load_dwordx4 a[144:147], v17, s[8:11], s36 offen offset:1024 sc1
  v_mfma_f32_16x16x32_bf16 v[136:139], v[40:43], a[80:83], v[136:139]
  s_lshl_b32 s23, s22, 12
  ds_read_b64_tr_b16 v[36:37], v8 offset:16384
  v_accvgpr_read_b32 v23, a203
  v_mfma_f32_16x16x32_bf16 v[168:171], v[40:43], a[84:87], v[168:171]
  s_add_u32 s34, s34, s23
  ds_read_b64_tr_b16 v[38:39], v8 offset:17408
  v_cvt_pk_bf16_f32 v29, v22, v23
  v_mfma_f32_16x16x32_bf16 v[200:203], v[40:43], a[88:91], v[200:203]
  v_accvgpr_read_b32 v20, a204
  v_accvgpr_read_b32 v21, a205
  v_mfma_f32_16x16x32_bf16 v[232:235], v[40:43], a[92:95], v[232:235]
  v_cvt_pk_bf16_f32 v30, v20, v21
  v_accvgpr_read_b32 v22, a206
  v_mfma_f32_16x16x32_bf16 v[236:239], v[44:47], a[92:95], v[236:239]
  ds_read_b64_tr_b16 v[40:41], v9 offset:16384
  v_accvgpr_read_b32 v23, a207
  v_mfma_f32_16x16x32_bf16 v[204:207], v[44:47], a[88:91], v[204:207]
  ds_read_b64_tr_b16 v[42:43], v9 offset:17408
  v_cvt_pk_bf16_f32 v31, v22, v23
  v_mfma_f32_16x16x32_bf16 v[172:175], v[44:47], a[84:87], v[172:175]
  s_waitcnt lgkmcnt(6)
  v_mfma_f32_16x16x32_bf16 v[140:143], v[44:47], a[80:83], v[140:143]
  buffer_load_dwordx4 a[148:151], v17, s[8:11], s37 offen offset:1024 sc1
  v_mfma_f32_16x16x32_bf16 v[144:147], v[48:51], a[80:83], v[144:147]
  ds_read_b64_tr_b16 v[44:45], v10 offset:16384
  v_mfma_f32_16x16x32_bf16 v[176:179], v[48:51], a[84:87], v[176:179]
  ds_read_b64_tr_b16 v[46:47], v10 offset:17408
  v_mfma_f32_16x16x32_bf16 v[208:211], v[48:51], a[88:91], v[208:211]
  buffer_store_dwordx4 v[28:31], v2, s[8:11], s33 offen offset:1024
  v_mfma_f32_16x16x32_bf16 v[240:243], v[48:51], a[92:95], v[240:243]
  v_accvgpr_read_b32 v20, a208
  v_accvgpr_read_b32 v21, a209
  v_mfma_f32_16x16x32_bf16 v[244:247], v[52:55], a[92:95], v[244:247]
  ds_read_b64_tr_b16 v[48:49], v11 offset:16384
  v_cvt_pk_bf16_f32 v24, v20, v21
  v_mfma_f32_16x16x32_bf16 v[212:215], v[52:55], a[88:91], v[212:215]
  ds_read_b64_tr_b16 v[50:51], v11 offset:17408
  v_accvgpr_read_b32 v22, a210
  v_mfma_f32_16x16x32_bf16 v[180:183], v[52:55], a[84:87], v[180:183]
  v_accvgpr_read_b32 v23, a211
  v_cvt_pk_bf16_f32 v25, v22, v23
  v_mfma_f32_16x16x32_bf16 v[148:151], v[52:55], a[80:83], v[148:151]
  buffer_load_dwordx4 a[152:155], v17, s[8:11], s38 offen offset:1024 sc1
  v_mfma_f32_16x16x32_bf16 v[152:155], v[56:59], a[80:83], v[152:155]
  ds_read_b64_tr_b16 v[52:53], v12 offset:16384
  v_accvgpr_read_b32 v20, a212
  v_mfma_f32_16x16x32_bf16 v[184:187], v[56:59], a[84:87], v[184:187]
  ds_read_b64_tr_b16 v[54:55], v12 offset:17408
  v_accvgpr_read_b32 v21, a213
  v_mfma_f32_16x16x32_bf16 v[216:219], v[56:59], a[88:91], v[216:219]
  v_cvt_pk_bf16_f32 v26, v20, v21
  v_accvgpr_read_b32 v22, a214
  v_mfma_f32_16x16x32_bf16 v[248:251], v[56:59], a[92:95], v[248:251]
  v_accvgpr_read_b32 v23, a215
  v_cvt_pk_bf16_f32 v27, v22, v23
  v_mfma_f32_16x16x32_bf16 v[252:255], v[60:63], a[92:95], v[252:255]
  ds_read_b64_tr_b16 v[56:57], v13 offset:16384
  v_mfma_f32_16x16x32_bf16 v[220:223], v[60:63], a[88:91], v[220:223]
  ds_read_b64_tr_b16 v[58:59], v13 offset:17408
  v_mfma_f32_16x16x32_bf16 v[188:191], v[60:63], a[84:87], v[188:191]
  s_waitcnt vmcnt(17) lgkmcnt(6)
  v_mfma_f32_16x16x32_bf16 v[156:159], v[60:63], a[80:83], v[156:159]
  buffer_load_dwordx4 a[156:159], v17, s[8:11], s39 offen offset:1024 sc1
  v_mfma_f32_16x16x32_bf16 v[128:131], v[32:35], a[96:99], v[128:131]
  ds_read_b64_tr_b16 v[60:61], v14 offset:16384
  v_mfma_f32_16x16x32_bf16 v[160:163], v[32:35], a[100:103], v[160:163]
  ds_read_b64_tr_b16 v[62:63], v14 offset:17408
  v_mfma_f32_16x16x32_bf16 v[192:195], v[32:35], a[104:107], v[192:195]
  buffer_store_dwordx4 v[24:27], v2, s[8:11], s33 offen offset:2048
  v_mfma_f32_16x16x32_bf16 v[224:227], v[32:35], a[108:111], v[224:227]
  v_accvgpr_read_b32 v20, a216
  v_accvgpr_read_b32 v21, a217
  v_mfma_f32_16x16x32_bf16 v[228:231], v[36:39], a[108:111], v[228:231]
  ds_read_b64_tr_b16 v[32:33], v7 offset:24576
  v_cvt_pk_bf16_f32 v28, v20, v21
  v_mfma_f32_16x16x32_bf16 v[196:199], v[36:39], a[104:107], v[196:199]
  ds_read_b64_tr_b16 v[34:35], v7 offset:25600
  v_accvgpr_read_b32 v22, a218
  v_mfma_f32_16x16x32_bf16 v[164:167], v[36:39], a[100:103], v[164:167]
  v_accvgpr_read_b32 v23, a219
  v_cvt_pk_bf16_f32 v29, v22, v23
  v_mfma_f32_16x16x32_bf16 v[132:135], v[36:39], a[96:99], v[132:135]
  buffer_load_dwordx4 a[160:163], v17, s[8:11], s36 offen offset:2048 sc1
  v_mfma_f32_16x16x32_bf16 v[136:139], v[40:43], a[96:99], v[136:139]
  ds_read_b64_tr_b16 v[36:37], v8 offset:24576
  v_accvgpr_read_b32 v20, a220
  v_mfma_f32_16x16x32_bf16 v[168:171], v[40:43], a[100:103], v[168:171]
  ds_read_b64_tr_b16 v[38:39], v8 offset:25600
  v_accvgpr_read_b32 v21, a221
  v_mfma_f32_16x16x32_bf16 v[200:203], v[40:43], a[104:107], v[200:203]
  v_cvt_pk_bf16_f32 v30, v20, v21
  v_accvgpr_read_b32 v22, a222
  v_mfma_f32_16x16x32_bf16 v[232:235], v[40:43], a[108:111], v[232:235]
  v_accvgpr_read_b32 v23, a223
  v_cvt_pk_bf16_f32 v31, v22, v23
  v_mfma_f32_16x16x32_bf16 v[236:239], v[44:47], a[108:111], v[236:239]
  ds_read_b64_tr_b16 v[40:41], v9 offset:24576
  v_mfma_f32_16x16x32_bf16 v[204:207], v[44:47], a[104:107], v[204:207]
  ds_read_b64_tr_b16 v[42:43], v9 offset:25600
  v_mfma_f32_16x16x32_bf16 v[172:175], v[44:47], a[100:103], v[172:175]
  s_waitcnt lgkmcnt(6)
  v_mfma_f32_16x16x32_bf16 v[140:143], v[44:47], a[96:99], v[140:143]
  buffer_load_dwordx4 a[164:167], v17, s[8:11], s37 offen offset:2048 sc1
  v_mfma_f32_16x16x32_bf16 v[144:147], v[48:51], a[96:99], v[144:147]
  ds_read_b64_tr_b16 v[44:45], v10 offset:24576
  v_mfma_f32_16x16x32_bf16 v[176:179], v[48:51], a[100:103], v[176:179]
  ds_read_b64_tr_b16 v[46:47], v10 offset:25600
  v_mfma_f32_16x16x32_bf16 v[208:211], v[48:51], a[104:107], v[208:211]
  buffer_store_dwordx4 v[28:31], v2, s[8:11], s33 offen offset:3072
  v_mfma_f32_16x16x32_bf16 v[240:243], v[48:51], a[108:111], v[240:243]
  v_accvgpr_read_b32 v20, a224
  v_accvgpr_read_b32 v21, a225
  v_mfma_f32_16x16x32_bf16 v[244:247], v[52:55], a[108:111], v[244:247]
  ds_read_b64_tr_b16 v[48:49], v11 offset:24576
  v_cvt_pk_bf16_f32 v24, v20, v21
  v_mfma_f32_16x16x32_bf16 v[212:215], v[52:55], a[104:107], v[212:215]
  ds_read_b64_tr_b16 v[50:51], v11 offset:25600
  s_add_u32 s33, s33, 4096
  v_mfma_f32_16x16x32_bf16 v[180:183], v[52:55], a[100:103], v[180:183]
  v_accvgpr_read_b32 v22, a226
  v_accvgpr_read_b32 v23, a227
  v_mfma_f32_16x16x32_bf16 v[148:151], v[52:55], a[96:99], v[148:151]
  buffer_load_dwordx4 a[168:171], v17, s[8:11], s38 offen offset:2048 sc1
  v_mfma_f32_16x16x32_bf16 v[152:155], v[56:59], a[96:99], v[152:155]
  ds_read_b64_tr_b16 v[52:53], v12 offset:24576
  v_cvt_pk_bf16_f32 v25, v22, v23
  v_mfma_f32_16x16x32_bf16 v[184:187], v[56:59], a[100:103], v[184:187]
  ds_read_b64_tr_b16 v[54:55], v12 offset:25600
  v_accvgpr_read_b32 v20, a228
  v_mfma_f32_16x16x32_bf16 v[216:219], v[56:59], a[104:107], v[216:219]
  v_accvgpr_read_b32 v21, a229
  v_cvt_pk_bf16_f32 v26, v20, v21
  v_mfma_f32_16x16x32_bf16 v[248:251], v[56:59], a[108:111], v[248:251]
  buffer_load_dword v19, v18, s[8:11], s26 offen sc1
  v_mfma_f32_16x16x32_bf16 v[252:255], v[60:63], a[108:111], v[252:255]
  ds_read_b64_tr_b16 v[56:57], v13 offset:24576
  v_accvgpr_read_b32 v22, a230
  v_mfma_f32_16x16x32_bf16 v[220:223], v[60:63], a[104:107], v[220:223]
  ds_read_b64_tr_b16 v[58:59], v13 offset:25600
  v_accvgpr_read_b32 v23, a231
  v_mfma_f32_16x16x32_bf16 v[188:191], v[60:63], a[100:103], v[188:191]
  s_waitcnt vmcnt(18) lgkmcnt(6)
  v_cvt_pk_bf16_f32 v27, v22, v23
  v_mfma_f32_16x16x32_bf16 v[156:159], v[60:63], a[96:99], v[156:159]
  buffer_load_dwordx4 a[172:175], v17, s[8:11], s39 offen offset:2048 sc1
  v_mfma_f32_16x16x32_bf16 v[128:131], v[32:35], a[112:115], v[128:131]
  ds_read_b64_tr_b16 v[60:61], v14 offset:24576
  v_mfma_f32_16x16x32_bf16 v[160:163], v[32:35], a[116:119], v[160:163]
  ds_read_b64_tr_b16 v[62:63], v14 offset:25600
  v_mfma_f32_16x16x32_bf16 v[192:195], v[32:35], a[120:123], v[192:195]
  s_waitcnt vmcnt(63)
  s_barrier
  v_mfma_f32_16x16x32_bf16 v[224:227], v[32:35], a[124:127], v[224:227]
  buffer_store_dwordx4 v[24:27], v2, s[8:11], s33 offen
  v_mfma_f32_16x16x32_bf16 v[228:231], v[36:39], a[124:127], v[228:231]
  ds_read_b64_tr_b16 v[32:33], v7 offset:32768
  v_mov_b32 v5, v2
  v_mfma_f32_16x16x32_bf16 v[196:199], v[36:39], a[120:123], v[196:199]
  ds_read_b64_tr_b16 v[34:35], v7 offset:33792
  v_accvgpr_read_b32 v20, a232
  v_mfma_f32_16x16x32_bf16 v[164:167], v[36:39], a[116:119], v[164:167]
  v_accvgpr_read_b32 v21, a233
  v_cvt_pk_bf16_f32 v28, v20, v21
  v_mfma_f32_16x16x32_bf16 v[132:135], v[36:39], a[112:115], v[132:135]
  buffer_load_dwordx4 a[176:179], v17, s[8:11], s36 offen offset:3072 sc1
  v_mfma_f32_16x16x32_bf16 v[136:139], v[40:43], a[112:115], v[136:139]
  ds_read_b64_tr_b16 v[36:37], v8 offset:32768
  v_mov_b32 v6, v2
  v_mfma_f32_16x16x32_bf16 v[168:171], v[40:43], a[116:119], v[168:171]
  ds_read_b64_tr_b16 v[38:39], v8 offset:33792
  v_accvgpr_read_b32 v22, a234
  v_mfma_f32_16x16x32_bf16 v[200:203], v[40:43], a[120:123], v[200:203]
  v_accvgpr_read_b32 v23, a235
  v_cvt_pk_bf16_f32 v29, v22, v23
  v_mfma_f32_16x16x32_bf16 v[232:235], v[40:43], a[124:127], v[232:235]
  v_accvgpr_read_b32 v20, a236
  v_accvgpr_read_b32 v21, a237
  v_mfma_f32_16x16x32_bf16 v[236:239], v[44:47], a[124:127], v[236:239]
  ds_read_b64_tr_b16 v[40:41], v9 offset:32768
  v_mov_b32 v15, v2
  v_mfma_f32_16x16x32_bf16 v[204:207], v[44:47], a[120:123], v[204:207]
  ds_read_b64_tr_b16 v[42:43], v9 offset:33792
  v_cvt_pk_bf16_f32 v30, v20, v21
  v_mfma_f32_16x16x32_bf16 v[172:175], v[44:47], a[116:119], v[172:175]
  s_waitcnt lgkmcnt(6)
  v_accvgpr_read_b32 v22, a238
  v_accvgpr_read_b32 v23, a239
  v_mfma_f32_16x16x32_bf16 v[140:143], v[44:47], a[112:115], v[140:143]
  buffer_load_dwordx4 a[180:183], v17, s[8:11], s37 offen offset:3072 sc1
  v_mfma_f32_16x16x32_bf16 v[144:147], v[48:51], a[112:115], v[144:147]
  ds_read_b64_tr_b16 v[44:45], v10 offset:32768
  v_mov_b32 v16, v2
  v_mfma_f32_16x16x32_bf16 v[176:179], v[48:51], a[116:119], v[176:179]
  ds_read_b64_tr_b16 v[46:47], v10 offset:33792
  v_cvt_pk_bf16_f32 v31, v22, v23
  v_mfma_f32_16x16x32_bf16 v[208:211], v[48:51], a[120:123], v[208:211]
  buffer_store_dwordx4 v[28:31], v2, s[8:11], s33 offen offset:1024
  v_mfma_f32_16x16x32_bf16 v[240:243], v[48:51], a[124:127], v[240:243]
  v_accvgpr_read_b32 v20, a240
  v_accvgpr_read_b32 v21, a241
  v_mfma_f32_16x16x32_bf16 v[244:247], v[52:55], a[124:127], v[244:247]
  ds_read_b64_tr_b16 v[48:49], v11 offset:32768
  v_cvt_pk_bf16_f32 v24, v20, v21
  v_mfma_f32_16x16x32_bf16 v[212:215], v[52:55], a[120:123], v[212:215]
  ds_read_b64_tr_b16 v[50:51], v11 offset:33792
  v_accvgpr_read_b32 v22, a242
  v_mfma_f32_16x16x32_bf16 v[180:183], v[52:55], a[116:119], v[180:183]
  v_accvgpr_read_b32 v23, a243
  v_cvt_pk_bf16_f32 v25, v22, v23
  v_mfma_f32_16x16x32_bf16 v[148:151], v[52:55], a[112:115], v[148:151]
  buffer_load_dwordx4 a[184:187], v17, s[8:11], s38 offen offset:3072 sc1
  v_mfma_f32_16x16x32_bf16 v[152:155], v[56:59], a[112:115], v[152:155]
  ds_read_b64_tr_b16 v[52:53], v12 offset:32768
  v_accvgpr_read_b32 v20, a244
  v_mfma_f32_16x16x32_bf16 v[184:187], v[56:59], a[116:119], v[184:187]
  ds_read_b64_tr_b16 v[54:55], v12 offset:33792
  v_accvgpr_read_b32 v21, a245
  v_mfma_f32_16x16x32_bf16 v[216:219], v[56:59], a[120:123], v[216:219]
  v_cvt_pk_bf16_f32 v26, v20, v21
  v_accvgpr_read_b32 v22, a246
  v_mfma_f32_16x16x32_bf16 v[248:251], v[56:59], a[124:127], v[248:251]
  s_waitcnt vmcnt(6)
  v_cmp_eq_u32 vcc, 0, v19
  s_cbranch_vccnz L_spin_15
L_back_16:
  s_cmp_eq_u32 s3, 0
  s_cbranch_scc1 L_acq_17
L_acqd_18:
  v_mfma_f32_16x16x32_bf16 v[252:255], v[60:63], a[124:127], v[252:255]
  ds_read_b64_tr_b16 v[56:57], v13 offset:32768
  v_accvgpr_read_b32 v23, a247
  v_mfma_f32_16x16x32_bf16 v[220:223], v[60:63], a[120:123], v[220:223]
  ds_read_b64_tr_b16 v[58:59], v13 offset:33792
  v_cvt_pk_bf16_f32 v27, v22, v23
  v_mfma_f32_16x16x32_bf16 v[188:191], v[60:63], a[116:119], v[188:191]
  s_waitcnt vmcnt(18) lgkmcnt(6)
  v_mfma_f32_16x16x32_bf16 v[156:159], v[60:63], a[112:115], v[156:159]
  buffer_load_dwordx4 a[188:191], v17, s[8:11], s39 offen offset:3072 sc1
  v_mfma_f32_16x16x32_bf16 v[128:131], v[32:35], a[128:131], v[128:131]
  ds_read_b64_tr_b16 v[60:61], v14 offset:32768
  v_mfma_f32_16x16x32_bf16 v[160:163], v[32:35], a[132:135], v[160:163]
  ds_read_b64_tr_b16 v[62:63], v14 offset:33792
  v_mfma_f32_16x16x32_bf16 v[192:195], v[32:35], a[136:139], v[192:195]
  s_mov_b32 m0, s30
  v_mfma_f32_16x16x32_bf16 v[224:227], v[32:35], a[140:143], v[224:227]
  buffer_load_dwordx4 v5, s[12:15], s29 offen sc1 lds
  v_mfma_f32_16x16x32_bf16 v[228:231], v[36:39], a[140:143], v[228:231]
  ds_read_b64_tr_b16 v[32:33], v7 offset:40960
  v_mfma_f32_16x16x32_bf16 v[196:199], v[36:39], a[136:139], v[196:199]
  ds_read_b64_tr_b16 v[34:35], v7 offset:41984
  v_mfma_f32_16x16x32_bf16 v[164:167], v[36:39], a[132:135], v[164:167]
  buffer_store_dwordx4 v[24:27], v2, s[8:11], s33 offen offset:2048
  v_mfma_f32_16x16x32_bf16 v[132:135], v[36:39], a[128:131], v[132:135]
  buffer_load_dwordx4 v6, s[12:15], s29 offen offset:1024 sc1 lds
  v_mfma_f32_16x16x32_bf16 v[136:139], v[40:43], a[128:131], v[136:139]
  ds_read_b64_tr_b16 v[36:37], v8 offset:40960
  v_accvgpr_read_b32 v20, a248
  v_mfma_f32_16x16x32_bf16 v[168:171], v[40:43], a[132:135], v[168:171]
  ds_read_b64_tr_b16 v[38:39], v8 offset:41984
  v_accvgpr_read_b32 v21, a249
  v_mfma_f32_16x16x32_bf16 v[200:203], v[40:43], a[136:139], v[200:203]
  v_cvt_pk_bf16_f32 v28, v20, v21
  v_accvgpr_read_b32 v22, a250
  v_mfma_f32_16x16x32_bf16 v[232:235], v[40:43], a[140:143], v[232:235]
  buffer_load_dwordx4 v15, s[12:15], s29 offen offset:2048 sc1 lds
  v_mfma_f32_16x16x32_bf16 v[236:239], v[44:47], a[140:143], v[236:239]
  ds_read_b64_tr_b16 v[40:41], v9 offset:40960
  v_accvgpr_read_b32 v23, a251
  v_mfma_f32_16x16x32_bf16 v[204:207], v[44:47], a[136:139], v[204:207]
  ds_read_b64_tr_b16 v[42:43], v9 offset:41984
  v_cvt_pk_bf16_f32 v29, v22, v23
  v_mfma_f32_16x16x32_bf16 v[172:175], v[44:47], a[132:135], v[172:175]
  s_waitcnt lgkmcnt(6)
  v_accvgpr_read_b32 v20, a252
  v_accvgpr_read_b32 v21, a253
  v_mfma_f32_16x16x32_bf16 v[140:143], v[44:47], a[128:131], v[140:143]
  buffer_load_dwordx4 v16, s[12:15], s29 offen offset:3072 sc1 lds
  v_mfma_f32_16x16x32_bf16 v[144:147], v[48:51], a[128:131], v[144:147]
  ds_read_b64_tr_b16 v[44:45], v10 offset:40960
  v_cvt_pk_bf16_f32 v30, v20, v21
  v_mfma_f32_16x16x32_bf16 v[176:179], v[48:51], a[132:135], v[176:179]
  s_add_u32 m0, s30, 4096
  ds_read_b64_tr_b16 v[46:47], v10 offset:41984
  v_accvgpr_read_b32 v22, a254
  v_mfma_f32_16x16x32_bf16 v[208:211], v[48:51], a[136:139], v[208:211]
  s_add_u32 s29, s29, s48
  v_accvgpr_read_b32 v23, a255
  v_cvt_pk_bf16_f32 v31, v22, v23
  v_mfma_f32_16x16x32_bf16 v[240:243], v[48:51], a[140:143], v[240:243]
  buffer_load_dwordx4 v5, s[12:15], s29 offen sc1 lds
  v_mfma_f32_16x16x32_bf16 v[244:247], v[52:55], a[140:143], v[244:247]
  ds_read_b64_tr_b16 v[48:49], v11 offset:40960
  v_mfma_f32_16x16x32_bf16 v[212:215], v[52:55], a[136:139], v[212:215]
  ds_read_b64_tr_b16 v[50:51], v11 offset:41984
  v_mfma_f32_16x16x32_bf16 v[180:183], v[52:55], a[132:135], v[180:183]
  buffer_store_dwordx4 v[28:31], v2, s[8:11], s33 offen offset:3072
  v_mfma_f32_16x16x32_bf16 v[148:151], v[52:55], a[128:131], v[148:151]
  buffer_load_dwordx4 v6, s[12:15], s29 offen offset:1024 sc1 lds
  v_mfma_f32_16x16x32_bf16 v[152:155], v[56:59], a[128:131], v[152:155]
  ds_read_b64_tr_b16 v[52:53], v12 offset:40960
  v_mov_b32 v3, v2
  v_mfma_f32_16x16x32_bf16 v[184:187], v[56:59], a[132:135], v[184:187]
  ds_read_b64_tr_b16 v[54:55], v12 offset:41984
  v_mov_b32 v4, v2
  v_mfma_f32_16x16x32_bf16 v[216:219], v[56:59], a[136:139], v[216:219]
  v_mov_b32 v70, 0x3f803f80
  v_and_b32 v68, 15, v1
  v_mfma_f32_16x16x32_bf16 v[248:251], v[56:59], a[140:143], v[248:251]
  buffer_load_dwordx4 v15, s[12:15], s29 offen offset:2048 sc1 lds
  v_mfma_f32_16x16x32_bf16 v[252:255], v[60:63], a[140:143], v[252:255]
  ds_read_b64_tr_b16 v[56:57], v13 offset:40960
  v_lshrrev_b32 v69, 4, v1
  v_mfma_f32_16x16x32_bf16 v[220:223], v[60:63], a[136:139], v[220:223]
  ds_read_b64_tr_b16 v[58:59], v13 offset:41984
  v_xor_b32 v71, v68, v69
  v_mfma_f32_16x16x32_bf16 v[188:191], v[60:63], a[132:135], v[188:191]
  s_waitcnt vmcnt(22) lgkmcnt(6)
  v_and_b32 v71, 2, v71
  v_cmp_eq_u32 vcc, 0, v71
  v_mfma_f32_16x16x32_bf16 v[156:159], v[60:63], a[128:131], v[156:159]
  buffer_load_dwordx4 v16, s[12:15], s29 offen offset:3072 sc1 lds
  v_mfma_f32_16x16x32_bf16 v[128:131], v[32:35], a[144:147], v[128:131]
  s_add_u32 s29, s29, s49
  ds_read_b64_tr_b16 v[60:61], v14 offset:40960
  v_and_b32 v71, 1, v68
  v_mfma_f32_16x16x32_bf16 v[160:163], v[32:35], a[148:151], v[160:163]
  s_add_u32 s30, s30, 32768
  ds_read_b64_tr_b16 v[62:63], v14 offset:41984
  v_mul_u32_u24 v71, 0xaaaa, v71
  v_mfma_f32_16x16x32_bf16 v[192:195], v[32:35], a[152:155], v[192:195]
  s_mov_b32 m0, s30
  v_cndmask_b32 v104, 0, v70, vcc
  v_add_u32 v108, 0x4444, v71
  v_mfma_f32_16x16x32_bf16 v[224:227], v[32:35], a[156:159], v[224:227]
  buffer_load_dwordx4 v5, s[12:15], s29 offen sc1 lds
  v_mfma_f32_16x16x32_bf16 v[228:231], v[36:39], a[156:159], v[228:231]
  ds_read_b64_tr_b16 v[32:33], v7 offset:49152
  v_lshlrev_b32 v72, 2, v69
  v_mfma_f32_16x16x32_bf16 v[196:199], v[36:39], a[152:155], v[196:199]
  ds_read_b64_tr_b16 v[34:35], v7 offset:50176
  v_sub_u32 v73, v68, v72
  v_mfma_f32_16x16x32_bf16 v[164:167], v[36:39], a[148:151], v[164:167]
  s_add_u32 s72, s66, 58720256
  s_addc_u32 s73, s67, 0
  v_mov_b32 v74, 0xf149f2ca
  v_mfma_f32_16x16x32_bf16 v[132:135], v[36:39], a[144:147], v[132:135]
  buffer_load_dwordx4 v6, s[12:15], s29 offen offset:1024 sc1 lds
  v_mfma_f32_16x16x32_bf16 v[136:139], v[40:43], a[144:147], v[136:139]
  ds_read_b64_tr_b16 v[36:37], v8 offset:49152
  v_cmp_gt_i32 vcc, 0, v73
  v_mfma_f32_16x16x32_bf16 v[168:171], v[40:43], a[148:151], v[168:171]
  ds_read_b64_tr_b16 v[38:39], v8 offset:50176
  v_mov_b32 v96, 0
  v_mfma_f32_16x16x32_bf16 v[200:203], v[40:43], a[152:155], v[200:203]
  s_cmp_lt_u32 s44, 29
  s_cselect_b32 s74, 1409024, 0
  v_mov_b32 v97, 0
  v_mfma_f32_16x16x32_bf16 v[232:235], v[40:43], a[156:159], v[232:235]
  buffer_load_dwordx4 v15, s[12:15], s29 offen offset:2048 sc1 lds
  v_mfma_f32_16x16x32_bf16 v[236:239], v[44:47], a[156:159], v[236:239]
  ds_read_b64_tr_b16 v[40:41], v9 offset:49152
  v_cndmask_b32 v64, 0, v74, vcc
  v_mfma_f32_16x16x32_bf16 v[204:207], v[44:47], a[152:155], v[204:207]
  ds_read_b64_tr_b16 v[42:43], v9 offset:50176
  v_cmp_gt_i32 vcc, 1, v73
  v_mfma_f32_16x16x32_bf16 v[172:175], v[44:47], a[148:151], v[172:175]
  s_waitcnt lgkmcnt(6)
  v_mov_b32 v98, 0
  v_mov_b32 v99, 0
  v_mfma_f32_16x16x32_bf16 v[140:143], v[44:47], a[144:147], v[140:143]
  buffer_load_dwordx4 v16, s[12:15], s29 offen offset:3072 sc1 lds
  v_mfma_f32_16x16x32_bf16 v[144:147], v[48:51], a[144:147], v[144:147]
  ds_read_b64_tr_b16 v[44:45], v10 offset:49152
  v_cndmask_b32 v65, 0, v74, vcc
  v_mfma_f32_16x16x32_bf16 v[176:179], v[48:51], a[148:151], v[176:179]
  s_add_u32 m0, s30, 4096
  ds_read_b64_tr_b16 v[46:47], v10 offset:50176
  v_cmp_gt_i32 vcc, 2, v73
  v_mfma_f32_16x16x32_bf16 v[208:211], v[48:51], a[152:155], v[208:211]
  s_add_u32 s29, s29, s48
  v_mov_b32 v100, 0
  v_mov_b32 v101, 0
  v_mfma_f32_16x16x32_bf16 v[240:243], v[48:51], a[156:159], v[240:243]
  buffer_load_dwordx4 v5, s[12:15], s29 offen sc1 lds
  v_mfma_f32_16x16x32_bf16 v[244:247], v[52:55], a[156:159], v[244:247]
  ds_read_b64_tr_b16 v[48:49], v11 offset:49152
  v_cndmask_b32 v66, 0, v74, vcc
  v_mfma_f32_16x16x32_bf16 v[212:215], v[52:55], a[152:155], v[212:215]
  ds_read_b64_tr_b16 v[50:51], v11 offset:50176
  v_cmp_gt_i32 vcc, 3, v73
  v_mfma_f32_16x16x32_bf16 v[180:183], v[52:55], a[148:151], v[180:183]
  v_mov_b32 v102, 0
  v_mov_b32 v103, 0
  v_mfma_f32_16x16x32_bf16 v[148:151], v[52:55], a[144:147], v[148:151]
  buffer_load_dwordx4 v6, s[12:15], s29 offen offset:1024 sc1 lds
  v_mfma_f32_16x16x32_bf16 v[152:155], v[56:59], a[144:147], v[152:155]
  ds_read_b64_tr_b16 v[52:53], v12 offset:49152
  v_cndmask_b32 v67, 0, v74, vcc
  v_mfma_f32_16x16x32_bf16 v[184:187], v[56:59], a[148:151], v[184:187]
  ds_read_b64_tr_b16 v[54:55], v12 offset:50176
  v_mov_b32 v105, v104
  v_mfma_f32_16x16x32_bf16 v[216:219], v[56:59], a[152:155], v[216:219]
  v_mov_b32 v106, v104
  v_mov_b32 v107, v104
  v_mfma_f32_16x16x32_bf16 v[248:251], v[56:59], a[156:159], v[248:251]
  buffer_load_dwordx4 v15, s[12:15], s29 offen offset:2048 sc1 lds
  v_mfma_f32_16x16x32_bf16 v[252:255], v[60:63], a[156:159], v[252:255]
  ds_read_b64_tr_b16 v[56:57], v13 offset:49152
  v_cndmask_b32 v112, 0, v64, s[64:65]
  v_mfma_f32_16x16x32_bf16 v[220:223], v[60:63], a[152:155], v[220:223]
  ds_read_b64_tr_b16 v[58:59], v13 offset:50176
  v_cndmask_b32 v116, 0, v74, s[64:65]
  v_mfma_f32_16x16x32_bf16 v[188:191], v[60:63], a[148:151], v[188:191]
  s_waitcnt vmcnt(23) lgkmcnt(6)
  v_mov_b32 v120, 0
  v_mov_b32 v124, v112
  v_mfma_f32_16x16x32_bf16 v[156:159], v[60:63], a[144:147], v[156:159]
  buffer_load_dwordx4 v16, s[12:15], s29 offen offset:3072 sc1 lds
  v_mfma_f32_16x16x32_bf16 v[128:131], v[32:35], a[160:163], v[128:131]
  s_add_u32 s29, s29, s49
  ds_read_b64_tr_b16 v[60:61], v14 offset:49152
  v_cndmask_b32 v113, 0, v65, s[64:65]
  v_mfma_f32_16x16x32_bf16 v[160:163], v[32:35], a[164:167], v[160:163]
  s_add_u32 s30, s30, 32768
  ds_read_b64_tr_b16 v[62:63], v14 offset:50176
  v_cndmask_b32 v117, 0, v74, s[64:65]
  v_mfma_f32_16x16x32_bf16 v[192:195], v[32:35], a[168:171], v[192:195]
  s_mov_b32 m0, s30
  v_mov_b32 v121, 0
  v_mov_b32 v125, v113
  v_mfma_f32_16x16x32_bf16 v[224:227], v[32:35], a[172:175], v[224:227]
  buffer_load_dwordx4 v5, s[12:15], s29 offen sc1 lds
  v_mfma_f32_16x16x32_bf16 v[228:231], v[36:39], a[172:175], v[228:231]
  ds_read_b64_tr_b16 v[32:33], v7 offset:57344
  v_cndmask_b32 v114, 0, v66, s[64:65]
  v_mfma_f32_16x16x32_bf16 v[196:199], v[36:39], a[168:171], v[196:199]
  ds_read_b64_tr_b16 v[34:35], v7 offset:58368
  v_cndmask_b32 v118, 0, v74, s[64:65]
  v_mfma_f32_16x16x32_bf16 v[164:167], v[36:39], a[164:167], v[164:167]
  s_bitcmp1_b32 s20, 0
  s_cselect_b32 s23, 1024, 0
  s_cselect_b32 s24, 0, 2048
  v_mfma_f32_16x16x32_bf16 v[132:135], v[36:39], a[160:163], v[132:135]
  buffer_load_dwordx4 v6, s[12:15], s29 offen offset:1024 sc1 lds
  v_mfma_f32_16x16x32_bf16 v[136:139], v[40:43], a[160:163], v[136:139]
  s_mul_i32 s25, s44, 3072
  ds_read_b64_tr_b16 v[36:37], v8 offset:57344
  v_mov_b32 v122, 0
  v_mfma_f32_16x16x32_bf16 v[168:171], v[40:43], a[164:167], v[168:171]
  s_add_u32 s52, s23, s25
  ds_read_b64_tr_b16 v[38:39], v8 offset:58368
  v_mov_b32 v126, v114
  v_mfma_f32_16x16x32_bf16 v[200:203], v[40:43], a[168:171], v[200:203]
  v_cndmask_b32 v115, 0, v67, s[64:65]
  v_cndmask_b32 v119, 0, v74, s[64:65]
  v_mfma_f32_16x16x32_bf16 v[232:235], v[40:43], a[172:175], v[232:235]
  buffer_load_dwordx4 v15, s[12:15], s29 offen offset:2048 sc1 lds
  v_mfma_f32_16x16x32_bf16 v[236:239], v[44:47], a[172:175], v[236:239]
  s_add_u32 s53, s24, s25
  ds_read_b64_tr_b16 v[40:41], v9 offset:57344
  v_mov_b32 v123, 0
  v_mfma_f32_16x16x32_bf16 v[204:207], v[44:47], a[168:171], v[204:207]
  ds_read_b64_tr_b16 v[42:43], v9 offset:58368
  v_mov_b32 v127, v115
  v_mfma_f32_16x16x32_bf16 v[172:175], v[44:47], a[164:167], v[172:175]
  s_waitcnt lgkmcnt(6)
  v_xor_b32 v72, v68, v72
  v_lshlrev_b32 v71, 10, v69
  v_mfma_f32_16x16x32_bf16 v[140:143], v[44:47], a[160:163], v[140:143]
  buffer_load_dwordx4 v16, s[12:15], s29 offen offset:3072 sc1 lds
  v_mfma_f32_16x16x32_bf16 v[144:147], v[48:51], a[160:163], v[144:147]
  ds_read_b64_tr_b16 v[44:45], v10 offset:57344
  v_lshl_add_u32 v109, v72, 4, v71
  v_mfma_f32_16x16x32_bf16 v[176:179], v[48:51], a[164:167], v[176:179]
  s_add_u32 m0, s30, 4096
  ds_read_b64_tr_b16 v[46:47], v10 offset:58368
  v_xor_b32 v71, 32, v109
  v_mfma_f32_16x16x32_bf16 v[208:211], v[48:51], a[168:171], v[208:211]
  s_add_u32 s29, s29, s48
  v_add_u32 v110, 3072, v71
  v_add_u32 v111, 6144, v109
  v_mfma_f32_16x16x32_bf16 v[240:243], v[48:51], a[172:175], v[240:243]
  buffer_load_dwordx4 v5, s[12:15], s29 offen sc1 lds
  v_mfma_f32_16x16x32_bf16 v[244:247], v[52:55], a[172:175], v[244:247]
  ds_read_b64_tr_b16 v[48:49], v11 offset:57344
  v_add_u32 v17, 9216, v71
  v_mfma_f32_16x16x32_bf16 v[212:215], v[52:55], a[168:171], v[212:215]
  ds_read_b64_tr_b16 v[50:51], v11 offset:58368
  v_mfma_f32_16x16x32_bf16 v[180:183], v[52:55], a[164:167], v[180:183]
  v_mfma_f32_16x16x32_bf16 v[148:151], v[52:55], a[160:163], v[148:151]
  buffer_load_dwordx4 v6, s[12:15], s29 offen offset:1024 sc1 lds
  v_mfma_f32_16x16x32_bf16 v[152:155], v[56:59], a[160:163], v[152:155]
  ds_read_b64_tr_b16 v[52:53], v12 offset:57344
  v_mfma_f32_16x16x32_bf16 v[184:187], v[56:59], a[164:167], v[184:187]
  ds_read_b64_tr_b16 v[54:55], v12 offset:58368
  v_mfma_f32_16x16x32_bf16 v[216:219], v[56:59], a[168:171], v[216:219]
  s_waitcnt vmcnt(17)
  v_mov_b32 v19, 2
  s_cmp_eq_u32 s3, 0
  s_cbranch_scc1 L_xsig_19
  s_mov_b64 exec, 1
  buffer_store_dword v19, off, s[8:11], s28
  s_mov_b64 exec, -1
L_sigd_20:
  v_mfma_f32_16x16x32_bf16 v[248:251], v[56:59], a[172:175], v[248:251]
  buffer_load_dwordx4 v15, s[12:15], s29 offen offset:2048 sc1 lds
  v_mfma_f32_16x16x32_bf16 v[252:255], v[60:63], a[172:175], v[252:255]
  ds_read_b64_tr_b16 v[56:57], v13 offset:57344
  v_mfma_f32_16x16x32_bf16 v[220:223], v[60:63], a[168:171], v[220:223]
  ds_read_b64_tr_b16 v[58:59], v13 offset:58368
  v_mfma_f32_16x16x32_bf16 v[188:191], v[60:63], a[164:167], v[188:191]
  s_waitcnt vmcnt(26) lgkmcnt(6)
  v_mfma_f32_16x16x32_bf16 v[156:159], v[60:63], a[160:163], v[156:159]
  buffer_load_dwordx4 v16, s[12:15], s29 offen offset:3072 sc1 lds
  v_mfma_f32_16x16x32_bf16 v[128:131], v[32:35], a[176:179], v[128:131]
  s_add_u32 s29, s29, s49
  ds_read_b64_tr_b16 v[60:61], v14 offset:57344
  v_mov_b32 v8, v64
  v_mfma_f32_16x16x32_bf16 v[160:163], v[32:35], a[180:183], v[160:163]
  s_add_u32 s30, s30, 32768
  ds_read_b64_tr_b16 v[62:63], v14 offset:58368
  v_mov_b32 v9, v65
  v_mfma_f32_16x16x32_bf16 v[132:135], v[36:39], a[176:179], v[132:135]
  s_waitcnt vmcnt(17)
  s_barrier
  v_mfma_f32_16x16x32_bf16 v[164:167], v[36:39], a[180:183], v[164:167]
  s_mov_b32 m0, s30
  ds_read_b128 a[128:131], v3 offset:0
  v_mov_b32 v10, v66
  v_mfma_f32_16x16x32_bf16 v[136:139], v[40:43], a[176:179], v[136:139]
  buffer_load_dwordx4 v5, s[12:15], s29 offen sc1 lds
  v_mfma_f32_16x16x32_bf16 v[168:171], v[40:43], a[180:183], v[168:171]
  ds_read_b128 a[132:135], v3 offset:1024
  v_mov_b32 v11, v67
  v_mfma_f32_16x16x32_bf16 v[140:143], v[44:47], a[176:179], v[140:143]
  ds_read_b128 a[136:139], v3 offset:2048
  v_mov_b32 v26, v74
  v_mfma_f32_16x16x32_bf16 v[172:175], v[44:47], a[180:183], v[172:175]
  s_waitcnt lgkmcnt(3)
  v_mov_b32 v27, v74
  v_add_u32 v12, s52, v2
  v_mfma_f32_16x16x32_bf16 v[144:147], v[48:51], a[176:179], v[144:147]
  buffer_load_dwordx4 v6, s[12:15], s29 offen offset:1024 sc1 lds
  v_mfma_f32_16x16x32_bf16 v[176:179], v[48:51], a[180:183], v[176:179]
  ds_read_b128 a[140:143], v3 offset:3072
  v_add_u32 v13, s53, v2
  v_mfma_f32_16x16x32_bf16 v[148:151], v[52:55], a[176:179], v[148:151]
  ds_read_b128 a[144:147], v3 offset:4096
  v_cvt_pk_bf16_f32 v64, v128, v129
  v_mfma_f32_16x16x32_bf16 v[180:183], v[52:55], a[180:183], v[180:183]
  ds_read_b128 a[148:151], v3 offset:5120
  v_cvt_pk_bf16_f32 v65, v130, v131
  v_mfma_f32_16x16x32_bf16 v[152:155], v[56:59], a[176:179], v[152:155]
  buffer_load_dwordx4 v15, s[12:15], s29 offen offset:2048 sc1 lds
  v_mfma_f32_16x16x32_bf16 v[184:187], v[56:59], a[180:183], v[184:187]
  ds_read_b128 a[152:155], v3 offset:6144
  v_cvt_pk_bf16_f32 v66, v132, v133
  v_mfma_f32_16x16x32_bf16 v[156:159], v[60:63], a[176:179], v[156:159]
  ds_read_b128 a[156:159], v3 offset:7168
  v_cvt_pk_bf16_f32 v67, v134, v135
  v_mfma_f32_16x16x32_bf16 v[188:191], v[60:63], a[180:183], v[188:191]
  v_cvt_pk_bf16_f32 v68, v136, v137
  v_cvt_pk_bf16_f32 v69, v138, v139
  v_mfma_f32_16x16x32_bf16 v[192:195], v[32:35], a[184:187], v[192:195]
  buffer_load_dwordx4 v16, s[12:15], s29 offen offset:3072 sc1 lds
  v_mfma_f32_16x16x32_bf16 v[224:227], v[32:35], a[188:191], v[224:227]
  v_cvt_pk_bf16_f32 v70, v140, v141
  v_cvt_pk_bf16_f32 v71, v142, v143
  v_mfma_f32_16x16x32_bf16 v[196:199], v[36:39], a[184:187], v[196:199]
  v_cvt_pk_bf16_f32 v72, v144, v145
  v_cvt_pk_bf16_f32 v73, v146, v147
  v_mfma_f32_16x16x32_bf16 v[228:231], v[36:39], a[188:191], v[228:231]
  v_cvt_pk_bf16_f32 v74, v148, v149
  v_cvt_pk_bf16_f32 v75, v150, v151
  v_mfma_f32_16x16x32_bf16 v[200:203], v[40:43], a[184:187], v[200:203]
  v_cvt_pk_bf16_f32 v76, v152, v153
  v_cvt_pk_bf16_f32 v77, v154, v155
  v_mfma_f32_16x16x32_bf16 v[232:235], v[40:43], a[188:191], v[232:235]
  v_cvt_pk_bf16_f32 v78, v156, v157
  v_cvt_pk_bf16_f32 v79, v158, v159
  v_mfma_f32_16x16x32_bf16 v[204:207], v[44:47], a[184:187], v[204:207]
  v_cvt_pk_bf16_f32 v80, v160, v161
  v_cvt_pk_bf16_f32 v81, v162, v163
  v_mfma_f32_16x16x32_bf16 v[236:239], v[44:47], a[188:191], v[236:239]
  v_cvt_pk_bf16_f32 v82, v164, v165
  v_cvt_pk_bf16_f32 v83, v166, v167
  v_mfma_f32_16x16x32_bf16 v[208:211], v[48:51], a[184:187], v[208:211]
  v_cvt_pk_bf16_f32 v84, v168, v169
  v_cvt_pk_bf16_f32 v85, v170, v171
  v_mfma_f32_16x16x32_bf16 v[240:243], v[48:51], a[188:191], v[240:243]
  v_cvt_pk_bf16_f32 v86, v172, v173
  v_cvt_pk_bf16_f32 v87, v174, v175
  v_mfma_f32_16x16x32_bf16 v[212:215], v[52:55], a[184:187], v[212:215]
  v_cvt_pk_bf16_f32 v88, v176, v177
  v_cvt_pk_bf16_f32 v89, v178, v179
  v_mfma_f32_16x16x32_bf16 v[244:247], v[52:55], a[188:191], v[244:247]
  v_cvt_pk_bf16_f32 v90, v180, v181
  v_cvt_pk_bf16_f32 v91, v182, v183
  v_mfma_f32_16x16x32_bf16 v[216:219], v[56:59], a[184:187], v[216:219]
  v_cvt_pk_bf16_f32 v92, v184, v185
  v_cvt_pk_bf16_f32 v93, v186, v187
  v_mfma_f32_16x16x32_bf16 v[248:251], v[56:59], a[188:191], v[248:251]
  v_cvt_pk_bf16_f32 v94, v188, v189
  v_cvt_pk_bf16_f32 v95, v190, v191
  v_mfma_f32_16x16x32_bf16 v[220:223], v[60:63], a[184:187], v[220:223]
  v_cvt_pk_bf16_f32 v192, v192, v193
  v_cvt_pk_bf16_f32 v193, v194, v195
  v_mfma_f32_16x16x32_bf16 v[252:255], v[60:63], a[188:191], v[252:255]
  s_waitcnt lgkmcnt(0)
  v_cvt_pk_bf16_f32 v194, v196, v197
  v_cvt_pk_bf16_f32 v195, v198, v199
  v_mfma_f32_16x16x32_bf16 v[32:35], a[128:131], v[64:67], v[112:115]
  v_cvt_pk_bf16_f32 v196, v200, v201
  v_cvt_pk_bf16_f32 v197, v202, v203
  v_mfma_f32_16x16x32_bf16 v[32:35], a[132:135], v[68:71], v[32:35]
  v_cvt_pk_bf16_f32 v198, v204, v205
  v_cvt_pk_bf16_f32 v199, v206, v207
  v_mfma_f32_16x16x32_bf16 v[32:35], a[136:139], v[72:75], v[32:35]
  v_cvt_pk_bf16_f32 v200, v208, v209
  v_cvt_pk_bf16_f32 v201, v210, v211
  v_mfma_f32_16x16x32_bf16 v[32:35], a[140:143], v[76:79], v[32:35]
  v_cvt_pk_bf16_f32 v202, v212, v213
  v_cvt_pk_bf16_f32 v203, v214, v215
  v_mfma_f32_16x16x32_bf16 v[36:39], a[144:147], v[64:67], v[116:119]
  v_cvt_pk_bf16_f32 v204, v216, v217
  v_cvt_pk_bf16_f32 v205, v218, v219
  v_mfma_f32_16x16x32_bf16 v[36:39], a[148:151], v[68:71], v[36:39]
  v_cvt_pk_bf16_f32 v206, v220, v221
  v_cvt_pk_bf16_f32 v207, v222, v223
  v_mfma_f32_16x16x32_bf16 v[36:39], a[152:155], v[72:75], v[36:39]
  v_cvt_pk_bf16_f32 v208, v224, v225
  v_cvt_pk_bf16_f32 v209, v226, v227
  v_mfma_f32_16x16x32_bf16 v[36:39], a[156:159], v[76:79], v[36:39]
  v_cvt_pk_bf16_f32 v210, v228, v229
  v_cvt_pk_bf16_f32 v211, v230, v231
  v_mfma_f32_16x16x32_bf16 v[40:43], a[128:131], v[80:83], v[120:123]
  v_cvt_pk_bf16_f32 v212, v232, v233
  v_cvt_pk_bf16_f32 v213, v234, v235
  v_mfma_f32_16x16x32_bf16 v[40:43], a[132:135], v[84:87], v[40:43]
  v_cvt_pk_bf16_f32 v214, v236, v237
  v_cvt_pk_bf16_f32 v215, v238, v239
  v_mfma_f32_16x16x32_bf16 v[40:43], a[136:139], v[88:91], v[40:43]
  v_cvt_pk_bf16_f32 v216, v240, v241
  v_cvt_pk_bf16_f32 v217, v242, v243
  v_mfma_f32_16x16x32_bf16 v[40:43], a[140:143], v[92:95], v[40:43]
  v_cvt_pk_bf16_f32 v218, v244, v245
  v_cvt_pk_bf16_f32 v219, v246, v247
  v_mfma_f32_16x16x32_bf16 v[44:47], a[144:147], v[80:83], v[124:127]
  v_cvt_pk_bf16_f32 v220, v248, v249
  v_cvt_pk_bf16_f32 v221, v250, v251
  v_mfma_f32_16x16x32_bf16 v[44:47], a[148:151], v[84:87], v[44:47]
  v_cvt_pk_bf16_f32 v222, v252, v253
  v_cvt_pk_bf16_f32 v223, v254, v255
  v_mfma_f32_16x16x32_bf16 v[44:47], a[152:155], v[88:91], v[44:47]
  v_mfma_f32_16x16x32_bf16 v[44:47], a[156:159], v[92:95], v[44:47]
  v_mfma_f32_16x16x32_bf16 v[48:51], a[128:131], v[192:195], 0
  ds_read_b128 a[160:163], v4 offset:8192
  v_max3_f32 v28, v32, v33, v34
  v_max3_f32 v28, v28, v35, v36
  v_mfma_f32_16x16x32_bf16 v[48:51], a[132:135], v[196:199], v[48:51]
  ds_read_b128 a[164:167], v4 offset:9216
  v_max3_f32 v28, v28, v37, v38
  v_mfma_f32_16x16x32_bf16 v[48:51], a[136:139], v[200:203], v[48:51]
  ds_read_b128 a[168:171], v4 offset:10240
  v_max_f32 v28, v28, v39
  v_mfma_f32_16x16x32_bf16 v[48:51], a[140:143], v[204:207], v[48:51]
  ds_read_b128 a[172:175], v4 offset:11264
  v_max3_f32 v29, v40, v41, v42
  v_max3_f32 v29, v29, v43, v44
  v_mfma_f32_16x16x32_bf16 v[52:55], a[144:147], v[192:195], 0
  ds_read_b128 a[176:179], v4 offset:12288
  v_max3_f32 v29, v29, v45, v46
  v_max_f32 v29, v29, v47
  v_mfma_f32_16x16x32_bf16 v[52:55], a[148:151], v[196:199], v[52:55]
  ds_read_b128 a[180:183], v4 offset:13312
  v_mov_b32 v30, v28
  v_mov_b32 v31, v29
  v_mfma_f32_16x16x32_bf16 v[52:55], a[152:155], v[200:203], v[52:55]
  ds_read_b128 a[184:187], v4 offset:14336
  s_nop 0
  v_permlane16_swap_b32 v28, v30
  v_mfma_f32_16x16x32_bf16 v[52:55], a[156:159], v[204:207], v[52:55]
  ds_read_b128 a[188:191], v4 offset:15360
  v_permlane16_swap_b32 v29, v31
  v_max_f32 v28, v28, v30
  v_mfma_f32_16x16x32_bf16 v[56:59], a[128:131], v[208:211], 0
  ds_read_b128 a[128:131], v3 offset:16384
  v_max_f32 v29, v29, v31
  v_mfma_f32_16x16x32_bf16 v[56:59], a[132:135], v[212:215], v[56:59]
  ds_read_b128 a[132:135], v3 offset:17408
  v_mov_b32 v30, v28
  v_mfma_f32_16x16x32_bf16 v[56:59], a[136:139], v[216:219], v[56:59]
  ds_read_b128 a[136:139], v3 offset:18432
  v_mov_b32 v31, v29
  v_mfma_f32_16x16x32_bf16 v[56:59], a[140:143], v[220:223], v[56:59]
  ds_read_b128 a[140:143], v3 offset:19456
  s_nop 0
  v_mfma_f32_16x16x32_bf16 v[60:63], a[144:147], v[208:211], 0
  ds_read_b128 a[144:147], v3 offset:20480
  v_permlane32_swap_b32 v28, v30
  v_mfma_f32_16x16x32_bf16 v[60:63], a[148:151], v[212:215], v[60:63]
  ds_read_b128 a[148:151], v3 offset:21504
  v_permlane32_swap_b32 v29, v31
  v_mfma_f32_16x16x32_bf16 v[60:63], a[152:155], v[216:219], v[60:63]
  ds_read_b128 a[152:155], v3 offset:22528
  v_max_f32 v28, v28, v30
  v_mfma_f32_16x16x32_bf16 v[60:63], a[156:159], v[220:223], v[60:63]
  ds_read_b128 a[156:159], v3 offset:23552
  v_max_f32 v29, v29, v31
  s_add_u32 m0, s30, 4096
  s_add_u32 s29, s29, s48
  v_pk_add_f32 v[32:33], v[32:33], v[28:29] op_sel:[0,0] op_sel_hi:[1,0] neg_lo:[0,1] neg_hi:[0,1]
  v_pk_add_f32 v[34:35], v[34:35], v[28:29] op_sel:[0,0] op_sel_hi:[1,0] neg_lo:[0,1] neg_hi:[0,1]
  v_pk_add_f32 v[36:37], v[36:37], v[28:29] op_sel:[0,0] op_sel_hi:[1,0] neg_lo:[0,1] neg_hi:[0,1]
  v_pk_add_f32 v[38:39], v[38:39], v[28:29] op_sel:[0,0] op_sel_hi:[1,0] neg_lo:[0,1] neg_hi:[0,1]
  v_pk_add_f32 v[40:41], v[40:41], v[28:29] op_sel:[0,1] op_sel_hi:[1,1] neg_lo:[0,1] neg_hi:[0,1]
  v_pk_add_f32 v[42:43], v[42:43], v[28:29] op_sel:[0,1] op_sel_hi:[1,1] neg_lo:[0,1] neg_hi:[0,1]
  v_pk_add_f32 v[44:45], v[44:45], v[28:29] op_sel:[0,1] op_sel_hi:[1,1] neg_lo:[0,1] neg_hi:[0,1]
  v_pk_add_f32 v[46:47], v[46:47], v[28:29] op_sel:[0,1] op_sel_hi:[1,1] neg_lo:[0,1] neg_hi:[0,1]
  v_pk_mul_f32 v[144:145], v[28:29], -1.0 op_sel:[0,0] op_sel_hi:[0,0]
  v_pk_mul_f32 v[146:147], v[28:29], -1.0 op_sel:[0,0] op_sel_hi:[0,0]
  v_pk_mul_f32 v[148:149], v[28:29], -1.0 op_sel:[0,0] op_sel_hi:[0,0]
  v_pk_mul_f32 v[150:151], v[28:29], -1.0 op_sel:[0,0] op_sel_hi:[0,0]
  v_pk_mul_f32 v[152:153], v[28:29], -1.0 op_sel:[1,0] op_sel_hi:[1,0]
  v_pk_mul_f32 v[154:155], v[28:29], -1.0 op_sel:[1,0] op_sel_hi:[1,0]
  v_pk_mul_f32 v[156:157], v[28:29], -1.0 op_sel:[1,0] op_sel_hi:[1,0]
  v_pk_mul_f32 v[158:159], v[28:29], -1.0 op_sel:[1,0] op_sel_hi:[1,0]
  v_pk_mul_f32 v[128:129], v[28:29], -1.0 op_sel:[0,0] op_sel_hi:[0,0]
  v_pk_mul_f32 v[130:131], v[28:29], -1.0 op_sel:[0,0] op_sel_hi:[0,0]
  v_pk_mul_f32 v[132:133], v[28:29], -1.0 op_sel:[0,0] op_sel_hi:[0,0]
  buffer_load_dwordx4 v5, s[12:15], s29 offen sc1 lds
  v_pk_mul_f32 v[134:135], v[28:29], -1.0 op_sel:[0,0] op_sel_hi:[0,0]
  v_pk_mul_f32 v[136:137], v[28:29], -1.0 op_sel:[1,0] op_sel_hi:[1,0]
  v_pk_mul_f32 v[138:139], v[28:29], -1.0 op_sel:[1,0] op_sel_hi:[1,0]
  v_pk_mul_f32 v[140:141], v[28:29], -1.0 op_sel:[1,0] op_sel_hi:[1,0]
  v_pk_mul_f32 v[142:143], v[28:29], -1.0 op_sel:[1,0] op_sel_hi:[1,0]
  v_exp_f32 v20, v32
  v_exp_f32 v21, v33
  v_exp_f32 v22, v34
  v_cvt_pk_bf16_f32 v112, v20, v21
  v_exp_f32 v23, v35
  v_exp_f32 v24, v36
  v_cvt_pk_bf16_f32 v113, v22, v23
  v_exp_f32 v25, v37
  v_exp_f32 v20, v38
  v_cvt_pk_bf16_f32 v114, v24, v25
  v_exp_f32 v21, v39
  v_exp_f32 v22, v40
  v_cvt_pk_bf16_f32 v115, v20, v21
  v_exp_f32 v23, v41
  buffer_load_dwordx4 v6, s[12:15], s29 offen offset:1024 sc1 lds
  v_exp_f32 v24, v42
  v_cvt_pk_bf16_f32 v116, v22, v23
  v_exp_f32 v25, v43
  v_exp_f32 v20, v44
  v_cvt_pk_bf16_f32 v117, v24, v25
  v_exp_f32 v21, v45
  v_exp_f32 v22, v46
  v_cvt_pk_bf16_f32 v118, v20, v21
  v_exp_f32 v23, v47
  s_nop 0
  v_cvt_pk_bf16_f32 v119, v22, v23
  v_max3_f32 v28, v48, v49, v50
  v_max3_f32 v28, v28, v51, v52
  v_max3_f32 v28, v28, v53, v54
  v_max_f32 v28, v28, v55
  v_max3_f32 v29, v56, v57, v58
  v_max3_f32 v29, v29, v59, v60
  v_max3_f32 v29, v29, v61, v62
  v_max_f32 v29, v29, v63
  buffer_load_dwordx4 v15, s[12:15], s29 offen offset:2048 sc1 lds
  v_mov_b32 v30, v28
  v_mov_b32 v31, v29
  s_nop 0
  v_permlane16_swap_b32 v28, v30
  v_permlane16_swap_b32 v29, v31
  v_max_f32 v28, v28, v30
  v_max_f32 v29, v29, v31
  v_mov_b32 v30, v28
  v_mov_b32 v31, v29
  s_nop 0
  v_permlane32_swap_b32 v28, v30
  v_permlane32_swap_b32 v29, v31
  v_max_f32 v28, v28, v30
  v_max_f32 v29, v29, v31
  v_pk_add_f32 v[48:49], v[48:49], v[28:29] op_sel:[0,0] op_sel_hi:[1,0] neg_lo:[0,1] neg_hi:[0,1]
  v_pk_add_f32 v[50:51], v[50:51], v[28:29] op_sel:[0,0] op_sel_hi:[1,0] neg_lo:[0,1] neg_hi:[0,1]
  v_pk_add_f32 v[52:53], v[52:53], v[28:29] op_sel:[0,0] op_sel_hi:[1,0] neg_lo:[0,1] neg_hi:[0,1]
  v_pk_add_f32 v[54:55], v[54:55], v[28:29] op_sel:[0,0] op_sel_hi:[1,0] neg_lo:[0,1] neg_hi:[0,1]
  v_pk_add_f32 v[56:57], v[56:57], v[28:29] op_sel:[0,1] op_sel_hi:[1,1] neg_lo:[0,1] neg_hi:[0,1]
  buffer_load_dwordx4 v16, s[12:15], s29 offen offset:3072 sc1 lds
  s_add_u32 s29, s29, s49
  s_add_u32 s30, s30, 32768
  v_pk_add_f32 v[58:59], v[58:59], v[28:29] op_sel:[0,1] op_sel_hi:[1,1] neg_lo:[0,1] neg_hi:[0,1]
  v_pk_add_f32 v[60:61], v[60:61], v[28:29] op_sel:[0,1] op_sel_hi:[1,1] neg_lo:[0,1] neg_hi:[0,1]
  v_pk_add_f32 v[62:63], v[62:63], v[28:29] op_sel:[0,1] op_sel_hi:[1,1] neg_lo:[0,1] neg_hi:[0,1]
  v_pk_mul_f32 v[176:177], v[28:29], -1.0 op_sel:[0,0] op_sel_hi:[0,0]
  v_pk_mul_f32 v[178:179], v[28:29], -1.0 op_sel:[0,0] op_sel_hi:[0,0]
  v_pk_mul_f32 v[180:181], v[28:29], -1.0 op_sel:[0,0] op_sel_hi:[0,0]
  v_pk_mul_f32 v[182:183], v[28:29], -1.0 op_sel:[0,0] op_sel_hi:[0,0]
  v_pk_mul_f32 v[184:185], v[28:29], -1.0 op_sel:[1,0] op_sel_hi:[1,0]
  v_pk_mul_f32 v[186:187], v[28:29], -1.0 op_sel:[1,0] op_sel_hi:[1,0]
  v_pk_mul_f32 v[188:189], v[28:29], -1.0 op_sel:[1,0] op_sel_hi:[1,0]
  v_pk_mul_f32 v[190:191], v[28:29], -1.0 op_sel:[1,0] op_sel_hi:[1,0]
  v_pk_mul_f32 v[160:161], v[28:29], -1.0 op_sel:[0,0] op_sel_hi:[0,0]
  v_pk_mul_f32 v[162:163], v[28:29], -1.0 op_sel:[0,0] op_sel_hi:[0,0]
  v_pk_mul_f32 v[164:165], v[28:29], -1.0 op_sel:[0,0] op_sel_hi:[0,0]
  v_pk_mul_f32 v[166:167], v[28:29], -1.0 op_sel:[0,0] op_sel_hi:[0,0]
  v_pk_mul_f32 v[168:169], v[28:29], -1.0 op_sel:[1,0] op_sel_hi:[1,0]
  v_pk_mul_f32 v[170:171], v[28:29], -1.0 op_sel:[1,0] op_sel_hi:[1,0]
  v_pk_mul_f32 v[172:173], v[28:29], -1.0 op_sel:[1,0] op_sel_hi:[1,0]
  v_pk_mul_f32 v[174:175], v[28:29], -1.0 op_sel:[1,0] op_sel_hi:[1,0]
  s_cmp_eq_u32 s42, 1
  s_cbranch_scc1 L_mask0
L_mask0d:
  s_waitcnt vmcnt(17) lgkmcnt(0)
  s_barrier
  s_lshl_b32 s23, s2, 2
  s_add_u32 s23, s23, s20
  s_lshl_b32 s23, s23, 12
  v_lshl_add_u32 v31, v18, 5, s23
  s_mov_b32 s76, s50
  s_mov_b32 s77, s51
  v_mfma_f32_16x16x32_bf16 v[32:35], a[128:131], v[64:67], v[144:147]
  buffer_load_dword v19, v18, s[8:11], s26 offen sc1
  v_exp_f32 v20, v48
  v_mfma_f32_16x16x32_bf16 v[32:35], a[132:135], v[68:71], v[32:35]
  s_mov_b32 m0, s30
  v_exp_f32 v21, v49
  v_mfma_f32_16x16x32_bf16 v[32:35], a[136:139], v[72:75], v[32:35]
  buffer_load_dwordx4 v5, s[12:15], s29 offen sc1 lds
  v_mfma_f32_16x16x32_bf16 v[32:35], a[140:143], v[76:79], v[32:35]
  v_exp_f32 v22, v50
  v_mfma_f32_16x16x32_bf16 v[36:39], a[144:147], v[64:67], v[148:151]
  v_cvt_pk_bf16_f32 v120, v20, v21
  v_mfma_f32_16x16x32_bf16 v[36:39], a[148:151], v[68:71], v[36:39]
  buffer_load_dwordx4 a[192:195], v2, s[4:7], s34 offen sc1
  v_mfma_f32_16x16x32_bf16 v[36:39], a[152:155], v[72:75], v[36:39]
  v_exp_f32 v23, v51
  v_mfma_f32_16x16x32_bf16 v[36:39], a[156:159], v[76:79], v[36:39]
  buffer_load_dwordx4 v6, s[12:15], s29 offen offset:1024 sc1 lds
  v_mfma_f32_16x16x32_bf16 v[40:43], a[128:131], v[80:83], v[152:155]
  v_exp_f32 v24, v52
  v_mfma_f32_16x16x32_bf16 v[40:43], a[132:135], v[84:87], v[40:43]
  v_cvt_pk_bf16_f32 v121, v22, v23
  v_mfma_f32_16x16x32_bf16 v[40:43], a[136:139], v[88:91], v[40:43]
  buffer_load_dwordx4 a[196:199], v2, s[4:7], s34 offen offset:1024 sc1
  v_mfma_f32_16x16x32_bf16 v[40:43], a[140:143], v[92:95], v[40:43]
  v_exp_f32 v25, v53
  v_mfma_f32_16x16x32_bf16 v[44:47], a[144:147], v[80:83], v[156:159]
  buffer_load_dwordx4 v15, s[12:15], s29 offen offset:2048 sc1 lds
  v_mfma_f32_16x16x32_bf16 v[44:47], a[148:151], v[84:87], v[44:47]
  v_exp_f32 v20, v54
  v_mfma_f32_16x16x32_bf16 v[44:47], a[152:155], v[88:91], v[44:47]
  s_waitcnt lgkmcnt(0)
  v_cvt_pk_bf16_f32 v122, v24, v25
  v_mfma_f32_16x16x32_bf16 v[44:47], a[156:159], v[92:95], v[44:47]
  v_exp_f32 v21, v55
  v_mfma_f32_16x16x32_bf16 a[0:3], a[160:163], v[112:115], 0
  v_exp_f32 v22, v56
  v_mfma_f32_16x16x32_bf16 a[4:7], a[164:167], v[112:115], 0
  buffer_load_dwordx4 v16, s[12:15], s29 offen offset:3072 sc1 lds
  v_mfma_f32_16x16x32_bf16 a[8:11], a[168:171], v[112:115], 0
  v_cvt_pk_bf16_f32 v123, v20, v21
  v_mfma_f32_16x16x32_bf16 a[12:15], a[172:175], v[112:115], 0
  buffer_load_dwordx4 a[200:203], v2, s[4:7], s34 offen offset:2048 sc1
  v_mfma_f32_16x16x32_bf16 a[16:19], a[176:179], v[112:115], 0
  s_add_u32 m0, s30, 4096
  v_exp_f32 v23, v57
  v_mfma_f32_16x16x32_bf16 a[20:23], a[180:183], v[112:115], 0
  s_add_u32 s29, s29, s48
  v_exp_f32 v24, v58
  v_mfma_f32_16x16x32_bf16 a[24:27], a[184:187], v[112:115], 0
  buffer_load_dwordx4 v5, s[12:15], s29 offen sc1 lds
  v_mfma_f32_16x16x32_bf16 a[28:31], a[188:191], v[112:115], 0
  s_add_u32 s31, s31, 32768
  v_cvt_pk_bf16_f32 v124, v22, v23
  v_mfma_f32_16x16x32_bf16 a[32:35], a[160:163], v[116:119], 0
  s_cmp_ge_u32 s31, 163840
  v_exp_f32 v25, v59
  v_mfma_f32_16x16x32_bf16 a[36:39], a[164:167], v[116:119], 0
  s_cselect_b32 s24, 163840, 0
  v_exp_f32 v20, v60
  v_mfma_f32_16x16x32_bf16 a[40:43], a[168:171], v[116:119], 0
  s_sub_u32 s31, s31, s24
  v_cvt_pk_bf16_f32 v125, v24, v25
  v_mfma_f32_16x16x32_bf16 a[44:47], a[172:175], v[116:119], 0
  buffer_load_dwordx4 v6, s[12:15], s29 offen offset:1024 sc1 lds
  v_mfma_f32_16x16x32_bf16 a[48:51], a[176:179], v[116:119], 0
  v_exp_f32 v21, v61
  v_mfma_f32_16x16x32_bf16 a[52:55], a[180:183], v[116:119], 0
  v_exp_f32 v22, v62
  v_mfma_f32_16x16x32_bf16 a[56:59], a[184:187], v[116:119], 0
  v_cvt_pk_bf16_f32 v126, v20, v21
  v_mfma_f32_16x16x32_bf16 a[60:63], a[188:191], v[116:119], 0
  buffer_load_dwordx4 v15, s[12:15], s29 offen offset:2048 sc1 lds
  v_smfmac_f32_16x16x64_bf16 v[96:99], v[104:107], v[112:119], v108
  v_mfma_f32_16x16x32_bf16 v[48:51], a[128:131], v[192:195], v[176:179]
  v_exp_f32 v23, v63
  v_mfma_f32_16x16x32_bf16 v[48:51], a[132:135], v[196:199], v[48:51]
  buffer_load_dwordx4 a[204:207], v2, s[4:7], s34 offen offset:3072 sc1
  v_mfma_f32_16x16x32_bf16 v[48:51], a[136:139], v[200:203], v[48:51]
  v_exp_f32 v20, v32
  v_mfma_f32_16x16x32_bf16 v[48:51], a[140:143], v[204:207], v[48:51]
  buffer_load_dwordx4 v16, s[12:15], s29 offen offset:3072 sc1 lds
  v_mfma_f32_16x16x32_bf16 v[52:55], a[144:147], v[192:195], v[180:183]
  s_add_u32 s29, s29, s49
  v_cvt_pk_bf16_f32 v127, v22, v23
  v_add_u32 v3, s31, v2
  v_mfma_f32_16x16x32_bf16 v[52:55], a[148:151], v[196:199], v[52:55]
  s_add_u32 s30, s30, 32768
  v_exp_f32 v21, v33
  v_mfma_f32_16x16x32_bf16 v[52:55], a[152:155], v[200:203], v[52:55]
  s_add_u32 s34, s34, 32768
  v_exp_f32 v22, v34
  v_mfma_f32_16x16x32_bf16 v[52:55], a[156:159], v[204:207], v[52:55]
  buffer_load_dwordx4 a[208:211], v2, s[4:7], s34 offen sc1
  v_mfma_f32_16x16x32_bf16 v[56:59], a[128:131], v[208:211], v[184:187]
  s_cmp_ge_u32 s30, 163840
  ds_read_b128 a[128:131], v3 offset:0
  v_cvt_pk_bf16_f32 v112, v20, v21
  v_mfma_f32_16x16x32_bf16 v[56:59], a[132:135], v[212:215], v[56:59]
  s_cselect_b32 s23, 163840, 0
  v_exp_f32 v23, v35
  v_mfma_f32_16x16x32_bf16 v[56:59], a[136:139], v[216:219], v[56:59]
  s_sub_u32 s30, s30, s23
  ds_read_b128 a[132:135], v3 offset:1024
  v_exp_f32 v24, v36
  v_mfma_f32_16x16x32_bf16 v[56:59], a[140:143], v[220:223], v[56:59]
  buffer_load_dwordx4 a[212:215], v2, s[4:7], s34 offen offset:1024 sc1
  v_mfma_f32_16x16x32_bf16 v[60:63], a[144:147], v[208:211], v[188:191]
  s_add_u32 s32, s32, 1
  ds_read_b128 a[136:139], v3 offset:2048
  v_cvt_pk_bf16_f32 v113, v22, v23
  v_mfma_f32_16x16x32_bf16 v[60:63], a[148:151], v[212:215], v[60:63]
  v_exp_f32 v25, v37
  v_mfma_f32_16x16x32_bf16 v[60:63], a[152:155], v[216:219], v[60:63]
  ds_read_b128 a[140:143], v3 offset:3072
  v_exp_f32 v20, v38
  v_mfma_f32_16x16x32_bf16 v[60:63], a[156:159], v[220:223], v[60:63]
  buffer_load_dwordx4 a[216:219], v2, s[4:7], s34 offen offset:2048 sc1
  v_mfma_f32_16x16x32_bf16 a[64:67], a[160:163], v[120:123], 0
  ds_read_b128 a[144:147], v3 offset:4096
  v_cvt_pk_bf16_f32 v114, v24, v25
  v_mfma_f32_16x16x32_bf16 a[68:71], a[164:167], v[120:123], 0
  v_exp_f32 v21, v39
  v_mfma_f32_16x16x32_bf16 a[72:75], a[168:171], v[120:123], 0
  ds_read_b128 a[148:151], v3 offset:5120
  v_exp_f32 v22, v40
  v_mfma_f32_16x16x32_bf16 a[76:79], a[172:175], v[120:123], 0
  buffer_load_dwordx4 a[220:223], v2, s[4:7], s34 offen offset:3072 sc1
  v_mfma_f32_16x16x32_bf16 a[80:83], a[176:179], v[120:123], 0
  ds_read_b128 a[152:155], v3 offset:6144
  v_cvt_pk_bf16_f32 v115, v20, v21
  v_mfma_f32_16x16x32_bf16 a[84:87], a[180:183], v[120:123], 0
  buffer_load_dword v0, v31, s[76:79], 0 offen
  v_exp_f32 v23, v41
  v_mfma_f32_16x16x32_bf16 a[88:91], a[184:187], v[120:123], 0
  ds_read_b128 a[156:159], v3 offset:7168
  v_mfma_f32_16x16x32_bf16 a[92:95], a[188:191], v[120:123], 0
  v_exp_f32 v24, v42
  v_mfma_f32_16x16x32_bf16 a[96:99], a[160:163], v[124:127], 0
  ds_read_b128 a[160:163], v4 offset:24576
  v_cvt_pk_bf16_f32 v116, v22, v23
  v_mfma_f32_16x16x32_bf16 a[100:103], a[164:167], v[124:127], 0
  ds_read_b128 a[164:167], v4 offset:25600
  v_exp_f32 v25, v43
  v_mfma_f32_16x16x32_bf16 a[104:107], a[168:171], v[124:127], 0
  ds_read_b128 a[168:171], v4 offset:26624
  v_exp_f32 v20, v44
  v_mfma_f32_16x16x32_bf16 a[108:111], a[172:175], v[124:127], 0
  ds_read_b128 a[172:175], v4 offset:27648
  v_cvt_pk_bf16_f32 v117, v24, v25
  v_mfma_f32_16x16x32_bf16 a[112:115], a[176:179], v[124:127], 0
  ds_read_b128 a[176:179], v4 offset:28672
  v_exp_f32 v21, v45
  v_mfma_f32_16x16x32_bf16 a[116:119], a[180:183], v[124:127], 0
  ds_read_b128 a[180:183], v4 offset:29696
  v_exp_f32 v22, v46
  v_mfma_f32_16x16x32_bf16 a[120:123], a[184:187], v[124:127], 0
  ds_read_b128 a[184:187], v4 offset:30720
  v_cvt_pk_bf16_f32 v118, v20, v21
  v_mfma_f32_16x16x32_bf16 a[124:127], a[188:191], v[124:127], 0
  ds_read_b128 a[188:191], v4 offset:31744
  v_exp_f32 v23, v47
  v_smfmac_f32_16x16x64_bf16 v[100:103], v[104:107], v[120:127], v108
  s_waitcnt lgkmcnt(8)
  v_cvt_pk_bf16_f32 v119, v22, v23
  s_waitcnt vmcnt(17)
  v_cmp_gt_u32 vcc, 2, v19
  s_cbranch_vccnz L_spin_23
L_back_24:
  s_cmp_eq_u32 s3, 0
  s_cbranch_scc1 L_acq_25
L_acqd_26:
  s_bitcmp0_b64 s[46:47], s32
  s_branch L_dual_end
L_mask0:
  s_bitcmp1_b32 s44, 0
  s_cbranch_scc1 L_odd_27
  v_pk_add_f32 v[128:129], v[128:129], v[8:9]
  v_pk_add_f32 v[130:131], v[130:131], v[10:11]
  v_pk_add_f32 v[140:141], v[140:141], v[8:9]
  v_pk_add_f32 v[142:143], v[142:143], v[10:11]
  v_pk_mov_b32 v[132:133], v[26:27], v[26:27]
  v_pk_mov_b32 v[134:135], v[26:27], v[26:27]
  v_pk_mov_b32 v[144:145], v[26:27], v[26:27]
  v_pk_mov_b32 v[146:147], v[26:27], v[26:27]
  v_pk_mov_b32 v[148:149], v[26:27], v[26:27]
  v_pk_mov_b32 v[150:151], v[26:27], v[26:27]
  v_pk_mov_b32 v[152:153], v[26:27], v[26:27]
  v_pk_mov_b32 v[154:155], v[26:27], v[26:27]
  v_pk_mov_b32 v[156:157], v[26:27], v[26:27]
  v_pk_mov_b32 v[158:159], v[26:27], v[26:27]
  s_branch L_mask0d
L_odd_27:
  v_pk_add_f32 v[144:145], v[144:145], v[8:9]
  v_pk_add_f32 v[146:147], v[146:147], v[10:11]
  v_pk_add_f32 v[156:157], v[156:157], v[8:9]
  v_pk_add_f32 v[158:159], v[158:159], v[10:11]
  v_pk_mov_b32 v[148:149], v[26:27], v[26:27]
  v_pk_mov_b32 v[150:151], v[26:27], v[26:27]
  s_branch L_mask0d
.p2align 6
L_dual:
  v_mfma_f32_16x16x32_bf16 v[32:35], a[128:131], v[64:67], v[128:131]
  v_mov_b32 v4, v3
  v_mfma_f32_16x16x32_bf16 v[32:35], a[132:135], v[68:71], v[32:35]
  v_exp_f32 v20, v48
  v_mfma_f32_16x16x32_bf16 v[32:35], a[136:139], v[72:75], v[32:35]
  v_exp_f32 v21, v49
  v_mfma_f32_16x16x32_bf16 v[32:35], a[140:143], v[76:79], v[32:35]
  v_exp_f32 v22, v50
  v_mfma_f32_16x16x32_bf16 v[36:39], a[144:147], v[64:67], v[132:135]
  v_cvt_pk_bf16_f32 v120, v20, v21
  v_mfma_f32_16x16x32_bf16 v[36:39], a[148:151], v[68:71], v[36:39]
  v_exp_f32 v23, v51
  v_mfma_f32_16x16x32_bf16 v[36:39], a[152:155], v[72:75], v[36:39]
  v_exp_f32 v24, v52
  v_mfma_f32_16x16x32_bf16 v[36:39], a[156:159], v[76:79], v[36:39]
  v_cvt_pk_bf16_f32 v121, v22, v23
  v_mfma_f32_16x16x32_bf16 v[40:43], a[128:131], v[80:83], v[136:139]
  v_exp_f32 v25, v53
  v_mfma_f32_16x16x32_bf16 v[40:43], a[132:135], v[84:87], v[40:43]
  v_exp_f32 v20, v54
  v_mfma_f32_16x16x32_bf16 v[40:43], a[136:139], v[88:91], v[40:43]
  v_cvt_pk_bf16_f32 v122, v24, v25
  v_mfma_f32_16x16x32_bf16 v[40:43], a[140:143], v[92:95], v[40:43]
  v_exp_f32 v21, v55
  v_mfma_f32_16x16x32_bf16 v[44:47], a[144:147], v[80:83], v[140:143]
  v_exp_f32 v22, v56
  v_mfma_f32_16x16x32_bf16 v[44:47], a[148:151], v[84:87], v[44:47]
  v_cvt_pk_bf16_f32 v123, v20, v21
  v_mfma_f32_16x16x32_bf16 v[44:47], a[152:155], v[88:91], v[44:47]
  v_exp_f32 v23, v57
  v_mfma_f32_16x16x32_bf16 v[44:47], a[156:159], v[92:95], v[44:47]
  s_waitcnt vmcnt(16) lgkmcnt(0)
  s_barrier
  v_mfma_f32_16x16x32_bf16 a[0:3], a[160:163], v[112:115], a[0:3]
  v_exp_f32 v24, v58
  v_mfma_f32_16x16x32_bf16 a[4:7], a[164:167], v[112:115], a[4:7]
  v_cvt_pk_bf16_f32 v124, v22, v23
  v_mfma_f32_16x16x32_bf16 a[8:11], a[168:171], v[112:115], a[8:11]
  v_exp_f32 v25, v59
  v_mfma_f32_16x16x32_bf16 a[12:15], a[172:175], v[112:115], a[12:15]
  v_exp_f32 v20, v60
  v_mfma_f32_16x16x32_bf16 a[16:19], a[176:179], v[112:115], a[16:19]
  v_cvt_pk_bf16_f32 v125, v24, v25
  v_mfma_f32_16x16x32_bf16 a[20:23], a[180:183], v[112:115], a[20:23]
  v_exp_f32 v21, v61
  v_mfma_f32_16x16x32_bf16 a[24:27], a[184:187], v[112:115], a[24:27]
  v_exp_f32 v22, v62
  v_mfma_f32_16x16x32_bf16 a[28:31], a[188:191], v[112:115], a[28:31]
  v_cvt_pk_bf16_f32 v126, v20, v21
  v_mfma_f32_16x16x32_bf16 a[32:35], a[160:163], v[116:119], a[32:35]
  v_exp_f32 v23, v63
  v_mfma_f32_16x16x32_bf16 a[36:39], a[164:167], v[116:119], a[36:39]
  v_exp_f32 v20, v32
  v_mfma_f32_16x16x32_bf16 a[40:43], a[168:171], v[116:119], a[40:43]
  v_cvt_pk_bf16_f32 v127, v22, v23
  v_mfma_f32_16x16x32_bf16 a[44:47], a[172:175], v[116:119], a[44:47]
  v_exp_f32 v21, v33
  v_mfma_f32_16x16x32_bf16 a[48:51], a[176:179], v[116:119], a[48:51]
  v_exp_f32 v22, v34
  v_mfma_f32_16x16x32_bf16 a[52:55], a[180:183], v[116:119], a[52:55]
  v_mfma_f32_16x16x32_bf16 a[56:59], a[184:187], v[116:119], a[56:59]
  v_mfma_f32_16x16x32_bf16 a[60:63], a[188:191], v[116:119], a[60:63]
  v_smfmac_f32_16x16x64_bf16 v[96:99], v[104:107], v[112:119], v108
  v_cvt_pk_bf16_f32 v112, v20, v21
  v_mfma_f32_16x16x32_bf16 v[48:51], a[128:131], v[192:195], v[160:163]
  v_exp_f32 v23, v35
  v_mfma_f32_16x16x32_bf16 v[48:51], a[132:135], v[196:199], v[48:51]
  v_exp_f32 v24, v36
  v_mfma_f32_16x16x32_bf16 v[48:51], a[136:139], v[200:203], v[48:51]
  v_cvt_pk_bf16_f32 v113, v22, v23
  v_mfma_f32_16x16x32_bf16 v[48:51], a[140:143], v[204:207], v[48:51]
  v_exp_f32 v25, v37
  v_mfma_f32_16x16x32_bf16 v[52:55], a[144:147], v[192:195], v[164:167]
  v_exp_f32 v20, v38
  v_mfma_f32_16x16x32_bf16 v[52:55], a[148:151], v[196:199], v[52:55]
  v_cvt_pk_bf16_f32 v114, v24, v25
  v_mfma_f32_16x16x32_bf16 v[52:55], a[152:155], v[200:203], v[52:55]
  v_exp_f32 v21, v39
  v_mfma_f32_16x16x32_bf16 v[52:55], a[156:159], v[204:207], v[52:55]
  v_exp_f32 v22, v40
  v_mfma_f32_16x16x32_bf16 v[56:59], a[128:131], v[208:211], v[168:171]
  ds_read_b128 a[128:131], v3 offset:16384
  v_cvt_pk_bf16_f32 v115, v20, v21
  v_mfma_f32_16x16x32_bf16 v[56:59], a[132:135], v[212:215], v[56:59]
  v_exp_f32 v23, v41
  v_mfma_f32_16x16x32_bf16 v[56:59], a[136:139], v[216:219], v[56:59]
  ds_read_b128 a[132:135], v3 offset:17408
  v_mfma_f32_16x16x32_bf16 v[56:59], a[140:143], v[220:223], v[56:59]
  v_exp_f32 v24, v42
  v_mfma_f32_16x16x32_bf16 v[60:63], a[144:147], v[208:211], v[172:175]
  ds_read_b128 a[136:139], v3 offset:18432
  v_cvt_pk_bf16_f32 v116, v22, v23
  v_mfma_f32_16x16x32_bf16 v[60:63], a[148:151], v[212:215], v[60:63]
  v_exp_f32 v25, v43
  v_mfma_f32_16x16x32_bf16 v[60:63], a[152:155], v[216:219], v[60:63]
  ds_read_b128 a[140:143], v3 offset:19456
  v_mfma_f32_16x16x32_bf16 v[60:63], a[156:159], v[220:223], v[60:63]
  v_exp_f32 v20, v44
  v_mfma_f32_16x16x32_bf16 a[64:67], a[160:163], v[120:123], a[64:67]
  ds_read_b128 a[144:147], v3 offset:20480
  v_cvt_pk_bf16_f32 v117, v24, v25
  v_mfma_f32_16x16x32_bf16 a[68:71], a[164:167], v[120:123], a[68:71]
  v_exp_f32 v21, v45
  v_mfma_f32_16x16x32_bf16 a[72:75], a[168:171], v[120:123], a[72:75]
  ds_read_b128 a[148:151], v3 offset:21504
  v_mfma_f32_16x16x32_bf16 a[76:79], a[172:175], v[120:123], a[76:79]
  v_exp_f32 v22, v46
  v_mfma_f32_16x16x32_bf16 a[80:83], a[176:179], v[120:123], a[80:83]
  ds_read_b128 a[152:155], v3 offset:22528
  v_cvt_pk_bf16_f32 v118, v20, v21
  v_mfma_f32_16x16x32_bf16 a[84:87], a[180:183], v[120:123], a[84:87]
  v_exp_f32 v23, v47
  v_mfma_f32_16x16x32_bf16 a[88:91], a[184:187], v[120:123], a[88:91]
  ds_read_b128 a[156:159], v3 offset:23552
  v_cvt_pk_bf16_f32 v119, v22, v23
  v_mfma_f32_16x16x32_bf16 a[92:95], a[188:191], v[120:123], a[92:95]
  v_mfma_f32_16x16x32_bf16 a[96:99], a[160:163], v[124:127], a[96:99]
  ds_read_b128 a[160:163], v4 offset:8192
  v_mfma_f32_16x16x32_bf16 a[100:103], a[164:167], v[124:127], a[100:103]
  ds_read_b128 a[164:167], v4 offset:9216
  v_mfma_f32_16x16x32_bf16 a[104:107], a[168:171], v[124:127], a[104:107]
  ds_read_b128 a[168:171], v4 offset:10240
  v_mfma_f32_16x16x32_bf16 a[108:111], a[172:175], v[124:127], a[108:111]
  ds_read_b128 a[172:175], v4 offset:11264
  v_mfma_f32_16x16x32_bf16 a[112:115], a[176:179], v[124:127], a[112:115]
  ds_read_b128 a[176:179], v4 offset:12288
  v_mfma_f32_16x16x32_bf16 a[116:119], a[180:183], v[124:127], a[116:119]
  ds_read_b128 a[180:183], v4 offset:13312
  v_mfma_f32_16x16x32_bf16 a[120:123], a[184:187], v[124:127], a[120:123]
  ds_read_b128 a[184:187], v4 offset:14336
  v_mfma_f32_16x16x32_bf16 a[124:127], a[188:191], v[124:127], a[124:127]
  ds_read_b128 a[188:191], v4 offset:15360
  v_smfmac_f32_16x16x64_bf16 v[100:103], v[104:107], v[120:127], v108
  s_waitcnt lgkmcnt(8)
  v_mfma_f32_16x16x32_bf16 v[32:35], a[128:131], v[64:67], v[144:147]
  v_exp_f32 v20, v48
  v_mfma_f32_16x16x32_bf16 v[32:35], a[132:135], v[68:71], v[32:35]
  s_mov_b32 m0, s30
  v_exp_f32 v21, v49
  v_mfma_f32_16x16x32_bf16 v[32:35], a[136:139], v[72:75], v[32:35]
  buffer_load_dwordx4 v5, s[12:15], s29 offen sc1 lds
  v_mfma_f32_16x16x32_bf16 v[32:35], a[140:143], v[76:79], v[32:35]
  v_exp_f32 v22, v50
  v_cvt_pk_bf16_f32 v120, v20, v21
  v_mfma_f32_16x16x32_bf16 v[36:39], a[144:147], v[64:67], v[148:151]
  v_exp_f32 v23, v51
  v_mfma_f32_16x16x32_bf16 v[36:39], a[148:151], v[68:71], v[36:39]
  v_exp_f32 v24, v52
  v_mfma_f32_16x16x32_bf16 v[36:39], a[152:155], v[72:75], v[36:39]
  v_cvt_pk_bf16_f32 v121, v22, v23
  v_mfma_f32_16x16x32_bf16 v[36:39], a[156:159], v[76:79], v[36:39]
  buffer_load_dwordx4 v6, s[12:15], s29 offen offset:1024 sc1 lds
  v_mfma_f32_16x16x32_bf16 v[40:43], a[128:131], v[80:83], v[152:155]
  v_exp_f32 v25, v53
  v_mfma_f32_16x16x32_bf16 v[40:43], a[132:135], v[84:87], v[40:43]
  v_exp_f32 v20, v54
  v_mfma_f32_16x16x32_bf16 v[40:43], a[136:139], v[88:91], v[40:43]
  v_cvt_pk_bf16_f32 v122, v24, v25
  v_mfma_f32_16x16x32_bf16 v[40:43], a[140:143], v[92:95], v[40:43]
  v_exp_f32 v21, v55
  v_mfma_f32_16x16x32_bf16 v[44:47], a[144:147], v[80:83], v[156:159]
  buffer_load_dwordx4 v15, s[12:15], s29 offen offset:2048 sc1 lds
  v_mfma_f32_16x16x32_bf16 v[44:47], a[148:151], v[84:87], v[44:47]
  v_exp_f32 v22, v56
  v_mfma_f32_16x16x32_bf16 v[44:47], a[152:155], v[88:91], v[44:47]
  s_waitcnt lgkmcnt(0)
  v_cvt_pk_bf16_f32 v123, v20, v21
  v_mfma_f32_16x16x32_bf16 v[44:47], a[156:159], v[92:95], v[44:47]
  v_exp_f32 v23, v57
  v_mfma_f32_16x16x32_bf16 a[0:3], a[160:163], v[112:115], a[0:3]
  v_exp_f32 v24, v58
  v_mfma_f32_16x16x32_bf16 a[4:7], a[164:167], v[112:115], a[4:7]
  buffer_load_dwordx4 v16, s[12:15], s29 offen offset:3072 sc1 lds
  v_mfma_f32_16x16x32_bf16 a[8:11], a[168:171], v[112:115], a[8:11]
  v_cvt_pk_bf16_f32 v124, v22, v23
  v_mfma_f32_16x16x32_bf16 a[12:15], a[172:175], v[112:115], a[12:15]
  v_exp_f32 v25, v59
  v_mfma_f32_16x16x32_bf16 a[16:19], a[176:179], v[112:115], a[16:19]
  s_add_u32 m0, s30, 4096
  v_exp_f32 v20, v60
  v_mfma_f32_16x16x32_bf16 a[20:23], a[180:183], v[112:115], a[20:23]
  s_add_u32 s29, s29, s48
  v_cvt_pk_bf16_f32 v125, v24, v25
  v_mfma_f32_16x16x32_bf16 a[24:27], a[184:187], v[112:115], a[24:27]
  buffer_load_dwordx4 v5, s[12:15], s29 offen sc1 lds
  v_mfma_f32_16x16x32_bf16 a[28:31], a[188:191], v[112:115], a[28:31]
  s_add_u32 s31, s31, 32768
  v_exp_f32 v21, v61
  v_mfma_f32_16x16x32_bf16 a[32:35], a[160:163], v[116:119], a[32:35]
  s_cmp_ge_u32 s31, 163840
  v_exp_f32 v22, v62
  v_mfma_f32_16x16x32_bf16 a[36:39], a[164:167], v[116:119], a[36:39]
  s_cselect_b32 s24, 163840, 0
  v_cvt_pk_bf16_f32 v126, v20, v21
  v_mfma_f32_16x16x32_bf16 a[40:43], a[168:171], v[116:119], a[40:43]
  s_sub_u32 s31, s31, s24
  v_exp_f32 v23, v63
  v_mfma_f32_16x16x32_bf16 a[44:47], a[172:175], v[116:119], a[44:47]
  buffer_load_dwordx4 v6, s[12:15], s29 offen offset:1024 sc1 lds
  v_mfma_f32_16x16x32_bf16 a[48:51], a[176:179], v[116:119], a[48:51]
  v_exp_f32 v20, v32
  v_mfma_f32_16x16x32_bf16 a[52:55], a[180:183], v[116:119], a[52:55]
  v_cvt_pk_bf16_f32 v127, v22, v23
  v_add_u32 v3, s31, v2
  v_mfma_f32_16x16x32_bf16 a[56:59], a[184:187], v[116:119], a[56:59]
  v_exp_f32 v21, v33
  v_mfma_f32_16x16x32_bf16 a[60:63], a[188:191], v[116:119], a[60:63]
  buffer_load_dwordx4 v15, s[12:15], s29 offen offset:2048 sc1 lds
  v_smfmac_f32_16x16x64_bf16 v[96:99], v[104:107], v[112:119], v108
  v_mfma_f32_16x16x32_bf16 v[48:51], a[128:131], v[192:195], v[176:179]
  v_exp_f32 v22, v34
  v_mfma_f32_16x16x32_bf16 v[48:51], a[132:135], v[196:199], v[48:51]
  v_cvt_pk_bf16_f32 v112, v20, v21
  v_mfma_f32_16x16x32_bf16 v[48:51], a[136:139], v[200:203], v[48:51]
  v_exp_f32 v23, v35
  v_mfma_f32_16x16x32_bf16 v[48:51], a[140:143], v[204:207], v[48:51]
  buffer_load_dwordx4 v16, s[12:15], s29 offen offset:3072 sc1 lds
  v_mfma_f32_16x16x32_bf16 v[52:55], a[144:147], v[192:195], v[180:183]
  s_add_u32 s29, s29, s49
  v_exp_f32 v24, v36
  v_mfma_f32_16x16x32_bf16 v[52:55], a[148:151], v[196:199], v[52:55]
  s_add_u32 s30, s30, 32768
  v_cvt_pk_bf16_f32 v113, v22, v23
  v_mfma_f32_16x16x32_bf16 v[52:55], a[152:155], v[200:203], v[52:55]
  s_cmp_ge_u32 s30, 163840
  v_exp_f32 v25, v37
  v_mfma_f32_16x16x32_bf16 v[52:55], a[156:159], v[204:207], v[52:55]
  s_cselect_b32 s23, 163840, 0
  v_exp_f32 v20, v38
  v_mfma_f32_16x16x32_bf16 v[56:59], a[128:131], v[208:211], v[184:187]
  s_sub_u32 s30, s30, s23
  ds_read_b128 a[128:131], v3 offset:0
  v_cvt_pk_bf16_f32 v114, v24, v25
  v_mfma_f32_16x16x32_bf16 v[56:59], a[132:135], v[212:215], v[56:59]
  s_add_u32 s32, s32, 1
  v_exp_f32 v21, v39
  v_mfma_f32_16x16x32_bf16 v[56:59], a[136:139], v[216:219], v[56:59]
  s_bitcmp0_b64 s[46:47], s32
  ds_read_b128 a[132:135], v3 offset:1024
  v_mfma_f32_16x16x32_bf16 v[56:59], a[140:143], v[220:223], v[56:59]
  v_exp_f32 v22, v40
  v_mfma_f32_16x16x32_bf16 v[60:63], a[144:147], v[208:211], v[188:191]
  ds_read_b128 a[136:139], v3 offset:2048
  v_cvt_pk_bf16_f32 v115, v20, v21
  v_mfma_f32_16x16x32_bf16 v[60:63], a[148:151], v[212:215], v[60:63]
  v_exp_f32 v23, v41
  v_mfma_f32_16x16x32_bf16 v[60:63], a[152:155], v[216:219], v[60:63]
  ds_read_b128 a[140:143], v3 offset:3072
  v_mfma_f32_16x16x32_bf16 v[60:63], a[156:159], v[220:223], v[60:63]
  v_exp_f32 v24, v42
  v_mfma_f32_16x16x32_bf16 a[64:67], a[160:163], v[120:123], a[64:67]
  ds_read_b128 a[144:147], v3 offset:4096
  v_cvt_pk_bf16_f32 v116, v22, v23
  v_mfma_f32_16x16x32_bf16 a[68:71], a[164:167], v[120:123], a[68:71]
  v_exp_f32 v25, v43
  v_mfma_f32_16x16x32_bf16 a[72:75], a[168:171], v[120:123], a[72:75]
  ds_read_b128 a[148:151], v3 offset:5120
  v_mfma_f32_16x16x32_bf16 a[76:79], a[172:175], v[120:123], a[76:79]
  v_exp_f32 v20, v44
  v_mfma_f32_16x16x32_bf16 a[80:83], a[176:179], v[120:123], a[80:83]
  ds_read_b128 a[152:155], v3 offset:6144
  v_cvt_pk_bf16_f32 v117, v24, v25
  v_mfma_f32_16x16x32_bf16 a[84:87], a[180:183], v[120:123], a[84:87]
  v_exp_f32 v21, v45
  v_mfma_f32_16x16x32_bf16 a[88:91], a[184:187], v[120:123], a[88:91]
  ds_read_b128 a[156:159], v3 offset:7168
  v_mfma_f32_16x16x32_bf16 a[92:95], a[188:191], v[120:123], a[92:95]
  v_exp_f32 v22, v46
  v_mfma_f32_16x16x32_bf16 a[96:99], a[160:163], v[124:127], a[96:99]
  ds_read_b128 a[160:163], v4 offset:24576
  v_cvt_pk_bf16_f32 v118, v20, v21
  v_mfma_f32_16x16x32_bf16 a[100:103], a[164:167], v[124:127], a[100:103]
  ds_read_b128 a[164:167], v4 offset:25600
  v_exp_f32 v23, v47
  v_mfma_f32_16x16x32_bf16 a[104:107], a[168:171], v[124:127], a[104:107]
  ds_read_b128 a[168:171], v4 offset:26624
  v_cvt_pk_bf16_f32 v119, v22, v23
  v_mfma_f32_16x16x32_bf16 a[108:111], a[172:175], v[124:127], a[108:111]
  ds_read_b128 a[172:175], v4 offset:27648
  v_mfma_f32_16x16x32_bf16 a[112:115], a[176:179], v[124:127], a[112:115]
  ds_read_b128 a[176:179], v4 offset:28672
  v_mfma_f32_16x16x32_bf16 a[116:119], a[180:183], v[124:127], a[116:119]
  ds_read_b128 a[180:183], v4 offset:29696
  v_mfma_f32_16x16x32_bf16 a[120:123], a[184:187], v[124:127], a[120:123]
  ds_read_b128 a[184:187], v4 offset:30720
  v_mfma_f32_16x16x32_bf16 a[124:127], a[188:191], v[124:127], a[124:127]
  ds_read_b128 a[188:191], v4 offset:31744
  v_smfmac_f32_16x16x64_bf16 v[100:103], v[104:107], v[120:127], v108
  s_waitcnt lgkmcnt(8)
L_dual_end:
  s_cbranch_scc1 L_dual
L_dual_out:
  s_cmp_eq_u32 s32, s27
  s_cbranch_scc1 L_sw_28
L_swd_29:
  s_cmp_ge_u32 s32, s42
  s_cbranch_scc1 L_trans
  s_bitcmp1_b32 s44, 0
  s_cbranch_scc1 L_odd_30
  v_pk_add_f32 v[128:129], v[128:129], v[8:9]
  v_pk_add_f32 v[130:131], v[130:131], v[10:11]
  v_pk_add_f32 v[140:141], v[140:141], v[8:9]
  v_pk_add_f32 v[142:143], v[142:143], v[10:11]
  v_pk_mov_b32 v[132:133], v[26:27], v[26:27]
  v_pk_mov_b32 v[134:135], v[26:27], v[26:27]
  v_pk_mov_b32 v[144:145], v[26:27], v[26:27]
  v_pk_mov_b32 v[146:147], v[26:27], v[26:27]
  v_pk_mov_b32 v[148:149], v[26:27], v[26:27]
  v_pk_mov_b32 v[150:151], v[26:27], v[26:27]
  v_pk_mov_b32 v[152:153], v[26:27], v[26:27]
  v_pk_mov_b32 v[154:155], v[26:27], v[26:27]
  v_pk_mov_b32 v[156:157], v[26:27], v[26:27]
  v_pk_mov_b32 v[158:159], v[26:27], v[26:27]
  s_branch L_dual
L_odd_30:
  v_pk_add_f32 v[144:145], v[144:145], v[8:9]
  v_pk_add_f32 v[146:147], v[146:147], v[10:11]
  v_pk_add_f32 v[156:157], v[156:157], v[8:9]
  v_pk_add_f32 v[158:159], v[158:159], v[10:11]
  v_pk_mov_b32 v[148:149], v[26:27], v[26:27]
  v_pk_mov_b32 v[150:151], v[26:27], v[26:27]
  s_branch L_dual
L_sw_28:
  v_mov_b32 v5, v109
  v_mov_b32 v6, v110
  v_mov_b32 v15, v111
  v_mov_b32 v16, v17
  s_mov_b32 s12, s50
  s_mov_b32 s13, s51
  s_mov_b32 s14, 0x400000
  s_movk_i32 s48, 16384
  s_mov_b32 s49, 114688
  s_mov_b32 s29, s35
  s_add_u32 s24, s32, 1
  s_cmp_lt_u32 s24, s42
  s_cbranch_scc1 L_dual
  s_branch L_swd_29
L_trans:
  s_waitcnt lgkmcnt(0)
  v_mfma_f32_16x16x32_bf16 a[0:3], a[160:163], v[112:115], a[0:3]
  s_add_u32 s34, s34, 32768
  v_exp_f32 v20, v48
  v_exp_f32 v21, v49
  v_mfma_f32_16x16x32_bf16 a[4:7], a[164:167], v[112:115], a[4:7]
  buffer_load_dwordx4 a[224:227], v2, s[4:7], s34 offen sc1
  v_mfma_f32_16x16x32_bf16 a[8:11], a[168:171], v[112:115], a[8:11]
  v_exp_f32 v22, v50
  v_cvt_pk_bf16_f32 v120, v20, v21
  v_mfma_f32_16x16x32_bf16 a[12:15], a[172:175], v[112:115], a[12:15]
  v_exp_f32 v23, v51
  v_mfma_f32_16x16x32_bf16 a[16:19], a[176:179], v[112:115], a[16:19]
  buffer_load_dwordx4 a[228:231], v2, s[4:7], s34 offen offset:1024 sc1
  v_mfma_f32_16x16x32_bf16 a[20:23], a[180:183], v[112:115], a[20:23]
  v_exp_f32 v24, v52
  v_cvt_pk_bf16_f32 v121, v22, v23
  v_mfma_f32_16x16x32_bf16 a[24:27], a[184:187], v[112:115], a[24:27]
  v_exp_f32 v25, v53
  v_mfma_f32_16x16x32_bf16 a[28:31], a[188:191], v[112:115], a[28:31]
  buffer_load_dwordx4 a[232:235], v2, s[4:7], s34 offen offset:2048 sc1
  v_mfma_f32_16x16x32_bf16 a[32:35], a[160:163], v[116:119], a[32:35]
  v_exp_f32 v20, v54
  v_cvt_pk_bf16_f32 v122, v24, v25
  v_mfma_f32_16x16x32_bf16 a[36:39], a[164:167], v[116:119], a[36:39]
  v_exp_f32 v21, v55
  v_mfma_f32_16x16x32_bf16 a[40:43], a[168:171], v[116:119], a[40:43]
  buffer_load_dwordx4 a[236:239], v2, s[4:7], s34 offen offset:3072 sc1
  v_mfma_f32_16x16x32_bf16 a[44:47], a[172:175], v[116:119], a[44:47]
  v_exp_f32 v22, v56
  v_cvt_pk_bf16_f32 v123, v20, v21
  v_mfma_f32_16x16x32_bf16 a[48:51], a[176:179], v[116:119], a[48:51]
  s_waitcnt vmcnt(16)
  s_barrier
  v_mfma_f32_16x16x32_bf16 a[52:55], a[180:183], v[116:119], a[52:55]
  v_exp_f32 v23, v57
  v_mfma_f32_16x16x32_bf16 a[56:59], a[184:187], v[116:119], a[56:59]
  v_exp_f32 v24, v58
  v_cvt_pk_bf16_f32 v124, v22, v23
  v_mfma_f32_16x16x32_bf16 a[60:63], a[188:191], v[116:119], a[60:63]
  v_exp_f32 v25, v59
  v_smfmac_f32_16x16x64_bf16 v[96:99], v[104:107], v[112:119], v108
  v_cvt_pk_bf16_f32 v125, v24, v25
  s_lshl_b32 s23, s44, 18
  s_lshl_b32 s24, s21, 12
  s_add_u32 s23, s23, s24
  s_add_u32 s23, s23, 37748736
  s_add_u32 s24, s23, 131072
  v_mov_b32 v33, 0x71800000
  v_accvgpr_read_b32 v40, a0
  v_accvgpr_read_b32 v41, a1
  v_accvgpr_read_b32 v42, a2
  v_accvgpr_read_b32 v43, a3
  v_accvgpr_read_b32 v44, a4
  v_accvgpr_read_b32 v45, a5
  v_accvgpr_read_b32 v46, a6
  v_accvgpr_read_b32 v47, a7
  v_add_f32 v32, v96, v97
  v_add_f32 v34, v98, v99
  v_add_f32 v35, v32, v34
  v_rcp_f32 v32, v32
  v_rcp_f32 v34, v34
  v_cmp_nlt_f32 s[36:37], v35, v33
  s_add_u32 s34, s34, 32768
  buffer_load_dwordx4 a[240:243], v2, s[4:7], s34 offen sc1
  v_pk_mul_f32 v[40:41], v[40:41], v[32:33] op_sel_hi:[1,0]
  v_pk_mul_f32 v[42:43], v[42:43], v[32:33] op_sel_hi:[1,0]
  v_pk_mul_f32 v[44:45], v[44:45], v[32:33] op_sel_hi:[1,0]
  v_pk_mul_f32 v[46:47], v[46:47], v[32:33] op_sel_hi:[1,0]
  v_cvt_pk_bf16_f32 v128, v40, v41
  v_cvt_pk_bf16_f32 v129, v42, v43
  v_cvt_pk_bf16_f32 v130, v44, v45
  v_cvt_pk_bf16_f32 v131, v46, v47
  buffer_load_dwordx4 a[244:247], v2, s[4:7], s34 offen offset:1024 sc1
  buffer_store_dwordx4 v[128:131], v2, s[8:11], s23 offen offset:0 sc1
  v_accvgpr_read_b32 v40, a8
  v_accvgpr_read_b32 v41, a9
  v_accvgpr_read_b32 v42, a10
  v_accvgpr_read_b32 v43, a11
  v_accvgpr_read_b32 v44, a12
  v_accvgpr_read_b32 v45, a13
  v_accvgpr_read_b32 v46, a14
  v_accvgpr_read_b32 v47, a15
  buffer_load_dwordx4 a[248:251], v2, s[4:7], s34 offen offset:2048 sc1
  v_pk_mul_f32 v[40:41], v[40:41], v[32:33] op_sel_hi:[1,0]
  v_pk_mul_f32 v[42:43], v[42:43], v[32:33] op_sel_hi:[1,0]
  v_pk_mul_f32 v[44:45], v[44:45], v[32:33] op_sel_hi:[1,0]
  v_pk_mul_f32 v[46:47], v[46:47], v[32:33] op_sel_hi:[1,0]
  v_cvt_pk_bf16_f32 v132, v40, v41
  v_cvt_pk_bf16_f32 v133, v42, v43
  v_cvt_pk_bf16_f32 v134, v44, v45
  v_cvt_pk_bf16_f32 v135, v46, v47
  buffer_load_dwordx4 a[252:255], v2, s[4:7], s34 offen offset:3072 sc1
  buffer_store_dwordx4 v[132:135], v2, s[8:11], s23 offen offset:1024 sc1
  v_accvgpr_read_b32 v40, a16
  v_accvgpr_read_b32 v41, a17
  v_accvgpr_read_b32 v42, a18
  v_accvgpr_read_b32 v43, a19
  v_accvgpr_read_b32 v44, a20
  v_accvgpr_read_b32 v45, a21
  v_accvgpr_read_b32 v46, a22
  v_accvgpr_read_b32 v47, a23
  s_add_u32 s34, s34, 32768
  buffer_load_dwordx4 v[224:227], v2, s[4:7], s34 offen sc1
  v_pk_mul_f32 v[40:41], v[40:41], v[32:33] op_sel_hi:[1,0]
  v_pk_mul_f32 v[42:43], v[42:43], v[32:33] op_sel_hi:[1,0]
  v_pk_mul_f32 v[44:45], v[44:45], v[32:33] op_sel_hi:[1,0]
  v_pk_mul_f32 v[46:47], v[46:47], v[32:33] op_sel_hi:[1,0]
  v_cvt_pk_bf16_f32 v136, v40, v41
  v_cvt_pk_bf16_f32 v137, v42, v43
  v_cvt_pk_bf16_f32 v138, v44, v45
  v_cvt_pk_bf16_f32 v139, v46, v47
  buffer_load_dwordx4 v[228:231], v2, s[4:7], s34 offen offset:1024 sc1
  buffer_store_dwordx4 v[136:139], v2, s[8:11], s23 offen offset:2048 sc1
  v_accvgpr_read_b32 v40, a24
  v_accvgpr_read_b32 v41, a25
  v_accvgpr_read_b32 v42, a26
  v_accvgpr_read_b32 v43, a27
  v_accvgpr_read_b32 v44, a28
  v_accvgpr_read_b32 v45, a29
  v_accvgpr_read_b32 v46, a30
  v_accvgpr_read_b32 v47, a31
  buffer_load_dwordx4 v[232:235], v2, s[4:7], s34 offen offset:2048 sc1
  v_pk_mul_f32 v[40:41], v[40:41], v[32:33] op_sel_hi:[1,0]
  v_pk_mul_f32 v[42:43], v[42:43], v[32:33] op_sel_hi:[1,0]
  v_pk_mul_f32 v[44:45], v[44:45], v[32:33] op_sel_hi:[1,0]
  v_pk_mul_f32 v[46:47], v[46:47], v[32:33] op_sel_hi:[1,0]
  v_cvt_pk_bf16_f32 v140, v40, v41
  v_cvt_pk_bf16_f32 v141, v42, v43
  v_cvt_pk_bf16_f32 v142, v44, v45
  v_cvt_pk_bf16_f32 v143, v46, v47
  buffer_load_dwordx4 v[236:239], v2, s[4:7], s34 offen offset:3072 sc1
  buffer_store_dwordx4 v[140:143], v2, s[8:11], s23 offen offset:3072 sc1
  v_accvgpr_read_b32 v40, a32
  v_accvgpr_read_b32 v41, a33
  v_accvgpr_read_b32 v42, a34
  v_accvgpr_read_b32 v43, a35
  v_accvgpr_read_b32 v44, a36
  v_accvgpr_read_b32 v45, a37
  v_accvgpr_read_b32 v46, a38
  v_accvgpr_read_b32 v47, a39
  s_mov_b32 s64, 0
  buffer_load_dwordx4 a[0:3], v12, s[72:75], s64 offen sc1
  v_pk_mul_f32 v[40:41], v[40:41], v[34:35] op_sel_hi:[1,0]
  v_pk_mul_f32 v[42:43], v[42:43], v[34:35] op_sel_hi:[1,0]
  v_pk_mul_f32 v[44:45], v[44:45], v[34:35] op_sel_hi:[1,0]
  v_pk_mul_f32 v[46:47], v[46:47], v[34:35] op_sel_hi:[1,0]
  v_cvt_pk_bf16_f32 v144, v40, v41
  v_cvt_pk_bf16_f32 v145, v42, v43
  v_cvt_pk_bf16_f32 v146, v44, v45
  v_cvt_pk_bf16_f32 v147, v46, v47
  buffer_load_dwordx4 a[4:7], v12, s[72:75], s64 offen offset:1024 sc1
  buffer_store_dwordx4 v[144:147], v2, s[8:11], s24 offen offset:0 sc1
  v_accvgpr_read_b32 v40, a40
  v_accvgpr_read_b32 v41, a41
  v_accvgpr_read_b32 v42, a42
  v_accvgpr_read_b32 v43, a43
  v_accvgpr_read_b32 v44, a44
  v_accvgpr_read_b32 v45, a45
  v_accvgpr_read_b32 v46, a46
  v_accvgpr_read_b32 v47, a47
  buffer_load_dwordx4 a[8:11], v13, s[72:75], s64 offen sc1
  v_pk_mul_f32 v[40:41], v[40:41], v[34:35] op_sel_hi:[1,0]
  v_pk_mul_f32 v[42:43], v[42:43], v[34:35] op_sel_hi:[1,0]
  v_pk_mul_f32 v[44:45], v[44:45], v[34:35] op_sel_hi:[1,0]
  v_pk_mul_f32 v[46:47], v[46:47], v[34:35] op_sel_hi:[1,0]
  v_cvt_pk_bf16_f32 v148, v40, v41
  v_cvt_pk_bf16_f32 v149, v42, v43
  v_cvt_pk_bf16_f32 v150, v44, v45
  v_cvt_pk_bf16_f32 v151, v46, v47
  s_mov_b32 s64, 88064
  buffer_load_dwordx4 a[12:15], v12, s[72:75], s64 offen sc1
  buffer_store_dwordx4 v[148:151], v2, s[8:11], s24 offen offset:1024 sc1
  v_accvgpr_read_b32 v40, a48
  v_accvgpr_read_b32 v41, a49
  v_accvgpr_read_b32 v42, a50
  v_accvgpr_read_b32 v43, a51
  v_accvgpr_read_b32 v44, a52
  v_accvgpr_read_b32 v45, a53
  v_accvgpr_read_b32 v46, a54
  v_accvgpr_read_b32 v47, a55
  buffer_load_dwordx4 a[16:19], v12, s[72:75], s64 offen offset:1024 sc1
  v_pk_mul_f32 v[40:41], v[40:41], v[34:35] op_sel_hi:[1,0]
  v_pk_mul_f32 v[42:43], v[42:43], v[34:35] op_sel_hi:[1,0]
  v_pk_mul_f32 v[44:45], v[44:45], v[34:35] op_sel_hi:[1,0]
  v_pk_mul_f32 v[46:47], v[46:47], v[34:35] op_sel_hi:[1,0]
  v_cvt_pk_bf16_f32 v152, v40, v41
  v_cvt_pk_bf16_f32 v153, v42, v43
  v_cvt_pk_bf16_f32 v154, v44, v45
  v_cvt_pk_bf16_f32 v155, v46, v47
  buffer_load_dwordx4 a[20:23], v13, s[72:75], s64 offen sc1
  buffer_store_dwordx4 v[152:155], v2, s[8:11], s24 offen offset:2048 sc1
  v_accvgpr_read_b32 v40, a56
  v_accvgpr_read_b32 v41, a57
  v_accvgpr_read_b32 v42, a58
  v_accvgpr_read_b32 v43, a59
  v_accvgpr_read_b32 v44, a60
  v_accvgpr_read_b32 v45, a61
  v_accvgpr_read_b32 v46, a62
  v_accvgpr_read_b32 v47, a63
  s_mov_b32 s64, 176128
  buffer_load_dwordx4 a[24:27], v12, s[72:75], s64 offen sc1
  v_pk_mul_f32 v[40:41], v[40:41], v[34:35] op_sel_hi:[1,0]
  v_pk_mul_f32 v[42:43], v[42:43], v[34:35] op_sel_hi:[1,0]
  v_pk_mul_f32 v[44:45], v[44:45], v[34:35] op_sel_hi:[1,0]
  v_pk_mul_f32 v[46:47], v[46:47], v[34:35] op_sel_hi:[1,0]
  v_cvt_pk_bf16_f32 v156, v40, v41
  v_cvt_pk_bf16_f32 v157, v42, v43
  v_cvt_pk_bf16_f32 v158, v44, v45
  v_cvt_pk_bf16_f32 v159, v46, v47
  buffer_load_dwordx4 a[28:31], v12, s[72:75], s64 offen offset:1024 sc1
  buffer_store_dwordx4 v[156:159], v2, s[8:11], s24 offen offset:3072 sc1
L_noepi_31:
  s_add_u32 s24, s32, 1
  s_cmp_eq_u32 s24, s43
  s_cbranch_scc1 L_mask1
L_mask1d:
  s_nop 0
  v_mfma_f32_16x16x32_bf16 v[48:51], a[128:131], v[192:195], v[160:163]
  buffer_load_dwordx4 a[32:35], v13, s[72:75], s64 offen sc1
  s_cmp_ge_u32 s30, 163840
  v_exp_f32 v20, v60
  v_mfma_f32_16x16x32_bf16 v[48:51], a[132:135], v[196:199], v[48:51]
  s_cselect_b32 s23, 163840, 0
  v_exp_f32 v21, v61
  v_mfma_f32_16x16x32_bf16 v[48:51], a[136:139], v[200:203], v[48:51]
  s_mov_b32 s64, 264192
  buffer_load_dwordx4 a[36:39], v12, s[72:75], s64 offen sc1
  s_sub_u32 s30, s30, s23
  v_exp_f32 v22, v62
  v_mfma_f32_16x16x32_bf16 v[48:51], a[140:143], v[204:207], v[48:51]
  buffer_load_dwordx4 a[40:43], v12, s[72:75], s64 offen offset:1024 sc1
  s_add_u32 s31, s31, 32768
  v_mfma_f32_16x16x32_bf16 v[52:55], a[144:147], v[192:195], v[164:167]
  s_cmp_ge_u32 s31, 163840
  v_cvt_pk_bf16_f32 v126, v20, v21
  v_mfma_f32_16x16x32_bf16 v[52:55], a[148:151], v[196:199], v[52:55]
  buffer_load_dwordx4 a[44:47], v13, s[72:75], s64 offen sc1
  s_cselect_b32 s24, 163840, 0
  v_exp_f32 v23, v63
  v_mfma_f32_16x16x32_bf16 v[52:55], a[152:155], v[200:203], v[52:55]
  s_sub_u32 s31, s31, s24
  v_cvt_pk_bf16_f32 v127, v22, v23
  v_mfma_f32_16x16x32_bf16 v[52:55], a[156:159], v[204:207], v[52:55]
  s_mov_b32 s64, 352256
  buffer_load_dwordx4 a[48:51], v12, s[72:75], s64 offen sc1
  s_mov_b32 m0, s30
  v_exp_f32 v20, v48
  v_mfma_f32_16x16x32_bf16 v[56:59], a[128:131], v[208:211], v[168:171]
  v_exp_f32 v21, v49
  v_mfma_f32_16x16x32_bf16 v[56:59], a[132:135], v[212:215], v[56:59]
  buffer_load_dwordx4 a[52:55], v12, s[72:75], s64 offen offset:1024 sc1
  v_exp_f32 v22, v50
  v_mfma_f32_16x16x32_bf16 v[56:59], a[136:139], v[216:219], v[56:59]
  ds_read_b128 a[128:131], v3 offset:16384
  v_mfma_f32_16x16x32_bf16 v[56:59], a[140:143], v[220:223], v[56:59]
  ds_read_b128 a[132:135], v3 offset:17408
  v_mfma_f32_16x16x32_bf16 v[60:63], a[144:147], v[208:211], v[172:175]
  buffer_load_dwordx4 a[56:59], v13, s[72:75], s64 offen sc1
  ds_read_b128 a[136:139], v3 offset:18432
  v_cvt_pk_bf16_f32 v112, v20, v21
  v_mfma_f32_16x16x32_bf16 v[60:63], a[148:151], v[212:215], v[60:63]
  ds_read_b128 a[140:143], v3 offset:19456
  v_mov_b32 v4, v3
  v_mfma_f32_16x16x32_bf16 v[60:63], a[152:155], v[216:219], v[60:63]
  s_mov_b32 s64, 440320
  buffer_load_dwordx4 a[60:63], v12, s[72:75], s64 offen sc1
  s_branch L_single_mid
L_mask1:
  s_bitcmp1_b32 s45, 0
  s_cbranch_scc1 L_odd_32
  v_pk_add_f32 v[160:161], v[160:161], v[8:9]
  v_pk_add_f32 v[162:163], v[162:163], v[10:11]
  v_pk_add_f32 v[172:173], v[172:173], v[8:9]
  v_pk_add_f32 v[174:175], v[174:175], v[10:11]
  v_pk_mov_b32 v[164:165], v[26:27], v[26:27]
  v_pk_mov_b32 v[166:167], v[26:27], v[26:27]
  v_pk_mov_b32 v[176:177], v[26:27], v[26:27]
  v_pk_mov_b32 v[178:179], v[26:27], v[26:27]
  v_pk_mov_b32 v[180:181], v[26:27], v[26:27]
  v_pk_mov_b32 v[182:183], v[26:27], v[26:27]
  v_pk_mov_b32 v[184:185], v[26:27], v[26:27]
  v_pk_mov_b32 v[186:187], v[26:27], v[26:27]
  v_pk_mov_b32 v[188:189], v[26:27], v[26:27]
  v_pk_mov_b32 v[190:191], v[26:27], v[26:27]
  s_branch L_mask1d
L_odd_32:
  v_pk_add_f32 v[176:177], v[176:177], v[8:9]
  v_pk_add_f32 v[178:179], v[178:179], v[10:11]
  v_pk_add_f32 v[188:189], v[188:189], v[8:9]
  v_pk_add_f32 v[190:191], v[190:191], v[10:11]
  v_pk_mov_b32 v[180:181], v[26:27], v[26:27]
  v_pk_mov_b32 v[182:183], v[26:27], v[26:27]
  s_branch L_mask1d
.p2align 6
L_single:
  v_mfma_f32_16x16x32_bf16 v[48:51], a[128:131], v[192:195], v[160:163]
  s_cmp_ge_u32 s30, 163840
  v_exp_f32 v20, v60
  v_mfma_f32_16x16x32_bf16 v[48:51], a[132:135], v[196:199], v[48:51]
  s_cselect_b32 s23, 163840, 0
  v_exp_f32 v21, v61
  v_mfma_f32_16x16x32_bf16 v[48:51], a[136:139], v[200:203], v[48:51]
  s_sub_u32 s30, s30, s23
  v_exp_f32 v22, v62
  v_mfma_f32_16x16x32_bf16 v[48:51], a[140:143], v[204:207], v[48:51]
  s_add_u32 s31, s31, 32768
  ds_read_b128 a[180:183], v4 offset:29696
  v_mfma_f32_16x16x32_bf16 v[52:55], a[144:147], v[192:195], v[164:167]
  s_cmp_ge_u32 s31, 163840
  ds_read_b128 a[184:187], v4 offset:30720
  v_cvt_pk_bf16_f32 v126, v20, v21
  v_mfma_f32_16x16x32_bf16 v[52:55], a[148:151], v[196:199], v[52:55]
  s_cselect_b32 s24, 163840, 0
  v_exp_f32 v23, v63
  v_mfma_f32_16x16x32_bf16 v[52:55], a[152:155], v[200:203], v[52:55]
  s_sub_u32 s31, s31, s24
  ds_read_b128 a[188:191], v4 offset:31744
  v_cvt_pk_bf16_f32 v127, v22, v23
  v_mfma_f32_16x16x32_bf16 v[52:55], a[156:159], v[204:207], v[52:55]
  s_mov_b32 m0, s30
  v_exp_f32 v20, v48
  v_mfma_f32_16x16x32_bf16 v[56:59], a[128:131], v[208:211], v[168:171]
  v_exp_f32 v21, v49
  v_mfma_f32_16x16x32_bf16 v[56:59], a[132:135], v[212:215], v[56:59]
  v_exp_f32 v22, v50
  v_mfma_f32_16x16x32_bf16 v[56:59], a[136:139], v[216:219], v[56:59]
  ds_read_b128 a[128:131], v3 offset:16384
  v_mfma_f32_16x16x32_bf16 v[56:59], a[140:143], v[220:223], v[56:59]
  ds_read_b128 a[132:135], v3 offset:17408
  v_mfma_f32_16x16x32_bf16 v[60:63], a[144:147], v[208:211], v[172:175]
  ds_read_b128 a[136:139], v3 offset:18432
  v_cvt_pk_bf16_f32 v112, v20, v21
  v_mfma_f32_16x16x32_bf16 v[60:63], a[148:151], v[212:215], v[60:63]
  ds_read_b128 a[140:143], v3 offset:19456
  v_mov_b32 v4, v3
  v_mfma_f32_16x16x32_bf16 v[60:63], a[152:155], v[216:219], v[60:63]
  s_waitcnt vmcnt(16) lgkmcnt(4)
  s_barrier
L_single_mid:
  v_mfma_f32_16x16x32_bf16 v[60:63], a[156:159], v[220:223], v[60:63]
  v_exp_f32 v23, v51
  v_mfma_f32_16x16x32_bf16 a[64:67], a[160:163], v[120:123], a[64:67]
  v_exp_f32 v24, v52
  v_mfma_f32_16x16x32_bf16 a[68:71], a[164:167], v[120:123], a[68:71]
  buffer_load_dwordx4 v5, s[12:15], s29 offen sc1 lds
  v_mfma_f32_16x16x32_bf16 a[72:75], a[168:171], v[120:123], a[72:75]
  ds_read_b128 a[144:147], v3 offset:20480
  v_cvt_pk_bf16_f32 v113, v22, v23
  v_mfma_f32_16x16x32_bf16 a[76:79], a[172:175], v[120:123], a[76:79]
  v_exp_f32 v25, v53
  v_mfma_f32_16x16x32_bf16 a[80:83], a[176:179], v[120:123], a[80:83]
  v_exp_f32 v20, v54
  v_mfma_f32_16x16x32_bf16 a[84:87], a[180:183], v[120:123], a[84:87]
  ds_read_b128 a[148:151], v3 offset:21504
  v_cvt_pk_bf16_f32 v114, v24, v25
  v_mfma_f32_16x16x32_bf16 a[88:91], a[184:187], v[120:123], a[88:91]
  v_exp_f32 v21, v55
  v_mfma_f32_16x16x32_bf16 a[92:95], a[188:191], v[120:123], a[92:95]
  buffer_load_dwordx4 v6, s[12:15], s29 offen offset:1024 sc1 lds
  v_mfma_f32_16x16x32_bf16 a[96:99], a[160:163], v[124:127], a[96:99]
  v_exp_f32 v22, v56
  v_mfma_f32_16x16x32_bf16 a[100:103], a[164:167], v[124:127], a[100:103]
  ds_read_b128 a[152:155], v3 offset:22528
  v_cvt_pk_bf16_f32 v115, v20, v21
  v_mfma_f32_16x16x32_bf16 a[104:107], a[168:171], v[124:127], a[104:107]
  ds_read_b128 a[156:159], v3 offset:23552
  v_exp_f32 v23, v57
  v_mfma_f32_16x16x32_bf16 a[108:111], a[172:175], v[124:127], a[108:111]
  ds_read_b128 a[160:163], v4 offset:8192
  v_add_u32 v3, s31, v2
  v_mfma_f32_16x16x32_bf16 a[112:115], a[176:179], v[124:127], a[112:115]
  v_exp_f32 v24, v58
  v_mfma_f32_16x16x32_bf16 a[116:119], a[180:183], v[124:127], a[116:119]
  buffer_load_dwordx4 v15, s[12:15], s29 offen offset:2048 sc1 lds
  v_mfma_f32_16x16x32_bf16 a[120:123], a[184:187], v[124:127], a[120:123]
  ds_read_b128 a[164:167], v4 offset:9216
  v_cvt_pk_bf16_f32 v116, v22, v23
  v_mfma_f32_16x16x32_bf16 a[124:127], a[188:191], v[124:127], a[124:127]
  v_exp_f32 v25, v59
  v_smfmac_f32_16x16x64_bf16 v[100:103], v[104:107], v[120:127], v108
  s_waitcnt lgkmcnt(2)
  ds_read_b128 a[168:171], v4 offset:10240
  v_mfma_f32_16x16x32_bf16 v[48:51], a[128:131], v[192:195], v[176:179]
  ds_read_b128 a[172:175], v4 offset:11264
  v_mfma_f32_16x16x32_bf16 v[48:51], a[132:135], v[196:199], v[48:51]
  ds_read_b128 a[176:179], v4 offset:12288
  v_mfma_f32_16x16x32_bf16 v[48:51], a[136:139], v[200:203], v[48:51]
  buffer_load_dwordx4 v16, s[12:15], s29 offen offset:3072 sc1 lds
  v_mfma_f32_16x16x32_bf16 v[48:51], a[140:143], v[204:207], v[48:51]
  s_add_u32 m0, s30, 4096
  ds_read_b128 a[180:183], v4 offset:13312
  v_cvt_pk_bf16_f32 v117, v24, v25
  v_mfma_f32_16x16x32_bf16 v[52:55], a[144:147], v[192:195], v[180:183]
  s_add_u32 s29, s29, s48
  v_exp_f32 v20, v60
  v_mfma_f32_16x16x32_bf16 v[52:55], a[148:151], v[196:199], v[52:55]
  v_exp_f32 v21, v61
  v_mfma_f32_16x16x32_bf16 v[52:55], a[152:155], v[200:203], v[52:55]
  v_exp_f32 v22, v62
  v_mfma_f32_16x16x32_bf16 v[52:55], a[156:159], v[204:207], v[52:55]
  ds_read_b128 a[184:187], v4 offset:14336
  v_cvt_pk_bf16_f32 v118, v20, v21
  v_mfma_f32_16x16x32_bf16 v[56:59], a[128:131], v[208:211], v[184:187]
  buffer_load_dwordx4 v5, s[12:15], s29 offen sc1 lds
  v_mfma_f32_16x16x32_bf16 v[56:59], a[132:135], v[212:215], v[56:59]
  ds_read_b128 a[188:191], v4 offset:15360
  v_exp_f32 v23, v63
  v_mfma_f32_16x16x32_bf16 v[56:59], a[136:139], v[216:219], v[56:59]
  ds_read_b128 a[128:131], v3 offset:0
  v_cvt_pk_bf16_f32 v119, v22, v23
  v_mfma_f32_16x16x32_bf16 v[56:59], a[140:143], v[220:223], v[56:59]
  v_exp_f32 v20, v48
  v_mfma_f32_16x16x32_bf16 v[60:63], a[144:147], v[208:211], v[188:191]
  v_exp_f32 v21, v49
  v_mfma_f32_16x16x32_bf16 v[60:63], a[148:151], v[212:215], v[60:63]
  v_exp_f32 v22, v50
  v_mfma_f32_16x16x32_bf16 v[60:63], a[152:155], v[216:219], v[60:63]
  buffer_load_dwordx4 v6, s[12:15], s29 offen offset:1024 sc1 lds
  v_mfma_f32_16x16x32_bf16 v[60:63], a[156:159], v[220:223], v[60:63]
  s_waitcnt lgkmcnt(1)
  ds_read_b128 a[132:135], v3 offset:1024
  v_cvt_pk_bf16_f32 v120, v20, v21
  v_mfma_f32_16x16x32_bf16 a[64:67], a[160:163], v[112:115], a[64:67]
  v_exp_f32 v23, v51
  v_mfma_f32_16x16x32_bf16 a[68:71], a[164:167], v[112:115], a[68:71]
  v_exp_f32 v24, v52
  v_mfma_f32_16x16x32_bf16 a[72:75], a[168:171], v[112:115], a[72:75]
  ds_read_b128 a[136:139], v3 offset:2048
  v_cvt_pk_bf16_f32 v121, v22, v23
  v_mfma_f32_16x16x32_bf16 a[76:79], a[172:175], v[112:115], a[76:79]
  v_exp_f32 v25, v53
  v_mfma_f32_16x16x32_bf16 a[80:83], a[176:179], v[112:115], a[80:83]
  buffer_load_dwordx4 v15, s[12:15], s29 offen offset:2048 sc1 lds
  v_mfma_f32_16x16x32_bf16 a[84:87], a[180:183], v[112:115], a[84:87]
  ds_read_b128 a[140:143], v3 offset:3072
  v_exp_f32 v20, v54
  v_mfma_f32_16x16x32_bf16 a[88:91], a[184:187], v[112:115], a[88:91]
  ds_read_b128 a[144:147], v3 offset:4096
  v_cvt_pk_bf16_f32 v122, v24, v25
  v_mfma_f32_16x16x32_bf16 a[92:95], a[188:191], v[112:115], a[92:95]
  ds_read_b128 a[148:151], v3 offset:5120
  v_exp_f32 v21, v55
  v_mfma_f32_16x16x32_bf16 a[96:99], a[160:163], v[116:119], a[96:99]
  ds_read_b128 a[152:155], v3 offset:6144
  v_exp_f32 v22, v56
  v_mfma_f32_16x16x32_bf16 a[100:103], a[164:167], v[116:119], a[100:103]
  ds_read_b128 a[156:159], v3 offset:7168
  v_cvt_pk_bf16_f32 v123, v20, v21
  v_mfma_f32_16x16x32_bf16 a[104:107], a[168:171], v[116:119], a[104:107]
  buffer_load_dwordx4 v16, s[12:15], s29 offen offset:3072 sc1 lds
  v_mfma_f32_16x16x32_bf16 a[108:111], a[172:175], v[116:119], a[108:111]
  s_add_u32 s29, s29, s49
  v_exp_f32 v23, v57
  v_mfma_f32_16x16x32_bf16 a[112:115], a[176:179], v[116:119], a[112:115]
  s_add_u32 s30, s30, 32768
  ds_read_b128 a[160:163], v4 offset:24576
  v_exp_f32 v24, v58
  v_mfma_f32_16x16x32_bf16 a[116:119], a[180:183], v[116:119], a[116:119]
  s_add_u32 s32, s32, 1
  ds_read_b128 a[164:167], v4 offset:25600
  v_cvt_pk_bf16_f32 v124, v22, v23
  v_mfma_f32_16x16x32_bf16 a[120:123], a[184:187], v[116:119], a[120:123]
  s_bitcmp0_b64 s[46:47], s32
  ds_read_b128 a[168:171], v4 offset:26624
  v_exp_f32 v25, v59
  v_mfma_f32_16x16x32_bf16 a[124:127], a[188:191], v[116:119], a[124:127]
  ds_read_b128 a[172:175], v4 offset:27648
  v_cvt_pk_bf16_f32 v125, v24, v25
  v_smfmac_f32_16x16x64_bf16 v[100:103], v[104:107], v[112:119], v108
  s_waitcnt lgkmcnt(4)
  ds_read_b128 a[176:179], v4 offset:28672
L_single_end:
  s_cbranch_scc1 L_single
L_single_out:
  s_cmp_eq_u32 s32, s27
  s_cbranch_scc1 L_sw_33
L_swd_34:
  s_cmp_ge_u32 s32, s43
  s_cbranch_scc1 L_drain
  s_bitcmp1_b32 s45, 0
  s_cbranch_scc1 L_odd_35
  v_pk_add_f32 v[160:161], v[160:161], v[8:9]
  v_pk_add_f32 v[162:163], v[162:163], v[10:11]
  v_pk_add_f32 v[172:173], v[172:173], v[8:9]
  v_pk_add_f32 v[174:175], v[174:175], v[10:11]
  v_pk_mov_b32 v[164:165], v[26:27], v[26:27]
  v_pk_mov_b32 v[166:167], v[26:27], v[26:27]
  v_pk_mov_b32 v[176:177], v[26:27], v[26:27]
  v_pk_mov_b32 v[178:179], v[26:27], v[26:27]
  v_pk_mov_b32 v[180:181], v[26:27], v[26:27]
  v_pk_mov_b32 v[182:183], v[26:27], v[26:27]
  v_pk_mov_b32 v[184:185], v[26:27], v[26:27]
  v_pk_mov_b32 v[186:187], v[26:27], v[26:27]
  v_pk_mov_b32 v[188:189], v[26:27], v[26:27]
  v_pk_mov_b32 v[190:191], v[26:27], v[26:27]
  s_branch L_single
L_odd_35:
  v_pk_add_f32 v[176:177], v[176:177], v[8:9]
  v_pk_add_f32 v[178:179], v[178:179], v[10:11]
  v_pk_add_f32 v[188:189], v[188:189], v[8:9]
  v_pk_add_f32 v[190:191], v[190:191], v[10:11]
  v_pk_mov_b32 v[180:181], v[26:27], v[26:27]
  v_pk_mov_b32 v[182:183], v[26:27], v[26:27]
  s_branch L_single
L_sw_33:
  v_mov_b32 v5, v109
  v_mov_b32 v6, v110
  v_mov_b32 v15, v111
  v_mov_b32 v16, v17
  s_mov_b32 s12, s50
  s_mov_b32 s13, s51
  s_mov_b32 s14, 0x400000
  s_movk_i32 s48, 16384
  s_mov_b32 s49, 114688
  s_mov_b32 s29, s35
  s_add_u32 s24, s32, 1
  s_cmp_lt_u32 s24, s43
  s_cbranch_scc1 L_single
  s_branch L_swd_34
L_drain:
  ds_read_b128 a[180:183], v4 offset:29696
  ds_read_b128 a[184:187], v4 offset:30720
  ds_read_b128 a[188:191], v4 offset:31744
  v_exp_f32 v20, v60
  v_exp_f32 v21, v61
  v_exp_f32 v22, v62
  v_cvt_pk_bf16_f32 v126, v20, v21
  v_exp_f32 v23, v63
  s_nop 0
  v_cvt_pk_bf16_f32 v127, v22, v23
  s_waitcnt lgkmcnt(0)
  s_cmp_lt_u32 s20, 2
  s_cbranch_scc1 L_nobar_36
  s_barrier
  s_cmp_ge_u32 s30, 163840
  s_cselect_b32 s23, 163840, 0
  s_sub_u32 s30, s30, s23
  v_mfma_f32_16x16x32_bf16 a[64:67], a[160:163], v[120:123], a[64:67]
  s_mov_b32 m0, s30
  v_mfma_f32_16x16x32_bf16 a[68:71], a[164:167], v[120:123], a[68:71]
  buffer_load_dwordx4 v5, s[12:15], s29 offen sc1 lds
  v_mfma_f32_16x16x32_bf16 a[72:75], a[168:171], v[120:123], a[72:75]
  v_mfma_f32_16x16x32_bf16 a[76:79], a[172:175], v[120:123], a[76:79]
  buffer_load_dwordx4 v6, s[12:15], s29 offen offset:1024 sc1 lds
  v_mfma_f32_16x16x32_bf16 a[80:83], a[176:179], v[120:123], a[80:83]
  v_mfma_f32_16x16x32_bf16 a[84:87], a[180:183], v[120:123], a[84:87]
  buffer_load_dwordx4 v15, s[12:15], s29 offen offset:2048 sc1 lds
  v_mfma_f32_16x16x32_bf16 a[88:91], a[184:187], v[120:123], a[88:91]
  v_mfma_f32_16x16x32_bf16 a[92:95], a[188:191], v[120:123], a[92:95]
  buffer_load_dwordx4 v16, s[12:15], s29 offen offset:3072 sc1 lds
  v_mfma_f32_16x16x32_bf16 a[96:99], a[160:163], v[124:127], a[96:99]
  s_add_u32 m0, s30, 4096
  v_mfma_f32_16x16x32_bf16 a[100:103], a[164:167], v[124:127], a[100:103]
  s_add_u32 s29, s29, s48
  v_mfma_f32_16x16x32_bf16 a[104:107], a[168:171], v[124:127], a[104:107]
  buffer_load_dwordx4 v5, s[12:15], s29 offen sc1 lds
  v_mfma_f32_16x16x32_bf16 a[108:111], a[172:175], v[124:127], a[108:111]
  v_mfma_f32_16x16x32_bf16 a[112:115], a[176:179], v[124:127], a[112:115]
  buffer_load_dwordx4 v6, s[12:15], s29 offen offset:1024 sc1 lds
  v_mfma_f32_16x16x32_bf16 a[116:119], a[180:183], v[124:127], a[116:119]
  v_mfma_f32_16x16x32_bf16 a[120:123], a[184:187], v[124:127], a[120:123]
  buffer_load_dwordx4 v15, s[12:15], s29 offen offset:2048 sc1 lds
  v_mfma_f32_16x16x32_bf16 a[124:127], a[188:191], v[124:127], a[124:127]
  v_smfmac_f32_16x16x64_bf16 v[100:103], v[104:107], v[120:127], v108
  buffer_load_dwordx4 v16, s[12:15], s29 offen offset:3072 sc1 lds
  s_branch L_epib_37
L_nobar_36:
  v_mfma_f32_16x16x32_bf16 a[64:67], a[160:163], v[120:123], a[64:67]
  s_and_b32 s23, s44, 60
  v_mfma_f32_16x16x32_bf16 a[68:71], a[164:167], v[120:123], a[68:71]
  s_lshr_b32 s24, s21, 3
  v_mfma_f32_16x16x32_bf16 a[72:75], a[168:171], v[120:123], a[72:75]
  s_add_u32 s23, s23, s24
  v_mfma_f32_16x16x32_bf16 a[76:79], a[172:175], v[120:123], a[76:79]
  s_lshl_b32 s23, s23, 3
  v_mfma_f32_16x16x32_bf16 a[80:83], a[176:179], v[120:123], a[80:83]
  s_and_b32 s24, s21, 7
  v_mfma_f32_16x16x32_bf16 a[84:87], a[180:183], v[120:123], a[84:87]
  s_add_u32 s23, s23, s24
  v_mfma_f32_16x16x32_bf16 a[88:91], a[184:187], v[120:123], a[88:91]
  s_lshl_b32 s23, s23, 2
  v_mfma_f32_16x16x32_bf16 a[92:95], a[188:191], v[120:123], a[92:95]
  s_add_u32 s23, s23, s20
  v_mfma_f32_16x16x32_bf16 a[96:99], a[160:163], v[124:127], a[96:99]
  s_lshl_b32 s23, s23, 2
  v_mfma_f32_16x16x32_bf16 a[100:103], a[164:167], v[124:127], a[100:103]
  s_add_u32 s44, s23, 73424896
  v_mfma_f32_16x16x32_bf16 a[104:107], a[168:171], v[124:127], a[104:107]
  v_mfma_f32_16x16x32_bf16 a[108:111], a[172:175], v[124:127], a[108:111]
  v_mfma_f32_16x16x32_bf16 a[112:115], a[176:179], v[124:127], a[112:115]
  s_waitcnt vmcnt(16)
  s_cmp_lg_u64 s[36:37], 0
  s_cbranch_scc1 L_nopost_38
  v_mov_b32 v31, 1
  s_mov_b64 exec, 1
  buffer_store_dword v31, off, s[8:11], s44 sc1
  s_mov_b64 exec, -1
L_nopost_38:
  v_mfma_f32_16x16x32_bf16 a[116:119], a[180:183], v[124:127], a[116:119]
  v_mfma_f32_16x16x32_bf16 a[120:123], a[184:187], v[124:127], a[120:123]
  v_mfma_f32_16x16x32_bf16 a[124:127], a[188:191], v[124:127], a[124:127]
  v_smfmac_f32_16x16x64_bf16 v[100:103], v[104:107], v[120:127], v108
L_epib_37:
  s_lshl_b32 s23, s45, 18
  s_lshl_b32 s24, s21, 12
  s_add_u32 s23, s23, s24
  s_add_u32 s23, s23, 37748736
  s_add_u32 s24, s23, 131072
  v_mov_b32 v49, 0x71800000
  v_accvgpr_read_b32 v56, a64
  v_accvgpr_read_b32 v57, a65
  v_accvgpr_read_b32 v58, a66
  v_accvgpr_read_b32 v59, a67
  v_accvgpr_read_b32 v60, a68
  v_accvgpr_read_b32 v61, a69
  v_accvgpr_read_b32 v62, a70
  v_accvgpr_read_b32 v63, a71
  v_add_f32 v48, v100, v101
  v_add_f32 v50, v102, v103
  v_add_f32 v51, v48, v50
  v_rcp_f32 v48, v48
  v_rcp_f32 v50, v50
  v_cmp_nlt_f32 s[38:39], v51, v49
  v_pk_mul_f32 v[56:57], v[56:57], v[48:49] op_sel_hi:[1,0]
  v_pk_mul_f32 v[58:59], v[58:59], v[48:49] op_sel_hi:[1,0]
  v_pk_mul_f32 v[60:61], v[60:61], v[48:49] op_sel_hi:[1,0]
  v_pk_mul_f32 v[62:63], v[62:63], v[48:49] op_sel_hi:[1,0]
  v_cvt_pk_bf16_f32 v160, v56, v57
  v_cvt_pk_bf16_f32 v161, v58, v59
  v_cvt_pk_bf16_f32 v162, v60, v61
  v_cvt_pk_bf16_f32 v163, v62, v63
  buffer_store_dwordx4 v[160:163], v2, s[8:11], s23 offen offset:0 sc1
  v_accvgpr_read_b32 v56, a72
  v_accvgpr_read_b32 v57, a73
  v_accvgpr_read_b32 v58, a74
  v_accvgpr_read_b32 v59, a75
  v_accvgpr_read_b32 v60, a76
  v_accvgpr_read_b32 v61, a77
  v_accvgpr_read_b32 v62, a78
  v_accvgpr_read_b32 v63, a79
  v_pk_mul_f32 v[56:57], v[56:57], v[48:49] op_sel_hi:[1,0]
  v_pk_mul_f32 v[58:59], v[58:59], v[48:49] op_sel_hi:[1,0]
  v_pk_mul_f32 v[60:61], v[60:61], v[48:49] op_sel_hi:[1,0]
  v_pk_mul_f32 v[62:63], v[62:63], v[48:49] op_sel_hi:[1,0]
  v_cvt_pk_bf16_f32 v164, v56, v57
  v_cvt_pk_bf16_f32 v165, v58, v59
  v_cvt_pk_bf16_f32 v166, v60, v61
  v_cvt_pk_bf16_f32 v167, v62, v63
  buffer_store_dwordx4 v[164:167], v2, s[8:11], s23 offen offset:1024 sc1
  v_accvgpr_read_b32 v56, a80
  v_accvgpr_read_b32 v57, a81
  v_accvgpr_read_b32 v58, a82
  v_accvgpr_read_b32 v59, a83
  v_accvgpr_read_b32 v60, a84
  v_accvgpr_read_b32 v61, a85
  v_accvgpr_read_b32 v62, a86
  v_accvgpr_read_b32 v63, a87
  v_pk_mul_f32 v[56:57], v[56:57], v[48:49] op_sel_hi:[1,0]
  v_pk_mul_f32 v[58:59], v[58:59], v[48:49] op_sel_hi:[1,0]
  v_pk_mul_f32 v[60:61], v[60:61], v[48:49] op_sel_hi:[1,0]
  v_pk_mul_f32 v[62:63], v[62:63], v[48:49] op_sel_hi:[1,0]
  v_cvt_pk_bf16_f32 v168, v56, v57
  v_cvt_pk_bf16_f32 v169, v58, v59
  v_cvt_pk_bf16_f32 v170, v60, v61
  v_cvt_pk_bf16_f32 v171, v62, v63
  buffer_store_dwordx4 v[168:171], v2, s[8:11], s23 offen offset:2048 sc1
  v_accvgpr_read_b32 v56, a88
  v_accvgpr_read_b32 v57, a89
  v_accvgpr_read_b32 v58, a90
  v_accvgpr_read_b32 v59, a91
  v_accvgpr_read_b32 v60, a92
  v_accvgpr_read_b32 v61, a93
  v_accvgpr_read_b32 v62, a94
  v_accvgpr_read_b32 v63, a95
  v_pk_mul_f32 v[56:57], v[56:57], v[48:49] op_sel_hi:[1,0]
  v_pk_mul_f32 v[58:59], v[58:59], v[48:49] op_sel_hi:[1,0]
  v_pk_mul_f32 v[60:61], v[60:61], v[48:49] op_sel_hi:[1,0]
  v_pk_mul_f32 v[62:63], v[62:63], v[48:49] op_sel_hi:[1,0]
  v_cvt_pk_bf16_f32 v172, v56, v57
  v_cvt_pk_bf16_f32 v173, v58, v59
  v_cvt_pk_bf16_f32 v174, v60, v61
  v_cvt_pk_bf16_f32 v175, v62, v63
  buffer_store_dwordx4 v[172:175], v2, s[8:11], s23 offen offset:3072 sc1
  v_accvgpr_read_b32 v56, a96
  v_accvgpr_read_b32 v57, a97
  v_accvgpr_read_b32 v58, a98
  v_accvgpr_read_b32 v59, a99
  v_accvgpr_read_b32 v60, a100
  v_accvgpr_read_b32 v61, a101
  v_accvgpr_read_b32 v62, a102
  v_accvgpr_read_b32 v63, a103
  v_pk_mul_f32 v[56:57], v[56:57], v[50:51] op_sel_hi:[1,0]
  v_pk_mul_f32 v[58:59], v[58:59], v[50:51] op_sel_hi:[1,0]
  v_pk_mul_f32 v[60:61], v[60:61], v[50:51] op_sel_hi:[1,0]
  v_pk_mul_f32 v[62:63], v[62:63], v[50:51] op_sel_hi:[1,0]
  v_cvt_pk_bf16_f32 v176, v56, v57
  v_cvt_pk_bf16_f32 v177, v58, v59
  v_cvt_pk_bf16_f32 v178, v60, v61
  v_cvt_pk_bf16_f32 v179, v62, v63
  buffer_store_dwordx4 v[176:179], v2, s[8:11], s24 offen offset:0 sc1
  v_accvgpr_read_b32 v56, a104
  v_accvgpr_read_b32 v57, a105
  v_accvgpr_read_b32 v58, a106
  v_accvgpr_read_b32 v59, a107
  v_accvgpr_read_b32 v60, a108
  v_accvgpr_read_b32 v61, a109
  v_accvgpr_read_b32 v62, a110
  v_accvgpr_read_b32 v63, a111
  v_pk_mul_f32 v[56:57], v[56:57], v[50:51] op_sel_hi:[1,0]
  v_pk_mul_f32 v[58:59], v[58:59], v[50:51] op_sel_hi:[1,0]
  v_pk_mul_f32 v[60:61], v[60:61], v[50:51] op_sel_hi:[1,0]
  v_pk_mul_f32 v[62:63], v[62:63], v[50:51] op_sel_hi:[1,0]
  v_cvt_pk_bf16_f32 v180, v56, v57
  v_cvt_pk_bf16_f32 v181, v58, v59
  v_cvt_pk_bf16_f32 v182, v60, v61
  v_cvt_pk_bf16_f32 v183, v62, v63
  buffer_store_dwordx4 v[180:183], v2, s[8:11], s24 offen offset:1024 sc1
  v_accvgpr_read_b32 v56, a112
  v_accvgpr_read_b32 v57, a113
  v_accvgpr_read_b32 v58, a114
  v_accvgpr_read_b32 v59, a115
  v_accvgpr_read_b32 v60, a116
  v_accvgpr_read_b32 v61, a117
  v_accvgpr_read_b32 v62, a118
  v_accvgpr_read_b32 v63, a119
  v_pk_mul_f32 v[56:57], v[56:57], v[50:51] op_sel_hi:[1,0]
  v_pk_mul_f32 v[58:59], v[58:59], v[50:51] op_sel_hi:[1,0]
  v_pk_mul_f32 v[60:61], v[60:61], v[50:51] op_sel_hi:[1,0]
  v_pk_mul_f32 v[62:63], v[62:63], v[50:51] op_sel_hi:[1,0]
  v_cvt_pk_bf16_f32 v184, v56, v57
  v_cvt_pk_bf16_f32 v185, v58, v59
  v_cvt_pk_bf16_f32 v186, v60, v61
  v_cvt_pk_bf16_f32 v187, v62, v63
  buffer_store_dwordx4 v[184:187], v2, s[8:11], s24 offen offset:2048 sc1
  v_accvgpr_read_b32 v56, a120
  v_accvgpr_read_b32 v57, a121
  v_accvgpr_read_b32 v58, a122
  v_accvgpr_read_b32 v59, a123
  v_accvgpr_read_b32 v60, a124
  v_accvgpr_read_b32 v61, a125
  v_accvgpr_read_b32 v62, a126
  v_accvgpr_read_b32 v63, a127
  v_pk_mul_f32 v[56:57], v[56:57], v[50:51] op_sel_hi:[1,0]
  v_pk_mul_f32 v[58:59], v[58:59], v[50:51] op_sel_hi:[1,0]
  v_pk_mul_f32 v[60:61], v[60:61], v[50:51] op_sel_hi:[1,0]
  v_pk_mul_f32 v[62:63], v[62:63], v[50:51] op_sel_hi:[1,0]
  v_cvt_pk_bf16_f32 v188, v56, v57
  v_cvt_pk_bf16_f32 v189, v58, v59
  v_cvt_pk_bf16_f32 v190, v60, v61
  v_cvt_pk_bf16_f32 v191, v62, v63
  buffer_store_dwordx4 v[188:191], v2, s[8:11], s24 offen offset:3072 sc1
  s_or_b64 vcc, s[36:37], s[38:39]
  s_cbranch_scc1 L_fix
L_fixed:
  s_mov_b32 s33, s29
  s_cmp_ge_u32 s20, 2
  s_cselect_b32 s23, s49, 0
  s_add_u32 s33, s33, s23
  s_lshl_b32 s23, s22, 2
  s_lshr_b32 s23, 0x30241302, s23
  s_and_b32 s23, s23, 7
  s_lshl_b32 s27, s23, 15
  s_add_u32 s28, s27, 32768
  s_cmp_ge_u32 s28, 163840
  s_cselect_b32 s28, 0, s28
  s_add_u32 s29, s28, 32768
  s_cmp_ge_u32 s29, 163840
  s_cselect_b32 s29, 0, s29
  s_add_u32 s30, s29, 32768
  s_cmp_ge_u32 s30, 163840
  s_cselect_b32 s30, 0, s30
  s_add_u32 s31, s30, 32768
  s_cmp_ge_u32 s31, 163840
  s_cselect_b32 s31, 0, s31
  s_lshl_b32 s34, s20, 13
  s_and_b32 s26, s2, 7
  s_lshl_b32 s26, s26, 1
  s_and_b32 s23, s2, 16
  s_add_u32 s26, s26, s23
  s_bfe_u32 s23, s2, 0x10003
  s_add_u32 s26, s26, s23
  v_and_b32 v21, 15, v1
  v_lshrrev_b32 v22, 4, v1
  v_lshrrev_b32 v24, 2, v21
  v_lshl_add_u32 v25, v22, 2, v24
  v_lshlrev_b32 v24, 2, v24
  v_and_b32 v26, 1, v22
  v_lshl_add_u32 v24, v26, 1, v24
  s_lshl_b32 s23, s20, 2
  v_bfe_u32 v26, v21, 1, 1
  v_or_b32 v26, s23, v26
  v_xor_b32 v24, v24, v26
  v_lshlrev_b32 v24, 4, v24
  v_lshl_add_u32 v24, v25, 8, v24
  v_and_b32 v26, 1, v21
  v_lshl_add_u32 v7, v26, 3, v24
  v_xor_b32 v8, 32, v7
  v_add_u32 v11, s27, v7
  v_add_u32 v12, s27, v8
  s_and_b32 s23, s45, 60
  s_lshr_b32 s24, s21, 3
  s_add_u32 s23, s23, s24
  s_lshl_b32 s23, s23, 3
  s_and_b32 s24, s21, 7
  s_add_u32 s23, s23, s24
  s_lshl_b32 s23, s23, 2
  s_add_u32 s23, s23, s20
  s_lshl_b32 s23, s23, 2
  s_add_u32 s45, s23, 73424896
  s_cmp_lt_u32 s20, 2
  s_cbranch_scc1 L_nopa_39
  s_and_b32 s23, s44, 60
  s_lshr_b32 s24, s21, 3
  s_add_u32 s23, s23, s24
  s_lshl_b32 s23, s23, 3
  s_and_b32 s24, s21, 7
  s_add_u32 s23, s23, s24
  s_lshl_b32 s23, s23, 2
  s_add_u32 s23, s23, s20
  s_lshl_b32 s23, s23, 2
  s_add_u32 s44, s23, 73424896
  s_waitcnt vmcnt(8)
  v_mov_b32 v31, 1
  s_mov_b64 exec, 1
  buffer_store_dword v31, off, s[8:11], s44 sc1
  s_mov_b64 exec, -1
L_nopa_39:
  s_waitcnt vmcnt(8)
  s_barrier
  ds_read_b64_tr_b16 a[128:129], v11 offset:0
  ds_read_b64_tr_b16 a[130:131], v11 offset:4096
  ds_read_b64_tr_b16 a[132:133], v11 offset:8192
  ds_read_b64_tr_b16 a[134:135], v11 offset:12288
  ds_read_b64_tr_b16 a[136:137], v11 offset:16384
  ds_read_b64_tr_b16 a[138:139], v11 offset:20480
  ds_read_b64_tr_b16 a[140:141], v11 offset:24576
  ds_read_b64_tr_b16 a[142:143], v11 offset:28672
  ds_read_b64_tr_b16 a[144:145], v12 offset:0
  ds_read_b64_tr_b16 a[146:147], v12 offset:4096
  ds_read_b64_tr_b16 a[148:149], v12 offset:8192
  ds_read_b64_tr_b16 a[150:151], v12 offset:12288
  ds_read_b64_tr_b16 a[152:153], v12 offset:16384
  ds_read_b64_tr_b16 a[154:155], v12 offset:20480
  ds_read_b64_tr_b16 a[156:157], v12 offset:24576
  ds_read_b64_tr_b16 a[158:159], v12 offset:28672
  v_add_u32 v11, s28, v7
  v_add_u32 v12, s28, v8
  ds_read_b64_tr_b16 a[160:161], v11 offset:0
  ds_read_b64_tr_b16 a[162:163], v11 offset:4096
  ds_read_b64_tr_b16 a[164:165], v11 offset:8192
  ds_read_b64_tr_b16 a[166:167], v11 offset:12288
  ds_read_b64_tr_b16 a[168:169], v11 offset:16384
  ds_read_b64_tr_b16 a[170:171], v11 offset:20480
  ds_read_b64_tr_b16 a[172:173], v11 offset:24576
  ds_read_b64_tr_b16 a[174:175], v11 offset:28672
  ds_read_b64_tr_b16 a[176:177], v12 offset:0
  ds_read_b64_tr_b16 a[178:179], v12 offset:4096
  ds_read_b64_tr_b16 a[180:181], v12 offset:8192
  ds_read_b64_tr_b16 a[182:183], v12 offset:12288
  ds_read_b64_tr_b16 a[184:185], v12 offset:16384
  ds_read_b64_tr_b16 a[186:187], v12 offset:20480
  ds_read_b64_tr_b16 a[188:189], v12 offset:24576
  ds_read_b64_tr_b16 a[190:191], v12 offset:28672
  v_add_u32 v11, s29, v7
  v_add_u32 v12, s29, v8
  s_mov_b32 s42, s45
  s_lshr_b32 s23, s26, 1
  s_lshl_b32 s32, s23, 20
  s_lshl_b32 s24, s20, 18
  s_add_u32 s32, s32, s24
  s_and_b32 s24, s26, 1
  s_lshl_b32 s24, s24, 1
  s_lshr_b32 s25, s22, 2
  s_add_u32 s24, s24, s25
  s_lshl_b32 s35, s23, 2
  s_add_u32 s35, s35, s24
  s_lshl_b32 s35, s35, 7
  s_add_u32 s35, s35, 73424896
  s_lshl_b32 s25, s24, 15
  s_add_u32 s32, s32, s25
  s_add_u32 s32, s32, 37748736
  s_lshl_b32 s44, s23, 20
  s_add_u32 s44, s44, s25
  s_lshl_b32 s36, s23, 7
  s_add_u32 s36, s36, 73408512
  s_waitcnt vmcnt(0)
  v_mov_b32 v31, 1
  s_mov_b64 exec, 1
  buffer_store_dword v31, off, s[8:11], s42 sc1
  s_mov_b64 exec, -1
  s_add_u32 m0, s31, s34
  s_nop 0
  buffer_load_dwordx4 v5, s[12:15], s33 offen lds
  ds_read_b64_tr_b16 a[64:65], v11 offset:0
  ds_read_b64_tr_b16 a[66:67], v11 offset:4096
  ds_read_b64_tr_b16 a[68:69], v11 offset:8192
  ds_read_b64_tr_b16 a[70:71], v11 offset:12288
  ds_read_b64_tr_b16 a[72:73], v11 offset:16384
  ds_read_b64_tr_b16 a[74:75], v11 offset:20480
  buffer_load_dwordx4 v6, s[12:15], s33 offen offset:1024 lds
  ds_read_b64_tr_b16 a[76:77], v11 offset:24576
  ds_read_b64_tr_b16 a[78:79], v11 offset:28672
  ds_read_b64_tr_b16 a[80:81], v12 offset:0
  ds_read_b64_tr_b16 a[82:83], v12 offset:4096
  ds_read_b64_tr_b16 a[84:85], v12 offset:8192
  ds_read_b64_tr_b16 a[86:87], v12 offset:12288
  buffer_load_dwordx4 v15, s[12:15], s33 offen offset:2048 lds
  ds_read_b64_tr_b16 a[88:89], v12 offset:16384
  ds_read_b64_tr_b16 a[90:91], v12 offset:20480
  ds_read_b64_tr_b16 a[92:93], v12 offset:24576
  ds_read_b64_tr_b16 a[94:95], v12 offset:28672
  v_add_u32 v11, s30, v7
  v_add_u32 v12, s30, v8
  buffer_load_dwordx4 v16, s[12:15], s33 offen offset:3072 lds
  ds_read_b64_tr_b16 a[96:97], v11 offset:0
  ds_read_b64_tr_b16 a[98:99], v11 offset:4096
  ds_read_b64_tr_b16 a[100:101], v11 offset:8192
  ds_read_b64_tr_b16 a[102:103], v11 offset:12288
  ds_read_b64_tr_b16 a[104:105], v11 offset:16384
  ds_read_b64_tr_b16 a[106:107], v11 offset:20480
  s_add_u32 m0, m0, 4096
  s_add_u32 s33, s33, s48
  buffer_load_dwordx4 v5, s[12:15], s33 offen lds
  ds_read_b64_tr_b16 a[108:109], v11 offset:24576
  ds_read_b64_tr_b16 a[110:111], v11 offset:28672
  ds_read_b64_tr_b16 a[112:113], v12 offset:0
  ds_read_b64_tr_b16 a[114:115], v12 offset:4096
  ds_read_b64_tr_b16 a[116:117], v12 offset:8192
  ds_read_b64_tr_b16 a[118:119], v12 offset:12288
  buffer_load_dwordx4 v6, s[12:15], s33 offen offset:1024 lds
  ds_read_b64_tr_b16 a[120:121], v12 offset:16384
  ds_read_b64_tr_b16 a[122:123], v12 offset:20480
  ds_read_b64_tr_b16 a[124:125], v12 offset:24576
  ds_read_b64_tr_b16 a[126:127], v12 offset:28672
  s_and_b32 s23, s22, 3
  s_lshl_b32 s23, s23, 2
  buffer_load_dwordx4 v15, s[12:15], s33 offen offset:2048 lds
  s_add_u32 s23, s23, s20
  s_lshl_b32 s23, s23, 10
  s_add_u32 s44, s44, s23
  s_add_u32 s44, s44, 37748736
  s_and_b32 s23, s26, 1
  s_lshl_b32 s23, s23, 3
  buffer_load_dwordx4 v16, s[12:15], s33 offen offset:3072 lds
  s_add_u32 s23, s23, s22
  s_lshl_b32 s23, s23, 2
  s_add_u32 s42, s36, s23
  v_lshlrev_b32 v20, 2, v21
  v_add_u32 v3, s27, v2
  v_lshlrev_b32 v4, 2, v1
  buffer_load_dword v19, v18, s[8:11], s35 offen sc1
  s_waitcnt lgkmcnt(0)
  s_barrier
  s_add_u32 m0, s30, s34
  s_add_u32 s33, s33, s49
  buffer_load_dwordx4 v5, s[12:15], s33 offen lds
  buffer_load_dwordx4 v6, s[12:15], s33 offen offset:1024 lds
  buffer_load_dwordx4 v15, s[12:15], s33 offen offset:2048 lds
  buffer_load_dwordx4 v16, s[12:15], s33 offen offset:3072 lds
  s_add_u32 m0, m0, 4096
  s_add_u32 s33, s33, s48
  buffer_load_dwordx4 v5, s[12:15], s33 offen lds
  buffer_load_dwordx4 v6, s[12:15], s33 offen offset:1024 lds
  buffer_load_dwordx4 v15, s[12:15], s33 offen offset:2048 lds
  buffer_load_dwordx4 v16, s[12:15], s33 offen offset:3072 lds
  s_waitcnt vmcnt(8)
  v_cmp_eq_u32 vcc, 0, v19
  s_cbranch_vccnz L_spin_40
L_back_41:
  s_add_u32 m0, s27, s34
  s_nop 0
  buffer_load_dwordx4 v2, s[8:11], s32 offen sc1 lds
  v_and_b32 v25, 7, v1
  v_lshlrev_b32 v25, 10, v25
  buffer_load_dwordx4 v2, s[8:11], s32 offen offset:1024 sc1 lds
  v_bfe_u32 v26, v1, 3, 2
  v_lshl_add_u32 v25, v26, 3, v25
  buffer_load_dwordx4 v2, s[8:11], s32 offen offset:2048 sc1 lds
  v_lshrrev_b32 v26, 5, v1
  v_lshl_add_u32 v25, v26, 6, v25
  buffer_load_dwordx4 v2, s[8:11], s32 offen offset:3072 sc1 lds
  s_lshl_b32 s23, s26, 3
  s_add_u32 s23, s23, s22
  s_add_u32 m0, m0, 4096
  s_add_u32 s32, s32, 131072
  buffer_load_dwordx4 v2, s[8:11], s32 offen sc1 lds
  s_lshl_b32 s23, s23, 13
  s_lshl_b32 s24, s20, 8
  buffer_load_dwordx4 v2, s[8:11], s32 offen offset:1024 sc1 lds
  s_add_u32 s23, s23, s24
  v_add_u32 v30, s23, v25
  buffer_load_dwordx4 v2, s[8:11], s32 offen offset:2048 sc1 lds
  s_lshl_b32 s23, s26, 7
  s_add_u32 s23, s23, 73412608
  buffer_load_dwordx4 v2, s[8:11], s32 offen offset:3072 sc1 lds
  v_lshlrev_b32 v26, 12, v22
  v_min_u32 v26, 0x2000, v26
  s_add_u32 m0, s28, s34
  s_sub_u32 s32, s32, 126976
  buffer_load_dwordx4 v2, s[8:11], s32 offen sc1 lds
  v_add_u32 v26, s23, v26
  v_mov_b32 v27, s36
  buffer_load_dwordx4 v2, s[8:11], s32 offen offset:1024 sc1 lds
  v_cmp_gt_u32 vcc, 8, v1
  v_lshlrev_b32 v28, 7, v1
  buffer_load_dwordx4 v2, s[8:11], s32 offen offset:2048 sc1 lds
  s_mov_b32 s72, s56
  v_cndmask_b32 v26, v26, v27, vcc
  buffer_load_dwordx4 v2, s[8:11], s32 offen offset:3072 sc1 lds
  s_mov_b32 s73, s57
  s_movk_i32 s74, 2752
  s_add_u32 m0, m0, 4096
  s_add_u32 s32, s32, 131072
  buffer_load_dwordx4 v2, s[8:11], s32 offen sc1 lds
  s_mov_b32 s76, s60
  s_mov_b32 s77, s61
  buffer_load_dwordx4 v2, s[8:11], s32 offen offset:1024 sc1 lds
  s_movk_i32 s78, 1024
  buffer_load_dwordx4 v2, s[8:11], s32 offen offset:2048 sc1 lds
  buffer_load_dwordx4 v2, s[8:11], s32 offen offset:3072 sc1 lds
  s_waitcnt vmcnt(8)
  s_barrier
  ds_read_b128 v[128:131], v3 offset:0
  ds_read_b128 v[132:135], v3 offset:1024
  ds_read_b128 v[136:139], v3 offset:2048
  ds_read_b128 v[140:143], v3 offset:3072
  ds_read_b128 v[144:147], v3 offset:4096
  ds_read_b128 v[148:151], v3 offset:5120
  ds_read_b128 v[152:155], v3 offset:6144
  ds_read_b128 v[156:159], v3 offset:7168
  ds_read_b128 v[160:163], v3 offset:8192
  ds_read_b128 v[164:167], v3 offset:9216
  ds_read_b128 v[168:171], v3 offset:10240
  ds_read_b128 v[172:175], v3 offset:11264
  s_waitcnt lgkmcnt(8)
  v_mfma_f32_16x16x32_bf16 v[64:67], a[128:131], v[128:131], 0
  ds_read_b128 v[176:179], v3 offset:12288
  v_mfma_f32_16x16x32_bf16 v[64:67], a[132:135], v[132:135], v[64:67]
  s_add_u32 m0, s29, s34
  v_add_u32 v11, s31, v7
  v_add_u32 v12, s31, v8
  v_mfma_f32_16x16x32_bf16 v[64:67], a[136:139], v[136:139], v[64:67]
  s_sub_u32 s32, s32, 126976
  ds_read_b128 v[180:183], v3 offset:13312
  v_mfma_f32_16x16x32_bf16 v[64:67], a[140:143], v[140:143], v[64:67]
  buffer_load_dwordx4 v2, s[8:11], s32 offen sc1 lds
  v_mfma_f32_16x16x32_bf16 v[68:71], a[156:159], v[140:143], 0
  ds_read_b128 v[184:187], v3 offset:14336
  v_mfma_f32_16x16x32_bf16 v[68:71], a[152:155], v[136:139], v[68:71]
  ds_read_b64_tr_b16 v[192:193], v11 offset:0
  v_mfma_f32_16x16x32_bf16 v[68:71], a[148:151], v[132:135], v[68:71]
  ds_read_b128 v[188:191], v3 offset:15360
  v_mfma_f32_16x16x32_bf16 v[68:71], a[144:147], v[128:131], v[68:71]
  s_waitcnt lgkmcnt(5)
  ds_read_b64_tr_b16 v[194:195], v11 offset:4096
  v_mfma_f32_16x16x32_bf16 v[76:79], a[144:147], v[144:147], 0
  ds_read_b128 v[128:131], v3 offset:16384
  v_mfma_f32_16x16x32_bf16 v[76:79], a[148:151], v[148:151], v[76:79]
  buffer_load_dwordx4 v2, s[8:11], s32 offen offset:1024 sc1 lds
  v_mfma_f32_16x16x32_bf16 v[76:79], a[152:155], v[152:155], v[76:79]
  ds_read_b128 v[132:135], v3 offset:17408
  v_mfma_f32_16x16x32_bf16 v[76:79], a[156:159], v[156:159], v[76:79]
  ds_read_b64_tr_b16 v[196:197], v11 offset:8192
  v_mfma_f32_16x16x32_bf16 v[72:75], a[140:143], v[156:159], 0
  ds_read_b128 v[136:139], v3 offset:18432
  v_mfma_f32_16x16x32_bf16 v[72:75], a[136:139], v[152:155], v[72:75]
  buffer_load_dwordx4 v2, s[8:11], s32 offen offset:2048 sc1 lds
  v_mfma_f32_16x16x32_bf16 v[72:75], a[132:135], v[148:151], v[72:75]
  ds_read_b128 v[140:143], v3 offset:19456
  v_mfma_f32_16x16x32_bf16 v[72:75], a[128:131], v[144:147], v[72:75]
  s_waitcnt lgkmcnt(11)
  ds_read_b64_tr_b16 v[198:199], v11 offset:12288
  v_mfma_f32_16x16x32_bf16 v[80:83], a[128:131], v[160:163], 0
  ds_read_b128 v[144:147], v3 offset:20480
  v_mfma_f32_16x16x32_bf16 v[80:83], a[132:135], v[164:167], v[80:83]
  buffer_load_dwordx4 v2, s[8:11], s32 offen offset:3072 sc1 lds
  v_mfma_f32_16x16x32_bf16 v[80:83], a[136:139], v[168:171], v[80:83]
  ds_read_b128 v[148:151], v3 offset:21504
  v_mfma_f32_16x16x32_bf16 v[80:83], a[140:143], v[172:175], v[80:83]
  s_add_u32 m0, m0, 4096
  ds_read_b64_tr_b16 v[200:201], v11 offset:16384
  v_mfma_f32_16x16x32_bf16 v[84:87], a[156:159], v[172:175], 0
  s_add_u32 s32, s32, 131072
  ds_read_b128 v[152:155], v3 offset:22528
  v_mfma_f32_16x16x32_bf16 v[84:87], a[152:155], v[168:171], v[84:87]
  buffer_load_dwordx4 v2, s[8:11], s32 offen sc1 lds
  v_mfma_f32_16x16x32_bf16 v[84:87], a[148:151], v[164:167], v[84:87]
  ds_read_b128 v[156:159], v3 offset:23552
  v_mfma_f32_16x16x32_bf16 v[84:87], a[144:147], v[160:163], v[84:87]
  s_waitcnt lgkmcnt(12)
  ds_read_b64_tr_b16 v[202:203], v11 offset:20480
  v_mfma_f32_16x16x32_bf16 v[92:95], a[144:147], v[176:179], 0
  ds_read_b128 v[160:163], v3 offset:24576
  v_mfma_f32_16x16x32_bf16 v[92:95], a[148:151], v[180:183], v[92:95]
  buffer_load_dwordx4 v2, s[8:11], s32 offen offset:1024 sc1 lds
  v_mfma_f32_16x16x32_bf16 v[92:95], a[152:155], v[184:187], v[92:95]
  ds_read_b128 v[164:167], v3 offset:25600
  v_mfma_f32_16x16x32_bf16 v[92:95], a[156:159], v[188:191], v[92:95]
  ds_read_b64_tr_b16 v[204:205], v11 offset:24576
  v_mfma_f32_16x16x32_bf16 v[88:91], a[140:143], v[188:191], 0
  ds_read_b128 v[168:171], v3 offset:26624
  v_mfma_f32_16x16x32_bf16 v[88:91], a[136:139], v[184:187], v[88:91]
  buffer_load_dwordx4 v2, s[8:11], s32 offen offset:2048 sc1 lds
  v_mfma_f32_16x16x32_bf16 v[88:91], a[132:135], v[180:183], v[88:91]
  ds_read_b128 v[172:175], v3 offset:27648
  v_mfma_f32_16x16x32_bf16 v[88:91], a[128:131], v[176:179], v[88:91]
  s_waitcnt lgkmcnt(12)
  ds_read_b64_tr_b16 v[206:207], v11 offset:28672
  v_mfma_f32_16x16x32_bf16 v[96:99], a[128:131], v[128:131], 0
  ds_read_b128 v[176:179], v3 offset:28672
  v_mfma_f32_16x16x32_bf16 v[96:99], a[132:135], v[132:135], v[96:99]
  ds_read_b128 v[180:183], v3 offset:29696
  v_mfma_f32_16x16x32_bf16 v[96:99], a[136:139], v[136:139], v[96:99]
  ds_read_b128 v[184:187], v3 offset:30720
  v_mfma_f32_16x16x32_bf16 v[96:99], a[140:143], v[140:143], v[96:99]
  ds_read_b128 v[188:191], v3 offset:31744
  v_mfma_f32_16x16x32_bf16 v[100:103], a[156:159], v[140:143], 0
  buffer_load_dwordx4 v2, s[8:11], s32 offen offset:3072 sc1 lds
  v_mfma_f32_16x16x32_bf16 v[100:103], a[152:155], v[136:139], v[100:103]
  ds_read_b64_tr_b16 v[208:209], v12 offset:0
  v_mfma_f32_16x16x32_bf16 v[100:103], a[148:151], v[132:135], v[100:103]
  ds_read_b64_tr_b16 v[210:211], v12 offset:4096
  v_mfma_f32_16x16x32_bf16 v[100:103], a[144:147], v[128:131], v[100:103]
  s_waitcnt lgkmcnt(13)
  ds_read_b64_tr_b16 v[212:213], v12 offset:8192
  v_mfma_f32_16x16x32_bf16 v[108:111], a[144:147], v[144:147], 0
  buffer_load_dword v0, v26, s[8:11], 0 offen sc1
  v_mfma_f32_16x16x32_bf16 v[108:111], a[148:151], v[148:151], v[108:111]
  ds_read_b64_tr_b16 v[214:215], v12 offset:12288
  v_mfma_f32_16x16x32_bf16 v[108:111], a[152:155], v[152:155], v[108:111]
  v_add_u32 v3, s28, v2
  v_mfma_f32_16x16x32_bf16 v[108:111], a[156:159], v[156:159], v[108:111]
  s_waitcnt vmcnt(9) lgkmcnt(4)
  s_barrier
  v_mfma_f32_16x16x32_bf16 v[104:107], a[140:143], v[156:159], 0
  ds_read_b128 v[128:131], v3 offset:0
  v_mfma_f32_16x16x32_bf16 v[104:107], a[136:139], v[152:155], v[104:107]
  ds_read_b128 v[132:135], v3 offset:1024
  v_mfma_f32_16x16x32_bf16 v[104:107], a[132:135], v[148:151], v[104:107]
  ds_read_b128 v[136:139], v3 offset:2048
  v_mfma_f32_16x16x32_bf16 v[104:107], a[128:131], v[144:147], v[104:107]
  s_waitcnt lgkmcnt(12)
  s_add_u32 m0, s27, s34
  ds_read_b64_tr_b16 v[216:217], v12 offset:16384
  v_mfma_f32_16x16x32_bf16 v[112:115], a[128:131], v[160:163], 0
  s_sub_u32 s32, s32, 126976
  ds_read_b128 v[140:143], v3 offset:3072
  v_mfma_f32_16x16x32_bf16 v[112:115], a[132:135], v[164:167], v[112:115]
  buffer_load_dwordx4 v2, s[8:11], s32 offen sc1 lds
  v_mfma_f32_16x16x32_bf16 v[112:115], a[136:139], v[168:171], v[112:115]
  ds_read_b128 v[144:147], v3 offset:4096
  v_mfma_f32_16x16x32_bf16 v[112:115], a[140:143], v[172:175], v[112:115]
  ds_read_b128 v[148:151], v3 offset:5120
  v_mfma_f32_16x16x32_bf16 v[116:119], a[156:159], v[172:175], 0
  ds_read_b128 v[152:155], v3 offset:6144
  v_mfma_f32_16x16x32_bf16 v[116:119], a[152:155], v[168:171], v[116:119]
  buffer_load_dwordx4 v2, s[8:11], s32 offen offset:1024 sc1 lds
  v_mfma_f32_16x16x32_bf16 v[116:119], a[148:151], v[164:167], v[116:119]
  ds_read_b128 v[156:159], v3 offset:7168
  v_mfma_f32_16x16x32_bf16 v[116:119], a[144:147], v[160:163], v[116:119]
  s_waitcnt lgkmcnt(13)
  ds_read_b64_tr_b16 v[218:219], v12 offset:20480
  v_mfma_f32_16x16x32_bf16 v[124:127], a[144:147], v[176:179], 0
  ds_read_b128 v[160:163], v3 offset:8192
  v_mfma_f32_16x16x32_bf16 v[124:127], a[148:151], v[180:183], v[124:127]
  ds_read_b128 v[164:167], v3 offset:9216
  v_mfma_f32_16x16x32_bf16 v[124:127], a[152:155], v[184:187], v[124:127]
  ds_read_b128 v[168:171], v3 offset:10240
  v_mfma_f32_16x16x32_bf16 v[124:127], a[156:159], v[188:191], v[124:127]
  buffer_load_dwordx4 v2, s[8:11], s32 offen offset:2048 sc1 lds
  v_mfma_f32_16x16x32_bf16 v[120:123], a[140:143], v[188:191], 0
  s_lshl_b32 s43, s22, 2
  ds_read_b128 v[172:175], v3 offset:11264
  v_mfma_f32_16x16x32_bf16 v[120:123], a[136:139], v[184:187], v[120:123]
  s_add_u32 s43, s43, s20
  ds_read_b64_tr_b16 v[220:221], v12 offset:24576
  v_mfma_f32_16x16x32_bf16 v[120:123], a[132:135], v[180:183], v[120:123]
  s_mul_i32 s37, s43, 3072
  ds_read_b64_tr_b16 v[222:223], v12 offset:28672
  v_mfma_f32_16x16x32_bf16 v[120:123], a[128:131], v[176:179], v[120:123]
  s_waitcnt lgkmcnt(11)
  v_mfma_f32_16x16x32_bf16 v[64:67], a[160:163], v[128:131], v[64:67]
  ds_read_b128 v[176:179], v3 offset:12288
  v_mfma_f32_16x16x32_bf16 v[64:67], a[164:167], v[132:135], v[64:67]
  buffer_load_dwordx4 v2, s[8:11], s32 offen offset:3072 sc1 lds
  v_mfma_f32_16x16x32_bf16 v[64:67], a[168:171], v[136:139], v[64:67]
  ds_read_b128 v[180:183], v3 offset:13312
  v_mfma_f32_16x16x32_bf16 v[64:67], a[172:175], v[140:143], v[64:67]
  s_add_u32 m0, m0, 4096
  v_add_u32 v11, s30, v7
  v_add_u32 v12, s30, v8
  v_mfma_f32_16x16x32_bf16 v[68:71], a[188:191], v[140:143], v[68:71]
  s_add_u32 s32, s32, 131072
  ds_read_b128 v[184:187], v3 offset:14336
  v_mfma_f32_16x16x32_bf16 v[68:71], a[184:187], v[136:139], v[68:71]
  buffer_load_dwordx4 v2, s[8:11], s32 offen sc1 lds
  v_mfma_f32_16x16x32_bf16 v[68:71], a[180:183], v[132:135], v[68:71]
  ds_read_b128 v[188:191], v3 offset:15360
  v_mfma_f32_16x16x32_bf16 v[68:71], a[176:179], v[128:131], v[68:71]
  s_waitcnt lgkmcnt(11)
  ds_read_b64_tr_b16 a[128:129], v11 offset:0
  v_mfma_f32_16x16x32_bf16 v[76:79], a[176:179], v[144:147], v[76:79]
  ds_read_b128 v[128:131], v3 offset:16384
  v_mfma_f32_16x16x32_bf16 v[76:79], a[180:183], v[148:151], v[76:79]
  buffer_load_dwordx4 v2, s[8:11], s32 offen offset:1024 sc1 lds
  v_mfma_f32_16x16x32_bf16 v[76:79], a[184:187], v[152:155], v[76:79]
  ds_read_b128 v[132:135], v3 offset:17408
  v_mfma_f32_16x16x32_bf16 v[76:79], a[188:191], v[156:159], v[76:79]
  ds_read_b64_tr_b16 a[130:131], v11 offset:4096
  v_mfma_f32_16x16x32_bf16 v[72:75], a[172:175], v[156:159], v[72:75]
  ds_read_b128 v[136:139], v3 offset:18432
  v_mfma_f32_16x16x32_bf16 v[72:75], a[168:171], v[152:155], v[72:75]
  buffer_load_dwordx4 v2, s[8:11], s32 offen offset:2048 sc1 lds
  v_mfma_f32_16x16x32_bf16 v[72:75], a[164:167], v[148:151], v[72:75]
  ds_read_b128 v[140:143], v3 offset:19456
  v_mfma_f32_16x16x32_bf16 v[72:75], a[160:163], v[144:147], v[72:75]
  s_waitcnt lgkmcnt(12)
  ds_read_b64_tr_b16 a[132:133], v11 offset:8192
  v_mfma_f32_16x16x32_bf16 v[80:83], a[160:163], v[160:163], v[80:83]
  ds_read_b128 v[144:147], v3 offset:20480
  v_mfma_f32_16x16x32_bf16 v[80:83], a[164:167], v[164:167], v[80:83]
  buffer_load_dwordx4 v2, s[8:11], s32 offen offset:3072 sc1 lds
  v_mfma_f32_16x16x32_bf16 v[80:83], a[168:171], v[168:171], v[80:83]
  ds_read_b128 v[148:151], v3 offset:21504
  v_mfma_f32_16x16x32_bf16 v[80:83], a[172:175], v[172:175], v[80:83]
  ds_read_b64_tr_b16 a[134:135], v11 offset:12288
  v_mfma_f32_16x16x32_bf16 v[84:87], a[188:191], v[172:175], v[84:87]
  ds_read_b128 v[152:155], v3 offset:22528
  v_mfma_f32_16x16x32_bf16 v[84:87], a[184:187], v[168:171], v[84:87]
  buffer_load_dwordx2 v[32:33], v30, s[68:71], 0 offen offset:0
  v_mfma_f32_16x16x32_bf16 v[84:87], a[180:183], v[164:167], v[84:87]
  ds_read_b128 v[156:159], v3 offset:23552
  v_mfma_f32_16x16x32_bf16 v[84:87], a[176:179], v[160:163], v[84:87]
  s_waitcnt lgkmcnt(12)
  ds_read_b64_tr_b16 a[136:137], v11 offset:16384
  v_mfma_f32_16x16x32_bf16 v[92:95], a[176:179], v[176:179], v[92:95]
  ds_read_b128 v[160:163], v3 offset:24576
  v_mfma_f32_16x16x32_bf16 v[92:95], a[180:183], v[180:183], v[92:95]
  buffer_load_dwordx2 v[34:35], v30, s[68:71], 0 offen offset:32
  v_mfma_f32_16x16x32_bf16 v[92:95], a[184:187], v[184:187], v[92:95]
  ds_read_b128 v[164:167], v3 offset:25600
  v_mfma_f32_16x16x32_bf16 v[92:95], a[188:191], v[188:191], v[92:95]
  ds_read_b64_tr_b16 a[138:139], v11 offset:20480
  v_mfma_f32_16x16x32_bf16 v[88:91], a[172:175], v[188:191], v[88:91]
  ds_read_b128 v[168:171], v3 offset:26624
  v_mfma_f32_16x16x32_bf16 v[88:91], a[168:171], v[184:187], v[88:91]
  buffer_load_dwordx2 v[36:37], v30, s[68:71], 0 offen offset:128
  v_mfma_f32_16x16x32_bf16 v[88:91], a[164:167], v[180:183], v[88:91]
  ds_read_b128 v[172:175], v3 offset:27648
  v_mfma_f32_16x16x32_bf16 v[88:91], a[160:163], v[176:179], v[88:91]
  s_waitcnt lgkmcnt(12)
  ds_read_b64_tr_b16 a[140:141], v11 offset:24576
  v_mfma_f32_16x16x32_bf16 v[96:99], a[160:163], v[128:131], v[96:99]
  ds_read_b128 v[176:179], v3 offset:28672
  v_mfma_f32_16x16x32_bf16 v[96:99], a[164:167], v[132:135], v[96:99]
  ds_read_b128 v[180:183], v3 offset:29696
  v_mfma_f32_16x16x32_bf16 v[96:99], a[168:171], v[136:139], v[96:99]
  ds_read_b128 v[184:187], v3 offset:30720
  v_mfma_f32_16x16x32_bf16 v[96:99], a[172:175], v[140:143], v[96:99]
  ds_read_b128 v[188:191], v3 offset:31744
  v_mfma_f32_16x16x32_bf16 v[100:103], a[188:191], v[140:143], v[100:103]
  buffer_load_dwordx2 v[38:39], v30, s[68:71], 0 offen offset:160
  v_mfma_f32_16x16x32_bf16 v[100:103], a[184:187], v[136:139], v[100:103]
  ds_read_b64_tr_b16 a[142:143], v11 offset:28672
  v_mfma_f32_16x16x32_bf16 v[100:103], a[180:183], v[132:135], v[100:103]
  ds_read_b64_tr_b16 a[144:145], v12 offset:0
  v_mfma_f32_16x16x32_bf16 v[100:103], a[176:179], v[128:131], v[100:103]
  s_waitcnt lgkmcnt(13)
  ds_read_b64_tr_b16 a[146:147], v12 offset:4096
  v_mfma_f32_16x16x32_bf16 v[108:111], a[176:179], v[144:147], v[108:111]
  buffer_load_dword v0, v28, s[72:75], 0 offen
  v_mfma_f32_16x16x32_bf16 v[108:111], a[180:183], v[148:151], v[108:111]
  ds_read_b64_tr_b16 a[148:149], v12 offset:8192
  v_mfma_f32_16x16x32_bf16 v[108:111], a[184:187], v[152:155], v[108:111]
  v_add_u32 v3, s29, v2
  v_mfma_f32_16x16x32_bf16 v[108:111], a[188:191], v[156:159], v[108:111]
  s_waitcnt vmcnt(14) lgkmcnt(4)
  s_barrier
  v_mfma_f32_16x16x32_bf16 v[104:107], a[172:175], v[156:159], v[104:107]
  ds_read_b128 v[128:131], v3 offset:0
  v_mfma_f32_16x16x32_bf16 v[104:107], a[168:171], v[152:155], v[104:107]
  ds_read_b128 v[132:135], v3 offset:1024
  v_mfma_f32_16x16x32_bf16 v[104:107], a[164:167], v[148:151], v[104:107]
  ds_read_b128 v[136:139], v3 offset:2048
  v_mfma_f32_16x16x32_bf16 v[104:107], a[160:163], v[144:147], v[104:107]
  s_waitcnt lgkmcnt(12)
  ds_read_b64_tr_b16 a[150:151], v12 offset:12288
  v_mfma_f32_16x16x32_bf16 v[112:115], a[160:163], v[160:163], v[112:115]
  ds_read_b128 v[140:143], v3 offset:3072
  v_mfma_f32_16x16x32_bf16 v[112:115], a[164:167], v[164:167], v[112:115]
  buffer_load_dword v0, v28, s[76:79], 0 offen
  v_mfma_f32_16x16x32_bf16 v[112:115], a[168:171], v[168:171], v[112:115]
  ds_read_b128 v[144:147], v3 offset:4096
  v_mfma_f32_16x16x32_bf16 v[112:115], a[172:175], v[172:175], v[112:115]
  s_add_u32 m0, s28, s34
  ds_read_b128 v[148:151], v3 offset:5120
  v_mfma_f32_16x16x32_bf16 v[116:119], a[188:191], v[172:175], v[116:119]
  s_sub_u32 s32, s32, 126976
  ds_read_b128 v[152:155], v3 offset:6144
  v_mfma_f32_16x16x32_bf16 v[116:119], a[184:187], v[168:171], v[116:119]
  buffer_load_dwordx4 v2, s[8:11], s32 offen sc1 lds
  v_mfma_f32_16x16x32_bf16 v[116:119], a[180:183], v[164:167], v[116:119]
  ds_read_b128 v[156:159], v3 offset:7168
  v_mfma_f32_16x16x32_bf16 v[116:119], a[176:179], v[160:163], v[116:119]
  s_waitcnt lgkmcnt(13)
  ds_read_b64_tr_b16 a[152:153], v12 offset:16384
  v_mfma_f32_16x16x32_bf16 v[124:127], a[176:179], v[176:179], v[124:127]
  ds_read_b128 v[160:163], v3 offset:8192
  v_mfma_f32_16x16x32_bf16 v[124:127], a[180:183], v[180:183], v[124:127]
  ds_read_b128 v[164:167], v3 offset:9216
  v_mfma_f32_16x16x32_bf16 v[124:127], a[184:187], v[184:187], v[124:127]
  ds_read_b128 v[168:171], v3 offset:10240
  v_mfma_f32_16x16x32_bf16 v[124:127], a[188:191], v[188:191], v[124:127]
  buffer_load_dwordx4 v2, s[8:11], s32 offen offset:1024 sc1 lds
  v_mfma_f32_16x16x32_bf16 v[120:123], a[172:175], v[188:191], v[120:123]
  ds_read_b128 v[172:175], v3 offset:11264
  v_mfma_f32_16x16x32_bf16 v[120:123], a[168:171], v[184:187], v[120:123]
  ds_read_b64_tr_b16 a[154:155], v12 offset:20480
  v_mfma_f32_16x16x32_bf16 v[120:123], a[164:167], v[180:183], v[120:123]
  ds_read_b64_tr_b16 a[156:157], v12 offset:24576
  v_mfma_f32_16x16x32_bf16 v[120:123], a[160:163], v[176:179], v[120:123]
  s_waitcnt lgkmcnt(11)
  ds_read_b64_tr_b16 a[158:159], v12 offset:28672
  v_mfma_f32_16x16x32_bf16 v[64:67], a[64:67], v[128:131], v[64:67]
  ds_read_b128 v[176:179], v3 offset:12288
  v_mfma_f32_16x16x32_bf16 v[64:67], a[68:71], v[132:135], v[64:67]
  buffer_load_dwordx4 v2, s[8:11], s32 offen offset:2048 sc1 lds
  v_mfma_f32_16x16x32_bf16 v[64:67], a[72:75], v[136:139], v[64:67]
  ds_read_b128 v[180:183], v3 offset:13312
  v_mfma_f32_16x16x32_bf16 v[64:67], a[76:79], v[140:143], v[64:67]
  s_add_u32 s4, s66, 58720256
  s_addc_u32 s5, s67, 0
  v_mfma_f32_16x16x32_bf16 v[68:71], a[92:95], v[140:143], v[68:71]
  ds_read_b128 v[184:187], v3 offset:14336
  v_mfma_f32_16x16x32_bf16 v[68:71], a[88:91], v[136:139], v[68:71]
  buffer_load_dwordx4 v2, s[8:11], s32 offen offset:3072 sc1 lds
  v_mfma_f32_16x16x32_bf16 v[68:71], a[84:87], v[132:135], v[68:71]
  ds_read_b128 v[188:191], v3 offset:15360
  v_mfma_f32_16x16x32_bf16 v[68:71], a[80:83], v[128:131], v[68:71]
  s_waitcnt lgkmcnt(12)
  s_add_u32 m0, m0, 4096
  v_mfma_f32_16x16x32_bf16 v[76:79], a[80:83], v[144:147], v[76:79]
  s_add_u32 s32, s32, 131072
  ds_read_b128 v[128:131], v3 offset:16384
  v_mfma_f32_16x16x32_bf16 v[76:79], a[84:87], v[148:151], v[76:79]
  buffer_load_dwordx4 v2, s[8:11], s32 offen sc1 lds
  v_mfma_f32_16x16x32_bf16 v[76:79], a[88:91], v[152:155], v[76:79]
  ds_read_b128 v[132:135], v3 offset:17408
  v_mfma_f32_16x16x32_bf16 v[76:79], a[92:95], v[156:159], v[76:79]
  s_cmp_lt_u32 s43, 29
  s_cselect_b32 s6, 1409024, 0
  v_mfma_f32_16x16x32_bf16 v[72:75], a[76:79], v[156:159], v[72:75]
  ds_read_b128 v[136:139], v3 offset:18432
  v_mfma_f32_16x16x32_bf16 v[72:75], a[72:75], v[152:155], v[72:75]
  buffer_load_dwordx4 v2, s[8:11], s32 offen offset:1024 sc1 lds
  v_mfma_f32_16x16x32_bf16 v[72:75], a[68:71], v[148:151], v[72:75]
  ds_read_b128 v[140:143], v3 offset:19456
  v_mfma_f32_16x16x32_bf16 v[72:75], a[64:67], v[144:147], v[72:75]
  s_waitcnt lgkmcnt(11)
  v_mfma_f32_16x16x32_bf16 v[80:83], a[64:67], v[160:163], v[80:83]
  ds_read_b128 v[144:147], v3 offset:20480
  v_mfma_f32_16x16x32_bf16 v[80:83], a[68:71], v[164:167], v[80:83]
  buffer_load_dwordx4 v2, s[8:11], s32 offen offset:2048 sc1 lds
  v_mfma_f32_16x16x32_bf16 v[80:83], a[72:75], v[168:171], v[80:83]
  ds_read_b128 v[148:151], v3 offset:21504
  v_mfma_f32_16x16x32_bf16 v[80:83], a[76:79], v[172:175], v[80:83]
  s_bitcmp1_b32 s20, 0
  s_cselect_b32 s64, 1024, 0
  s_cselect_b32 s65, 0, 2048
  v_mfma_f32_16x16x32_bf16 v[84:87], a[92:95], v[172:175], v[84:87]
  ds_read_b128 v[152:155], v3 offset:22528
  v_mfma_f32_16x16x32_bf16 v[84:87], a[88:91], v[168:171], v[84:87]
  buffer_load_dwordx4 v2, s[8:11], s32 offen offset:3072 sc1 lds
  v_mfma_f32_16x16x32_bf16 v[84:87], a[84:87], v[164:167], v[84:87]
  ds_read_b128 v[156:159], v3 offset:23552
  v_mfma_f32_16x16x32_bf16 v[84:87], a[80:83], v[160:163], v[84:87]
  s_waitcnt lgkmcnt(8)
  v_mfma_f32_16x16x32_bf16 v[92:95], a[80:83], v[176:179], v[92:95]
  ds_read_b128 v[160:163], v3 offset:24576
  v_mfma_f32_16x16x32_bf16 v[92:95], a[84:87], v[180:183], v[92:95]
  v_add_u32 v23, s64, v2
  v_add_u32 v24, s65, v2
  v_mfma_f32_16x16x32_bf16 v[92:95], a[88:91], v[184:187], v[92:95]
  ds_read_b128 v[164:167], v3 offset:25600
  v_mfma_f32_16x16x32_bf16 v[92:95], a[92:95], v[188:191], v[92:95]
  v_mfma_f32_16x16x32_bf16 v[88:91], a[76:79], v[188:191], v[88:91]
  ds_read_b128 v[168:171], v3 offset:26624
  v_mfma_f32_16x16x32_bf16 v[88:91], a[72:75], v[184:187], v[88:91]
  v_mfma_f32_16x16x32_bf16 v[88:91], a[68:71], v[180:183], v[88:91]
  ds_read_b128 v[172:175], v3 offset:27648
  v_mfma_f32_16x16x32_bf16 v[88:91], a[64:67], v[176:179], v[88:91]
  s_waitcnt lgkmcnt(8)
  v_mfma_f32_16x16x32_bf16 v[96:99], a[64:67], v[128:131], v[96:99]
  ds_read_b128 v[176:179], v3 offset:28672
  v_mfma_f32_16x16x32_bf16 v[96:99], a[68:71], v[132:135], v[96:99]
  ds_read_b128 v[180:183], v3 offset:29696
  v_mfma_f32_16x16x32_bf16 v[96:99], a[72:75], v[136:139], v[96:99]
  ds_read_b128 v[184:187], v3 offset:30720
  v_mfma_f32_16x16x32_bf16 v[96:99], a[76:79], v[140:143], v[96:99]
  ds_read_b128 v[188:191], v3 offset:31744
  v_mfma_f32_16x16x32_bf16 v[100:103], a[92:95], v[140:143], v[100:103]
  v_mfma_f32_16x16x32_bf16 v[100:103], a[88:91], v[136:139], v[100:103]
  v_mfma_f32_16x16x32_bf16 v[100:103], a[84:87], v[132:135], v[100:103]
  v_mfma_f32_16x16x32_bf16 v[100:103], a[80:83], v[128:131], v[100:103]
  s_waitcnt lgkmcnt(8)
  v_mfma_f32_16x16x32_bf16 v[108:111], a[80:83], v[144:147], v[108:111]
  v_mfma_f32_16x16x32_bf16 v[108:111], a[84:87], v[148:151], v[108:111]
  v_mfma_f32_16x16x32_bf16 v[108:111], a[88:91], v[152:155], v[108:111]
  v_add_u32 v3, s27, v2
  v_mfma_f32_16x16x32_bf16 v[108:111], a[92:95], v[156:159], v[108:111]
  s_waitcnt vmcnt(14) lgkmcnt(0)
  s_barrier
  v_mfma_f32_16x16x32_bf16 v[104:107], a[76:79], v[156:159], v[104:107]
  ds_read_b128 v[128:131], v3 offset:0
  v_mfma_f32_16x16x32_bf16 v[104:107], a[72:75], v[152:155], v[104:107]
  ds_read_b128 v[132:135], v3 offset:1024
  v_mfma_f32_16x16x32_bf16 v[104:107], a[68:71], v[148:151], v[104:107]
  ds_read_b128 v[136:139], v3 offset:2048
  v_mfma_f32_16x16x32_bf16 v[104:107], a[64:67], v[144:147], v[104:107]
  s_waitcnt lgkmcnt(7)
  s_add_u32 m0, s29, s34
  v_mfma_f32_16x16x32_bf16 v[112:115], a[64:67], v[160:163], v[112:115]
  s_sub_u32 s32, s32, 126976
  ds_read_b128 v[140:143], v3 offset:3072
  v_mfma_f32_16x16x32_bf16 v[112:115], a[68:71], v[164:167], v[112:115]
  buffer_load_dwordx4 v2, s[8:11], s32 offen sc1 lds
  v_mfma_f32_16x16x32_bf16 v[112:115], a[72:75], v[168:171], v[112:115]
  ds_read_b128 v[144:147], v3 offset:4096
  v_mfma_f32_16x16x32_bf16 v[112:115], a[76:79], v[172:175], v[112:115]
  ds_read_b128 v[148:151], v3 offset:5120
  v_mfma_f32_16x16x32_bf16 v[116:119], a[92:95], v[172:175], v[116:119]
  ds_read_b128 v[152:155], v3 offset:6144
  v_mfma_f32_16x16x32_bf16 v[116:119], a[88:91], v[168:171], v[116:119]
  buffer_load_dwordx4 v2, s[8:11], s32 offen offset:1024 sc1 lds
  v_mfma_f32_16x16x32_bf16 v[116:119], a[84:87], v[164:167], v[116:119]
  ds_read_b128 v[156:159], v3 offset:7168
  v_mfma_f32_16x16x32_bf16 v[116:119], a[80:83], v[160:163], v[116:119]
  s_waitcnt lgkmcnt(8)
  v_mfma_f32_16x16x32_bf16 v[124:127], a[80:83], v[176:179], v[124:127]
  ds_read_b128 v[160:163], v3 offset:8192
  v_mfma_f32_16x16x32_bf16 v[124:127], a[84:87], v[180:183], v[124:127]
  ds_read_b128 v[164:167], v3 offset:9216
  v_mfma_f32_16x16x32_bf16 v[124:127], a[88:91], v[184:187], v[124:127]
  ds_read_b128 v[168:171], v3 offset:10240
  v_mfma_f32_16x16x32_bf16 v[124:127], a[92:95], v[188:191], v[124:127]
  buffer_load_dwordx4 v2, s[8:11], s32 offen offset:2048 sc1 lds
  v_mfma_f32_16x16x32_bf16 v[120:123], a[76:79], v[188:191], v[120:123]
  ds_read_b128 v[172:175], v3 offset:11264
  v_mfma_f32_16x16x32_bf16 v[120:123], a[72:75], v[184:187], v[120:123]
  v_mfma_f32_16x16x32_bf16 v[120:123], a[68:71], v[180:183], v[120:123]
  v_mfma_f32_16x16x32_bf16 v[120:123], a[64:67], v[176:179], v[120:123]
  s_waitcnt lgkmcnt(8)
  v_mfma_f32_16x16x32_bf16 v[64:67], a[96:99], v[128:131], v[64:67]
  ds_read_b128 v[176:179], v3 offset:12288
  v_mfma_f32_16x16x32_bf16 v[64:67], a[100:103], v[132:135], v[64:67]
  buffer_load_dwordx4 v2, s[8:11], s32 offen offset:3072 sc1 lds
  v_mfma_f32_16x16x32_bf16 v[64:67], a[104:107], v[136:139], v[64:67]
  ds_read_b128 v[180:183], v3 offset:13312
  v_mfma_f32_16x16x32_bf16 v[64:67], a[108:111], v[140:143], v[64:67]
  s_add_u32 m0, m0, 4096
  v_mfma_f32_16x16x32_bf16 v[68:71], a[124:127], v[140:143], v[68:71]
  s_add_u32 s32, s32, 131072
  ds_read_b128 v[184:187], v3 offset:14336
  v_mfma_f32_16x16x32_bf16 v[68:71], a[120:123], v[136:139], v[68:71]
  buffer_load_dwordx4 v2, s[8:11], s32 offen sc1 lds
  v_mfma_f32_16x16x32_bf16 v[68:71], a[116:119], v[132:135], v[68:71]
  ds_read_b128 v[188:191], v3 offset:15360
  v_mfma_f32_16x16x32_bf16 v[68:71], a[112:115], v[128:131], v[68:71]
  s_waitcnt lgkmcnt(8)
  v_mfma_f32_16x16x32_bf16 v[76:79], a[112:115], v[144:147], v[76:79]
  ds_read_b128 v[128:131], v3 offset:16384
  v_mfma_f32_16x16x32_bf16 v[76:79], a[116:119], v[148:151], v[76:79]
  buffer_load_dwordx4 v2, s[8:11], s32 offen offset:1024 sc1 lds
  v_mfma_f32_16x16x32_bf16 v[76:79], a[120:123], v[152:155], v[76:79]
  ds_read_b128 v[132:135], v3 offset:17408
  v_mfma_f32_16x16x32_bf16 v[76:79], a[124:127], v[156:159], v[76:79]
  v_mfma_f32_16x16x32_bf16 v[72:75], a[108:111], v[156:159], v[72:75]
  ds_read_b128 v[136:139], v3 offset:18432
  v_mfma_f32_16x16x32_bf16 v[72:75], a[104:107], v[152:155], v[72:75]
  buffer_load_dwordx4 v2, s[8:11], s32 offen offset:2048 sc1 lds
  v_mfma_f32_16x16x32_bf16 v[72:75], a[100:103], v[148:151], v[72:75]
  ds_read_b128 v[140:143], v3 offset:19456
  v_mfma_f32_16x16x32_bf16 v[72:75], a[96:99], v[144:147], v[72:75]
  s_waitcnt lgkmcnt(8)
  v_mfma_f32_16x16x32_bf16 v[80:83], a[96:99], v[160:163], v[80:83]
  ds_read_b128 v[144:147], v3 offset:20480
  v_mfma_f32_16x16x32_bf16 v[80:83], a[100:103], v[164:167], v[80:83]
  buffer_load_dwordx4 v2, s[8:11], s32 offen offset:3072 sc1 lds
  v_mfma_f32_16x16x32_bf16 v[80:83], a[104:107], v[168:171], v[80:83]
  ds_read_b128 v[148:151], v3 offset:21504
  v_mfma_f32_16x16x32_bf16 v[80:83], a[108:111], v[172:175], v[80:83]
  s_add_u32 m0, s31, s34
  v_mfma_f32_16x16x32_bf16 v[84:87], a[124:127], v[172:175], v[84:87]
  s_add_u32 s33, s33, s49
  ds_read_b128 v[152:155], v3 offset:22528
  v_mfma_f32_16x16x32_bf16 v[84:87], a[120:123], v[168:171], v[84:87]
  buffer_load_dwordx4 v5, s[12:15], s33 offen lds
  v_mfma_f32_16x16x32_bf16 v[84:87], a[116:119], v[164:167], v[84:87]
  ds_read_b128 v[156:159], v3 offset:23552
  v_mfma_f32_16x16x32_bf16 v[84:87], a[112:115], v[160:163], v[84:87]
  s_waitcnt lgkmcnt(8)
  v_mfma_f32_16x16x32_bf16 v[92:95], a[112:115], v[176:179], v[92:95]
  ds_read_b128 v[160:163], v3 offset:24576
  v_mfma_f32_16x16x32_bf16 v[92:95], a[116:119], v[180:183], v[92:95]
  buffer_load_dwordx4 v6, s[12:15], s33 offen offset:1024 lds
  v_mfma_f32_16x16x32_bf16 v[92:95], a[120:123], v[184:187], v[92:95]
  ds_read_b128 v[164:167], v3 offset:25600
  v_mfma_f32_16x16x32_bf16 v[92:95], a[124:127], v[188:191], v[92:95]
  v_mfma_f32_16x16x32_bf16 v[88:91], a[108:111], v[188:191], v[88:91]
  ds_read_b128 v[168:171], v3 offset:26624
  v_mfma_f32_16x16x32_bf16 v[88:91], a[104:107], v[184:187], v[88:91]
  buffer_load_dwordx4 v15, s[12:15], s33 offen offset:2048 lds
  v_mfma_f32_16x16x32_bf16 v[88:91], a[100:103], v[180:183], v[88:91]
  ds_read_b128 v[172:175], v3 offset:27648
  v_mfma_f32_16x16x32_bf16 v[88:91], a[96:99], v[176:179], v[88:91]
  s_waitcnt lgkmcnt(8)
  v_mfma_f32_16x16x32_bf16 v[96:99], a[96:99], v[128:131], v[96:99]
  ds_read_b128 v[176:179], v3 offset:28672
  v_mfma_f32_16x16x32_bf16 v[96:99], a[100:103], v[132:135], v[96:99]
  ds_read_b128 v[180:183], v3 offset:29696
  v_mfma_f32_16x16x32_bf16 v[96:99], a[104:107], v[136:139], v[96:99]
  ds_read_b128 v[184:187], v3 offset:30720
  v_mfma_f32_16x16x32_bf16 v[96:99], a[108:111], v[140:143], v[96:99]
  ds_read_b128 v[188:191], v3 offset:31744
  v_mfma_f32_16x16x32_bf16 v[100:103], a[124:127], v[140:143], v[100:103]
  buffer_load_dwordx4 v16, s[12:15], s33 offen offset:3072 lds
  v_mfma_f32_16x16x32_bf16 v[100:103], a[120:123], v[136:139], v[100:103]
  v_mfma_f32_16x16x32_bf16 v[100:103], a[116:119], v[132:135], v[100:103]
  s_add_u32 m0, m0, 4096
  v_mfma_f32_16x16x32_bf16 v[100:103], a[112:115], v[128:131], v[100:103]
  s_waitcnt lgkmcnt(8)
  s_add_u32 s33, s33, s48
  v_mfma_f32_16x16x32_bf16 v[108:111], a[112:115], v[144:147], v[108:111]
  buffer_load_dwordx4 v5, s[12:15], s33 offen lds
  v_mfma_f32_16x16x32_bf16 v[108:111], a[116:119], v[148:151], v[108:111]
  v_mfma_f32_16x16x32_bf16 v[108:111], a[120:123], v[152:155], v[108:111]
  v_add_u32 v3, s28, v2
  v_mfma_f32_16x16x32_bf16 v[108:111], a[124:127], v[156:159], v[108:111]
  s_waitcnt vmcnt(13) lgkmcnt(0)
  s_barrier
  s_cmp_lg_u32 s20, 2
  s_cbranch_scc1 L_sigd_43
  v_mov_b32 v19, 1
  s_cmp_eq_u32 s3, 0
  s_cbranch_scc1 L_xsig_42
  s_mov_b64 exec, 1
  buffer_store_dword v19, off, s[8:11], s42
  s_mov_b64 exec, -1
L_sigd_43:
  v_mfma_f32_16x16x32_bf16 v[104:107], a[108:111], v[156:159], v[104:107]
  ds_read_b128 v[128:131], v3 offset:0
  v_mfma_f32_16x16x32_bf16 v[104:107], a[104:107], v[152:155], v[104:107]
  ds_read_b128 v[132:135], v3 offset:1024
  v_mfma_f32_16x16x32_bf16 v[104:107], a[100:103], v[148:151], v[104:107]
  ds_read_b128 v[136:139], v3 offset:2048
  v_mfma_f32_16x16x32_bf16 v[104:107], a[96:99], v[144:147], v[104:107]
  s_waitcnt lgkmcnt(7)
  v_mfma_f32_16x16x32_bf16 v[112:115], a[96:99], v[160:163], v[112:115]
  ds_read_b128 v[140:143], v3 offset:3072
  v_mfma_f32_16x16x32_bf16 v[112:115], a[100:103], v[164:167], v[112:115]
  buffer_load_dwordx4 v6, s[12:15], s33 offen offset:1024 lds
  v_mfma_f32_16x16x32_bf16 v[112:115], a[104:107], v[168:171], v[112:115]
  ds_read_b128 v[144:147], v3 offset:4096
  v_mfma_f32_16x16x32_bf16 v[112:115], a[108:111], v[172:175], v[112:115]
  ds_read_b128 v[148:151], v3 offset:5120
  v_mfma_f32_16x16x32_bf16 v[116:119], a[124:127], v[172:175], v[116:119]
  ds_read_b128 v[152:155], v3 offset:6144
  v_mfma_f32_16x16x32_bf16 v[116:119], a[120:123], v[168:171], v[116:119]
  buffer_load_dwordx4 v15, s[12:15], s33 offen offset:2048 lds
  v_mfma_f32_16x16x32_bf16 v[116:119], a[116:119], v[164:167], v[116:119]
  ds_read_b128 v[156:159], v3 offset:7168
  v_mfma_f32_16x16x32_bf16 v[116:119], a[112:115], v[160:163], v[116:119]
  s_waitcnt lgkmcnt(8)
  v_mfma_f32_16x16x32_bf16 v[124:127], a[112:115], v[176:179], v[124:127]
  ds_read_b128 v[160:163], v3 offset:8192
  v_mfma_f32_16x16x32_bf16 v[124:127], a[116:119], v[180:183], v[124:127]
  ds_read_b128 v[164:167], v3 offset:9216
  v_mfma_f32_16x16x32_bf16 v[124:127], a[120:123], v[184:187], v[124:127]
  ds_read_b128 v[168:171], v3 offset:10240
  v_mfma_f32_16x16x32_bf16 v[124:127], a[124:127], v[188:191], v[124:127]
  buffer_load_dwordx4 v16, s[12:15], s33 offen offset:3072 lds
  v_mfma_f32_16x16x32_bf16 v[120:123], a[108:111], v[188:191], v[120:123]
  ds_read_b128 v[172:175], v3 offset:11264
  v_mfma_f32_16x16x32_bf16 v[120:123], a[104:107], v[184:187], v[120:123]
  v_mfma_f32_16x16x32_bf16 v[120:123], a[100:103], v[180:183], v[120:123]
  v_mfma_f32_16x16x32_bf16 v[120:123], a[96:99], v[176:179], v[120:123]
  s_waitcnt lgkmcnt(8)
  s_add_u32 m0, s27, s34
  v_mfma_f32_16x16x32_bf16 v[64:67], v[192:195], v[128:131], v[64:67]
  s_sub_u32 s32, s32, 126976
  ds_read_b128 v[176:179], v3 offset:12288
  v_mfma_f32_16x16x32_bf16 v[64:67], v[196:199], v[132:135], v[64:67]
  buffer_load_dwordx4 v2, s[8:11], s32 offen sc1 lds
  v_mfma_f32_16x16x32_bf16 v[64:67], v[200:203], v[136:139], v[64:67]
  ds_read_b128 v[180:183], v3 offset:13312
  v_mfma_f32_16x16x32_bf16 v[64:67], v[204:207], v[140:143], v[64:67]
  v_mfma_f32_16x16x32_bf16 v[68:71], v[220:223], v[140:143], v[68:71]
  ds_read_b128 v[184:187], v3 offset:14336
  v_mfma_f32_16x16x32_bf16 v[68:71], v[216:219], v[136:139], v[68:71]
  buffer_load_dwordx4 v2, s[8:11], s32 offen offset:1024 sc1 lds
  v_mfma_f32_16x16x32_bf16 v[68:71], v[212:215], v[132:135], v[68:71]
  ds_read_b128 v[188:191], v3 offset:15360
  v_mfma_f32_16x16x32_bf16 v[68:71], v[208:211], v[128:131], v[68:71]
  s_waitcnt lgkmcnt(8)
  v_mfma_f32_16x16x32_bf16 v[76:79], v[208:211], v[144:147], v[76:79]
  ds_read_b128 v[128:131], v3 offset:16384
  v_mfma_f32_16x16x32_bf16 v[76:79], v[212:215], v[148:151], v[76:79]
  buffer_load_dwordx4 v2, s[8:11], s32 offen offset:2048 sc1 lds
  v_mfma_f32_16x16x32_bf16 v[76:79], v[216:219], v[152:155], v[76:79]
  ds_read_b128 v[132:135], v3 offset:17408
  v_mfma_f32_16x16x32_bf16 v[76:79], v[220:223], v[156:159], v[76:79]
  v_mfma_f32_16x16x32_bf16 v[72:75], v[204:207], v[156:159], v[72:75]
  ds_read_b128 v[136:139], v3 offset:18432
  v_mfma_f32_16x16x32_bf16 v[72:75], v[200:203], v[152:155], v[72:75]
  buffer_load_dwordx4 v2, s[8:11], s32 offen offset:3072 sc1 lds
  v_mfma_f32_16x16x32_bf16 v[72:75], v[196:199], v[148:151], v[72:75]
  ds_read_b128 v[140:143], v3 offset:19456
  v_mfma_f32_16x16x32_bf16 v[72:75], v[192:195], v[144:147], v[72:75]
  s_waitcnt lgkmcnt(8)
  s_add_u32 m0, m0, 4096
  v_mfma_f32_16x16x32_bf16 v[80:83], v[192:195], v[160:163], v[80:83]
  s_add_u32 s32, s32, 131072
  ds_read_b128 v[144:147], v3 offset:20480
  v_mfma_f32_16x16x32_bf16 v[80:83], v[196:199], v[164:167], v[80:83]
  buffer_load_dwordx4 v2, s[8:11], s32 offen sc1 lds
  v_mfma_f32_16x16x32_bf16 v[80:83], v[200:203], v[168:171], v[80:83]
  ds_read_b128 v[148:151], v3 offset:21504
  v_mfma_f32_16x16x32_bf16 v[80:83], v[204:207], v[172:175], v[80:83]
  v_mfma_f32_16x16x32_bf16 v[84:87], v[220:223], v[172:175], v[84:87]
  ds_read_b128 v[152:155], v3 offset:22528
  v_mfma_f32_16x16x32_bf16 v[84:87], v[216:219], v[168:171], v[84:87]
  buffer_load_dwordx4 v2, s[8:11], s32 offen offset:1024 sc1 lds
  v_mfma_f32_16x16x32_bf16 v[84:87], v[212:215], v[164:167], v[84:87]
  ds_read_b128 v[156:159], v3 offset:23552
  v_mfma_f32_16x16x32_bf16 v[84:87], v[208:211], v[160:163], v[84:87]
  s_waitcnt lgkmcnt(8)
  v_mfma_f32_16x16x32_bf16 v[92:95], v[208:211], v[176:179], v[92:95]
  ds_read_b128 v[160:163], v3 offset:24576
  v_mfma_f32_16x16x32_bf16 v[92:95], v[212:215], v[180:183], v[92:95]
  buffer_load_dwordx4 v2, s[8:11], s32 offen offset:2048 sc1 lds
  v_mfma_f32_16x16x32_bf16 v[92:95], v[216:219], v[184:187], v[92:95]
  ds_read_b128 v[164:167], v3 offset:25600
  v_mfma_f32_16x16x32_bf16 v[92:95], v[220:223], v[188:191], v[92:95]
  v_mfma_f32_16x16x32_bf16 v[88:91], v[204:207], v[188:191], v[88:91]
  ds_read_b128 v[168:171], v3 offset:26624
  v_mfma_f32_16x16x32_bf16 v[88:91], v[200:203], v[184:187], v[88:91]
  buffer_load_dwordx4 v2, s[8:11], s32 offen offset:3072 sc1 lds
  v_mfma_f32_16x16x32_bf16 v[88:91], v[196:199], v[180:183], v[88:91]
  ds_read_b128 v[172:175], v3 offset:27648
  v_mfma_f32_16x16x32_bf16 v[88:91], v[192:195], v[176:179], v[88:91]
  s_waitcnt lgkmcnt(8)
  v_mfma_f32_16x16x32_bf16 v[96:99], v[192:195], v[128:131], v[96:99]
  ds_read_b128 v[176:179], v3 offset:28672
  v_mfma_f32_16x16x32_bf16 v[96:99], v[196:199], v[132:135], v[96:99]
  ds_read_b128 v[180:183], v3 offset:29696
  v_mfma_f32_16x16x32_bf16 v[96:99], v[200:203], v[136:139], v[96:99]
  s_add_u32 m0, s30, s34
  ds_read_b128 v[184:187], v3 offset:30720
  v_mfma_f32_16x16x32_bf16 v[96:99], v[204:207], v[140:143], v[96:99]
  s_add_u32 s33, s33, s49
  ds_read_b128 v[188:191], v3 offset:31744
  v_mfma_f32_16x16x32_bf16 v[100:103], v[220:223], v[140:143], v[100:103]
  buffer_load_dwordx4 v5, s[12:15], s33 offen lds
  v_mfma_f32_16x16x32_bf16 v[100:103], v[216:219], v[136:139], v[100:103]
  v_mfma_f32_16x16x32_bf16 v[100:103], v[212:215], v[132:135], v[100:103]
  v_mfma_f32_16x16x32_bf16 v[100:103], v[208:211], v[128:131], v[100:103]
  s_waitcnt lgkmcnt(8)
  v_mfma_f32_16x16x32_bf16 v[108:111], v[208:211], v[144:147], v[108:111]
  buffer_load_dwordx4 v6, s[12:15], s33 offen offset:1024 lds
  v_mfma_f32_16x16x32_bf16 v[108:111], v[212:215], v[148:151], v[108:111]
  v_mfma_f32_16x16x32_bf16 v[108:111], v[216:219], v[152:155], v[108:111]
  v_add_u32 v3, s29, v2
  v_mfma_f32_16x16x32_bf16 v[108:111], v[220:223], v[156:159], v[108:111]
  s_waitcnt vmcnt(10) lgkmcnt(0)
  s_barrier
  v_mfma_f32_16x16x32_bf16 v[104:107], v[204:207], v[156:159], v[104:107]
  ds_read_b128 v[128:131], v3 offset:0
  v_mfma_f32_16x16x32_bf16 v[104:107], v[200:203], v[152:155], v[104:107]
  ds_read_b128 v[132:135], v3 offset:1024
  v_mfma_f32_16x16x32_bf16 v[104:107], v[196:199], v[148:151], v[104:107]
  ds_read_b128 v[136:139], v3 offset:2048
  v_mfma_f32_16x16x32_bf16 v[104:107], v[192:195], v[144:147], v[104:107]
  s_waitcnt lgkmcnt(7)
  v_add_u32 v11, s31, v7
  v_add_u32 v12, s31, v8
  v_mfma_f32_16x16x32_bf16 v[112:115], v[192:195], v[160:163], v[112:115]
  ds_read_b128 v[140:143], v3 offset:3072
  v_mfma_f32_16x16x32_bf16 v[112:115], v[196:199], v[164:167], v[112:115]
  buffer_load_dwordx4 v15, s[12:15], s33 offen offset:2048 lds
  v_mfma_f32_16x16x32_bf16 v[112:115], v[200:203], v[168:171], v[112:115]
  ds_read_b128 v[144:147], v3 offset:4096
  v_mfma_f32_16x16x32_bf16 v[112:115], v[204:207], v[172:175], v[112:115]
  ds_read_b128 v[148:151], v3 offset:5120
  v_mfma_f32_16x16x32_bf16 v[116:119], v[220:223], v[172:175], v[116:119]
  ds_read_b128 v[152:155], v3 offset:6144
  v_mfma_f32_16x16x32_bf16 v[116:119], v[216:219], v[168:171], v[116:119]
  buffer_load_dwordx4 v16, s[12:15], s33 offen offset:3072 lds
  v_mfma_f32_16x16x32_bf16 v[116:119], v[212:215], v[164:167], v[116:119]
  ds_read_b128 v[156:159], v3 offset:7168
  v_mfma_f32_16x16x32_bf16 v[116:119], v[208:211], v[160:163], v[116:119]
  s_waitcnt lgkmcnt(8)
  ds_read_b64_tr_b16 a[160:161], v11 offset:0
  v_mfma_f32_16x16x32_bf16 v[124:127], v[208:211], v[176:179], v[124:127]
  ds_read_b128 v[160:163], v3 offset:8192
  v_mfma_f32_16x16x32_bf16 v[124:127], v[212:215], v[180:183], v[124:127]
  s_add_u32 m0, m0, 4096
  ds_read_b128 v[164:167], v3 offset:9216
  v_mfma_f32_16x16x32_bf16 v[124:127], v[216:219], v[184:187], v[124:127]
  s_add_u32 s33, s33, s48
  ds_read_b128 v[168:171], v3 offset:10240
  v_mfma_f32_16x16x32_bf16 v[124:127], v[220:223], v[188:191], v[124:127]
  buffer_load_dwordx4 v5, s[12:15], s33 offen lds
  v_mfma_f32_16x16x32_bf16 v[120:123], v[204:207], v[188:191], v[120:123]
  ds_read_b128 v[172:175], v3 offset:11264
  v_mfma_f32_16x16x32_bf16 v[120:123], v[200:203], v[184:187], v[120:123]
  ds_read_b64_tr_b16 a[162:163], v11 offset:4096
  v_mfma_f32_16x16x32_bf16 v[120:123], v[196:199], v[180:183], v[120:123]
  ds_read_b64_tr_b16 a[164:165], v11 offset:8192
  v_mfma_f32_16x16x32_bf16 v[120:123], v[192:195], v[176:179], v[120:123]
  s_waitcnt lgkmcnt(11)
  ds_read_b64_tr_b16 a[166:167], v11 offset:12288
  v_mfma_f32_16x16x32_bf16 v[64:67], a[128:131], v[128:131], v[64:67]
  ds_read_b128 v[176:179], v3 offset:12288
  v_mfma_f32_16x16x32_bf16 v[64:67], a[132:135], v[132:135], v[64:67]
  buffer_load_dwordx4 v6, s[12:15], s33 offen offset:1024 lds
  v_mfma_f32_16x16x32_bf16 v[64:67], a[136:139], v[136:139], v[64:67]
  ds_read_b128 v[180:183], v3 offset:13312
  v_mfma_f32_16x16x32_bf16 v[64:67], a[140:143], v[140:143], v[64:67]
  ds_read_b64_tr_b16 a[168:169], v11 offset:16384
  v_mfma_f32_16x16x32_bf16 v[68:71], a[156:159], v[140:143], v[68:71]
  ds_read_b128 v[184:187], v3 offset:14336
  v_mfma_f32_16x16x32_bf16 v[68:71], a[152:155], v[136:139], v[68:71]
  buffer_load_dwordx4 v15, s[12:15], s33 offen offset:2048 lds
  v_mfma_f32_16x16x32_bf16 v[68:71], a[148:151], v[132:135], v[68:71]
  ds_read_b128 v[188:191], v3 offset:15360
  v_mfma_f32_16x16x32_bf16 v[68:71], a[144:147], v[128:131], v[68:71]
  s_waitcnt lgkmcnt(13)
  ds_read_b64_tr_b16 a[170:171], v11 offset:20480
  v_mfma_f32_16x16x32_bf16 v[76:79], a[144:147], v[144:147], v[76:79]
  ds_read_b128 v[128:131], v3 offset:16384
  v_mfma_f32_16x16x32_bf16 v[76:79], a[148:151], v[148:151], v[76:79]
  buffer_load_dwordx4 v16, s[12:15], s33 offen offset:3072 lds
  v_mfma_f32_16x16x32_bf16 v[76:79], a[152:155], v[152:155], v[76:79]
  ds_read_b128 v[132:135], v3 offset:17408
  v_mfma_f32_16x16x32_bf16 v[76:79], a[156:159], v[156:159], v[76:79]
  s_add_u32 m0, s28, s34
  ds_read_b64_tr_b16 a[172:173], v11 offset:24576
  v_mfma_f32_16x16x32_bf16 v[72:75], a[140:143], v[156:159], v[72:75]
  s_sub_u32 s32, s32, 126976
  ds_read_b128 v[136:139], v3 offset:18432
  v_mfma_f32_16x16x32_bf16 v[72:75], a[136:139], v[152:155], v[72:75]
  buffer_load_dwordx4 v2, s[8:11], s32 offen sc1 lds
  v_mfma_f32_16x16x32_bf16 v[72:75], a[132:135], v[148:151], v[72:75]
  ds_read_b128 v[140:143], v3 offset:19456
  v_mfma_f32_16x16x32_bf16 v[72:75], a[128:131], v[144:147], v[72:75]
  s_waitcnt lgkmcnt(14)
  ds_read_b64_tr_b16 a[174:175], v11 offset:28672
  v_mfma_f32_16x16x32_bf16 v[80:83], a[128:131], v[160:163], v[80:83]
  ds_read_b128 v[144:147], v3 offset:20480
  v_mfma_f32_16x16x32_bf16 v[80:83], a[132:135], v[164:167], v[80:83]
  buffer_load_dwordx4 v2, s[8:11], s32 offen offset:1024 sc1 lds
  v_mfma_f32_16x16x32_bf16 v[80:83], a[136:139], v[168:171], v[80:83]
  ds_read_b128 v[148:151], v3 offset:21504
  v_mfma_f32_16x16x32_bf16 v[80:83], a[140:143], v[172:175], v[80:83]
  ds_read_b64_tr_b16 a[176:177], v12 offset:0
  v_mfma_f32_16x16x32_bf16 v[84:87], a[156:159], v[172:175], v[84:87]
  ds_read_b128 v[152:155], v3 offset:22528
  v_mfma_f32_16x16x32_bf16 v[84:87], a[152:155], v[168:171], v[84:87]
  buffer_load_dwordx4 v2, s[8:11], s32 offen offset:2048 sc1 lds
  v_mfma_f32_16x16x32_bf16 v[84:87], a[148:151], v[164:167], v[84:87]
  ds_read_b128 v[156:159], v3 offset:23552
  v_mfma_f32_16x16x32_bf16 v[84:87], a[144:147], v[160:163], v[84:87]
  s_waitcnt lgkmcnt(12)
  ds_read_b64_tr_b16 a[178:179], v12 offset:4096
  v_mfma_f32_16x16x32_bf16 v[92:95], a[144:147], v[176:179], v[92:95]
  ds_read_b128 v[160:163], v3 offset:24576
  v_mfma_f32_16x16x32_bf16 v[92:95], a[148:151], v[180:183], v[92:95]
  buffer_load_dwordx4 v2, s[8:11], s32 offen offset:3072 sc1 lds
  v_mfma_f32_16x16x32_bf16 v[92:95], a[152:155], v[184:187], v[92:95]
  ds_read_b128 v[164:167], v3 offset:25600
  v_mfma_f32_16x16x32_bf16 v[92:95], a[156:159], v[188:191], v[92:95]
  s_add_u32 m0, m0, 4096
  ds_read_b64_tr_b16 a[180:181], v12 offset:8192
  v_mfma_f32_16x16x32_bf16 v[88:91], a[140:143], v[188:191], v[88:91]
  s_add_u32 s32, s32, 131072
  ds_read_b128 v[168:171], v3 offset:26624
  v_mfma_f32_16x16x32_bf16 v[88:91], a[136:139], v[184:187], v[88:91]
  buffer_load_dwordx4 v2, s[8:11], s32 offen sc1 lds
  v_mfma_f32_16x16x32_bf16 v[88:91], a[132:135], v[180:183], v[88:91]
  ds_read_b128 v[172:175], v3 offset:27648
  v_mfma_f32_16x16x32_bf16 v[88:91], a[128:131], v[176:179], v[88:91]
  s_waitcnt lgkmcnt(12)
  ds_read_b64_tr_b16 a[182:183], v12 offset:12288
  v_mfma_f32_16x16x32_bf16 v[96:99], a[128:131], v[128:131], v[96:99]
  ds_read_b128 v[176:179], v3 offset:28672
  v_mfma_f32_16x16x32_bf16 v[96:99], a[132:135], v[132:135], v[96:99]
  ds_read_b128 v[180:183], v3 offset:29696
  v_mfma_f32_16x16x32_bf16 v[96:99], a[136:139], v[136:139], v[96:99]
  ds_read_b128 v[184:187], v3 offset:30720
  v_mfma_f32_16x16x32_bf16 v[96:99], a[140:143], v[140:143], v[96:99]
  ds_read_b128 v[188:191], v3 offset:31744
  v_mfma_f32_16x16x32_bf16 v[100:103], a[156:159], v[140:143], v[100:103]
  buffer_load_dwordx4 v2, s[8:11], s32 offen offset:1024 sc1 lds
  v_mfma_f32_16x16x32_bf16 v[100:103], a[152:155], v[136:139], v[100:103]
  ds_read_b64_tr_b16 a[184:185], v12 offset:16384
  v_mfma_f32_16x16x32_bf16 v[100:103], a[148:151], v[132:135], v[100:103]
  ds_read_b64_tr_b16 a[186:187], v12 offset:20480
  v_mfma_f32_16x16x32_bf16 v[100:103], a[144:147], v[128:131], v[100:103]
  s_waitcnt lgkmcnt(13)
  ds_read_b64_tr_b16 a[188:189], v12 offset:24576
  v_mfma_f32_16x16x32_bf16 v[108:111], a[144:147], v[144:147], v[108:111]
  buffer_load_dword v19, v20, s[8:11], s36 offen sc1
  v_mfma_f32_16x16x32_bf16 v[108:111], a[148:151], v[148:151], v[108:111]
  buffer_load_dwordx4 v2, s[8:11], s32 offen offset:2048 sc1 lds
  v_mfma_f32_16x16x32_bf16 v[108:111], a[152:155], v[152:155], v[108:111]
  v_add_u32 v3, s27, v2
  v_mfma_f32_16x16x32_bf16 v[108:111], a[156:159], v[156:159], v[108:111]
  s_waitcnt vmcnt(8) lgkmcnt(3)
  s_barrier
  v_mfma_f32_16x16x32_bf16 v[104:107], a[140:143], v[156:159], v[104:107]
  ds_read_b128 v[128:131], v3 offset:0
  v_mfma_f32_16x16x32_bf16 v[104:107], a[136:139], v[152:155], v[104:107]
  ds_read_b128 v[132:135], v3 offset:1024
  v_mfma_f32_16x16x32_bf16 v[104:107], a[132:135], v[148:151], v[104:107]
  ds_read_b128 v[136:139], v3 offset:2048
  v_mfma_f32_16x16x32_bf16 v[104:107], a[128:131], v[144:147], v[104:107]
  s_waitcnt lgkmcnt(11)
  ds_read_b64_tr_b16 a[190:191], v12 offset:28672
  v_mfma_f32_16x16x32_bf16 v[112:115], a[128:131], v[160:163], v[112:115]
  ds_read_b128 v[140:143], v3 offset:3072
  v_mfma_f32_16x16x32_bf16 v[112:115], a[132:135], v[164:167], v[112:115]
  buffer_load_dwordx4 v2, s[8:11], s32 offen offset:3072 sc1 lds
  v_mfma_f32_16x16x32_bf16 v[112:115], a[136:139], v[168:171], v[112:115]
  ds_read_b128 v[144:147], v3 offset:4096
  v_mfma_f32_16x16x32_bf16 v[112:115], a[140:143], v[172:175], v[112:115]
  ds_read_b128 v[148:151], v3 offset:5120
  v_mfma_f32_16x16x32_bf16 v[116:119], a[156:159], v[172:175], v[116:119]
  s_add_u32 s35, s37, 440320
  ds_read_b128 v[152:155], v3 offset:6144
  v_mfma_f32_16x16x32_bf16 v[116:119], a[152:155], v[168:171], v[116:119]
  buffer_load_dwordx4 a[64:67], v23, s[4:7], s35 offen offset:1024 sc1
  v_mfma_f32_16x16x32_bf16 v[116:119], a[148:151], v[164:167], v[116:119]
  ds_read_b128 v[156:159], v3 offset:7168
  v_mfma_f32_16x16x32_bf16 v[116:119], a[144:147], v[160:163], v[116:119]
  s_waitcnt lgkmcnt(12)
  v_add_u32 v11, s30, v7
  v_add_u32 v12, s30, v8
  v_mfma_f32_16x16x32_bf16 v[124:127], a[144:147], v[176:179], v[124:127]
  ds_read_b128 v[160:163], v3 offset:8192
  v_mfma_f32_16x16x32_bf16 v[124:127], a[148:151], v[180:183], v[124:127]
  ds_read_b128 v[164:167], v3 offset:9216
  v_mfma_f32_16x16x32_bf16 v[124:127], a[152:155], v[184:187], v[124:127]
  ds_read_b128 v[168:171], v3 offset:10240
  v_mfma_f32_16x16x32_bf16 v[124:127], a[156:159], v[188:191], v[124:127]
  buffer_load_dwordx4 a[68:71], v24, s[4:7], s35 offen sc1
  v_mfma_f32_16x16x32_bf16 v[120:123], a[140:143], v[188:191], v[120:123]
  ds_read_b128 v[172:175], v3 offset:11264
  v_mfma_f32_16x16x32_bf16 v[120:123], a[136:139], v[184:187], v[120:123]
  ds_read_b64_tr_b16 v[192:193], v11 offset:0
  v_mfma_f32_16x16x32_bf16 v[120:123], a[132:135], v[180:183], v[120:123]
  ds_read_b64_tr_b16 v[194:195], v11 offset:4096
  v_mfma_f32_16x16x32_bf16 v[120:123], a[128:131], v[176:179], v[120:123]
  s_waitcnt lgkmcnt(10)
  ds_read_b64_tr_b16 v[196:197], v11 offset:8192
  v_mfma_f32_16x16x32_bf16 v[64:67], a[160:163], v[128:131], v[64:67]
  s_add_u32 s35, s37, 528384
  ds_read_b128 v[176:179], v3 offset:12288
  v_mfma_f32_16x16x32_bf16 v[64:67], a[164:167], v[132:135], v[64:67]
  buffer_load_dwordx4 a[72:75], v23, s[4:7], s35 offen sc1
  v_mfma_f32_16x16x32_bf16 v[64:67], a[168:171], v[136:139], v[64:67]
  ds_read_b128 v[180:183], v3 offset:13312
  v_mfma_f32_16x16x32_bf16 v[64:67], a[172:175], v[140:143], v[64:67]
  ds_read_b64_tr_b16 v[198:199], v11 offset:12288
  v_mfma_f32_16x16x32_bf16 v[68:71], a[188:191], v[140:143], v[68:71]
  ds_read_b128 v[184:187], v3 offset:14336
  v_mfma_f32_16x16x32_bf16 v[68:71], a[184:187], v[136:139], v[68:71]
  buffer_load_dwordx4 a[76:79], v23, s[4:7], s35 offen offset:1024 sc1
  v_mfma_f32_16x16x32_bf16 v[68:71], a[180:183], v[132:135], v[68:71]
  ds_read_b128 v[188:191], v3 offset:15360
  v_mfma_f32_16x16x32_bf16 v[68:71], a[176:179], v[128:131], v[68:71]
  s_waitcnt lgkmcnt(12)
  ds_read_b64_tr_b16 v[200:201], v11 offset:16384
  v_mfma_f32_16x16x32_bf16 v[76:79], a[176:179], v[144:147], v[76:79]
  ds_read_b128 v[128:131], v3 offset:16384
  v_mfma_f32_16x16x32_bf16 v[76:79], a[180:183], v[148:151], v[76:79]
  buffer_load_dwordx4 a[80:83], v24, s[4:7], s35 offen sc1
  v_mfma_f32_16x16x32_bf16 v[76:79], a[184:187], v[152:155], v[76:79]
  ds_read_b128 v[132:135], v3 offset:17408
  v_mfma_f32_16x16x32_bf16 v[76:79], a[188:191], v[156:159], v[76:79]
  ds_read_b64_tr_b16 v[202:203], v11 offset:20480
  v_mfma_f32_16x16x32_bf16 v[72:75], a[172:175], v[156:159], v[72:75]
  s_add_u32 s35, s37, 616448
  ds_read_b128 v[136:139], v3 offset:18432
  v_mfma_f32_16x16x32_bf16 v[72:75], a[168:171], v[152:155], v[72:75]
  buffer_load_dwordx4 a[84:87], v23, s[4:7], s35 offen sc1
  v_mfma_f32_16x16x32_bf16 v[72:75], a[164:167], v[148:151], v[72:75]
  ds_read_b128 v[140:143], v3 offset:19456
  v_mfma_f32_16x16x32_bf16 v[72:75], a[160:163], v[144:147], v[72:75]
  s_waitcnt lgkmcnt(14)
  ds_read_b64_tr_b16 v[204:205], v11 offset:24576
  v_mfma_f32_16x16x32_bf16 v[80:83], a[160:163], v[160:163], v[80:83]
  ds_read_b128 v[144:147], v3 offset:20480
  v_mfma_f32_16x16x32_bf16 v[80:83], a[164:167], v[164:167], v[80:83]
  buffer_load_dwordx4 a[88:91], v23, s[4:7], s35 offen offset:1024 sc1
  v_mfma_f32_16x16x32_bf16 v[80:83], a[168:171], v[168:171], v[80:83]
  ds_read_b128 v[148:151], v3 offset:21504
  v_mfma_f32_16x16x32_bf16 v[80:83], a[172:175], v[172:175], v[80:83]
  ds_read_b64_tr_b16 v[206:207], v11 offset:28672
  v_mfma_f32_16x16x32_bf16 v[84:87], a[188:191], v[172:175], v[84:87]
  ds_read_b128 v[152:155], v3 offset:22528
  v_mfma_f32_16x16x32_bf16 v[84:87], a[184:187], v[168:171], v[84:87]
  buffer_load_dwordx4 a[92:95], v24, s[4:7], s35 offen sc1
  v_mfma_f32_16x16x32_bf16 v[84:87], a[180:183], v[164:167], v[84:87]
  ds_read_b128 v[156:159], v3 offset:23552
  v_mfma_f32_16x16x32_bf16 v[84:87], a[176:179], v[160:163], v[84:87]
  s_waitcnt lgkmcnt(12)
  ds_read_b64_tr_b16 v[208:209], v12 offset:0
  v_mfma_f32_16x16x32_bf16 v[92:95], a[176:179], v[176:179], v[92:95]
  s_add_u32 s35, s37, 704512
  ds_read_b128 v[160:163], v3 offset:24576
  v_mfma_f32_16x16x32_bf16 v[92:95], a[180:183], v[180:183], v[92:95]
  buffer_load_dwordx4 a[96:99], v23, s[4:7], s35 offen sc1
  v_mfma_f32_16x16x32_bf16 v[92:95], a[184:187], v[184:187], v[92:95]
  ds_read_b128 v[164:167], v3 offset:25600
  v_mfma_f32_16x16x32_bf16 v[92:95], a[188:191], v[188:191], v[92:95]
  ds_read_b64_tr_b16 v[210:211], v12 offset:4096
  v_mfma_f32_16x16x32_bf16 v[88:91], a[172:175], v[188:191], v[88:91]
  ds_read_b128 v[168:171], v3 offset:26624
  v_mfma_f32_16x16x32_bf16 v[88:91], a[168:171], v[184:187], v[88:91]
  buffer_load_dwordx4 a[100:103], v23, s[4:7], s35 offen offset:1024 sc1
  v_mfma_f32_16x16x32_bf16 v[88:91], a[164:167], v[180:183], v[88:91]
  ds_read_b128 v[172:175], v3 offset:27648
  v_mfma_f32_16x16x32_bf16 v[88:91], a[160:163], v[176:179], v[88:91]
  s_waitcnt lgkmcnt(12)
  ds_read_b64_tr_b16 v[212:213], v12 offset:8192
  v_mfma_f32_16x16x32_bf16 v[96:99], a[160:163], v[128:131], v[96:99]
  ds_read_b128 v[176:179], v3 offset:28672
  v_mfma_f32_16x16x32_bf16 v[96:99], a[164:167], v[132:135], v[96:99]
  ds_read_b128 v[180:183], v3 offset:29696
  v_mfma_f32_16x16x32_bf16 v[96:99], a[168:171], v[136:139], v[96:99]
  ds_read_b128 v[184:187], v3 offset:30720
  v_mfma_f32_16x16x32_bf16 v[96:99], a[172:175], v[140:143], v[96:99]
  ds_read_b128 v[188:191], v3 offset:31744
  v_mfma_f32_16x16x32_bf16 v[100:103], a[188:191], v[140:143], v[100:103]
  buffer_load_dwordx4 a[104:107], v24, s[4:7], s35 offen sc1
  v_mfma_f32_16x16x32_bf16 v[100:103], a[184:187], v[136:139], v[100:103]
  ds_read_b64_tr_b16 v[214:215], v12 offset:12288
  v_mfma_f32_16x16x32_bf16 v[100:103], a[180:183], v[132:135], v[100:103]
  ds_read_b64_tr_b16 v[216:217], v12 offset:16384
  v_mfma_f32_16x16x32_bf16 v[100:103], a[176:179], v[128:131], v[100:103]
  s_waitcnt lgkmcnt(13)
  s_add_u32 s35, s37, 792576
  ds_read_b64_tr_b16 v[218:219], v12 offset:20480
  v_mfma_f32_16x16x32_bf16 v[108:111], a[176:179], v[144:147], v[108:111]
  buffer_load_dwordx4 a[108:111], v23, s[4:7], s35 offen sc1
  v_mfma_f32_16x16x32_bf16 v[108:111], a[180:183], v[148:151], v[108:111]
  ds_read_b64_tr_b16 v[220:221], v12 offset:24576
  v_mfma_f32_16x16x32_bf16 v[108:111], a[184:187], v[152:155], v[108:111]
  v_add_u32 v3, s28, v2
  v_mfma_f32_16x16x32_bf16 v[108:111], a[188:191], v[156:159], v[108:111]
  s_waitcnt vmcnt(12) lgkmcnt(4)
  s_barrier
  v_mfma_f32_16x16x32_bf16 v[104:107], a[172:175], v[156:159], v[104:107]
  ds_read_b128 v[128:131], v3 offset:0
  v_mfma_f32_16x16x32_bf16 v[104:107], a[168:171], v[152:155], v[104:107]
  ds_read_b128 v[132:135], v3 offset:1024
  v_mfma_f32_16x16x32_bf16 v[104:107], a[164:167], v[148:151], v[104:107]
  ds_read_b128 v[136:139], v3 offset:2048
  v_mfma_f32_16x16x32_bf16 v[104:107], a[160:163], v[144:147], v[104:107]
  s_waitcnt lgkmcnt(12)
  ds_read_b64_tr_b16 v[222:223], v12 offset:28672
  v_mfma_f32_16x16x32_bf16 v[112:115], a[160:163], v[160:163], v[112:115]
  ds_read_b128 v[140:143], v3 offset:3072
  v_mfma_f32_16x16x32_bf16 v[112:115], a[164:167], v[164:167], v[112:115]
  buffer_load_dwordx4 a[112:115], v23, s[4:7], s35 offen offset:1024 sc1
  v_mfma_f32_16x16x32_bf16 v[112:115], a[168:171], v[168:171], v[112:115]
  ds_read_b128 v[144:147], v3 offset:4096
  v_mfma_f32_16x16x32_bf16 v[112:115], a[172:175], v[172:175], v[112:115]
  ds_read_b128 v[148:151], v3 offset:5120
  v_mfma_f32_16x16x32_bf16 v[116:119], a[188:191], v[172:175], v[116:119]
  ds_read_b128 v[152:155], v3 offset:6144
  v_mfma_f32_16x16x32_bf16 v[116:119], a[184:187], v[168:171], v[116:119]
  buffer_load_dwordx4 a[116:119], v24, s[4:7], s35 offen sc1
  v_mfma_f32_16x16x32_bf16 v[116:119], a[180:183], v[164:167], v[116:119]
  ds_read_b128 v[156:159], v3 offset:7168
  v_mfma_f32_16x16x32_bf16 v[116:119], a[176:179], v[160:163], v[116:119]
  s_waitcnt lgkmcnt(13)
  v_mfma_f32_16x16x32_bf16 v[124:127], a[176:179], v[176:179], v[124:127]
  ds_read_b128 v[160:163], v3 offset:8192
  v_mfma_f32_16x16x32_bf16 v[124:127], a[180:183], v[180:183], v[124:127]
  ds_read_b128 v[164:167], v3 offset:9216
  v_mfma_f32_16x16x32_bf16 v[124:127], a[184:187], v[184:187], v[124:127]
  s_add_u32 s35, s37, 880640
  ds_read_b128 v[168:171], v3 offset:10240
  v_mfma_f32_16x16x32_bf16 v[124:127], a[188:191], v[188:191], v[124:127]
  buffer_load_dwordx4 a[120:123], v23, s[4:7], s35 offen sc1
  v_mfma_f32_16x16x32_bf16 v[120:123], a[172:175], v[188:191], v[120:123]
  ds_read_b128 v[172:175], v3 offset:11264
  v_mfma_f32_16x16x32_bf16 v[120:123], a[168:171], v[184:187], v[120:123]
  v_mfma_f32_16x16x32_bf16 v[120:123], a[164:167], v[180:183], v[120:123]
  s_waitcnt vmcnt(17)
  v_cmp_eq_u32 vcc, 0, v19
  s_cbranch_vccnz L_spin_44
L_back_45:
  v_mfma_f32_16x16x32_bf16 v[120:123], a[160:163], v[176:179], v[120:123]
  s_waitcnt lgkmcnt(8)
  v_mfma_f32_16x16x32_bf16 v[64:67], v[192:195], v[128:131], v[64:67]
  ds_read_b128 v[176:179], v3 offset:12288
  v_mfma_f32_16x16x32_bf16 v[64:67], v[196:199], v[132:135], v[64:67]
  buffer_load_dwordx4 a[124:127], v23, s[4:7], s35 offen offset:1024 sc1
  v_mfma_f32_16x16x32_bf16 v[64:67], v[200:203], v[136:139], v[64:67]
  ds_read_b128 v[180:183], v3 offset:13312
  v_mfma_f32_16x16x32_bf16 v[64:67], v[204:207], v[140:143], v[64:67]
  v_mfma_f32_16x16x32_bf16 v[68:71], v[220:223], v[140:143], v[68:71]
  ds_read_b128 v[184:187], v3 offset:14336
  v_mfma_f32_16x16x32_bf16 v[68:71], v[216:219], v[136:139], v[68:71]
  buffer_load_dwordx4 a[128:131], v24, s[4:7], s35 offen sc1
  v_mfma_f32_16x16x32_bf16 v[68:71], v[212:215], v[132:135], v[68:71]
  ds_read_b128 v[188:191], v3 offset:15360
  v_mfma_f32_16x16x32_bf16 v[68:71], v[208:211], v[128:131], v[68:71]
  s_waitcnt lgkmcnt(8)
  v_mfma_f32_16x16x32_bf16 v[76:79], v[208:211], v[144:147], v[76:79]
  s_add_u32 s35, s37, 968704
  ds_read_b128 v[128:131], v3 offset:16384
  v_mfma_f32_16x16x32_bf16 v[76:79], v[212:215], v[148:151], v[76:79]
  buffer_load_dwordx4 a[132:135], v23, s[4:7], s35 offen sc1
  v_mfma_f32_16x16x32_bf16 v[76:79], v[216:219], v[152:155], v[76:79]
  ds_read_b128 v[132:135], v3 offset:17408
  v_mfma_f32_16x16x32_bf16 v[76:79], v[220:223], v[156:159], v[76:79]
  v_mfma_f32_16x16x32_bf16 v[72:75], v[204:207], v[156:159], v[72:75]
  ds_read_b128 v[136:139], v3 offset:18432
  v_mfma_f32_16x16x32_bf16 v[72:75], v[200:203], v[152:155], v[72:75]
  buffer_load_dwordx4 a[136:139], v23, s[4:7], s35 offen offset:1024 sc1
  v_mfma_f32_16x16x32_bf16 v[72:75], v[196:199], v[148:151], v[72:75]
  ds_read_b128 v[140:143], v3 offset:19456
  v_mfma_f32_16x16x32_bf16 v[72:75], v[192:195], v[144:147], v[72:75]
  s_waitcnt lgkmcnt(8)
  v_cvt_pk_bf16_f32 v40, v64, v65
  v_cvt_pk_bf16_f32 v41, v66, v67
  v_mfma_f32_16x16x32_bf16 v[80:83], v[192:195], v[160:163], v[80:83]
  ds_read_b128 v[144:147], v3 offset:20480
  v_cvt_pk_bf16_f32 v42, v68, v69
  v_mfma_f32_16x16x32_bf16 v[80:83], v[196:199], v[164:167], v[80:83]
  buffer_load_dwordx4 a[140:143], v24, s[4:7], s35 offen sc1
  v_mfma_f32_16x16x32_bf16 v[80:83], v[200:203], v[168:171], v[80:83]
  ds_read_b128 v[148:151], v3 offset:21504
  v_cvt_pk_bf16_f32 v43, v70, v71
  v_mfma_f32_16x16x32_bf16 v[80:83], v[204:207], v[172:175], v[80:83]
  buffer_store_dwordx4 v[40:43], v2, s[8:11], s44 offen
  v_mfma_f32_16x16x32_bf16 v[84:87], v[220:223], v[172:175], v[84:87]
  ds_read_b128 v[152:155], v3 offset:22528
  v_mfma_f32_16x16x32_bf16 v[84:87], v[216:219], v[168:171], v[84:87]
  v_mfma_f32_16x16x32_bf16 v[84:87], v[212:215], v[164:167], v[84:87]
  ds_read_b128 v[156:159], v3 offset:23552
  v_mfma_f32_16x16x32_bf16 v[84:87], v[208:211], v[160:163], v[84:87]
  s_waitcnt lgkmcnt(8)
  v_cvt_pk_bf16_f32 v44, v72, v73
  v_cvt_pk_bf16_f32 v45, v74, v75
  v_mfma_f32_16x16x32_bf16 v[92:95], v[208:211], v[176:179], v[92:95]
  ds_read_b128 v[160:163], v3 offset:24576
  s_add_u32 s44, s44, 131072
  v_mfma_f32_16x16x32_bf16 v[92:95], v[212:215], v[180:183], v[92:95]
  v_cvt_pk_bf16_f32 v46, v76, v77
  v_cvt_pk_bf16_f32 v47, v78, v79
  v_mfma_f32_16x16x32_bf16 v[92:95], v[216:219], v[184:187], v[92:95]
  ds_read_b128 v[164:167], v3 offset:25600
  v_mfma_f32_16x16x32_bf16 v[92:95], v[220:223], v[188:191], v[92:95]
  buffer_store_dwordx4 v[44:47], v2, s[8:11], s44 offen
  v_mfma_f32_16x16x32_bf16 v[88:91], v[204:207], v[188:191], v[88:91]
  ds_read_b128 v[168:171], v3 offset:26624
  v_mfma_f32_16x16x32_bf16 v[88:91], v[200:203], v[184:187], v[88:91]
  v_mfma_f32_16x16x32_bf16 v[88:91], v[196:199], v[180:183], v[88:91]
  ds_read_b128 v[172:175], v3 offset:27648
  v_mfma_f32_16x16x32_bf16 v[88:91], v[192:195], v[176:179], v[88:91]
  s_waitcnt lgkmcnt(8)
  v_cvt_pk_bf16_f32 v48, v80, v81
  v_cvt_pk_bf16_f32 v49, v82, v83
  v_mfma_f32_16x16x32_bf16 v[96:99], v[192:195], v[128:131], v[96:99]
  ds_read_b128 v[176:179], v3 offset:28672
  s_add_u32 s44, s44, 131072
  v_mfma_f32_16x16x32_bf16 v[96:99], v[196:199], v[132:135], v[96:99]
  ds_read_b128 v[180:183], v3 offset:29696
  v_cvt_pk_bf16_f32 v50, v84, v85
  v_mfma_f32_16x16x32_bf16 v[96:99], v[200:203], v[136:139], v[96:99]
  ds_read_b128 v[184:187], v3 offset:30720
  v_cvt_pk_bf16_f32 v51, v86, v87
  v_mfma_f32_16x16x32_bf16 v[96:99], v[204:207], v[140:143], v[96:99]
  ds_read_b128 v[188:191], v3 offset:31744
  v_mfma_f32_16x16x32_bf16 v[100:103], v[220:223], v[140:143], v[100:103]
  buffer_store_dwordx4 v[48:51], v2, s[8:11], s44 offen
  v_mfma_f32_16x16x32_bf16 v[100:103], v[216:219], v[136:139], v[100:103]
  v_mfma_f32_16x16x32_bf16 v[100:103], v[212:215], v[132:135], v[100:103]
  v_mfma_f32_16x16x32_bf16 v[100:103], v[208:211], v[128:131], v[100:103]
  s_waitcnt lgkmcnt(8)
  v_cvt_pk_bf16_f32 v52, v88, v89
  v_cvt_pk_bf16_f32 v53, v90, v91
  v_mfma_f32_16x16x32_bf16 v[108:111], v[208:211], v[144:147], v[108:111]
  s_add_u32 s44, s44, 131072
  v_cvt_pk_bf16_f32 v54, v92, v93
  v_cvt_pk_bf16_f32 v55, v94, v95
  v_mfma_f32_16x16x32_bf16 v[108:111], v[212:215], v[148:151], v[108:111]
  buffer_store_dwordx4 v[52:55], v2, s[8:11], s44 offen
  v_mfma_f32_16x16x32_bf16 v[108:111], v[216:219], v[152:155], v[108:111]
  v_mfma_f32_16x16x32_bf16 v[108:111], v[220:223], v[156:159], v[108:111]
  v_mfma_f32_16x16x32_bf16 v[104:107], v[204:207], v[156:159], v[104:107]
  v_mfma_f32_16x16x32_bf16 v[104:107], v[200:203], v[152:155], v[104:107]
  v_mfma_f32_16x16x32_bf16 v[104:107], v[196:199], v[148:151], v[104:107]
  v_mfma_f32_16x16x32_bf16 v[104:107], v[192:195], v[144:147], v[104:107]
  s_waitcnt lgkmcnt(4)
  v_cvt_pk_bf16_f32 v40, v96, v97
  v_cvt_pk_bf16_f32 v41, v98, v99
  v_mfma_f32_16x16x32_bf16 v[112:115], v[192:195], v[160:163], v[112:115]
  s_add_u32 s44, s44, 131072
  v_cvt_pk_bf16_f32 v42, v100, v101
  v_cvt_pk_bf16_f32 v43, v102, v103
  v_mfma_f32_16x16x32_bf16 v[112:115], v[196:199], v[164:167], v[112:115]
  buffer_store_dwordx4 v[40:43], v2, s[8:11], s44 offen
  v_mfma_f32_16x16x32_bf16 v[112:115], v[200:203], v[168:171], v[112:115]
  v_mfma_f32_16x16x32_bf16 v[112:115], v[204:207], v[172:175], v[112:115]
  v_mfma_f32_16x16x32_bf16 v[116:119], v[220:223], v[172:175], v[116:119]
  v_mfma_f32_16x16x32_bf16 v[116:119], v[216:219], v[168:171], v[116:119]
  v_mfma_f32_16x16x32_bf16 v[116:119], v[212:215], v[164:167], v[116:119]
  v_mfma_f32_16x16x32_bf16 v[116:119], v[208:211], v[160:163], v[116:119]
  s_waitcnt lgkmcnt(0)
  v_cvt_pk_bf16_f32 v44, v104, v105
  v_cvt_pk_bf16_f32 v45, v106, v107
  v_mfma_f32_16x16x32_bf16 v[124:127], v[208:211], v[176:179], v[124:127]
  s_add_u32 s44, s44, 131072
  v_cvt_pk_bf16_f32 v46, v108, v109
  v_cvt_pk_bf16_f32 v47, v110, v111
  v_mfma_f32_16x16x32_bf16 v[124:127], v[212:215], v[180:183], v[124:127]
  buffer_store_dwordx4 v[44:47], v2, s[8:11], s44 offen
  v_mfma_f32_16x16x32_bf16 v[124:127], v[216:219], v[184:187], v[124:127]
  v_mfma_f32_16x16x32_bf16 v[124:127], v[220:223], v[188:191], v[124:127]
  v_mfma_f32_16x16x32_bf16 v[120:123], v[204:207], v[188:191], v[120:123]
  v_mfma_f32_16x16x32_bf16 v[120:123], v[200:203], v[184:187], v[120:123]
  v_mfma_f32_16x16x32_bf16 v[120:123], v[196:199], v[180:183], v[120:123]
  v_mfma_f32_16x16x32_bf16 v[120:123], v[192:195], v[176:179], v[120:123]
L_dend:
  v_cvt_pk_bf16_f32 v48, v112, v113
  v_cvt_pk_bf16_f32 v49, v114, v115
  s_add_u32 s44, s44, 131072
  v_cvt_pk_bf16_f32 v50, v116, v117
  v_cvt_pk_bf16_f32 v51, v118, v119
  buffer_store_dwordx4 v[48:51], v2, s[8:11], s44 offen
  s_nop 2
  v_cvt_pk_bf16_f32 v52, v120, v121
  v_cvt_pk_bf16_f32 v53, v122, v123
  s_add_u32 s44, s44, 131072
  v_cvt_pk_bf16_f32 v54, v124, v125
  v_cvt_pk_bf16_f32 v55, v126, v127
  buffer_store_dwordx4 v[52:55], v2, s[8:11], s44 offen
  s_add_u32 s12, s66, 60817408
  s_addc_u32 s13, s67, 0
  s_mov_b32 s14, 1409024
  s_add_u32 s51, s34, 4096
  s_mul_i32 s40, s20, 360448
  s_lshl_b32 s24, s22, 12
  s_add_u32 s40, s40, s24
  s_add_u32 s40, s40, 163840
  s_sub_u32 s23, s42, s36
  s_add_u32 s23, s23, s20
  s_lshl_b32 s23, s23, 2
  s_and_b32 s32, s26, 30
  s_lshl_b32 s32, s32, 7
  s_add_u32 s32, s32, 73412608
  s_add_u32 s42, s32, s23
  s_waitcnt vmcnt(0)
  v_mov_b32 v19, 1
  s_cmp_eq_u32 s3, 0
  s_cbranch_scc1 L_xsig_46
  s_mov_b64 exec, 1
  buffer_store_dword v19, off, s[8:11], s42
  s_mov_b64 exec, -1
L_sigd_47:
  s_lshl_b32 s23, s26, 2
  s_lshr_b32 s24, s22, 1
  s_add_u32 s23, s23, s24
  s_lshl_b32 s23, s23, 17
  s_add_u32 s23, s23, 37748736
  s_and_b32 s24, s22, 1
  s_lshl_b32 s44, s24, 7
  s_add_u32 s44, s44, s23
  s_lshl_b32 s45, s20, 12
  s_add_u32 s44, s44, s45
  s_add_u32 s45, s44, 32768
  s_add_u32 s46, s44, 65536
  s_add_u32 s47, s44, 98304
  v_lshlrev_b32 v96, 16, v32
  v_and_b32 v97, 0xffff0000, v32
  v_lshlrev_b32 v98, 16, v33
  v_and_b32 v99, 0xffff0000, v33
  v_lshlrev_b32 v100, 16, v34
  v_and_b32 v101, 0xffff0000, v34
  v_lshlrev_b32 v102, 16, v35
  v_and_b32 v103, 0xffff0000, v35
  v_lshlrev_b32 v104, 16, v36
  v_and_b32 v105, 0xffff0000, v36
  v_lshlrev_b32 v106, 16, v37
  v_and_b32 v107, 0xffff0000, v37
  v_lshlrev_b32 v108, 16, v38
  v_and_b32 v109, 0xffff0000, v38
  v_lshlrev_b32 v110, 16, v39
  v_and_b32 v111, 0xffff0000, v39
  v_and_b32 v29, 7, v1
  v_lshrrev_b32 v30, 3, v1
  v_lshlrev_b32 v30, 8, v30
  v_lshl_add_u32 v29, v29, 4, v30
  v_and_b32 v30, 7, v1
  v_lshlrev_b32 v30, 5, v30
  v_add_u32 v30, s27, v30
  s_lshl_b32 s23, s20, 3
  v_add_u32 v31, s23, v30
  v_mov_b32 v126, 0x3f80
  v_mov_b32 v127, 0x3f800000
  buffer_load_dword v19, v4, s[8:11], s32 offen sc1
  s_waitcnt vmcnt(0)
  v_cmp_eq_u32 vcc, 0, v19
  s_cbranch_vccnz L_spin_48
L_back_49:
  s_cmp_eq_u32 s3, 0
  s_cbranch_scc1 L_acq_50
L_acqd_51:
  buffer_load_dwordx4 v[64:67], v29, s[8:11], s44 offen sc1
  buffer_load_dwordx4 v[68:71], v29, s[8:11], s44 offen offset:2048 sc1
  buffer_load_dwordx4 v[72:75], v29, s[8:11], s45 offen sc1
  buffer_load_dwordx4 v[76:79], v29, s[8:11], s45 offen offset:2048 sc1
  buffer_load_dwordx4 v[80:83], v29, s[8:11], s46 offen sc1
  buffer_load_dwordx4 v[84:87], v29, s[8:11], s46 offen offset:2048 sc1
  buffer_load_dwordx4 v[88:91], v29, s[8:11], s47 offen sc1
  buffer_load_dwordx4 v[92:95], v29, s[8:11], s47 offen offset:2048 sc1
  s_add_u32 s35, s37, 1056768
  buffer_load_dwordx4 a[144:147], v23, s[4:7], s35 offen sc1
  buffer_load_dwordx4 a[148:151], v23, s[4:7], s35 offen offset:1024 sc1
  buffer_load_dwordx4 a[152:155], v24, s[4:7], s35 offen sc1
  s_add_u32 s35, s37, 1144832
  buffer_load_dwordx4 a[156:159], v23, s[4:7], s35 offen sc1
  buffer_load_dwordx4 a[160:163], v23, s[4:7], s35 offen offset:1024 sc1
  buffer_load_dwordx4 a[164:167], v24, s[4:7], s35 offen sc1
  s_waitcnt vmcnt(12)
  v_dot2c_f32_bf16 v96, v64, v126
  v_dot2c_f32_bf16 v97, v64, v127
  v_dot2c_f32_bf16 v98, v65, v126
  v_dot2c_f32_bf16 v99, v65, v127
  v_dot2c_f32_bf16 v100, v66, v126
  v_dot2c_f32_bf16 v101, v66, v127
  v_dot2c_f32_bf16 v102, v67, v126
  v_dot2c_f32_bf16 v103, v67, v127
  v_dot2c_f32_bf16 v104, v68, v126
  v_dot2c_f32_bf16 v105, v68, v127
  v_dot2c_f32_bf16 v106, v69, v126
  v_dot2c_f32_bf16 v107, v69, v127
  v_dot2c_f32_bf16 v108, v70, v126
  v_dot2c_f32_bf16 v109, v70, v127
  v_dot2c_f32_bf16 v110, v71, v126
  v_dot2c_f32_bf16 v111, v71, v127
  s_waitcnt vmcnt(10)
  s_add_u32 s35, s37, 1232896
  buffer_load_dwordx4 a[168:171], v23, s[4:7], s35 offen sc1
  v_dot2c_f32_bf16 v96, v72, v126
  v_dot2c_f32_bf16 v97, v72, v127
  v_dot2c_f32_bf16 v98, v73, v126
  v_dot2c_f32_bf16 v99, v73, v127
  v_dot2c_f32_bf16 v100, v74, v126
  v_dot2c_f32_bf16 v101, v74, v127
  v_dot2c_f32_bf16 v102, v75, v126
  v_dot2c_f32_bf16 v103, v75, v127
  v_dot2c_f32_bf16 v104, v76, v126
  v_dot2c_f32_bf16 v105, v76, v127
  v_dot2c_f32_bf16 v106, v77, v126
  v_dot2c_f32_bf16 v107, v77, v127
  v_dot2c_f32_bf16 v108, v78, v126
  buffer_load_dwordx4 a[172:175], v23, s[4:7], s35 offen offset:1024 sc1
  v_dot2c_f32_bf16 v109, v78, v127
  v_dot2c_f32_bf16 v110, v79, v126
  v_dot2c_f32_bf16 v111, v79, v127
  s_waitcnt vmcnt(10)
  v_dot2c_f32_bf16 v96, v80, v126
  v_dot2c_f32_bf16 v97, v80, v127
  v_dot2c_f32_bf16 v98, v81, v126
  v_dot2c_f32_bf16 v99, v81, v127
  v_dot2c_f32_bf16 v100, v82, v126
  v_dot2c_f32_bf16 v101, v82, v127
  v_dot2c_f32_bf16 v102, v83, v126
  v_dot2c_f32_bf16 v103, v83, v127
  v_dot2c_f32_bf16 v104, v84, v126
  buffer_load_dwordx4 a[176:179], v24, s[4:7], s35 offen sc1
  v_dot2c_f32_bf16 v105, v84, v127
  v_dot2c_f32_bf16 v106, v85, v126
  v_dot2c_f32_bf16 v107, v85, v127
  v_dot2c_f32_bf16 v108, v86, v126
  v_dot2c_f32_bf16 v109, v86, v127
  v_dot2c_f32_bf16 v110, v87, v126
  v_dot2c_f32_bf16 v111, v87, v127
  s_waitcnt vmcnt(9)
  v_dot2c_f32_bf16 v96, v88, v126
  v_dot2c_f32_bf16 v97, v88, v127
  v_dot2c_f32_bf16 v98, v89, v126
  v_dot2c_f32_bf16 v99, v89, v127
  v_dot2c_f32_bf16 v100, v90, v126
  s_add_u32 s35, s37, 1320960
  buffer_load_dwordx4 a[180:183], v23, s[4:7], s35 offen sc1
  v_dot2c_f32_bf16 v101, v90, v127
  v_dot2c_f32_bf16 v102, v91, v126
  v_dot2c_f32_bf16 v103, v91, v127
  v_dot2c_f32_bf16 v104, v92, v126
  v_dot2c_f32_bf16 v105, v92, v127
  v_dot2c_f32_bf16 v106, v93, v126
  v_dot2c_f32_bf16 v107, v93, v127
  v_dot2c_f32_bf16 v108, v94, v126
  v_dot2c_f32_bf16 v109, v94, v127
  v_dot2c_f32_bf16 v110, v95, v126
  v_dot2c_f32_bf16 v111, v95, v127
  s_nop 1
  v_cvt_pk_bf16_f32 v64, v96, v97
  buffer_load_dwordx4 a[184:187], v23, s[4:7], s35 offen offset:1024 sc1
  v_cvt_pk_bf16_f32 v65, v98, v99
  v_cvt_pk_bf16_f32 v66, v100, v101
  v_cvt_pk_bf16_f32 v67, v102, v103
  v_cvt_pk_bf16_f32 v68, v104, v105
  v_cvt_pk_bf16_f32 v69, v106, v107
  v_cvt_pk_bf16_f32 v70, v108, v109
  v_cvt_pk_bf16_f32 v71, v110, v111
  v_lshlrev_b32 v96, 16, v64
  v_and_b32 v97, 0xffff0000, v64
  v_lshlrev_b32 v98, 16, v65
  v_and_b32 v99, 0xffff0000, v65
  v_lshlrev_b32 v100, 16, v66
  v_and_b32 v101, 0xffff0000, v66
  buffer_load_dwordx4 a[188:191], v24, s[4:7], s35 offen sc1
  v_lshlrev_b32 v102, 16, v67
  v_and_b32 v103, 0xffff0000, v67
  v_lshlrev_b32 v104, 16, v68
  v_and_b32 v105, 0xffff0000, v68
  v_lshlrev_b32 v106, 16, v69
  v_and_b32 v107, 0xffff0000, v69
  v_lshlrev_b32 v108, 16, v70
  v_and_b32 v109, 0xffff0000, v70
  v_lshlrev_b32 v110, 16, v71
  v_and_b32 v111, 0xffff0000, v71
  s_add_u32 m0, s29, s34
  s_nop 0
  buffer_load_dwordx4 v2, s[12:15], s40 offen sc1 lds
  v_pk_add_f32 v[112:113], v[96:97], v[98:99]
  v_pk_add_f32 v[114:115], v[100:101], v[102:103]
  v_pk_add_f32 v[116:117], v[104:105], v[106:107]
  v_pk_add_f32 v[118:119], v[108:109], v[110:111]
  v_pk_add_f32 v[112:113], v[112:113], v[114:115]
  v_pk_add_f32 v[116:117], v[116:117], v[118:119]
  v_pk_add_f32 v[112:113], v[112:113], v[116:117]
  v_add_f32 v112, v112, v113
  s_nop 1
  v_add_f32_dpp v112, v112, v112 row_ror:8 row_mask:0xf bank_mask:0xf
  v_mov_b32 v113, v112
  s_nop 1
  v_permlane16_swap_b32 v112, v113
  v_add_f32 v112, v112, v113
  v_mov_b32 v113, v112
  s_nop 1
  v_permlane32_swap_b32 v112, v113
  v_add_f32 v112, v112, v113
  v_mul_f32 v112, 0x3c000000, v112
  v_pk_add_f32 v[72:73], v[96:97], v[112:113] op_sel_hi:[1,0] neg_lo:[0,1] neg_hi:[0,1]
  v_pk_add_f32 v[74:75], v[98:99], v[112:113] op_sel_hi:[1,0] neg_lo:[0,1] neg_hi:[0,1]
  v_pk_add_f32 v[76:77], v[100:101], v[112:113] op_sel_hi:[1,0] neg_lo:[0,1] neg_hi:[0,1]
  v_pk_add_f32 v[78:79], v[102:103], v[112:113] op_sel_hi:[1,0] neg_lo:[0,1] neg_hi:[0,1]
  buffer_load_dwordx4 v2, s[12:15], s40 offen offset:1024 sc1 lds
  v_pk_add_f32 v[80:81], v[104:105], v[112:113] op_sel_hi:[1,0] neg_lo:[0,1] neg_hi:[0,1]
  v_pk_add_f32 v[82:83], v[106:107], v[112:113] op_sel_hi:[1,0] neg_lo:[0,1] neg_hi:[0,1]
  v_pk_add_f32 v[84:85], v[108:109], v[112:113] op_sel_hi:[1,0] neg_lo:[0,1] neg_hi:[0,1]
  v_pk_add_f32 v[86:87], v[110:111], v[112:113] op_sel_hi:[1,0] neg_lo:[0,1] neg_hi:[0,1]
  v_pk_mul_f32 v[114:115], v[72:73], v[72:73]
  v_pk_fma_f32 v[114:115], v[74:75], v[74:75], v[114:115]
  v_pk_fma_f32 v[114:115], v[76:77], v[76:77], v[114:115]
  v_pk_fma_f32 v[114:115], v[78:79], v[78:79], v[114:115]
  v_pk_fma_f32 v[114:115], v[80:81], v[80:81], v[114:115]
  v_pk_fma_f32 v[114:115], v[82:83], v[82:83], v[114:115]
  v_pk_fma_f32 v[114:115], v[84:85], v[84:85], v[114:115]
  v_pk_fma_f32 v[114:115], v[86:87], v[86:87], v[114:115]
  v_add_f32 v113, v114, v115
  s_nop 1
  v_add_f32_dpp v113, v113, v113 row_ror:8 row_mask:0xf bank_mask:0xf
  v_mov_b32 v114, v113
  s_nop 1
  v_permlane16_swap_b32 v113, v114
  v_add_f32 v113, v113, v114
  v_mov_b32 v114, v113
  s_nop 1
  v_permlane32_swap_b32 v113, v114
  v_add_f32 v113, v113, v114
  ds_write_b64 v31, v[112:113]
  buffer_store_dwordx4 v[64:67], v29, s[8:11], s45 offen
  buffer_store_dwordx4 v[68:71], v29, s[8:11], s45 offen offset:2048
  s_waitcnt lgkmcnt(0)
  s_barrier
  ds_read_b128 v[112:115], v30
  ds_read_b128 v[116:119], v30 offset:16
  v_mov_b32 v125, 0x3727c5ac
  s_waitcnt lgkmcnt(0)
  v_add_f32 v120, v112, v114
  v_add_f32 v121, v116, v118
  v_add_f32 v120, v120, v121
  v_mul_f32 v120, 0x3e800000, v120
  v_add_f32 v121, v113, v115
  v_add_f32 v122, v117, v119
  v_add_f32 v121, v121, v122
  v_sub_f32 v112, v112, v120
  v_sub_f32 v114, v114, v120
  v_sub_f32 v116, v116, v120
  v_sub_f32 v118, v118, v120
  v_mul_f32 v122, v112, v112
  v_fmac_f32 v122, v114, v114
  v_fmac_f32 v122, v116, v116
  v_fmac_f32 v122, v118, v118
  v_fmac_f32 v121, 0x43000000, v122
  v_mul_f32 v121, 0x3b000000, v121
  v_add_f32 v122, v121, v125
  v_rsq_f32 v122, v122
  s_nop 0
  v_mul_f32 v121, v121, v122
  v_fma_f32 v121, v121, v122, v125
  v_rsq_f32 v121, v121
  s_nop 0
  v_mul_f32 v122, v122, v121
  v_mul_f32 v122, 0x3eeff558, v122
  v_mul_f32 v120, v120, v122
  v_pk_fma_f32 v[96:97], v[96:97], v[122:123], v[120:121] op_sel_hi:[1,0,0] neg_lo:[0,0,1] neg_hi:[0,0,1]
  v_pk_fma_f32 v[98:99], v[98:99], v[122:123], v[120:121] op_sel_hi:[1,0,0] neg_lo:[0,0,1] neg_hi:[0,0,1]
  v_pk_fma_f32 v[100:101], v[100:101], v[122:123], v[120:121] op_sel_hi:[1,0,0] neg_lo:[0,0,1] neg_hi:[0,0,1]
  v_pk_fma_f32 v[102:103], v[102:103], v[122:123], v[120:121] op_sel_hi:[1,0,0] neg_lo:[0,0,1] neg_hi:[0,0,1]
  v_pk_fma_f32 v[104:105], v[104:105], v[122:123], v[120:121] op_sel_hi:[1,0,0] neg_lo:[0,0,1] neg_hi:[0,0,1]
  v_pk_fma_f32 v[106:107], v[106:107], v[122:123], v[120:121] op_sel_hi:[1,0,0] neg_lo:[0,0,1] neg_hi:[0,0,1]
  v_pk_fma_f32 v[108:109], v[108:109], v[122:123], v[120:121] op_sel_hi:[1,0,0] neg_lo:[0,0,1] neg_hi:[0,0,1]
  v_pk_fma_f32 v[110:111], v[110:111], v[122:123], v[120:121] op_sel_hi:[1,0,0] neg_lo:[0,0,1] neg_hi:[0,0,1]
  v_cvt_pk_bf16_f32 v72, v96, v97
  v_cvt_pk_bf16_f32 v73, v98, v99
  v_cvt_pk_bf16_f32 v74, v100, v101
  v_cvt_pk_bf16_f32 v75, v102, v103
  v_cvt_pk_bf16_f32 v76, v104, v105
  v_cvt_pk_bf16_f32 v77, v106, v107
  v_cvt_pk_bf16_f32 v78, v108, v109
  v_cvt_pk_bf16_f32 v79, v110, v111
  buffer_store_dwordx4 v[72:75], v29, s[8:11], s44 offen
  buffer_store_dwordx4 v[76:79], v29, s[8:11], s44 offen offset:2048
  s_lshl_b32 s32, s26, 7
  s_add_u32 s32, s32, 73416704
  s_lshl_b32 s23, s43, 2
  s_add_u32 s42, s32, s23
  s_waitcnt vmcnt(0)
  v_mov_b32 v19, 1
  s_cmp_eq_u32 s3, 0
  s_cbranch_scc1 L_xsig_52
  s_mov_b64 exec, 1
  buffer_store_dword v19, off, s[8:11], s42
  s_mov_b64 exec, -1
L_sigd_53:
  s_lshr_b32 s64, s64, 5
  s_lshr_b32 s65, s65, 5
  v_lshlrev_b32 v20, 3, v22
  s_mul_i32 s23, s43, 96
  s_add_u32 s24, s23, s65
  s_add_u32 s23, s23, s64
  buffer_load_dwordx2 v[244:245], v20, s[72:75], s23 offen
  buffer_load_dwordx2 v[246:247], v20, s[72:75], s23 offen offset:32
  buffer_load_dwordx2 v[248:249], v20, s[72:75], s24 offen
  s_lshl_b32 s33, s26, 19
  s_add_u32 s33, s33, 37748736
  v_add_u32 v3, s28, v2
  v_add_u32 v4, s30, v2
  v_add_u32 v8, 4096, v2
  v_add_u32 v9, 8192, v2
  s_mul_i32 s23, s43, 3
  s_add_u32 s23, s23, 1
  s_lshr_b32 s54, s23, 1
  s_lshr_b32 s23, s43, 1
  s_mul_i32 s23, s23, 3
  s_add_u32 s55, s23, 1
  s_mul_i32 s23, s54, 47
  s_lshr_b32 s23, s23, 6
  s_and_b32 s23, s23, 24
  s_lshr_b32 s23, 0x4a355540, s23
  s_and_b32 s23, s23, 255
  s_add_u32 s54, s54, s23
  s_lshl_b32 s54, s54, 10
  s_add_u32 s54, s54, s33
  s_mul_i32 s23, s55, 47
  s_lshr_b32 s23, s23, 6
  s_and_b32 s23, s23, 24
  s_lshr_b32 s23, 0x4a355540, s23
  s_and_b32 s23, s23, 255
  s_add_u32 s55, s55, s23
  s_lshl_b32 s55, s55, 10
  s_add_u32 s55, s55, s33
  s_lshr_b32 s23, s64, 2
  s_add_u32 s55, s55, s23
  buffer_load_dword v19, v18, s[8:11], s32 offen sc1
  s_lshl_b32 s23, s20, 12
  s_add_u32 s41, s33, s23
  s_add_u32 s64, s28, s23
  s_add_u32 s65, s30, s23
  s_waitcnt vmcnt(0)
  v_cmp_eq_u32 vcc, 0, v19
  s_cbranch_vccnz L_spin_54
L_back_55:
  s_cmp_eq_u32 s3, 0
  s_cbranch_scc1 L_acq_56
L_acqd_57:
  s_add_u32 m0, s64, 0
  s_nop 0
  buffer_load_dwordx4 v2, s[8:11], s41 offen sc1 lds
  buffer_load_dwordx4 v2, s[8:11], s41 offen offset:1024 sc1 lds
  buffer_load_dwordx4 v2, s[8:11], s41 offen offset:2048 sc1 lds
  buffer_load_dwordx4 v2, s[8:11], s41 offen offset:3072 sc1 lds
  s_add_u32 m0, s64, 16384
  s_add_u32 s41, s41, 131072
  buffer_load_dwordx4 v2, s[8:11], s41 offen sc1 lds
  v_lshlrev_b32 v40, 16, v244
  v_and_b32 v41, 0xffff0000, v244
  v_lshlrev_b32 v42, 16, v245
  v_and_b32 v43, 0xffff0000, v245
  v_lshlrev_b32 v44, 16, v246
  v_and_b32 v45, 0xffff0000, v246
  v_lshlrev_b32 v46, 16, v247
  v_and_b32 v47, 0xffff0000, v247
  v_lshlrev_b32 v48, 16, v248
  v_and_b32 v49, 0xffff0000, v248
  v_lshlrev_b32 v50, 16, v249
  v_and_b32 v51, 0xffff0000, v249
  v_mul_f32 v40, 0x3eeff558, v40
  v_mul_f32 v41, 0x3eeff558, v41
  buffer_load_dwordx4 v2, s[8:11], s41 offen offset:1024 sc1 lds
  v_mul_f32 v42, 0x3eeff558, v42
  v_mul_f32 v43, 0x3eeff558, v43
  v_mul_f32 v44, 0x3eeff558, v44
  v_mul_f32 v45, 0x3eeff558, v45
  v_mul_f32 v46, 0x3eeff558, v46
  v_mul_f32 v47, 0x3eeff558, v47
  v_mul_f32 v48, 0x3eeff558, v48
  v_mul_f32 v49, 0x3eeff558, v49
  v_mul_f32 v50, 0x3eeff558, v50
  v_mul_f32 v51, 0x3eeff558, v51
  s_mov_b32 s39, 0x409d30fc
  v_mov_b32 v10, 0x40088e99
  v_add_u32 v27, s34, v2
  v_add_u32 v5, s27, v27
  buffer_load_dwordx4 v2, s[8:11], s41 offen offset:2048 sc1 lds
  v_add_u32 v6, s29, v27
  v_add_u32 v7, s31, v27
  s_lshl_b32 s23, s22, 1
  s_and_b32 s24, s20, 1
  s_add_u32 s23, s23, s24
  s_lshl_b32 s44, s23, 6
  v_add_u32 v20, s44, v20
  s_lshl_b32 s23, s23, 10
  s_lshr_b32 s24, s20, 1
  s_lshl_b32 s25, s24, 17
  s_add_u32 s23, s23, s25
  s_add_u32 s23, s23, s33
  s_add_u32 s45, s23, 32768
  s_add_u32 s46, s23, 294912
  buffer_load_dwordx4 v2, s[8:11], s41 offen offset:3072 sc1 lds
  s_lshl_b32 s23, s26, 2
  s_add_u32 s23, s23, s24
  s_lshl_b32 s23, s23, 14
  s_add_u32 s44, s44, s23
  s_add_u32 s35, s32, 4096
  s_add_u32 s42, s42, 4096
  s_lshl_b32 s23, s20, 3
  s_lshr_b32 s23, 0x6b4b6040, s23
  s_and_b32 s23, s23, 255
  s_lshl_b32 s23, s23, 10
  s_add_u32 s33, s33, s23
  s_mov_b32 s4, s66
  s_mov_b32 s5, s67
  s_cmp_lt_u32 s43, 29
  s_cselect_b32 s6, 0x10000000, 0
  s_waitcnt vmcnt(4)
  s_barrier
  ds_read_b128 v[128:131], v3 offset:0
  ds_read_b128 v[132:135], v3 offset:1024
  ds_read_b128 v[136:139], v3 offset:2048
  ds_read_b128 v[140:143], v3 offset:3072
  ds_read_b128 v[144:147], v3 offset:4096
  ds_read_b128 v[148:151], v3 offset:5120
  ds_read_b128 v[152:155], v3 offset:6144
  ds_read_b128 v[156:159], v3 offset:7168
  ds_read_b128 v[160:163], v3 offset:8192
  ds_read_b128 v[164:167], v3 offset:9216
  ds_read_b128 v[168:171], v3 offset:10240
  ds_read_b128 v[172:175], v3 offset:11264
  ds_read_b128 v[176:179], v3 offset:12288
  ds_read_b128 v[180:183], v3 offset:13312
  ds_read_b128 v[184:187], v3 offset:14336
  ds_read_b128 v[188:191], v3 offset:15360
  s_waitcnt lgkmcnt(8)
  v_mfma_f32_16x16x32_bf16 v[96:99], a[0:3], v[128:131], v[40:43]
  s_add_u32 m0, s65, 0
  v_mfma_f32_16x16x32_bf16 v[96:99], a[12:15], v[132:135], v[96:99]
  s_add_u32 s41, s41, 131072
  v_mfma_f32_16x16x32_bf16 v[96:99], a[24:27], v[136:139], v[96:99]
  buffer_load_dwordx4 v2, s[8:11], s41 offen sc1 lds
  v_mfma_f32_16x16x32_bf16 v[96:99], a[36:39], v[140:143], v[96:99]
  v_mfma_f32_16x16x32_bf16 v[96:99], a[48:51], v[144:147], v[96:99]
  v_mfma_f32_16x16x32_bf16 v[96:99], a[60:63], v[148:151], v[96:99]
  buffer_load_dwordx4 v2, s[8:11], s41 offen offset:1024 sc1 lds
  v_mfma_f32_16x16x32_bf16 v[96:99], a[72:75], v[152:155], v[96:99]
  v_mfma_f32_16x16x32_bf16 v[96:99], a[84:87], v[156:159], v[96:99]
  s_waitcnt lgkmcnt(0)
  v_mfma_f32_16x16x32_bf16 v[96:99], a[96:99], v[160:163], v[96:99]
  buffer_load_dwordx4 v2, s[8:11], s41 offen offset:2048 sc1 lds
  v_mfma_f32_16x16x32_bf16 v[96:99], a[108:111], v[164:167], v[96:99]
  v_mfma_f32_16x16x32_bf16 v[96:99], a[120:123], v[168:171], v[96:99]
  v_mfma_f32_16x16x32_bf16 v[96:99], a[132:135], v[172:175], v[96:99]
  buffer_load_dwordx4 v2, s[8:11], s41 offen offset:3072 sc1 lds
  v_mfma_f32_16x16x32_bf16 v[96:99], a[144:147], v[176:179], v[96:99]
  s_add_u32 m0, s65, 16384
  v_mfma_f32_16x16x32_bf16 v[96:99], a[156:159], v[180:183], v[96:99]
  s_add_u32 s41, s41, 131072
  v_mfma_f32_16x16x32_bf16 v[96:99], a[168:171], v[184:187], v[96:99]
  buffer_load_dwordx4 v2, s[8:11], s41 offen sc1 lds
  v_mfma_f32_16x16x32_bf16 v[96:99], a[180:183], v[188:191], v[96:99]
  v_mfma_f32_16x16x32_bf16 v[100:103], a[4:7], v[128:131], v[44:47]
  v_mfma_f32_16x16x32_bf16 v[100:103], a[16:19], v[132:135], v[100:103]
  buffer_load_dwordx4 v2, s[8:11], s41 offen offset:1024 sc1 lds
  v_mfma_f32_16x16x32_bf16 v[100:103], a[28:31], v[136:139], v[100:103]
  v_mfma_f32_16x16x32_bf16 v[100:103], a[40:43], v[140:143], v[100:103]
  v_mfma_f32_16x16x32_bf16 v[100:103], a[52:55], v[144:147], v[100:103]
  buffer_load_dwordx4 v2, s[8:11], s41 offen offset:2048 sc1 lds
  v_mfma_f32_16x16x32_bf16 v[100:103], a[64:67], v[148:151], v[100:103]
  v_fma_f32 v200, v96, v96, s39
  v_fma_f32 v201, v97, v97, s39
  v_mul_f32 v200, v200, v96
  v_mfma_f32_16x16x32_bf16 v[100:103], a[76:79], v[152:155], v[100:103]
  v_mul_f32 v201, v201, v97
  v_exp_f32 v200, -v200
  v_mfma_f32_16x16x32_bf16 v[100:103], a[88:91], v[156:159], v[100:103]
  buffer_load_dwordx4 v2, s[8:11], s41 offen offset:3072 sc1 lds
  v_mfma_f32_16x16x32_bf16 v[100:103], a[100:103], v[160:163], v[100:103]
  v_exp_f32 v201, -v201
  v_add_f32 v200, 1.0, v200
  v_mfma_f32_16x16x32_bf16 v[100:103], a[112:115], v[164:167], v[100:103]
  v_add_f32 v201, 1.0, v201
  v_rcp_f32 v200, v200
  v_mfma_f32_16x16x32_bf16 v[100:103], a[124:127], v[168:171], v[100:103]
  s_add_u32 m0, s29, s34
  v_rcp_f32 v201, v201
  v_mul_f32 v200, v96, v200
  v_mfma_f32_16x16x32_bf16 v[100:103], a[136:139], v[172:175], v[100:103]
  buffer_load_dwordx4 v2, s[12:15], s40 offen offset:2048 sc1 lds
  v_mul_f32 v201, v97, v201
  v_mfma_f32_16x16x32_bf16 v[100:103], a[148:151], v[176:179], v[100:103]
  v_cvt_pk_bf16_f32 v204, v200, v201
  v_fma_f32 v202, v98, v98, s39
  v_fma_f32 v203, v99, v99, s39
  v_mfma_f32_16x16x32_bf16 v[100:103], a[160:163], v[180:183], v[100:103]
  v_mul_f32 v202, v202, v98
  v_mul_f32 v203, v203, v99
  v_mfma_f32_16x16x32_bf16 v[100:103], a[172:175], v[184:187], v[100:103]
  s_waitcnt vmcnt(9)
  s_barrier
  v_mfma_f32_16x16x32_bf16 v[100:103], a[184:187], v[188:191], v[100:103]
  buffer_load_dwordx4 v2, s[12:15], s40 offen offset:3072 sc1 lds
  v_mfma_f32_16x16x32_bf16 v[104:107], a[8:11], v[128:131], v[48:51]
  ds_read_b128 v[128:131], v3 offset:16384
  v_exp_f32 v202, -v202
  v_mfma_f32_16x16x32_bf16 v[104:107], a[20:23], v[132:135], v[104:107]
  ds_read_b128 v[132:135], v3 offset:17408
  v_exp_f32 v203, -v203
  v_mfma_f32_16x16x32_bf16 v[104:107], a[32:35], v[136:139], v[104:107]
  ds_read_b128 v[136:139], v3 offset:18432
  v_add_f32 v202, 1.0, v202
  v_add_f32 v203, 1.0, v203
  v_mfma_f32_16x16x32_bf16 v[104:107], a[44:47], v[140:143], v[104:107]
  ds_read_b128 v[140:143], v3 offset:19456
  v_rcp_f32 v202, v202
  v_mfma_f32_16x16x32_bf16 v[104:107], a[56:59], v[144:147], v[104:107]
  ds_read_b128 v[144:147], v3 offset:20480
  v_rcp_f32 v203, v203
  v_mfma_f32_16x16x32_bf16 v[104:107], a[68:71], v[148:151], v[104:107]
  ds_read_b128 v[148:151], v3 offset:21504
  v_mul_f32 v202, v98, v202
  v_mul_f32 v203, v99, v203
  v_mfma_f32_16x16x32_bf16 v[104:107], a[80:83], v[152:155], v[104:107]
  s_add_u32 m0, s29, s51
  ds_read_b128 v[152:155], v3 offset:22528
  v_cvt_pk_bf16_f32 v205, v202, v203
  v_fma_f32 v200, v100, v100, s39
  v_mfma_f32_16x16x32_bf16 v[104:107], a[92:95], v[156:159], v[104:107]
  s_add_u32 s40, s40, 32768
  ds_read_b128 v[156:159], v3 offset:23552
  v_fma_f32 v201, v101, v101, s39
  v_mul_f32 v200, v200, v100
  v_mfma_f32_16x16x32_bf16 v[104:107], a[104:107], v[160:163], v[104:107]
  buffer_load_dwordx4 v2, s[12:15], s40 offen sc1 lds
  v_mul_f32 v201, v201, v101
  v_mfma_f32_16x16x32_bf16 v[104:107], a[116:119], v[164:167], v[104:107]
  v_exp_f32 v200, -v200
  v_mfma_f32_16x16x32_bf16 v[104:107], a[128:131], v[168:171], v[104:107]
  ds_read_b128 v[160:163], v3 offset:24576
  v_exp_f32 v201, -v201
  v_mfma_f32_16x16x32_bf16 v[104:107], a[140:143], v[172:175], v[104:107]
  v_add_f32 v200, 1.0, v200
  v_add_f32 v201, 1.0, v201
  v_mfma_f32_16x16x32_bf16 v[104:107], a[152:155], v[176:179], v[104:107]
  buffer_load_dwordx4 v2, s[12:15], s40 offen offset:1024 sc1 lds
  v_mfma_f32_16x16x32_bf16 v[104:107], a[164:167], v[180:183], v[104:107]
  ds_read_b128 v[164:167], v3 offset:25600
  v_rcp_f32 v200, v200
  v_mfma_f32_16x16x32_bf16 v[104:107], a[176:179], v[184:187], v[104:107]
  v_rcp_f32 v201, v201
  v_mul_f32 v200, v100, v200
  v_mfma_f32_16x16x32_bf16 v[104:107], a[188:191], v[188:191], v[104:107]
  s_waitcnt lgkmcnt(2)
  v_mul_f32 v201, v101, v201
  v_cvt_pk_bf16_f32 v206, v200, v201
  v_fma_f32 v202, v102, v102, s39
  v_mfma_f32_16x16x32_bf16 v[108:111], a[0:3], v[128:131], v[40:43]
  ds_read_b128 v[168:171], v3 offset:26624
  v_fma_f32 v203, v103, v103, s39
  v_mul_f32 v202, v202, v102
  v_mfma_f32_16x16x32_bf16 v[108:111], a[12:15], v[132:135], v[108:111]
  buffer_load_dwordx4 v2, s[12:15], s40 offen offset:2048 sc1 lds
  v_mul_f32 v203, v203, v103
  v_mfma_f32_16x16x32_bf16 v[108:111], a[24:27], v[136:139], v[108:111]
  v_exp_f32 v202, -v202
  v_mfma_f32_16x16x32_bf16 v[108:111], a[36:39], v[140:143], v[108:111]
  ds_read_b128 v[172:175], v3 offset:27648
  v_exp_f32 v203, -v203
  v_mfma_f32_16x16x32_bf16 v[108:111], a[48:51], v[144:147], v[108:111]
  v_add_f32 v202, 1.0, v202
  v_add_f32 v203, 1.0, v203
  v_mfma_f32_16x16x32_bf16 v[108:111], a[60:63], v[148:151], v[108:111]
  buffer_load_dwordx4 v2, s[12:15], s40 offen offset:3072 sc1 lds
  v_mfma_f32_16x16x32_bf16 v[108:111], a[72:75], v[152:155], v[108:111]
  ds_read_b128 v[176:179], v3 offset:28672
  v_rcp_f32 v202, v202
  v_mfma_f32_16x16x32_bf16 v[108:111], a[84:87], v[156:159], v[108:111]
  v_rcp_f32 v203, v203
  v_mfma_f32_16x16x32_bf16 v[112:115], a[4:7], v[128:131], v[44:47]
  s_add_u32 m0, s31, s34
  v_mul_f32 v202, v102, v202
  v_mul_f32 v203, v103, v203
  v_mfma_f32_16x16x32_bf16 v[112:115], a[16:19], v[132:135], v[112:115]
  s_add_u32 s40, s40, 32768
  ds_read_b128 v[180:183], v3 offset:29696
  v_cvt_pk_bf16_f32 v207, v202, v203
  v_mfma_f32_16x16x32_bf16 v[112:115], a[28:31], v[136:139], v[112:115]
  buffer_load_dwordx4 v2, s[12:15], s40 offen sc1 lds
  v_mfma_f32_16x16x32_bf16 v[112:115], a[40:43], v[140:143], v[112:115]
  buffer_store_dwordx4 v[204:207], v2, s[4:7], s54 offen
  s_add_u32 s54, s54, 131072
  v_mfma_f32_16x16x32_bf16 v[112:115], a[52:55], v[144:147], v[112:115]
  ds_read_b128 v[184:187], v3 offset:30720
  v_fma_f32 v200, v104, v104, s39
  v_fma_f32 v201, v105, v105, s39
  v_mfma_f32_16x16x32_bf16 v[112:115], a[64:67], v[148:151], v[112:115]
  v_mul_f32 v200, v200, v104
  v_mul_f32 v201, v201, v105
  v_mfma_f32_16x16x32_bf16 v[112:115], a[76:79], v[152:155], v[112:115]
  buffer_load_dwordx4 v2, s[12:15], s40 offen offset:1024 sc1 lds
  v_mfma_f32_16x16x32_bf16 v[112:115], a[88:91], v[156:159], v[112:115]
  ds_read_b128 v[188:191], v3 offset:31744
  v_exp_f32 v200, -v200
  v_mfma_f32_16x16x32_bf16 v[116:119], a[8:11], v[128:131], v[48:51]
  s_waitcnt vmcnt(9)
  s_barrier
  v_mfma_f32_16x16x32_bf16 v[116:119], a[20:23], v[132:135], v[116:119]
  v_exp_f32 v201, -v201
  v_add_f32 v200, 1.0, v200
  v_mfma_f32_16x16x32_bf16 v[116:119], a[32:35], v[136:139], v[116:119]
  ds_read_b128 v[128:131], v4 offset:0
  v_add_f32 v201, 1.0, v201
  v_mfma_f32_16x16x32_bf16 v[116:119], a[44:47], v[140:143], v[116:119]
  buffer_load_dwordx4 v2, s[12:15], s40 offen offset:2048 sc1 lds
  v_mfma_f32_16x16x32_bf16 v[116:119], a[56:59], v[144:147], v[116:119]
  v_rcp_f32 v200, v200
  v_mfma_f32_16x16x32_bf16 v[116:119], a[68:71], v[148:151], v[116:119]
  ds_read_b128 v[132:135], v4 offset:1024
  v_rcp_f32 v201, v201
  v_mfma_f32_16x16x32_bf16 v[116:119], a[80:83], v[152:155], v[116:119]
  v_mul_f32 v200, v104, v200
  v_mul_f32 v201, v105, v201
  v_cvt_pk_bf16_f32 v208, v200, v201
  v_mfma_f32_16x16x32_bf16 v[116:119], a[92:95], v[156:159], v[116:119]
  s_waitcnt lgkmcnt(2)
  v_fma_f32 v202, v106, v106, s39
  v_fma_f32 v203, v107, v107, s39
  v_mul_f32 v202, v202, v106
  v_mfma_f32_16x16x32_bf16 v[108:111], a[96:99], v[160:163], v[108:111]
  ds_read_b128 v[136:139], v4 offset:2048
  v_mul_f32 v203, v203, v107
  v_mfma_f32_16x16x32_bf16 v[108:111], a[108:111], v[164:167], v[108:111]
  buffer_load_dwordx4 v2, s[12:15], s40 offen offset:3072 sc1 lds
  v_mfma_f32_16x16x32_bf16 v[108:111], a[120:123], v[168:171], v[108:111]
  v_exp_f32 v202, -v202
  v_mfma_f32_16x16x32_bf16 v[108:111], a[132:135], v[172:175], v[108:111]
  s_add_u32 m0, s31, s51
  ds_read_b128 v[140:143], v4 offset:3072
  v_exp_f32 v203, -v203
  v_mfma_f32_16x16x32_bf16 v[108:111], a[144:147], v[176:179], v[108:111]
  s_add_u32 s40, s40, 32768
  v_add_f32 v202, 1.0, v202
  v_add_f32 v203, 1.0, v203
  v_mfma_f32_16x16x32_bf16 v[108:111], a[156:159], v[180:183], v[108:111]
  buffer_load_dwordx4 v2, s[12:15], s40 offen sc1 lds
  v_mfma_f32_16x16x32_bf16 v[108:111], a[168:171], v[184:187], v[108:111]
  ds_read_b128 v[144:147], v4 offset:4096
  v_rcp_f32 v202, v202
  v_mfma_f32_16x16x32_bf16 v[108:111], a[180:183], v[188:191], v[108:111]
  v_rcp_f32 v203, v203
  v_mfma_f32_16x16x32_bf16 v[112:115], a[100:103], v[160:163], v[112:115]
  v_mul_f32 v202, v106, v202
  v_mul_f32 v203, v107, v203
  v_mfma_f32_16x16x32_bf16 v[112:115], a[112:115], v[164:167], v[112:115]
  ds_read_b128 v[148:151], v4 offset:5120
  v_cvt_pk_bf16_f32 v209, v202, v203
  v_mfma_f32_16x16x32_bf16 v[112:115], a[124:127], v[168:171], v[112:115]
  buffer_load_dwordx4 v2, s[12:15], s40 offen offset:1024 sc1 lds
  v_mfma_f32_16x16x32_bf16 v[112:115], a[136:139], v[172:175], v[112:115]
  buffer_store_dwordx2 v[208:209], v2, s[4:7], s55 offen
  v_mfma_f32_16x16x32_bf16 v[112:115], a[148:151], v[176:179], v[112:115]
  ds_read_b128 v[152:155], v4 offset:6144
  s_add_u32 s55, s55, 131072
  v_mfma_f32_16x16x32_bf16 v[112:115], a[160:163], v[180:183], v[112:115]
  v_fma_f32 v200, v108, v108, s39
  v_fma_f32 v201, v109, v109, s39
  v_mul_f32 v200, v200, v108
  v_mul_f32 v201, v201, v109
  v_mfma_f32_16x16x32_bf16 v[112:115], a[172:175], v[184:187], v[112:115]
  buffer_load_dwordx4 v2, s[12:15], s40 offen offset:2048 sc1 lds
  v_exp_f32 v200, -v200
  v_mfma_f32_16x16x32_bf16 v[112:115], a[184:187], v[188:191], v[112:115]
  ds_read_b128 v[156:159], v4 offset:7168
  v_exp_f32 v201, -v201
  v_add_f32 v200, 1.0, v200
  v_add_f32 v201, 1.0, v201
  v_mfma_f32_16x16x32_bf16 v[116:119], a[104:107], v[160:163], v[116:119]
  v_rcp_f32 v200, v200
  v_rcp_f32 v201, v201
  v_mul_f32 v200, v108, v200
  v_mfma_f32_16x16x32_bf16 v[116:119], a[116:119], v[164:167], v[116:119]
  v_mul_f32 v201, v109, v201
  v_cvt_pk_bf16_f32 v204, v200, v201
  v_fma_f32 v202, v110, v110, s39
  v_fma_f32 v203, v111, v111, s39
  v_mul_f32 v202, v202, v110
  v_mfma_f32_16x16x32_bf16 v[116:119], a[128:131], v[168:171], v[116:119]
  ds_read_b128 v[160:163], v4 offset:8192
  v_mul_f32 v203, v203, v111
  v_exp_f32 v202, -v202
  v_mfma_f32_16x16x32_bf16 v[116:119], a[140:143], v[172:175], v[116:119]
  buffer_load_dwordx4 v2, s[12:15], s40 offen offset:3072 sc1 lds
  v_exp_f32 v203, -v203
  v_add_f32 v202, 1.0, v202
  v_mfma_f32_16x16x32_bf16 v[116:119], a[152:155], v[176:179], v[116:119]
  v_add_f32 v203, 1.0, v203
  v_rcp_f32 v202, v202
  v_rcp_f32 v203, v203
  v_mfma_f32_16x16x32_bf16 v[116:119], a[164:167], v[180:183], v[116:119]
  ds_read_b128 v[164:167], v4 offset:9216
  v_mul_f32 v202, v110, v202
  v_mul_f32 v203, v111, v203
  v_cvt_pk_bf16_f32 v205, v202, v203
  v_fma_f32 v200, v112, v112, s39
  v_mfma_f32_16x16x32_bf16 v[116:119], a[176:179], v[184:187], v[116:119]
  v_fma_f32 v201, v113, v113, s39
  v_mul_f32 v200, v200, v112
  v_mul_f32 v201, v201, v113
  v_exp_f32 v200, -v200
  v_mfma_f32_16x16x32_bf16 v[116:119], a[188:191], v[188:191], v[116:119]
  s_waitcnt lgkmcnt(2)
  s_add_u32 m0, s27, s34
  v_exp_f32 v201, -v201
  v_add_f32 v200, 1.0, v200
  v_add_f32 v201, 1.0, v201
  v_mfma_f32_16x16x32_bf16 v[96:99], a[0:3], v[128:131], v[40:43]
  s_add_u32 s40, s40, 32768
  ds_read_b128 v[168:171], v4 offset:10240
  v_rcp_f32 v200, v200
  v_rcp_f32 v201, v201
  v_mfma_f32_16x16x32_bf16 v[96:99], a[12:15], v[132:135], v[96:99]
  buffer_load_dwordx4 v2, s[12:15], s40 offen sc1 lds
  v_mul_f32 v200, v112, v200
  v_mul_f32 v201, v113, v201
  v_cvt_pk_bf16_f32 v206, v200, v201
  v_mfma_f32_16x16x32_bf16 v[96:99], a[24:27], v[136:139], v[96:99]
  v_fma_f32 v202, v114, v114, s39
  v_fma_f32 v203, v115, v115, s39
  v_mul_f32 v202, v202, v114
  v_mul_f32 v203, v203, v115
  v_mfma_f32_16x16x32_bf16 v[96:99], a[36:39], v[140:143], v[96:99]
  ds_read_b128 v[172:175], v4 offset:11264
  v_exp_f32 v202, -v202
  v_exp_f32 v203, -v203
  v_mfma_f32_16x16x32_bf16 v[96:99], a[48:51], v[144:147], v[96:99]
  v_add_f32 v202, 1.0, v202
  v_add_f32 v203, 1.0, v203
  v_rcp_f32 v202, v202
  v_mfma_f32_16x16x32_bf16 v[96:99], a[60:63], v[148:151], v[96:99]
  buffer_load_dwordx4 v2, s[12:15], s40 offen offset:1024 sc1 lds
  v_rcp_f32 v203, v203
  v_mfma_f32_16x16x32_bf16 v[96:99], a[72:75], v[152:155], v[96:99]
  ds_read_b128 v[176:179], v4 offset:12288
  v_mul_f32 v202, v114, v202
  v_mul_f32 v203, v115, v203
  v_cvt_pk_bf16_f32 v207, v202, v203
  v_mfma_f32_16x16x32_bf16 v[96:99], a[84:87], v[156:159], v[96:99]
  buffer_store_dwordx4 v[204:207], v2, s[4:7], s54 offen
  v_mfma_f32_16x16x32_bf16 v[100:103], a[4:7], v[128:131], v[44:47]
  s_add_u32 s54, s54, 131072
  v_fma_f32 v200, v116, v116, s39
  v_fma_f32 v201, v117, v117, s39
  v_mul_f32 v200, v200, v116
  v_mfma_f32_16x16x32_bf16 v[100:103], a[16:19], v[132:135], v[100:103]
  ds_read_b128 v[180:183], v4 offset:13312
  v_mul_f32 v201, v201, v117
  v_mfma_f32_16x16x32_bf16 v[100:103], a[28:31], v[136:139], v[100:103]
  buffer_load_dwordx4 v2, s[12:15], s40 offen offset:2048 sc1 lds
  v_mfma_f32_16x16x32_bf16 v[100:103], a[40:43], v[140:143], v[100:103]
  v_exp_f32 v200, -v200
  v_mfma_f32_16x16x32_bf16 v[100:103], a[52:55], v[144:147], v[100:103]
  ds_read_b128 v[184:187], v4 offset:14336
  v_exp_f32 v201, -v201
  v_mfma_f32_16x16x32_bf16 v[100:103], a[64:67], v[148:151], v[100:103]
  s_waitcnt vmcnt(6)
  v_mov_b32 v30, 1
  s_cmp_eq_u32 s3, 0
  s_cbranch_scc1 L_xsig_58
  s_mov_b64 exec, 1
  buffer_store_dword v30, off, s[8:11], s42
  s_mov_b64 exec, -1
L_sigd_59:
  v_mfma_f32_16x16x32_bf16 v[100:103], a[76:79], v[152:155], v[100:103]
  buffer_load_dwordx4 v2, s[12:15], s40 offen offset:3072 sc1 lds
  v_add_f32 v200, 1.0, v200
  v_mfma_f32_16x16x32_bf16 v[100:103], a[88:91], v[156:159], v[100:103]
  ds_read_b128 v[188:191], v4 offset:15360
  v_add_f32 v201, 1.0, v201
  v_mfma_f32_16x16x32_bf16 v[104:107], a[8:11], v[128:131], v[48:51]
  v_rcp_f32 v200, v200
  v_mfma_f32_16x16x32_bf16 v[104:107], a[20:23], v[132:135], v[104:107]
  s_add_u32 m0, s27, s51
  v_rcp_f32 v201, v201
  v_mul_f32 v200, v116, v200
  v_mfma_f32_16x16x32_bf16 v[104:107], a[32:35], v[136:139], v[104:107]
  s_add_u32 s40, s40, 32768
  ds_read_b128 v[128:131], v4 offset:16384
  v_mul_f32 v201, v117, v201
  v_mfma_f32_16x16x32_bf16 v[104:107], a[44:47], v[140:143], v[104:107]
  buffer_load_dwordx4 v2, s[12:15], s40 offen sc1 lds
  v_mfma_f32_16x16x32_bf16 v[104:107], a[56:59], v[144:147], v[104:107]
  v_cvt_pk_bf16_f32 v208, v200, v201
  v_fma_f32 v202, v118, v118, s39
  v_mfma_f32_16x16x32_bf16 v[104:107], a[68:71], v[148:151], v[104:107]
  ds_read_b128 v[132:135], v4 offset:17408
  v_fma_f32 v203, v119, v119, s39
  v_mfma_f32_16x16x32_bf16 v[104:107], a[80:83], v[152:155], v[104:107]
  v_mul_f32 v202, v202, v118
  v_mul_f32 v203, v203, v119
  v_mfma_f32_16x16x32_bf16 v[104:107], a[92:95], v[156:159], v[104:107]
  s_waitcnt lgkmcnt(2)
  v_exp_f32 v202, -v202
  v_mfma_f32_16x16x32_bf16 v[96:99], a[96:99], v[160:163], v[96:99]
  ds_read_b128 v[136:139], v4 offset:18432
  v_exp_f32 v203, -v203
  v_mfma_f32_16x16x32_bf16 v[96:99], a[108:111], v[164:167], v[96:99]
  buffer_load_dwordx4 v2, s[12:15], s40 offen offset:1024 sc1 lds
  v_mfma_f32_16x16x32_bf16 v[96:99], a[120:123], v[168:171], v[96:99]
  v_add_f32 v202, 1.0, v202
  v_add_f32 v203, 1.0, v203
  v_mfma_f32_16x16x32_bf16 v[96:99], a[132:135], v[172:175], v[96:99]
  ds_read_b128 v[140:143], v4 offset:19456
  v_rcp_f32 v202, v202
  v_mfma_f32_16x16x32_bf16 v[96:99], a[144:147], v[176:179], v[96:99]
  v_rcp_f32 v203, v203
  v_mfma_f32_16x16x32_bf16 v[96:99], a[156:159], v[180:183], v[96:99]
  buffer_load_dwordx4 v2, s[12:15], s40 offen offset:2048 sc1 lds
  v_mfma_f32_16x16x32_bf16 v[96:99], a[168:171], v[184:187], v[96:99]
  ds_read_b128 v[144:147], v4 offset:20480
  v_mul_f32 v202, v118, v202
  v_mfma_f32_16x16x32_bf16 v[96:99], a[180:183], v[188:191], v[96:99]
  v_mul_f32 v203, v119, v203
  v_cvt_pk_bf16_f32 v209, v202, v203
  v_mfma_f32_16x16x32_bf16 v[100:103], a[100:103], v[160:163], v[100:103]
  buffer_store_dwordx2 v[208:209], v2, s[4:7], s55 offen
  v_mfma_f32_16x16x32_bf16 v[100:103], a[112:115], v[164:167], v[100:103]
  ds_read_b128 v[148:151], v4 offset:21504
  s_add_u32 s55, s55, 131072
  v_mfma_f32_16x16x32_bf16 v[100:103], a[124:127], v[168:171], v[100:103]
  buffer_load_dwordx4 v2, s[12:15], s40 offen offset:3072 sc1 lds
  v_mfma_f32_16x16x32_bf16 v[100:103], a[136:139], v[172:175], v[100:103]
  v_mfma_f32_16x16x32_bf16 v[100:103], a[148:151], v[176:179], v[100:103]
  ds_read_b128 v[152:155], v4 offset:22528
  v_mfma_f32_16x16x32_bf16 v[100:103], a[160:163], v[180:183], v[100:103]
  buffer_load_dword v19, v18, s[8:11], s35 offen sc1
  v_fma_f32 v200, v96, v96, s39
  v_fma_f32 v201, v97, v97, s39
  v_mfma_f32_16x16x32_bf16 v[100:103], a[172:175], v[184:187], v[100:103]
  buffer_load_dwordx4 v[32:35], v2, s[8:11], s45 offen sc1
  v_mul_f32 v200, v200, v96
  v_mul_f32 v201, v201, v97
  v_mfma_f32_16x16x32_bf16 v[100:103], a[184:187], v[188:191], v[100:103]
  ds_read_b128 v[156:159], v4 offset:23552
  v_exp_f32 v200, -v200
  v_mfma_f32_16x16x32_bf16 v[104:107], a[104:107], v[160:163], v[104:107]
  v_exp_f32 v201, -v201
  v_add_f32 v200, 1.0, v200
  v_add_f32 v201, 1.0, v201
  v_mfma_f32_16x16x32_bf16 v[104:107], a[116:119], v[164:167], v[104:107]
  v_rcp_f32 v200, v200
  v_rcp_f32 v201, v201
  v_mfma_f32_16x16x32_bf16 v[104:107], a[128:131], v[168:171], v[104:107]
  ds_read_b128 v[160:163], v4 offset:24576
  v_mul_f32 v200, v96, v200
  v_mul_f32 v201, v97, v201
  v_cvt_pk_bf16_f32 v204, v200, v201
  v_mfma_f32_16x16x32_bf16 v[104:107], a[140:143], v[172:175], v[104:107]
  buffer_load_dwordx4 v[36:39], v2, s[8:11], s46 offen sc1
  v_fma_f32 v202, v98, v98, s39
  v_fma_f32 v203, v99, v99, s39
  v_mfma_f32_16x16x32_bf16 v[104:107], a[152:155], v[176:179], v[104:107]
  v_mul_f32 v202, v202, v98
  v_mul_f32 v203, v203, v99
  v_exp_f32 v202, -v202
  v_mfma_f32_16x16x32_bf16 v[104:107], a[164:167], v[180:183], v[104:107]
  ds_read_b128 v[164:167], v4 offset:25600
  v_exp_f32 v203, -v203
  v_add_f32 v202, 1.0, v202
  v_mfma_f32_16x16x32_bf16 v[104:107], a[176:179], v[184:187], v[104:107]
  v_add_f32 v203, 1.0, v203
  v_rcp_f32 v202, v202
  v_mfma_f32_16x16x32_bf16 v[104:107], a[188:191], v[188:191], v[104:107]
  s_waitcnt lgkmcnt(2)
  v_rcp_f32 v203, v203
  v_mul_f32 v202, v98, v202
  v_mfma_f32_16x16x32_bf16 v[108:111], a[0:3], v[128:131], v[40:43]
  ds_read_b128 v[168:171], v4 offset:26624
  v_mul_f32 v203, v99, v203
  v_cvt_pk_bf16_f32 v205, v202, v203
  v_mfma_f32_16x16x32_bf16 v[108:111], a[12:15], v[132:135], v[108:111]
  buffer_load_dwordx2 v[240:241], v20, s[76:79], 0 offen offset:0
  v_fma_f32 v200, v100, v100, s39
  v_mfma_f32_16x16x32_bf16 v[108:111], a[24:27], v[136:139], v[108:111]
  v_fma_f32 v201, v101, v101, s39
  v_mul_f32 v200, v200, v100
  v_mul_f32 v201, v201, v101
  v_mfma_f32_16x16x32_bf16 v[108:111], a[36:39], v[140:143], v[108:111]
  ds_read_b128 v[172:175], v4 offset:27648
  v_exp_f32 v200, -v200
  v_mfma_f32_16x16x32_bf16 v[108:111], a[48:51], v[144:147], v[108:111]
  v_exp_f32 v201, -v201
  v_add_f32 v200, 1.0, v200
  v_mfma_f32_16x16x32_bf16 v[108:111], a[60:63], v[148:151], v[108:111]
  buffer_load_dwordx2 v[242:243], v20, s[76:79], 0 offen offset:32
  v_add_f32 v201, 1.0, v201
  v_mfma_f32_16x16x32_bf16 v[108:111], a[72:75], v[152:155], v[108:111]
  ds_read_b128 v[176:179], v4 offset:28672
  v_rcp_f32 v200, v200
  v_mfma_f32_16x16x32_bf16 v[108:111], a[84:87], v[156:159], v[108:111]
  v_rcp_f32 v201, v201
  v_mul_f32 v200, v100, v200
  v_mul_f32 v201, v101, v201
  v_mfma_f32_16x16x32_bf16 v[112:115], a[4:7], v[128:131], v[44:47]
  v_cvt_pk_bf16_f32 v206, v200, v201
  v_fma_f32 v202, v102, v102, s39
  v_fma_f32 v203, v103, v103, s39
  v_mfma_f32_16x16x32_bf16 v[112:115], a[16:19], v[132:135], v[112:115]
  ds_read_b128 v[180:183], v4 offset:29696
  v_mul_f32 v202, v202, v102
  v_mul_f32 v203, v203, v103
  v_mfma_f32_16x16x32_bf16 v[112:115], a[28:31], v[136:139], v[112:115]
  s_waitcnt vmcnt(6)
  v_mov_b32 v30, 2
  s_cmp_eq_u32 s3, 0
  s_cbranch_scc1 L_xsig_64
  s_mov_b64 exec, 1
  buffer_store_dword v30, off, s[8:11], s42
  s_mov_b64 exec, -1
L_sigd_65:
  v_mfma_f32_16x16x32_bf16 v[112:115], a[40:43], v[140:143], v[112:115]
  v_exp_f32 v202, -v202
  v_exp_f32 v203, -v203
  v_mfma_f32_16x16x32_bf16 v[112:115], a[52:55], v[144:147], v[112:115]
  ds_read_b128 v[184:187], v4 offset:30720
  v_add_f32 v202, 1.0, v202
  v_add_f32 v203, 1.0, v203
  v_mfma_f32_16x16x32_bf16 v[112:115], a[64:67], v[148:151], v[112:115]
  s_waitcnt vmcnt(5)
  v_cmp_eq_u32 vcc, 0, v19
  s_cbranch_vccnz L_spin_60
L_back_61:
  s_cmp_eq_u32 s3, 0
  s_cbranch_scc1 L_acq_62
L_acqd_63:
  v_mfma_f32_16x16x32_bf16 v[112:115], a[76:79], v[152:155], v[112:115]
  v_rcp_f32 v202, v202
  v_rcp_f32 v203, v203
  v_mfma_f32_16x16x32_bf16 v[112:115], a[88:91], v[156:159], v[112:115]
  ds_read_b128 v[188:191], v4 offset:31744
  v_mul_f32 v202, v102, v202
  v_mul_f32 v203, v103, v203
  v_mfma_f32_16x16x32_bf16 v[116:119], a[8:11], v[128:131], v[48:51]
  buffer_load_dwordx4 v[52:55], v2, s[8:11], s33 offen sc1
  v_cvt_pk_bf16_f32 v207, v202, v203
  v_mfma_f32_16x16x32_bf16 v[116:119], a[20:23], v[132:135], v[116:119]
  buffer_store_dwordx4 v[204:207], v2, s[4:7], s54 offen
  v_mfma_f32_16x16x32_bf16 v[116:119], a[32:35], v[136:139], v[116:119]
  s_add_u32 s54, s54, 131072
  v_fma_f32 v200, v104, v104, s39
  v_fma_f32 v201, v105, v105, s39
  v_mul_f32 v200, v200, v104
  v_mul_f32 v201, v201, v105
  v_mfma_f32_16x16x32_bf16 v[116:119], a[44:47], v[140:143], v[116:119]
  buffer_load_dwordx4 v[56:59], v2, s[8:11], s33 offen offset:1024 sc1
  v_exp_f32 v200, -v200
  v_mfma_f32_16x16x32_bf16 v[116:119], a[56:59], v[144:147], v[116:119]
  v_exp_f32 v201, -v201
  v_add_f32 v200, 1.0, v200
  v_add_f32 v201, 1.0, v201
  v_mfma_f32_16x16x32_bf16 v[116:119], a[68:71], v[148:151], v[116:119]
  v_rcp_f32 v200, v200
  v_rcp_f32 v201, v201
  v_mfma_f32_16x16x32_bf16 v[116:119], a[80:83], v[152:155], v[116:119]
  buffer_load_dwordx4 v[60:63], v2, s[8:11], s33 offen offset:2048 sc1
  v_mul_f32 v200, v104, v200
  v_mfma_f32_16x16x32_bf16 v[116:119], a[92:95], v[156:159], v[116:119]
  s_waitcnt lgkmcnt(0)
  v_mul_f32 v201, v105, v201
  v_cvt_pk_bf16_f32 v208, v200, v201
  v_fma_f32 v202, v106, v106, s39
  v_mfma_f32_16x16x32_bf16 v[108:111], a[96:99], v[160:163], v[108:111]
  s_waitcnt vmcnt(10)
  ds_read_b128 a[0:3], v6 offset:0
  v_fma_f32 v203, v107, v107, s39
  v_mul_f32 v202, v202, v106
  v_mfma_f32_16x16x32_bf16 v[108:111], a[108:111], v[164:167], v[108:111]
  buffer_load_dwordx4 v[64:67], v2, s[8:11], s33 offen offset:3072 sc1
  v_mul_f32 v203, v203, v107
  v_mfma_f32_16x16x32_bf16 v[108:111], a[120:123], v[168:171], v[108:111]
  ds_read_b128 a[4:7], v6 offset:1024
  v_exp_f32 v202, -v202
  v_mfma_f32_16x16x32_bf16 v[108:111], a[132:135], v[172:175], v[108:111]
  ds_read_b128 a[8:11], v6 offset:2048
  v_exp_f32 v203, -v203
  v_add_f32 v202, 1.0, v202
  v_mfma_f32_16x16x32_bf16 v[108:111], a[144:147], v[176:179], v[108:111]
  buffer_load_dwordx4 v[68:71], v8, s[8:11], s33 offen sc1
  v_add_f32 v203, 1.0, v203
  v_mfma_f32_16x16x32_bf16 v[108:111], a[156:159], v[180:183], v[108:111]
  ds_read_b128 a[12:15], v6 offset:3072
  v_rcp_f32 v202, v202
  v_mfma_f32_16x16x32_bf16 v[108:111], a[168:171], v[184:187], v[108:111]
  ds_read_b128 a[16:19], v6 offset:4096
  v_rcp_f32 v203, v203
  v_mfma_f32_16x16x32_bf16 v[108:111], a[180:183], v[188:191], v[108:111]
  buffer_load_dwordx4 v[72:75], v8, s[8:11], s33 offen offset:1024 sc1
  v_mul_f32 v202, v106, v202
  v_mfma_f32_16x16x32_bf16 v[112:115], a[100:103], v[160:163], v[112:115]
  ds_read_b128 a[20:23], v6 offset:5120
  v_mul_f32 v203, v107, v203
  v_cvt_pk_bf16_f32 v209, v202, v203
  v_mfma_f32_16x16x32_bf16 v[112:115], a[112:115], v[164:167], v[112:115]
  buffer_store_dwordx2 v[208:209], v2, s[4:7], s55 offen
  s_add_u32 s55, s55, 131072
  v_mfma_f32_16x16x32_bf16 v[112:115], a[124:127], v[168:171], v[112:115]
  buffer_load_dword v19, v18, s[8:11], s35 offen sc1
  v_mfma_f32_16x16x32_bf16 v[112:115], a[136:139], v[172:175], v[112:115]
  buffer_load_dwordx4 v[76:79], v8, s[8:11], s33 offen offset:2048 sc1
  v_mfma_f32_16x16x32_bf16 v[112:115], a[148:151], v[176:179], v[112:115]
  ds_read_b128 a[24:27], v6 offset:6144
  v_mfma_f32_16x16x32_bf16 v[112:115], a[160:163], v[180:183], v[112:115]
  v_fma_f32 v200, v108, v108, s39
  v_fma_f32 v201, v109, v109, s39
  v_mul_f32 v200, v200, v108
  v_mfma_f32_16x16x32_bf16 v[112:115], a[172:175], v[184:187], v[112:115]
  buffer_load_dwordx4 v[80:83], v8, s[8:11], s33 offen offset:3072 sc1
  v_mul_f32 v201, v201, v109
  v_mfma_f32_16x16x32_bf16 v[112:115], a[184:187], v[188:191], v[112:115]
  ds_read_b128 a[28:31], v6 offset:7168
  v_exp_f32 v200, -v200
  v_mfma_f32_16x16x32_bf16 v[116:119], a[104:107], v[160:163], v[116:119]
  v_exp_f32 v201, -v201
  v_add_f32 v200, 1.0, v200
  v_mfma_f32_16x16x32_bf16 v[116:119], a[116:119], v[164:167], v[116:119]
  buffer_load_dwordx4 v[84:87], v9, s[8:11], s33 offen sc1
  v_add_f32 v201, 1.0, v201
  v_mfma_f32_16x16x32_bf16 v[116:119], a[128:131], v[168:171], v[116:119]
  ds_read_b128 a[32:35], v7 offset:0
  v_rcp_f32 v200, v200
  v_mfma_f32_16x16x32_bf16 v[116:119], a[140:143], v[172:175], v[116:119]
  v_rcp_f32 v201, v201
  v_mul_f32 v200, v108, v200
  v_mfma_f32_16x16x32_bf16 v[116:119], a[152:155], v[176:179], v[116:119]
  buffer_load_dwordx4 v[88:91], v9, s[8:11], s33 offen offset:1024 sc1
  v_mul_f32 v201, v109, v201
  v_mfma_f32_16x16x32_bf16 v[116:119], a[164:167], v[180:183], v[116:119]
  ds_read_b128 a[36:39], v7 offset:1024
  v_cvt_pk_bf16_f32 v204, v200, v201
  v_fma_f32 v202, v110, v110, s39
  v_mfma_f32_16x16x32_bf16 v[116:119], a[176:179], v[184:187], v[116:119]
  v_fma_f32 v203, v111, v111, s39
  v_mul_f32 v202, v202, v110
  v_mul_f32 v203, v203, v111
  v_mfma_f32_16x16x32_bf16 v[116:119], a[188:191], v[188:191], v[116:119]
  s_waitcnt vmcnt(10)
  ds_read_b128 a[40:43], v7 offset:2048
  v_exp_f32 v202, -v202
  v_mfma_f32_16x16x32_bf16 a[128:131], a[192:195], v[52:55], 0
  buffer_load_dwordx4 v[92:95], v9, s[8:11], s33 offen offset:2048 sc1
  v_exp_f32 v203, -v203
  v_mfma_f32_16x16x32_bf16 a[132:135], a[196:199], v[52:55], 0
  ds_read_b128 a[44:47], v7 offset:3072
  v_add_f32 v202, 1.0, v202
  v_add_f32 v203, 1.0, v203
  v_mfma_f32_16x16x32_bf16 a[136:139], a[200:203], v[52:55], 0
  v_rcp_f32 v202, v202
  v_rcp_f32 v203, v203
  v_mfma_f32_16x16x32_bf16 a[140:143], a[204:207], v[52:55], 0
  ds_read_b128 a[48:51], v7 offset:4096
  v_mul_f32 v202, v110, v202
  v_mul_f32 v203, v111, v203
  v_mfma_f32_16x16x32_bf16 a[128:131], a[208:211], v[56:59], a[128:131]
  v_cvt_pk_bf16_f32 v205, v202, v203
  v_fma_f32 v200, v112, v112, s39
  v_fma_f32 v201, v113, v113, s39
  v_mfma_f32_16x16x32_bf16 a[132:135], a[212:215], v[56:59], a[132:135]
  ds_read_b128 a[52:55], v7 offset:5120
  v_mul_f32 v200, v200, v112
  v_mul_f32 v201, v201, v113
  v_mfma_f32_16x16x32_bf16 a[136:139], a[216:219], v[56:59], a[136:139]
  v_exp_f32 v200, -v200
  v_exp_f32 v201, -v201
  v_mfma_f32_16x16x32_bf16 a[140:143], a[220:223], v[56:59], a[140:143]
  s_waitcnt vmcnt(9)
  ds_read_b128 a[56:59], v7 offset:6144
  v_add_f32 v200, 1.0, v200
  v_add_f32 v201, 1.0, v201
  v_mfma_f32_16x16x32_bf16 a[128:131], a[224:227], v[60:63], a[128:131]
  s_waitcnt vmcnt(6)
  v_mov_b32 v30, 3
  s_cmp_eq_u32 s3, 0
  s_cbranch_scc1 L_xsig_70
  s_mov_b64 exec, 1
  buffer_store_dword v30, off, s[8:11], s42
  s_mov_b64 exec, -1
L_sigd_71:
  v_mfma_f32_16x16x32_bf16 a[132:135], a[228:231], v[60:63], a[132:135]
  ds_read_b128 a[60:63], v7 offset:7168
  v_rcp_f32 v200, v200
  v_mfma_f32_16x16x32_bf16 a[136:139], a[232:235], v[60:63], a[136:139]
  s_waitcnt vmcnt(6)
  v_cmp_gt_u32 vcc, 2, v19
  s_cbranch_vccnz L_spin_66
L_back_67:
  s_cmp_eq_u32 s3, 0
  s_cbranch_scc1 L_acq_68
L_acqd_69:
  v_mfma_f32_16x16x32_bf16 a[140:143], a[236:239], v[60:63], a[140:143]
  s_add_u32 s33, s33, 131072
  v_rcp_f32 v201, v201
  v_mul_f32 v200, v112, v200
  v_mul_f32 v201, v113, v201
  v_mfma_f32_16x16x32_bf16 a[128:131], a[240:243], v[64:67], a[128:131]
  buffer_load_dwordx4 v[120:123], v2, s[8:11], s33 offen sc1
  v_cvt_pk_bf16_f32 v206, v200, v201
  v_mfma_f32_16x16x32_bf16 a[132:135], a[244:247], v[64:67], a[132:135]
  ds_read_b128 a[64:67], v5 offset:0
  v_fma_f32 v202, v114, v114, s39
  v_fma_f32 v203, v115, v115, s39
  v_mfma_f32_16x16x32_bf16 a[136:139], a[248:251], v[64:67], a[136:139]
  ds_read_b128 a[68:71], v5 offset:1024
  v_mul_f32 v202, v202, v114
  v_mul_f32 v203, v203, v115
  v_mfma_f32_16x16x32_bf16 a[140:143], a[252:255], v[64:67], a[140:143]
  s_waitcnt vmcnt(9) lgkmcnt(14)
  ds_read_b128 a[72:75], v5 offset:2048
  v_exp_f32 v202, -v202
  v_mfma_f32_16x16x32_bf16 a[128:131], v[224:227], v[68:71], a[128:131]
  buffer_load_dwordx4 v[124:127], v2, s[8:11], s33 offen offset:1024 sc1
  v_mfma_f32_16x16x32_bf16 a[132:135], v[228:231], v[68:71], a[132:135]
  ds_read_b128 a[76:79], v5 offset:3072
  v_exp_f32 v203, -v203
  v_mfma_f32_16x16x32_bf16 a[136:139], v[232:235], v[68:71], a[136:139]
  ds_read_b128 a[80:83], v5 offset:4096
  v_add_f32 v202, 1.0, v202
  v_add_f32 v203, 1.0, v203
  v_mfma_f32_16x16x32_bf16 a[140:143], v[236:239], v[68:71], a[140:143]
  buffer_load_dwordx4 v[192:195], v2, s[8:11], s33 offen offset:2048 sc1
  v_mfma_f32_16x16x32_bf16 a[128:131], a[0:3], v[72:75], a[128:131]
  ds_read_b128 a[84:87], v5 offset:5120
  v_rcp_f32 v202, v202
  v_mfma_f32_16x16x32_bf16 a[132:135], a[4:7], v[72:75], a[132:135]
  ds_read_b128 a[88:91], v5 offset:6144
  v_rcp_f32 v203, v203
  v_mfma_f32_16x16x32_bf16 a[136:139], a[8:11], v[72:75], a[136:139]
  buffer_load_dwordx4 v[128:131], v2, s[8:11], s33 offen offset:3072 sc1
  v_mul_f32 v202, v114, v202
  v_mfma_f32_16x16x32_bf16 a[140:143], a[12:15], v[72:75], a[140:143]
  s_waitcnt vmcnt(8) lgkmcnt(11)
  ds_read_b128 a[92:95], v5 offset:7168
  v_mul_f32 v203, v115, v203
  v_cvt_pk_bf16_f32 v207, v202, v203
  v_mfma_f32_16x16x32_bf16 a[128:131], a[16:19], v[76:79], a[128:131]
  buffer_store_dwordx4 v[204:207], v2, s[4:7], s54 offen
  v_mfma_f32_16x16x32_bf16 a[132:135], a[20:23], v[76:79], a[132:135]
  buffer_load_dwordx4 v[132:135], v8, s[8:11], s33 offen sc1
  v_mfma_f32_16x16x32_bf16 a[136:139], a[24:27], v[76:79], a[136:139]
  s_add_u32 s54, s54, 131072
  v_fma_f32 v200, v116, v116, s39
  v_fma_f32 v201, v117, v117, s39
  v_mul_f32 v200, v200, v116
  v_mul_f32 v201, v201, v117
  v_exp_f32 v200, -v200
  v_mfma_f32_16x16x32_bf16 a[140:143], a[28:31], v[76:79], a[140:143]
  v_exp_f32 v201, -v201
  v_add_f32 v200, 1.0, v200
  v_add_f32 v201, 1.0, v201
  v_rcp_f32 v200, v200
  v_mfma_f32_16x16x32_bf16 a[128:131], a[32:35], v[80:83], a[128:131]
  buffer_load_dwordx4 v[136:139], v8, s[8:11], s33 offen offset:1024 sc1
  v_rcp_f32 v201, v201
  v_mul_f32 v200, v116, v200
  v_mfma_f32_16x16x32_bf16 a[132:135], a[36:39], v[80:83], a[132:135]
  v_mul_f32 v201, v117, v201
  v_cvt_pk_bf16_f32 v208, v200, v201
  v_fma_f32 v202, v118, v118, s39
  v_fma_f32 v203, v119, v119, s39
  v_mul_f32 v202, v202, v118
  v_mfma_f32_16x16x32_bf16 a[136:139], a[40:43], v[80:83], a[136:139]
  v_mul_f32 v203, v203, v119
  v_exp_f32 v202, -v202
  v_exp_f32 v203, -v203
  v_mfma_f32_16x16x32_bf16 a[140:143], a[44:47], v[80:83], a[140:143]
  s_waitcnt vmcnt(9) lgkmcnt(4)
  v_add_f32 v202, 1.0, v202
  v_add_f32 v203, 1.0, v203
  v_rcp_f32 v202, v202
  v_mfma_f32_16x16x32_bf16 a[128:131], a[48:51], v[84:87], a[128:131]
  buffer_load_dword v19, v18, s[8:11], s35 offen sc1
  v_rcp_f32 v203, v203
  v_mul_f32 v202, v118, v202
  v_mfma_f32_16x16x32_bf16 a[132:135], a[52:55], v[84:87], a[132:135]
  buffer_load_dwordx4 v[140:143], v8, s[8:11], s33 offen offset:2048 sc1
  v_mul_f32 v203, v119, v203
  v_cvt_pk_bf16_f32 v209, v202, v203
  v_mfma_f32_16x16x32_bf16 a[136:139], a[56:59], v[84:87], a[136:139]
  buffer_store_dwordx2 v[208:209], v2, s[4:7], s55 offen
  s_add_u32 s55, s55, 131072
  v_mfma_f32_16x16x32_bf16 a[140:143], a[60:63], v[84:87], a[140:143]
  v_lshlrev_b32 v28, 16, v240
  v_and_b32 v29, 0xffff0000, v240
  v_mfma_f32_16x16x32_bf16 a[128:131], a[64:67], v[88:91], a[128:131]
  buffer_load_dwordx4 v[144:147], v8, s[8:11], s33 offen offset:3072 sc1
  v_mfma_f32_16x16x32_bf16 a[132:135], a[68:71], v[88:91], a[132:135]
  v_lshlrev_b32 v210, 16, v32
  v_and_b32 v211, 0xffff0000, v32
  v_mfma_f32_16x16x32_bf16 a[136:139], a[72:75], v[88:91], a[136:139]
  v_add_f32 v210, v210, v28
  v_add_f32 v211, v211, v29
  v_mfma_f32_16x16x32_bf16 a[140:143], a[76:79], v[88:91], a[140:143]
  s_waitcnt vmcnt(12) lgkmcnt(0)
  v_lshlrev_b32 v244, 16, v36
  v_and_b32 v245, 0xffff0000, v36
  v_mfma_f32_16x16x32_bf16 a[128:131], a[80:83], v[92:95], a[128:131]
  buffer_load_dwordx4 v[148:151], v9, s[8:11], s33 offen sc1
  v_mfma_f32_16x16x32_bf16 a[132:135], a[84:87], v[92:95], a[132:135]
  v_add_f32 v244, v244, v28
  v_add_f32 v245, v245, v29
  v_mfma_f32_16x16x32_bf16 a[136:139], a[88:91], v[92:95], a[136:139]
  v_lshlrev_b32 v28, 16, v241
  v_and_b32 v29, 0xffff0000, v241
  v_mfma_f32_16x16x32_bf16 a[140:143], a[92:95], v[92:95], a[140:143]
  s_waitcnt vmcnt(10)
  v_lshlrev_b32 v212, 16, v33
  v_and_b32 v213, 0xffff0000, v33
  v_mfma_f32_16x16x32_bf16 a[144:147], a[192:195], v[120:123], 0
  buffer_load_dwordx4 v[152:155], v9, s[8:11], s33 offen offset:1024 sc1
  v_mfma_f32_16x16x32_bf16 a[148:151], a[196:199], v[120:123], 0
  v_add_f32 v212, v212, v28
  v_add_f32 v213, v213, v29
  v_mfma_f32_16x16x32_bf16 a[152:155], a[200:203], v[120:123], 0
  v_lshlrev_b32 v246, 16, v37
  v_and_b32 v247, 0xffff0000, v37
  v_mfma_f32_16x16x32_bf16 a[156:159], a[204:207], v[120:123], 0
  buffer_load_dwordx4 v[156:159], v9, s[8:11], s33 offen offset:2048 sc1
  v_mfma_f32_16x16x32_bf16 a[144:147], a[208:211], v[124:127], a[144:147]
  v_add_f32 v246, v246, v28
  v_add_f32 v247, v247, v29
  v_mfma_f32_16x16x32_bf16 a[148:151], a[212:215], v[124:127], a[148:151]
  v_lshlrev_b32 v28, 16, v242
  v_and_b32 v29, 0xffff0000, v242
  v_mfma_f32_16x16x32_bf16 a[152:155], a[216:219], v[124:127], a[152:155]
  v_lshlrev_b32 v214, 16, v34
  v_and_b32 v215, 0xffff0000, v34
  v_mfma_f32_16x16x32_bf16 a[156:159], a[220:223], v[124:127], a[156:159]
  s_waitcnt vmcnt(10)
  v_add_f32 v214, v214, v28
  v_add_f32 v215, v215, v29
  v_mfma_f32_16x16x32_bf16 a[144:147], a[224:227], v[192:195], a[144:147]
  v_lshlrev_b32 v248, 16, v38
  v_and_b32 v249, 0xffff0000, v38
  v_mfma_f32_16x16x32_bf16 a[148:151], a[228:231], v[192:195], a[148:151]
  v_add_f32 v248, v248, v28
  v_add_f32 v249, v249, v29
  v_mfma_f32_16x16x32_bf16 a[152:155], a[232:235], v[192:195], a[152:155]
  v_lshlrev_b32 v28, 16, v243
  v_and_b32 v29, 0xffff0000, v243
  v_mfma_f32_16x16x32_bf16 a[156:159], a[236:239], v[192:195], a[156:159]
  v_lshlrev_b32 v216, 16, v35
  v_and_b32 v217, 0xffff0000, v35
  v_mfma_f32_16x16x32_bf16 a[144:147], a[240:243], v[128:131], a[144:147]
  s_waitcnt vmcnt(6)
  v_cmp_gt_u32 vcc, 3, v19
  s_cbranch_vccnz L_spin_72
L_back_73:
  s_cmp_eq_u32 s3, 0
  s_cbranch_scc1 L_acq_74
L_acqd_75:
  v_mfma_f32_16x16x32_bf16 a[148:151], a[244:247], v[128:131], a[148:151]
  s_waitcnt vmcnt(4)
  s_add_u32 s33, s33, 131072
  v_mov_b32 v30, 4
  s_cmp_eq_u32 s3, 0
  s_cbranch_scc1 L_xsig_76
  s_mov_b64 exec, 1
  buffer_store_dword v30, off, s[8:11], s42
  s_mov_b64 exec, -1
L_sigd_77:
  v_mfma_f32_16x16x32_bf16 a[152:155], a[248:251], v[128:131], a[152:155]
  buffer_load_dwordx4 a[96:99], v2, s[8:11], s33 offen sc1
  v_mfma_f32_16x16x32_bf16 a[156:159], a[252:255], v[128:131], a[156:159]
  s_waitcnt vmcnt(9)
  v_add_f32 v216, v216, v28
  v_add_f32 v217, v217, v29
  v_mfma_f32_16x16x32_bf16 a[144:147], v[224:227], v[132:135], a[144:147]
  v_lshlrev_b32 v250, 16, v39
  v_and_b32 v251, 0xffff0000, v39
  v_mfma_f32_16x16x32_bf16 a[148:151], v[228:231], v[132:135], a[148:151]
  buffer_load_dwordx4 a[100:103], v2, s[8:11], s33 offen offset:1024 sc1
  v_mfma_f32_16x16x32_bf16 a[152:155], v[232:235], v[132:135], a[152:155]
  v_add_f32 v250, v250, v28
  v_add_f32 v251, v251, v29
  v_mfma_f32_16x16x32_bf16 a[156:159], v[236:239], v[132:135], a[156:159]
  v_and_b32 v29, 1, v22
  v_lshrrev_b32 v28, 1, v22
  v_mfma_f32_16x16x32_bf16 a[144:147], a[0:3], v[136:139], a[144:147]
  buffer_load_dwordx4 a[104:107], v2, s[8:11], s33 offen offset:2048 sc1
  v_mfma_f32_16x16x32_bf16 a[148:151], a[4:7], v[136:139], a[148:151]
  v_lshlrev_b32 v29, 5, v29
  v_lshl_add_u32 v29, v28, 4, v29
  v_mfma_f32_16x16x32_bf16 a[152:155], a[8:11], v[136:139], a[152:155]
  v_lshl_add_u32 v17, v21, 10, v29
  v_add_u32 v27, s34, v3
  v_mfma_f32_16x16x32_bf16 a[156:159], a[12:15], v[136:139], a[156:159]
  s_waitcnt vmcnt(7)
  v_add_u32 v28, s34, v4
  s_lshl_b32 s23, s20, 11
  v_mfma_f32_16x16x32_bf16 a[144:147], a[16:19], v[140:143], a[144:147]
  buffer_load_dwordx4 a[108:111], v2, s[8:11], s33 offen offset:3072 sc1
  v_mfma_f32_16x16x32_bf16 a[148:151], a[20:23], v[140:143], a[148:151]
  v_add_u32 v3, s23, v3
  v_add_u32 v4, s23, v4
  v_mfma_f32_16x16x32_bf16 a[152:155], a[24:27], v[140:143], a[152:155]
  s_mov_b32 s16, s62
  s_mov_b32 s17, s63
  s_mov_b32 s18, 0x200000
  v_mfma_f32_16x16x32_bf16 a[156:159], a[28:31], v[140:143], a[156:159]
  buffer_load_dwordx4 a[112:115], v8, s[8:11], s33 offen sc1
  v_mfma_f32_16x16x32_bf16 a[144:147], a[32:35], v[144:147], a[144:147]
  v_mfma_f32_16x16x32_bf16 a[148:151], a[36:39], v[144:147], a[148:151]
  v_mfma_f32_16x16x32_bf16 a[152:155], a[40:43], v[144:147], a[152:155]
  buffer_load_dwordx4 a[116:119], v8, s[8:11], s33 offen offset:1024 sc1
  v_mfma_f32_16x16x32_bf16 a[156:159], a[44:47], v[144:147], a[156:159]
  s_waitcnt vmcnt(8)
  v_mfma_f32_16x16x32_bf16 a[144:147], a[48:51], v[148:151], a[144:147]
  v_mfma_f32_16x16x32_bf16 a[148:151], a[52:55], v[148:151], a[148:151]
  buffer_load_dwordx4 a[120:123], v8, s[8:11], s33 offen offset:2048 sc1
  v_mfma_f32_16x16x32_bf16 a[152:155], a[56:59], v[148:151], a[152:155]
  v_mfma_f32_16x16x32_bf16 a[156:159], a[60:63], v[148:151], a[156:159]
  v_mfma_f32_16x16x32_bf16 a[144:147], a[64:67], v[152:155], a[144:147]
  buffer_load_dwordx4 a[124:127], v8, s[8:11], s33 offen offset:3072 sc1
  v_mfma_f32_16x16x32_bf16 a[148:151], a[68:71], v[152:155], a[148:151]
  buffer_load_dword v19, v18, s[8:11], s35 offen sc1
  v_mfma_f32_16x16x32_bf16 a[152:155], a[72:75], v[152:155], a[152:155]
  v_mfma_f32_16x16x32_bf16 a[156:159], a[76:79], v[152:155], a[156:159]
  s_waitcnt vmcnt(10)
  v_mfma_f32_16x16x32_bf16 a[144:147], a[80:83], v[156:159], a[144:147]
  buffer_load_dwordx4 v[160:163], v9, s[8:11], s33 offen sc1
  v_mfma_f32_16x16x32_bf16 a[148:151], a[84:87], v[156:159], a[148:151]
  v_mfma_f32_16x16x32_bf16 a[152:155], a[88:91], v[156:159], a[152:155]
  v_mfma_f32_16x16x32_bf16 a[156:159], a[92:95], v[156:159], a[156:159]
  s_waitcnt vmcnt(8)
  v_mfma_f32_16x16x32_bf16 a[160:163], a[192:195], a[96:99], 0
  buffer_load_dwordx4 v[164:167], v9, s[8:11], s33 offen offset:1024 sc1
  v_mfma_f32_16x16x32_bf16 a[164:167], a[196:199], a[96:99], 0
  v_mfma_f32_16x16x32_bf16 a[168:171], a[200:203], a[96:99], 0
  ds_write_b128 v27, a[128:131] offset:0
  v_mfma_f32_16x16x32_bf16 a[172:175], a[204:207], a[96:99], 0
  buffer_load_dwordx4 v[168:171], v9, s[8:11], s33 offen offset:2048 sc1
  v_mfma_f32_16x16x32_bf16 a[160:163], a[208:211], a[100:103], a[160:163]
  v_mfma_f32_16x16x32_bf16 a[164:167], a[212:215], a[100:103], a[164:167]
  ds_write_b128 v27, a[132:135] offset:1024
  v_mfma_f32_16x16x32_bf16 a[168:171], a[216:219], a[100:103], a[168:171]
  v_mfma_f32_16x16x32_bf16 a[172:175], a[220:223], a[100:103], a[172:175]
  s_waitcnt vmcnt(8)
  v_mfma_f32_16x16x32_bf16 a[160:163], a[224:227], a[104:107], a[160:163]
  ds_write_b128 v27, a[136:139] offset:2048
  v_mfma_f32_16x16x32_bf16 a[164:167], a[228:231], a[104:107], a[164:167]
  v_mfma_f32_16x16x32_bf16 a[168:171], a[232:235], a[104:107], a[168:171]
  v_mfma_f32_16x16x32_bf16 a[172:175], a[236:239], a[104:107], a[172:175]
  ds_write_b128 v27, a[140:143] offset:3072
  v_mfma_f32_16x16x32_bf16 a[160:163], a[240:243], a[108:111], a[160:163]
  v_mfma_f32_16x16x32_bf16 a[164:167], a[244:247], a[108:111], a[164:167]
  v_mfma_f32_16x16x32_bf16 a[168:171], a[248:251], a[108:111], a[168:171]
  ds_write_b128 v27, a[144:147] offset:4096
  v_mfma_f32_16x16x32_bf16 a[172:175], a[252:255], a[108:111], a[172:175]
  s_waitcnt vmcnt(6)
  v_mfma_f32_16x16x32_bf16 a[160:163], v[224:227], a[112:115], a[160:163]
  v_mfma_f32_16x16x32_bf16 a[164:167], v[228:231], a[112:115], a[164:167]
  s_waitcnt vmcnt(3)
  v_cmp_gt_u32 vcc, 4, v19
  s_cbranch_vccnz L_spin_78
L_back_79:
  s_cmp_eq_u32 s3, 0
  s_cbranch_scc1 L_acq_80
L_acqd_81:
  v_mfma_f32_16x16x32_bf16 a[168:171], v[232:235], a[112:115], a[168:171]
  s_add_u32 s33, s33, 131072
  v_mfma_f32_16x16x32_bf16 a[172:175], v[236:239], a[112:115], a[172:175]
  buffer_load_dwordx4 v[172:175], v2, s[8:11], s33 offen sc1
  v_mfma_f32_16x16x32_bf16 a[160:163], a[0:3], a[116:119], a[160:163]
  ds_write_b128 v27, a[148:151] offset:5120
  v_mfma_f32_16x16x32_bf16 a[164:167], a[4:7], a[116:119], a[164:167]
  v_mfma_f32_16x16x32_bf16 a[168:171], a[8:11], a[116:119], a[168:171]
  buffer_load_dwordx4 v[176:179], v2, s[8:11], s33 offen offset:1024 sc1
  v_mfma_f32_16x16x32_bf16 a[172:175], a[12:15], a[116:119], a[172:175]
  s_waitcnt vmcnt(6)
  v_mfma_f32_16x16x32_bf16 a[160:163], a[16:19], a[120:123], a[160:163]
  ds_write_b128 v27, a[152:155] offset:6144
  v_mfma_f32_16x16x32_bf16 a[164:167], a[20:23], a[120:123], a[164:167]
  buffer_load_dwordx4 v[180:183], v2, s[8:11], s33 offen offset:2048 sc1
  v_mfma_f32_16x16x32_bf16 a[168:171], a[24:27], a[120:123], a[168:171]
  v_mfma_f32_16x16x32_bf16 a[172:175], a[28:31], a[120:123], a[172:175]
  ds_write_b128 v27, a[156:159] offset:7168
  v_mfma_f32_16x16x32_bf16 a[160:163], a[32:35], a[124:127], a[160:163]
  buffer_load_dwordx4 v[184:187], v2, s[8:11], s33 offen offset:3072 sc1
  v_mfma_f32_16x16x32_bf16 a[164:167], a[36:39], a[124:127], a[164:167]
  v_mfma_f32_16x16x32_bf16 a[168:171], a[40:43], a[124:127], a[168:171]
  v_mfma_f32_16x16x32_bf16 a[172:175], a[44:47], a[124:127], a[172:175]
  s_waitcnt vmcnt(5)
  v_mfma_f32_16x16x32_bf16 a[160:163], a[48:51], v[160:163], a[160:163]
  buffer_load_dwordx4 v[188:191], v8, s[8:11], s33 offen sc1
  v_mfma_f32_16x16x32_bf16 a[164:167], a[52:55], v[160:163], a[164:167]
  s_waitcnt lgkmcnt(0)
  s_barrier
  v_mfma_f32_16x16x32_bf16 a[168:171], a[56:59], v[160:163], a[168:171]
  ds_read_b128 v[52:55], v3 offset:0
  v_mfma_f32_16x16x32_bf16 a[172:175], a[60:63], v[160:163], a[172:175]
  buffer_load_dwordx4 v[96:99], v8, s[8:11], s33 offen offset:1024 sc1
  v_mfma_f32_16x16x32_bf16 a[160:163], a[64:67], v[164:167], a[160:163]
  ds_read_b128 v[56:59], v3 offset:1024
  v_mfma_f32_16x16x32_bf16 a[164:167], a[68:71], v[164:167], a[164:167]
  ds_read_b128 v[60:63], v3 offset:8192
  v_mfma_f32_16x16x32_bf16 a[168:171], a[72:75], v[164:167], a[168:171]
  buffer_load_dwordx4 v[100:103], v8, s[8:11], s33 offen offset:2048 sc1
  v_mfma_f32_16x16x32_bf16 a[172:175], a[76:79], v[164:167], a[172:175]
  s_waitcnt vmcnt(7)
  ds_read_b128 v[64:67], v3 offset:9216
  v_mfma_f32_16x16x32_bf16 a[160:163], a[80:83], v[168:171], a[160:163]
  ds_read_b128 v[68:71], v3 offset:16384
  v_mfma_f32_16x16x32_bf16 a[164:167], a[84:87], v[168:171], a[164:167]
  buffer_load_dwordx4 v[104:107], v8, s[8:11], s33 offen offset:3072 sc1
  v_mfma_f32_16x16x32_bf16 a[168:171], a[88:91], v[168:171], a[168:171]
  ds_read_b128 v[72:75], v3 offset:17408
  v_mfma_f32_16x16x32_bf16 a[172:175], a[92:95], v[168:171], a[172:175]
  s_waitcnt vmcnt(6)
  ds_read_b128 v[76:79], v3 offset:24576
  v_mfma_f32_16x16x32_bf16 a[176:179], a[192:195], v[172:175], 0
  buffer_load_dwordx4 v[108:111], v9, s[8:11], s33 offen sc1
  v_mfma_f32_16x16x32_bf16 a[180:183], a[196:199], v[172:175], 0
  ds_read_b128 v[80:83], v3 offset:25600
  v_mfma_f32_16x16x32_bf16 a[184:187], a[200:203], v[172:175], 0
  v_mfma_f32_16x16x32_bf16 a[188:191], a[204:207], v[172:175], 0
  buffer_load_dwordx4 v[112:115], v9, s[8:11], s33 offen offset:1024 sc1
  v_mfma_f32_16x16x32_bf16 a[176:179], a[208:211], v[176:179], a[176:179]
  v_mfma_f32_16x16x32_bf16 a[180:183], a[212:215], v[176:179], a[180:183]
  v_mfma_f32_16x16x32_bf16 a[184:187], a[216:219], v[176:179], a[184:187]
  buffer_load_dwordx4 v[116:119], v9, s[8:11], s33 offen offset:2048 sc1
  v_mfma_f32_16x16x32_bf16 a[188:191], a[220:223], v[176:179], a[188:191]
  s_waitcnt vmcnt(7)
  v_mfma_f32_16x16x32_bf16 a[176:179], a[224:227], v[180:183], a[176:179]
  s_waitcnt lgkmcnt(0)
  v_fmac_f32 v210, v52, v10
  v_fmac_f32 v211, v53, v10
  v_mfma_f32_16x16x32_bf16 a[180:183], a[228:231], v[180:183], a[180:183]
  v_fmac_f32 v212, v54, v10
  v_fmac_f32 v213, v55, v10
  v_mfma_f32_16x16x32_bf16 a[184:187], a[232:235], v[180:183], a[184:187]
  v_fmac_f32 v214, v56, v10
  v_fmac_f32 v215, v57, v10
  v_mfma_f32_16x16x32_bf16 a[188:191], a[236:239], v[180:183], a[188:191]
  v_fmac_f32 v216, v58, v10
  v_fmac_f32 v217, v59, v10
  v_mfma_f32_16x16x32_bf16 a[176:179], a[240:243], v[184:187], a[176:179]
  v_fmac_f32 v210, v60, v10
  v_fmac_f32 v211, v61, v10
  v_mfma_f32_16x16x32_bf16 a[180:183], a[244:247], v[184:187], a[180:183]
  v_fmac_f32 v212, v62, v10
  v_fmac_f32 v213, v63, v10
  v_mfma_f32_16x16x32_bf16 a[184:187], a[248:251], v[184:187], a[184:187]
  v_fmac_f32 v214, v64, v10
  v_fmac_f32 v215, v65, v10
  v_mfma_f32_16x16x32_bf16 a[188:191], a[252:255], v[184:187], a[188:191]
  s_waitcnt vmcnt(5)
  v_fmac_f32 v216, v66, v10
  v_fmac_f32 v217, v67, v10
  v_mfma_f32_16x16x32_bf16 a[176:179], v[224:227], v[188:191], a[176:179]
  v_fmac_f32 v210, v68, v10
  v_fmac_f32 v211, v69, v10
  v_mfma_f32_16x16x32_bf16 a[180:183], v[228:231], v[188:191], a[180:183]
  v_fmac_f32 v212, v70, v10
  v_fmac_f32 v213, v71, v10
  v_mfma_f32_16x16x32_bf16 a[184:187], v[232:235], v[188:191], a[184:187]
  v_fmac_f32 v214, v72, v10
  v_fmac_f32 v215, v73, v10
  v_mfma_f32_16x16x32_bf16 a[188:191], v[236:239], v[188:191], a[188:191]
  v_fmac_f32 v216, v74, v10
  v_fmac_f32 v217, v75, v10
  v_mfma_f32_16x16x32_bf16 a[176:179], a[0:3], v[96:99], a[176:179]
  v_fmac_f32 v210, v76, v10
  v_fmac_f32 v211, v77, v10
  v_mfma_f32_16x16x32_bf16 a[180:183], a[4:7], v[96:99], a[180:183]
  v_fmac_f32 v212, v78, v10
  v_fmac_f32 v213, v79, v10
  v_mfma_f32_16x16x32_bf16 a[184:187], a[8:11], v[96:99], a[184:187]
  v_fmac_f32 v214, v80, v10
  v_fmac_f32 v215, v81, v10
  v_mfma_f32_16x16x32_bf16 a[188:191], a[12:15], v[96:99], a[188:191]
  s_waitcnt vmcnt(3)
  v_fmac_f32 v216, v82, v10
  v_fmac_f32 v217, v83, v10
  v_mfma_f32_16x16x32_bf16 a[176:179], a[16:19], v[100:103], a[176:179]
  v_cvt_pk_bf16_f32 v84, v210, v211
  v_cvt_pk_bf16_f32 v86, v214, v215
  v_mfma_f32_16x16x32_bf16 a[180:183], a[20:23], v[100:103], a[180:183]
  v_cvt_pk_bf16_f32 v85, v212, v213
  v_cvt_pk_bf16_f32 v87, v216, v217
  v_mfma_f32_16x16x32_bf16 a[184:187], a[24:27], v[100:103], a[184:187]
  s_nop 0
  v_permlane16_swap_b32 v84, v86
  v_permlane16_swap_b32 v85, v87
  v_mfma_f32_16x16x32_bf16 a[188:191], a[28:31], v[100:103], a[188:191]
  buffer_store_dwordx4 v[84:87], v17, s[16:19], s44 offen
  v_mfma_f32_16x16x32_bf16 a[176:179], a[32:35], v[104:107], a[176:179]
  s_add_u32 s44, s44, 32768
  v_mfma_f32_16x16x32_bf16 a[180:183], a[36:39], v[104:107], a[180:183]
  ds_write_b128 v28, a[160:163] offset:0
  v_mfma_f32_16x16x32_bf16 a[184:187], a[40:43], v[104:107], a[184:187]
  v_mfma_f32_16x16x32_bf16 a[188:191], a[44:47], v[104:107], a[188:191]
  s_waitcnt vmcnt(2)
  v_mfma_f32_16x16x32_bf16 a[176:179], a[48:51], v[108:111], a[176:179]
  v_mfma_f32_16x16x32_bf16 a[180:183], a[52:55], v[108:111], a[180:183]
  ds_write_b128 v28, a[164:167] offset:1024
  v_mfma_f32_16x16x32_bf16 a[184:187], a[56:59], v[108:111], a[184:187]
  v_mfma_f32_16x16x32_bf16 a[188:191], a[60:63], v[108:111], a[188:191]
  v_mfma_f32_16x16x32_bf16 a[176:179], a[64:67], v[112:115], a[176:179]
  v_mfma_f32_16x16x32_bf16 a[180:183], a[68:71], v[112:115], a[180:183]
  ds_write_b128 v28, a[168:171] offset:2048
  v_mfma_f32_16x16x32_bf16 a[184:187], a[72:75], v[112:115], a[184:187]
  v_mfma_f32_16x16x32_bf16 a[188:191], a[76:79], v[112:115], a[188:191]
  s_waitcnt vmcnt(1)
  v_mfma_f32_16x16x32_bf16 a[176:179], a[80:83], v[116:119], a[176:179]
  v_mfma_f32_16x16x32_bf16 a[180:183], a[84:87], v[116:119], a[180:183]
  ds_write_b128 v28, a[172:175] offset:3072
  v_mfma_f32_16x16x32_bf16 a[184:187], a[88:91], v[116:119], a[184:187]
  v_mfma_f32_16x16x32_bf16 a[188:191], a[92:95], v[116:119], a[188:191]
  s_nop 4
  ds_write_b128 v28, a[176:179] offset:4096
  ds_write_b128 v28, a[180:183] offset:5120
  ds_write_b128 v28, a[184:187] offset:6144
  ds_write_b128 v28, a[188:191] offset:7168
  s_waitcnt lgkmcnt(0)
  s_barrier
  ds_read_b128 v[52:55], v4 offset:0
  ds_read_b128 v[56:59], v4 offset:1024
  ds_read_b128 v[60:63], v4 offset:8192
  ds_read_b128 v[64:67], v4 offset:9216
  ds_read_b128 v[68:71], v4 offset:16384
  ds_read_b128 v[72:75], v4 offset:17408
  ds_read_b128 v[76:79], v4 offset:24576
  ds_read_b128 v[80:83], v4 offset:25600
  s_waitcnt lgkmcnt(6)
  v_pk_fma_f32 v[244:245], v[52:53], v[10:11], v[244:245] op_sel_hi:[1,0,1]
  v_pk_fma_f32 v[246:247], v[54:55], v[10:11], v[246:247] op_sel_hi:[1,0,1]
  v_pk_fma_f32 v[248:249], v[56:57], v[10:11], v[248:249] op_sel_hi:[1,0,1]
  v_pk_fma_f32 v[250:251], v[58:59], v[10:11], v[250:251] op_sel_hi:[1,0,1]
  s_waitcnt lgkmcnt(4)
  v_pk_fma_f32 v[244:245], v[60:61], v[10:11], v[244:245] op_sel_hi:[1,0,1]
  v_pk_fma_f32 v[246:247], v[62:63], v[10:11], v[246:247] op_sel_hi:[1,0,1]
  v_pk_fma_f32 v[248:249], v[64:65], v[10:11], v[248:249] op_sel_hi:[1,0,1]
  v_pk_fma_f32 v[250:251], v[66:67], v[10:11], v[250:251] op_sel_hi:[1,0,1]
  s_waitcnt lgkmcnt(2)
  v_pk_fma_f32 v[244:245], v[68:69], v[10:11], v[244:245] op_sel_hi:[1,0,1]
  v_pk_fma_f32 v[246:247], v[70:71], v[10:11], v[246:247] op_sel_hi:[1,0,1]
  v_pk_fma_f32 v[248:249], v[72:73], v[10:11], v[248:249] op_sel_hi:[1,0,1]
  v_pk_fma_f32 v[250:251], v[74:75], v[10:11], v[250:251] op_sel_hi:[1,0,1]
  s_waitcnt lgkmcnt(0)
  v_pk_fma_f32 v[244:245], v[76:77], v[10:11], v[244:245] op_sel_hi:[1,0,1]
  v_pk_fma_f32 v[246:247], v[78:79], v[10:11], v[246:247] op_sel_hi:[1,0,1]
  v_pk_fma_f32 v[248:249], v[80:81], v[10:11], v[248:249] op_sel_hi:[1,0,1]
  v_pk_fma_f32 v[250:251], v[82:83], v[10:11], v[250:251] op_sel_hi:[1,0,1]
  v_cvt_pk_bf16_f32 v88, v244, v245
  v_cvt_pk_bf16_f32 v90, v248, v249
  v_cvt_pk_bf16_f32 v89, v246, v247
  v_cvt_pk_bf16_f32 v91, v250, v251
  s_nop 0
  v_permlane16_swap_b32 v88, v90
  v_permlane16_swap_b32 v89, v91
  buffer_store_dwordx4 v[88:91], v17, s[16:19], s44 offen
  s_endpgm
L_spin_5:
  s_mov_b32 s25, 131072
L_spin_5_l:
  buffer_load_dword v19, v26, s[16:19], 0 offen sc1
  s_waitcnt vmcnt(0)
  v_lshrrev_b32 v20, 4, v19
  v_and_b32 v21, 0x0f0f0f0f, v19
  v_and_b32 v20, 0x0f0f0f0f, v20
  v_sad_u8 v21, v21, 0, 0
  v_sad_u8 v20, v20, 0, v21
  v_cmp_ne_u32 vcc, 8, v20
  s_cbranch_vccz L_back_6
  s_sleep 1
  s_sub_u32 s25, s25, 1
  s_cmp_lg_u32 s25, 0
  s_cbranch_scc1 L_spin_5_l
  s_branch L_back_6
L_spin_11:
  s_mov_b32 s25, 131072
L_spin_11_l:
  buffer_load_dword v19, v26, s[16:19], 0 offen sc1
  s_waitcnt vmcnt(0)
  v_lshrrev_b32 v20, 4, v19
  v_and_b32 v21, 0x0f0f0f0f, v19
  v_and_b32 v20, 0x0f0f0f0f, v20
  v_sad_u8 v21, v21, 0, 0
  v_sad_u8 v20, v20, 0, v21
  v_cmp_ne_u32 vcc, 8, v20
  s_cbranch_vccz L_back_12
  s_sleep 1
  s_sub_u32 s25, s25, 1
  s_cmp_lg_u32 s25, 0
  s_cbranch_scc1 L_spin_11_l
  s_branch L_back_12
L_spin_15:
  s_mov_b32 s25, 131072
L_spin_15_l:
  buffer_load_dword v19, v18, s[8:11], s26 offen sc1
  s_waitcnt vmcnt(0)
  v_cmp_eq_u32 vcc, 0, v19
  s_cbranch_vccz L_back_16
  s_sleep 1
  s_sub_u32 s25, s25, 1
  s_cmp_lg_u32 s25, 0
  s_cbranch_scc1 L_spin_15_l
  s_branch L_back_16
L_spin_21:
  s_mov_b32 s25, 131072
L_spin_21_l:
  buffer_load_dword v19, v3, s[16:19], 0 offen offset:4 sc1
  s_waitcnt vmcnt(0)
  v_cmp_gt_u32 vcc, 8, v19
  s_cbranch_vccz L_back_22
  s_sleep 1
  s_sub_u32 s25, s25, 1
  s_cmp_lg_u32 s25, 0
  s_cbranch_scc1 L_spin_21_l
  s_branch L_back_22
L_spin_23:
  s_mov_b32 s25, 131072
L_spin_23_l:
  buffer_load_dword v19, v18, s[8:11], s26 offen sc1
  s_waitcnt vmcnt(0)
  v_cmp_gt_u32 vcc, 2, v19
  s_cbranch_vccz L_back_24
  s_sleep 1
  s_sub_u32 s25, s25, 1
  s_cmp_lg_u32 s25, 0
  s_cbranch_scc1 L_spin_23_l
  s_branch L_back_24
L_spin_40:
  s_mov_b32 s25, 131072
L_spin_40_l:
  buffer_load_dword v19, v18, s[8:11], s35 offen sc1
  s_waitcnt vmcnt(0)
  v_cmp_eq_u32 vcc, 0, v19
  s_cbranch_vccz L_back_41
  s_sleep 1
  s_sub_u32 s25, s25, 1
  s_cmp_lg_u32 s25, 0
  s_cbranch_scc1 L_spin_40_l
  s_branch L_back_41
L_spin_44:
  s_mov_b32 s25, 131072
L_spin_44_l:
  buffer_load_dword v19, v20, s[8:11], s36 offen sc1
  s_waitcnt vmcnt(0)
  v_cmp_eq_u32 vcc, 0, v19
  s_cbranch_vccz L_back_45
  s_sleep 1
  s_sub_u32 s25, s25, 1
  s_cmp_lg_u32 s25, 0
  s_cbranch_scc1 L_spin_44_l
  s_branch L_back_45
L_spin_48:
  s_mov_b32 s25, 131072
L_spin_48_l:
  buffer_load_dword v19, v4, s[8:11], s32 offen sc1
  s_waitcnt vmcnt(0)
  v_cmp_eq_u32 vcc, 0, v19
  s_cbranch_vccz L_back_49
  s_sleep 1
  s_sub_u32 s25, s25, 1
  s_cmp_lg_u32 s25, 0
  s_cbranch_scc1 L_spin_48_l
  s_branch L_back_49
L_spin_54:
  s_mov_b32 s25, 131072
L_spin_54_l:
  buffer_load_dword v19, v18, s[8:11], s32 offen sc1
  s_waitcnt vmcnt(0)
  v_cmp_eq_u32 vcc, 0, v19
  s_cbranch_vccz L_back_55
  s_sleep 1
  s_sub_u32 s25, s25, 1
  s_cmp_lg_u32 s25, 0
  s_cbranch_scc1 L_spin_54_l
  s_branch L_back_55
L_spin_60:
  s_mov_b32 s25, 131072
L_spin_60_l:
  buffer_load_dword v19, v18, s[8:11], s35 offen sc1
  s_waitcnt vmcnt(0)
  v_cmp_eq_u32 vcc, 0, v19
  s_cbranch_vccz L_back_61
  s_sleep 1
  s_sub_u32 s25, s25, 1
  s_cmp_lg_u32 s25, 0
  s_cbranch_scc1 L_spin_60_l
  s_branch L_back_61
L_spin_66:
  s_mov_b32 s25, 131072
L_spin_66_l:
  buffer_load_dword v19, v18, s[8:11], s35 offen sc1
  s_waitcnt vmcnt(0)
  v_cmp_gt_u32 vcc, 2, v19
  s_cbranch_vccz L_back_67
  s_sleep 1
  s_sub_u32 s25, s25, 1
  s_cmp_lg_u32 s25, 0
  s_cbranch_scc1 L_spin_66_l
  s_branch L_back_67
L_spin_72:
  s_mov_b32 s25, 131072
L_spin_72_l:
  buffer_load_dword v19, v18, s[8:11], s35 offen sc1
  s_waitcnt vmcnt(0)
  v_cmp_gt_u32 vcc, 3, v19
  s_cbranch_vccz L_back_73
  s_sleep 1
  s_sub_u32 s25, s25, 1
  s_cmp_lg_u32 s25, 0
  s_cbranch_scc1 L_spin_72_l
  s_branch L_back_73
L_spin_78:
  s_mov_b32 s25, 131072
L_spin_78_l:
  buffer_load_dword v19, v18, s[8:11], s35 offen sc1
  s_waitcnt vmcnt(0)
  v_cmp_gt_u32 vcc, 4, v19
  s_cbranch_vccz L_back_79
  s_sleep 1
  s_sub_u32 s25, s25, 1
  s_cmp_lg_u32 s25, 0
  s_cbranch_scc1 L_spin_78_l
  s_branch L_back_79
L_acq_17:
  buffer_inv sc1
  s_waitcnt vmcnt(0)
  s_branch L_acqd_18
L_acq_25:
  buffer_inv sc1
  s_waitcnt vmcnt(0)
  s_branch L_acqd_26
L_acq_50:
  buffer_inv sc1
  s_waitcnt vmcnt(0)
  s_branch L_acqd_51
L_acq_56:
  buffer_inv sc1
  s_waitcnt vmcnt(0)
  s_branch L_acqd_57
L_acq_62:
  buffer_inv sc1
  s_waitcnt vmcnt(0)
  s_branch L_acqd_63
L_acq_68:
  buffer_inv sc1
  s_waitcnt vmcnt(0)
  s_branch L_acqd_69
L_acq_74:
  buffer_inv sc1
  s_waitcnt vmcnt(0)
  s_branch L_acqd_75
L_acq_80:
  buffer_inv sc1
  s_waitcnt vmcnt(0)
  s_branch L_acqd_81
L_xsig_13:
  buffer_wbl2 sc1
  s_waitcnt vmcnt(0)
  s_mov_b64 exec, 1
  buffer_store_dword v19, off, s[8:11], s28 sc1
  s_mov_b64 exec, -1
  s_branch L_sigd_14
L_xsig_19:
  buffer_wbl2 sc1
  s_waitcnt vmcnt(0)
  s_mov_b64 exec, 1
  buffer_store_dword v19, off, s[8:11], s28 sc1
  s_mov_b64 exec, -1
  s_branch L_sigd_20
L_xsig_42:
  s_mov_b64 exec, 1
  buffer_store_dword v19, off, s[8:11], s42 sc1
  s_mov_b64 exec, -1
  s_branch L_sigd_43
L_xsig_46:
  buffer_wbl2 sc1
  s_waitcnt vmcnt(0)
  s_mov_b64 exec, 1
  buffer_store_dword v19, off, s[8:11], s42 sc1
  s_mov_b64 exec, -1
  s_branch L_sigd_47
L_xsig_52:
  buffer_wbl2 sc1
  s_waitcnt vmcnt(0)
  s_mov_b64 exec, 1
  buffer_store_dword v19, off, s[8:11], s42 sc1
  s_mov_b64 exec, -1
  s_branch L_sigd_53
L_xsig_58:
  buffer_wbl2 sc1
  s_waitcnt vmcnt(0)
  s_mov_b64 exec, 1
  buffer_store_dword v30, off, s[8:11], s42 sc1
  s_mov_b64 exec, -1
  s_branch L_sigd_59
L_xsig_64:
  buffer_wbl2 sc1
  s_waitcnt vmcnt(0)
  s_mov_b64 exec, 1
  buffer_store_dword v30, off, s[8:11], s42 sc1
  s_mov_b64 exec, -1
  s_branch L_sigd_65
L_xsig_70:
  buffer_wbl2 sc1
  s_waitcnt vmcnt(0)
  s_mov_b64 exec, 1
  buffer_store_dword v30, off, s[8:11], s42 sc1
  s_mov_b64 exec, -1
  s_branch L_sigd_71
L_xsig_76:
  buffer_wbl2 sc1
  s_waitcnt vmcnt(0)
  s_mov_b64 exec, 1
  buffer_store_dword v30, off, s[8:11], s42 sc1
  s_mov_b64 exec, -1
  s_branch L_sigd_77
L_fix:
  s_mov_b32 s46, 0
  s_cmp_eq_u64 s[38:39], 0
  s_cbranch_scc1 L_fix_next
L_fix_one:
  v_mov_b32 v160, 0
  v_mov_b32 v161, 0
  v_mov_b32 v162, 0
  v_mov_b32 v163, 0
  v_mov_b32 v164, 0
  v_mov_b32 v165, 0
  v_mov_b32 v166, 0
  v_mov_b32 v167, 0
  v_mov_b32 v168, 0
  v_mov_b32 v169, 0
  v_mov_b32 v170, 0
  v_mov_b32 v171, 0
  v_mov_b32 v172, 0
  v_mov_b32 v173, 0
  v_mov_b32 v174, 0
  v_mov_b32 v175, 0
  v_mov_b32 v28, 0xff7fffff
  v_mov_b32 v29, 0xff7fffff
  s_mov_b32 s32, 0
L_fix_p1:
  s_lshl_b32 s31, s21, 6
  s_add_u32 s31, s31, s32
  s_lshl_b32 s31, s31, 14
  s_add_u32 s30, s31, 4096
  s_add_u32 s42, s31, 8192
  s_add_u32 s43, s31, 12288
  buffer_load_dwordx4 a[128:131], v2, s[8:11], s31 offen sc1
  buffer_load_dwordx4 a[132:135], v2, s[8:11], s31 offen offset:1024 sc1
  buffer_load_dwordx4 a[136:139], v2, s[8:11], s31 offen offset:2048 sc1
  buffer_load_dwordx4 a[140:143], v2, s[8:11], s31 offen offset:3072 sc1
  buffer_load_dwordx4 a[144:147], v2, s[8:11], s30 offen sc1
  buffer_load_dwordx4 a[148:151], v2, s[8:11], s30 offen offset:1024 sc1
  buffer_load_dwordx4 a[152:155], v2, s[8:11], s30 offen offset:2048 sc1
  buffer_load_dwordx4 a[156:159], v2, s[8:11], s30 offen offset:3072 sc1
  s_cmp_lg_u32 s32, s45
  s_cbranch_scc1 L_fix_d1
  v_add_f32 v160, v160, v8
  v_mov_b32 v164, 0xf149f2ca
  v_add_f32 v172, v172, v8
  v_add_f32 v161, v161, v9
  v_mov_b32 v165, 0xf149f2ca
  v_add_f32 v173, v173, v9
  v_add_f32 v162, v162, v10
  v_mov_b32 v166, 0xf149f2ca
  v_add_f32 v174, v174, v10
  v_add_f32 v163, v163, v11
  v_mov_b32 v167, 0xf149f2ca
  v_add_f32 v175, v175, v11
L_fix_d1:
  s_waitcnt vmcnt(0)
  s_nop 1
  v_mfma_f32_16x16x32_bf16 v[48:51], a[128:131], v[192:195], v[160:163]
  v_mfma_f32_16x16x32_bf16 v[48:51], a[132:135], v[196:199], v[48:51]
  v_mfma_f32_16x16x32_bf16 v[48:51], a[136:139], v[200:203], v[48:51]
  v_mfma_f32_16x16x32_bf16 v[48:51], a[140:143], v[204:207], v[48:51]
  v_mfma_f32_16x16x32_bf16 v[52:55], a[144:147], v[192:195], v[164:167]
  v_mfma_f32_16x16x32_bf16 v[52:55], a[148:151], v[196:199], v[52:55]
  v_mfma_f32_16x16x32_bf16 v[52:55], a[152:155], v[200:203], v[52:55]
  v_mfma_f32_16x16x32_bf16 v[52:55], a[156:159], v[204:207], v[52:55]
  v_mfma_f32_16x16x32_bf16 v[56:59], a[128:131], v[208:211], v[168:171]
  v_mfma_f32_16x16x32_bf16 v[56:59], a[132:135], v[212:215], v[56:59]
  v_mfma_f32_16x16x32_bf16 v[56:59], a[136:139], v[216:219], v[56:59]
  v_mfma_f32_16x16x32_bf16 v[56:59], a[140:143], v[220:223], v[56:59]
  v_mfma_f32_16x16x32_bf16 v[60:63], a[144:147], v[208:211], v[172:175]
  v_mfma_f32_16x16x32_bf16 v[60:63], a[148:151], v[212:215], v[60:63]
  v_mfma_f32_16x16x32_bf16 v[60:63], a[152:155], v[216:219], v[60:63]
  v_mfma_f32_16x16x32_bf16 v[60:63], a[156:159], v[220:223], v[60:63]
  s_nop 7
  v_max3_f32 v28, v28, v48, v49
  v_max3_f32 v28, v28, v50, v51
  v_max3_f32 v28, v28, v52, v53
  v_max3_f32 v28, v28, v54, v55
  v_max3_f32 v29, v29, v56, v57
  v_max3_f32 v29, v29, v58, v59
  v_max3_f32 v29, v29, v60, v61
  v_max3_f32 v29, v29, v62, v63
  s_add_u32 s32, s32, 1
  s_cmp_le_u32 s32, s45
  s_cbranch_scc1 L_fix_p1
  v_mov_b32 v30, v28
  v_mov_b32 v31, v29
  s_nop 0
  v_permlane16_swap_b32 v28, v30
  v_permlane16_swap_b32 v29, v31
  v_max_f32 v28, v28, v30
  v_max_f32 v29, v29, v31
  v_mov_b32 v30, v28
  v_mov_b32 v31, v29
  s_nop 0
  v_permlane32_swap_b32 v28, v30
  v_permlane32_swap_b32 v29, v31
  v_max_f32 v28, v28, v30
  v_max_f32 v29, v29, v31
  v_pk_mul_f32 v[160:161], v[28:29], -1.0 op_sel:[0,0] op_sel_hi:[0,0]
  v_pk_mul_f32 v[162:163], v[28:29], -1.0 op_sel:[0,0] op_sel_hi:[0,0]
  v_pk_mul_f32 v[164:165], v[28:29], -1.0 op_sel:[0,0] op_sel_hi:[0,0]
  v_pk_mul_f32 v[166:167], v[28:29], -1.0 op_sel:[0,0] op_sel_hi:[0,0]
  v_pk_mul_f32 v[168:169], v[28:29], -1.0 op_sel:[1,0] op_sel_hi:[1,0]
  v_pk_mul_f32 v[170:171], v[28:29], -1.0 op_sel:[1,0] op_sel_hi:[1,0]
  v_pk_mul_f32 v[172:173], v[28:29], -1.0 op_sel:[1,0] op_sel_hi:[1,0]
  v_pk_mul_f32 v[174:175], v[28:29], -1.0 op_sel:[1,0] op_sel_hi:[1,0]
  v_accvgpr_write_b32 a64, 0
  v_accvgpr_write_b32 a65, 0
  v_accvgpr_write_b32 a66, 0
  v_accvgpr_write_b32 a67, 0
  v_accvgpr_write_b32 a68, 0
  v_accvgpr_write_b32 a69, 0
  v_accvgpr_write_b32 a70, 0
  v_accvgpr_write_b32 a71, 0
  v_accvgpr_write_b32 a72, 0
  v_accvgpr_write_b32 a73, 0
  v_accvgpr_write_b32 a74, 0
  v_accvgpr_write_b32 a75, 0
  v_accvgpr_write_b32 a76, 0
  v_accvgpr_write_b32 a77, 0
  v_accvgpr_write_b32 a78, 0
  v_accvgpr_write_b32 a79, 0
  v_accvgpr_write_b32 a80, 0
  v_accvgpr_write_b32 a81, 0
  v_accvgpr_write_b32 a82, 0
  v_accvgpr_write_b32 a83, 0
  v_accvgpr_write_b32 a84, 0
  v_accvgpr_write_b32 a85, 0
  v_accvgpr_write_b32 a86, 0
  v_accvgpr_write_b32 a87, 0
  v_accvgpr_write_b32 a88, 0
  v_accvgpr_write_b32 a89, 0
  v_accvgpr_write_b32 a90, 0
  v_accvgpr_write_b32 a91, 0
  v_accvgpr_write_b32 a92, 0
  v_accvgpr_write_b32 a93, 0
  v_accvgpr_write_b32 a94, 0
  v_accvgpr_write_b32 a95, 0
  v_accvgpr_write_b32 a96, 0
  v_accvgpr_write_b32 a97, 0
  v_accvgpr_write_b32 a98, 0
  v_accvgpr_write_b32 a99, 0
  v_accvgpr_write_b32 a100, 0
  v_accvgpr_write_b32 a101, 0
  v_accvgpr_write_b32 a102, 0
  v_accvgpr_write_b32 a103, 0
  v_accvgpr_write_b32 a104, 0
  v_accvgpr_write_b32 a105, 0
  v_accvgpr_write_b32 a106, 0
  v_accvgpr_write_b32 a107, 0
  v_accvgpr_write_b32 a108, 0
  v_accvgpr_write_b32 a109, 0
  v_accvgpr_write_b32 a110, 0
  v_accvgpr_write_b32 a111, 0
  v_accvgpr_write_b32 a112, 0
  v_accvgpr_write_b32 a113, 0
  v_accvgpr_write_b32 a114, 0
  v_accvgpr_write_b32 a115, 0
  v_accvgpr_write_b32 a116, 0
  v_accvgpr_write_b32 a117, 0
  v_accvgpr_write_b32 a118, 0
  v_accvgpr_write_b32 a119, 0
  v_accvgpr_write_b32 a120, 0
  v_accvgpr_write_b32 a121, 0
  v_accvgpr_write_b32 a122, 0
  v_accvgpr_write_b32 a123, 0
  v_accvgpr_write_b32 a124, 0
  v_accvgpr_write_b32 a125, 0
  v_accvgpr_write_b32 a126, 0
  v_accvgpr_write_b32 a127, 0
  v_mov_b32 v100, 0
  v_mov_b32 v101, 0
  v_mov_b32 v102, 0
  v_mov_b32 v103, 0
  s_mov_b32 s32, 0
L_fix_p2:
  s_lshl_b32 s31, s21, 6
  s_add_u32 s31, s31, s32
  s_lshl_b32 s31, s31, 14
  s_add_u32 s30, s31, 4096
  s_add_u32 s42, s31, 8192
  s_add_u32 s43, s31, 12288
  buffer_load_dwordx4 a[128:131], v2, s[8:11], s31 offen sc1
  buffer_load_dwordx4 a[132:135], v2, s[8:11], s31 offen offset:1024 sc1
  buffer_load_dwordx4 a[136:139], v2, s[8:11], s31 offen offset:2048 sc1
  buffer_load_dwordx4 a[140:143], v2, s[8:11], s31 offen offset:3072 sc1
  buffer_load_dwordx4 a[144:147], v2, s[8:11], s30 offen sc1
  buffer_load_dwordx4 a[148:151], v2, s[8:11], s30 offen offset:1024 sc1
  buffer_load_dwordx4 a[152:155], v2, s[8:11], s30 offen offset:2048 sc1
  buffer_load_dwordx4 a[156:159], v2, s[8:11], s30 offen offset:3072 sc1
  buffer_load_dwordx4 a[160:163], v2, s[8:11], s42 offen sc1
  buffer_load_dwordx4 a[164:167], v2, s[8:11], s42 offen offset:1024 sc1
  buffer_load_dwordx4 a[168:171], v2, s[8:11], s42 offen offset:2048 sc1
  buffer_load_dwordx4 a[172:175], v2, s[8:11], s42 offen offset:3072 sc1
  buffer_load_dwordx4 a[176:179], v2, s[8:11], s43 offen sc1
  buffer_load_dwordx4 a[180:183], v2, s[8:11], s43 offen offset:1024 sc1
  buffer_load_dwordx4 a[184:187], v2, s[8:11], s43 offen offset:2048 sc1
  buffer_load_dwordx4 a[188:191], v2, s[8:11], s43 offen offset:3072 sc1
  s_cmp_lg_u32 s32, s45
  s_cbranch_scc1 L_fix_d2
  v_add_f32 v160, v160, v8
  v_mov_b32 v164, 0xf149f2ca
  v_add_f32 v172, v172, v8
  v_add_f32 v161, v161, v9
  v_mov_b32 v165, 0xf149f2ca
  v_add_f32 v173, v173, v9
  v_add_f32 v162, v162, v10
  v_mov_b32 v166, 0xf149f2ca
  v_add_f32 v174, v174, v10
  v_add_f32 v163, v163, v11
  v_mov_b32 v167, 0xf149f2ca
  v_add_f32 v175, v175, v11
L_fix_d2:
  s_waitcnt vmcnt(0)
  s_nop 1
  v_mfma_f32_16x16x32_bf16 v[48:51], a[128:131], v[192:195], v[160:163]
  v_mfma_f32_16x16x32_bf16 v[48:51], a[132:135], v[196:199], v[48:51]
  v_mfma_f32_16x16x32_bf16 v[48:51], a[136:139], v[200:203], v[48:51]
  v_mfma_f32_16x16x32_bf16 v[48:51], a[140:143], v[204:207], v[48:51]
  v_mfma_f32_16x16x32_bf16 v[52:55], a[144:147], v[192:195], v[164:167]
  v_mfma_f32_16x16x32_bf16 v[52:55], a[148:151], v[196:199], v[52:55]
  v_mfma_f32_16x16x32_bf16 v[52:55], a[152:155], v[200:203], v[52:55]
  v_mfma_f32_16x16x32_bf16 v[52:55], a[156:159], v[204:207], v[52:55]
  v_mfma_f32_16x16x32_bf16 v[56:59], a[128:131], v[208:211], v[168:171]
  v_mfma_f32_16x16x32_bf16 v[56:59], a[132:135], v[212:215], v[56:59]
  v_mfma_f32_16x16x32_bf16 v[56:59], a[136:139], v[216:219], v[56:59]
  v_mfma_f32_16x16x32_bf16 v[56:59], a[140:143], v[220:223], v[56:59]
  v_mfma_f32_16x16x32_bf16 v[60:63], a[144:147], v[208:211], v[172:175]
  v_mfma_f32_16x16x32_bf16 v[60:63], a[148:151], v[212:215], v[60:63]
  v_mfma_f32_16x16x32_bf16 v[60:63], a[152:155], v[216:219], v[60:63]
  v_mfma_f32_16x16x32_bf16 v[60:63], a[156:159], v[220:223], v[60:63]
  s_nop 7
  v_exp_f32 v20, v48
  v_exp_f32 v21, v49
  v_exp_f32 v22, v50
  v_cvt_pk_bf16_f32 v120, v20, v21
  v_exp_f32 v23, v51
  v_exp_f32 v24, v52
  v_cvt_pk_bf16_f32 v121, v22, v23
  v_exp_f32 v25, v53
  v_exp_f32 v20, v54
  v_cvt_pk_bf16_f32 v122, v24, v25
  v_exp_f32 v21, v55
  v_exp_f32 v22, v56
  v_cvt_pk_bf16_f32 v123, v20, v21
  v_exp_f32 v23, v57
  v_exp_f32 v24, v58
  v_cvt_pk_bf16_f32 v124, v22, v23
  v_exp_f32 v25, v59
  v_exp_f32 v20, v60
  v_cvt_pk_bf16_f32 v125, v24, v25
  v_exp_f32 v21, v61
  v_exp_f32 v22, v62
  v_cvt_pk_bf16_f32 v126, v20, v21
  v_exp_f32 v23, v63
  s_nop 0
  v_cvt_pk_bf16_f32 v127, v22, v23
  s_nop 1
  v_mfma_f32_16x16x32_bf16 a[64:67], a[160:163], v[120:123], a[64:67]
  v_mfma_f32_16x16x32_bf16 a[68:71], a[164:167], v[120:123], a[68:71]
  v_mfma_f32_16x16x32_bf16 a[72:75], a[168:171], v[120:123], a[72:75]
  v_mfma_f32_16x16x32_bf16 a[76:79], a[172:175], v[120:123], a[76:79]
  v_mfma_f32_16x16x32_bf16 a[80:83], a[176:179], v[120:123], a[80:83]
  v_mfma_f32_16x16x32_bf16 a[84:87], a[180:183], v[120:123], a[84:87]
  v_mfma_f32_16x16x32_bf16 a[88:91], a[184:187], v[120:123], a[88:91]
  v_mfma_f32_16x16x32_bf16 a[92:95], a[188:191], v[120:123], a[92:95]
  v_mfma_f32_16x16x32_bf16 a[96:99], a[160:163], v[124:127], a[96:99]
  v_mfma_f32_16x16x32_bf16 a[100:103], a[164:167], v[124:127], a[100:103]
  v_mfma_f32_16x16x32_bf16 a[104:107], a[168:171], v[124:127], a[104:107]
  v_mfma_f32_16x16x32_bf16 a[108:111], a[172:175], v[124:127], a[108:111]
  v_mfma_f32_16x16x32_bf16 a[112:115], a[176:179], v[124:127], a[112:115]
  v_mfma_f32_16x16x32_bf16 a[116:119], a[180:183], v[124:127], a[116:119]
  v_mfma_f32_16x16x32_bf16 a[120:123], a[184:187], v[124:127], a[120:123]
  v_mfma_f32_16x16x32_bf16 a[124:127], a[188:191], v[124:127], a[124:127]
  v_smfmac_f32_16x16x64_bf16 v[100:103], v[104:107], v[120:127], v108
  s_add_u32 s32, s32, 1
  s_cmp_le_u32 s32, s45
  s_cbranch_scc1 L_fix_p2
  s_lshl_b32 s23, s45, 18
  s_lshl_b32 s24, s21, 12
  s_add_u32 s23, s23, s24
  s_add_u32 s23, s23, 37748736
  s_add_u32 s24, s23, 131072
  v_mov_b32 v49, 0x71800000
  v_accvgpr_read_b32 v56, a64
  v_accvgpr_read_b32 v57, a65
  v_accvgpr_read_b32 v58, a66
  v_accvgpr_read_b32 v59, a67
  v_accvgpr_read_b32 v60, a68
  v_accvgpr_read_b32 v61, a69
  v_accvgpr_read_b32 v62, a70
  v_accvgpr_read_b32 v63, a71
  v_add_f32 v48, v100, v101
  v_add_f32 v50, v102, v103
  v_add_f32 v51, v48, v50
  v_rcp_f32 v48, v48
  v_rcp_f32 v50, v50
  v_cmp_nlt_f32 s[38:39], v51, v49
  v_pk_mul_f32 v[56:57], v[56:57], v[48:49] op_sel_hi:[1,0]
  v_pk_mul_f32 v[58:59], v[58:59], v[48:49] op_sel_hi:[1,0]
  v_pk_mul_f32 v[60:61], v[60:61], v[48:49] op_sel_hi:[1,0]
  v_pk_mul_f32 v[62:63], v[62:63], v[48:49] op_sel_hi:[1,0]
  v_cvt_pk_bf16_f32 v160, v56, v57
  v_cvt_pk_bf16_f32 v161, v58, v59
  v_cvt_pk_bf16_f32 v162, v60, v61
  v_cvt_pk_bf16_f32 v163, v62, v63
  buffer_store_dwordx4 v[160:163], v2, s[8:11], s23 offen offset:0 sc1
  v_accvgpr_read_b32 v56, a72
  v_accvgpr_read_b32 v57, a73
  v_accvgpr_read_b32 v58, a74
  v_accvgpr_read_b32 v59, a75
  v_accvgpr_read_b32 v60, a76
  v_accvgpr_read_b32 v61, a77
  v_accvgpr_read_b32 v62, a78
  v_accvgpr_read_b32 v63, a79
  v_pk_mul_f32 v[56:57], v[56:57], v[48:49] op_sel_hi:[1,0]
  v_pk_mul_f32 v[58:59], v[58:59], v[48:49] op_sel_hi:[1,0]
  v_pk_mul_f32 v[60:61], v[60:61], v[48:49] op_sel_hi:[1,0]
  v_pk_mul_f32 v[62:63], v[62:63], v[48:49] op_sel_hi:[1,0]
  v_cvt_pk_bf16_f32 v164, v56, v57
  v_cvt_pk_bf16_f32 v165, v58, v59
  v_cvt_pk_bf16_f32 v166, v60, v61
  v_cvt_pk_bf16_f32 v167, v62, v63
  buffer_store_dwordx4 v[164:167], v2, s[8:11], s23 offen offset:1024 sc1
  v_accvgpr_read_b32 v56, a80
  v_accvgpr_read_b32 v57, a81
  v_accvgpr_read_b32 v58, a82
  v_accvgpr_read_b32 v59, a83
  v_accvgpr_read_b32 v60, a84
  v_accvgpr_read_b32 v61, a85
  v_accvgpr_read_b32 v62, a86
  v_accvgpr_read_b32 v63, a87
  v_pk_mul_f32 v[56:57], v[56:57], v[48:49] op_sel_hi:[1,0]
  v_pk_mul_f32 v[58:59], v[58:59], v[48:49] op_sel_hi:[1,0]
  v_pk_mul_f32 v[60:61], v[60:61], v[48:49] op_sel_hi:[1,0]
  v_pk_mul_f32 v[62:63], v[62:63], v[48:49] op_sel_hi:[1,0]
  v_cvt_pk_bf16_f32 v168, v56, v57
  v_cvt_pk_bf16_f32 v169, v58, v59
  v_cvt_pk_bf16_f32 v170, v60, v61
  v_cvt_pk_bf16_f32 v171, v62, v63
  buffer_store_dwordx4 v[168:171], v2, s[8:11], s23 offen offset:2048 sc1
  v_accvgpr_read_b32 v56, a88
  v_accvgpr_read_b32 v57, a89
  v_accvgpr_read_b32 v58, a90
  v_accvgpr_read_b32 v59, a91
  v_accvgpr_read_b32 v60, a92
  v_accvgpr_read_b32 v61, a93
  v_accvgpr_read_b32 v62, a94
  v_accvgpr_read_b32 v63, a95
  v_pk_mul_f32 v[56:57], v[56:57], v[48:49] op_sel_hi:[1,0]
  v_pk_mul_f32 v[58:59], v[58:59], v[48:49] op_sel_hi:[1,0]
  v_pk_mul_f32 v[60:61], v[60:61], v[48:49] op_sel_hi:[1,0]
  v_pk_mul_f32 v[62:63], v[62:63], v[48:49] op_sel_hi:[1,0]
  v_cvt_pk_bf16_f32 v172, v56, v57
  v_cvt_pk_bf16_f32 v173, v58, v59
  v_cvt_pk_bf16_f32 v174, v60, v61
  v_cvt_pk_bf16_f32 v175, v62, v63
  buffer_store_dwordx4 v[172:175], v2, s[8:11], s23 offen offset:3072 sc1
  v_accvgpr_read_b32 v56, a96
  v_accvgpr_read_b32 v57, a97
  v_accvgpr_read_b32 v58, a98
  v_accvgpr_read_b32 v59, a99
  v_accvgpr_read_b32 v60, a100
  v_accvgpr_read_b32 v61, a101
  v_accvgpr_read_b32 v62, a102
  v_accvgpr_read_b32 v63, a103
  v_pk_mul_f32 v[56:57], v[56:57], v[50:51] op_sel_hi:[1,0]
  v_pk_mul_f32 v[58:59], v[58:59], v[50:51] op_sel_hi:[1,0]
  v_pk_mul_f32 v[60:61], v[60:61], v[50:51] op_sel_hi:[1,0]
  v_pk_mul_f32 v[62:63], v[62:63], v[50:51] op_sel_hi:[1,0]
  v_cvt_pk_bf16_f32 v176, v56, v57
  v_cvt_pk_bf16_f32 v177, v58, v59
  v_cvt_pk_bf16_f32 v178, v60, v61
  v_cvt_pk_bf16_f32 v179, v62, v63
  buffer_store_dwordx4 v[176:179], v2, s[8:11], s24 offen offset:0 sc1
  v_accvgpr_read_b32 v56, a104
  v_accvgpr_read_b32 v57, a105
  v_accvgpr_read_b32 v58, a106
  v_accvgpr_read_b32 v59, a107
  v_accvgpr_read_b32 v60, a108
  v_accvgpr_read_b32 v61, a109
  v_accvgpr_read_b32 v62, a110
  v_accvgpr_read_b32 v63, a111
  v_pk_mul_f32 v[56:57], v[56:57], v[50:51] op_sel_hi:[1,0]
  v_pk_mul_f32 v[58:59], v[58:59], v[50:51] op_sel_hi:[1,0]
  v_pk_mul_f32 v[60:61], v[60:61], v[50:51] op_sel_hi:[1,0]
  v_pk_mul_f32 v[62:63], v[62:63], v[50:51] op_sel_hi:[1,0]
  v_cvt_pk_bf16_f32 v180, v56, v57
  v_cvt_pk_bf16_f32 v181, v58, v59
  v_cvt_pk_bf16_f32 v182, v60, v61
  v_cvt_pk_bf16_f32 v183, v62, v63
  buffer_store_dwordx4 v[180:183], v2, s[8:11], s24 offen offset:1024 sc1
  v_accvgpr_read_b32 v56, a112
  v_accvgpr_read_b32 v57, a113
  v_accvgpr_read_b32 v58, a114
  v_accvgpr_read_b32 v59, a115
  v_accvgpr_read_b32 v60, a116
  v_accvgpr_read_b32 v61, a117
  v_accvgpr_read_b32 v62, a118
  v_accvgpr_read_b32 v63, a119
  v_pk_mul_f32 v[56:57], v[56:57], v[50:51] op_sel_hi:[1,0]
  v_pk_mul_f32 v[58:59], v[58:59], v[50:51] op_sel_hi:[1,0]
  v_pk_mul_f32 v[60:61], v[60:61], v[50:51] op_sel_hi:[1,0]
  v_pk_mul_f32 v[62:63], v[62:63], v[50:51] op_sel_hi:[1,0]
  v_cvt_pk_bf16_f32 v184, v56, v57
  v_cvt_pk_bf16_f32 v185, v58, v59
  v_cvt_pk_bf16_f32 v186, v60, v61
  v_cvt_pk_bf16_f32 v187, v62, v63
  buffer_store_dwordx4 v[184:187], v2, s[8:11], s24 offen offset:2048 sc1
  v_accvgpr_read_b32 v56, a120
  v_accvgpr_read_b32 v57, a121
  v_accvgpr_read_b32 v58, a122
  v_accvgpr_read_b32 v59, a123
  v_accvgpr_read_b32 v60, a124
  v_accvgpr_read_b32 v61, a125
  v_accvgpr_read_b32 v62, a126
  v_accvgpr_read_b32 v63, a127
  v_pk_mul_f32 v[56:57], v[56:57], v[50:51] op_sel_hi:[1,0]
  v_pk_mul_f32 v[58:59], v[58:59], v[50:51] op_sel_hi:[1,0]
  v_pk_mul_f32 v[60:61], v[60:61], v[50:51] op_sel_hi:[1,0]
  v_pk_mul_f32 v[62:63], v[62:63], v[50:51] op_sel_hi:[1,0]
  v_cvt_pk_bf16_f32 v188, v56, v57
  v_cvt_pk_bf16_f32 v189, v58, v59
  v_cvt_pk_bf16_f32 v190, v60, v61
  v_cvt_pk_bf16_f32 v191, v62, v63
  buffer_store_dwordx4 v[188:191], v2, s[8:11], s24 offen offset:3072 sc1
L_fix_next:
  s_cmp_lg_u32 s46, 0
  s_cbranch_scc1 L_fix_fin
  s_cmp_eq_u64 s[36:37], 0
  s_cbranch_scc1 L_fix_out
  s_mov_b32 s46, 1
  s_sub_u32 s45, 63, s45
  v_mov_b32 v192, v64
  v_mov_b32 v193, v65
  v_mov_b32 v194, v66
  v_mov_b32 v195, v67
  v_mov_b32 v196, v68
  v_mov_b32 v197, v69
  v_mov_b32 v198, v70
  v_mov_b32 v199, v71
  v_mov_b32 v200, v72
  v_mov_b32 v201, v73
  v_mov_b32 v202, v74
  v_mov_b32 v203, v75
  v_mov_b32 v204, v76
  v_mov_b32 v205, v77
  v_mov_b32 v206, v78
  v_mov_b32 v207, v79
  v_mov_b32 v208, v80
  v_mov_b32 v209, v81
  v_mov_b32 v210, v82
  v_mov_b32 v211, v83
  v_mov_b32 v212, v84
  v_mov_b32 v213, v85
  v_mov_b32 v214, v86
  v_mov_b32 v215, v87
  v_mov_b32 v216, v88
  v_mov_b32 v217, v89
  v_mov_b32 v218, v90
  v_mov_b32 v219, v91
  v_mov_b32 v220, v92
  v_mov_b32 v221, v93
  v_mov_b32 v222, v94
  v_mov_b32 v223, v95
  s_branch L_fix_one
L_fix_fin:
  s_sub_u32 s45, 63, s45
  s_waitcnt vmcnt(0)
  s_cmp_ge_u32 s20, 2
  s_cbranch_scc1 L_fix_out
  v_mov_b32 v31, 1
  s_mov_b64 exec, 1
  buffer_store_dword v31, off, s[8:11], s44 sc1
  s_mov_b64 exec, -1
L_fix_out:
  s_waitcnt vmcnt(0)
  s_branch L_fixed
L_codeend:
.fill 4096, 4, 0xbf810000
.section .rodata,"a"
.p2align 6
.amdhsa_kernel sequential_preLN__compressed_kv_cla__mixer_channel_mlp__prompt_kernel
  .amdhsa_next_free_vgpr 512
  .amdhsa_next_free_sgpr 102
  .amdhsa_accum_offset 256
  .amdhsa_group_segment_fixed_size 0
  .amdhsa_kernarg_size 112
  .amdhsa_user_sgpr_count 2
  .amdhsa_user_sgpr_kernarg_segment_ptr 1
  .amdhsa_system_sgpr_workgroup_id_x 1
.end_amdhsa_kernel
```
